```python
import torch

def _softmax(x, axis=-1):
    return torch.softmax(x, dim=axis)
def _gelu(x):
    return torch.nn.functional.gelu(x, approximate="tanh")
def _silu(x):
    return torch.nn.functional.silu(x)
def _sigmoid(x):
    return torch.sigmoid(x)
def _layernorm(x, axis=-1, eps=1e-5):
    m = x.mean(dim=axis, keepdim=True)
    v = x.var(dim=axis, keepdim=True, unbiased=False)
    return (x - m) / torch.sqrt(v + eps)
def _scatter_add(tgt, idx, src, axis=0):
    return tgt.clone().index_add_(axis, idx, src)
def _segment_sum(src, seg, n):
    out = torch.zeros((n,) + src.shape[1:], dtype=src.dtype)
    return out.index_add_(0, seg, src)
def _pad(x, pw):
    flat = tuple(v for pair in reversed(pw) for v in pair)
    return torch.nn.functional.pad(x, flat)

kernel_name = 'parallel_sum__ssm_conv_s4d__mixer_channel_mlp__prompt'

def setup_inputs():

    _w = (lambda a: (lambda t: t.to(torch.bfloat16) if t.is_floating_point() else t)(torch.as_tensor(a)))
    def _A_setup():
        Bsz, L, D, N = 1, 2048, 640, 128
        return {
            "u": _w((lambda *s: torch.randn(*s, dtype=torch.bfloat16) * 0.05)(Bsz, L, D)),
            "log_A_real": _w((lambda *s: torch.randn(*s, dtype=torch.bfloat16) * 3.2)(D, N) * 0.5),
            "A_imag": _w((lambda *s: torch.randn(*s, dtype=torch.bfloat16) * 0.05)(D, N) * 3.14),
            "C_real": _w((lambda *s: torch.randn(*s, dtype=torch.bfloat16) * 0.1)(D, N) / N ** 0.5),
            "C_imag": _w((lambda *s: torch.randn(*s, dtype=torch.bfloat16) * 0.2)(D, N) / N ** 0.5),
            "log_dt": _w((lambda *s: torch.randn(*s, dtype=torch.bfloat16) * 0.05)(D) * 0.5 - 4.0),
            "D_skip": _w((lambda *s: torch.randn(*s, dtype=torch.bfloat16) * 0.05)(D)),
        }
    _A_in = _A_setup()

    def _B_setup():
        B, S, D, F = 1, 2048, 640, 1728
        return {
            "x": _w((lambda *s: torch.randn(*s, dtype=torch.bfloat16) * 0.05)(B, S, D)),
            "w1": _w((lambda *s: torch.randn(*s, dtype=torch.bfloat16) * 1.6)(D, F) * (D ** -0.5)),
            "b1": _w((lambda *s: torch.randn(*s, dtype=torch.bfloat16) * 0.8)(F)),
            "w2": _w((lambda *s: torch.randn(*s, dtype=torch.bfloat16) * 0.05)(F, D) * (F ** -0.5)),
            "b2": _w((lambda *s: torch.randn(*s, dtype=torch.bfloat16) * 0.05)(D)),
        }
    _B_in = _B_setup()

    return {
        "A_u": _A_in["u"],
        "A_log_A_real": _A_in["log_A_real"],
        "A_A_imag": _A_in["A_imag"],
        "A_C_real": _A_in["C_real"],
        "A_C_imag": _A_in["C_imag"],
        "A_log_dt": _A_in["log_dt"],
        "A_D_skip": _A_in["D_skip"],
        "B_x": _B_in["x"],
        "B_w1": _B_in["w1"],
        "B_b1": _B_in["b1"],
        "B_w2": _B_in["w2"],
        "B_b2": _B_in["b2"],
    }

def reference(A_u, A_log_A_real, A_A_imag, A_C_real, A_C_imag, A_log_dt, A_D_skip, B_x, B_w1, B_b1, B_w2, B_b2):
    def _A_ref(u, log_A_real, A_imag, C_real, C_imag, log_dt, D_skip):
        L = u.shape[1]
        dt = torch.exp(log_dt)
        A = -torch.exp(log_A_real) + 1j * A_imag
        C = (C_real + 1j * C_imag) * dt[:, None]
        pos = (lambda x, dt: x.to(dt))(torch.arange(L), log_dt.dtype)
        P = torch.exp((A * dt[:, None])[:, :, None] * pos[None, None, :])
        K = 2.0 * torch.einsum("dn,dnl->dl", C, P).real
        L2 = 2 * L
        u_t = (lambda x, *d: x.permute(*d))(u, 0, 2, 1)
        Kf = (lambda x, *a, **k: torch.fft.rfft(x.float(), *a, **k))(K, L2)
        Uf = (lambda x, *a, **k: torch.fft.rfft(x.float(), *a, **k))(u_t, L2)
        y = (lambda x, *a, **k: torch.fft.irfft(x, *a, **k).to(torch.bfloat16))(Uf * Kf[None, :, :], L2)[:, :, :L]
        y = (lambda x, *d: x.permute(*d))(y, 0, 2, 1)
        return y + u * D_skip[None, None, :]

    def _B_ref(x, w1, b1, w2, b2):
        y = _layernorm(x, axis=-1)
        h = _gelu(torch.einsum("bsd,df->bsf", y, w1) + b1)
        return torch.einsum("bsf,fd->bsd", h, w2) + b2

    x = A_u
    xn = _layernorm(x, axis=-1)
    return x + _A_ref(xn, A_log_A_real, A_A_imag, A_C_real, A_C_imag, A_log_dt, A_D_skip) + _B_ref(xn, B_w1, B_b1, B_w2, B_b2)
```

```asm
; @launch grid=(256,1,1) block=(256,1,1) lds=163840
.amdgcn_target "amdgcn-amd-amdhsa--gfx950"
.text
.globl parallel_sum__ssm_conv_s4d__mixer_channel_mlp__prompt_kernel
.p2align 8
.type parallel_sum__ssm_conv_s4d__mixer_channel_mlp__prompt_kernel,@function
parallel_sum__ssm_conv_s4d__mixer_channel_mlp__prompt_kernel:
    s_cmp_ge_u32 s2, 256
    s_cbranch_scc1 L_end
    s_load_dwordx16 s[36:51], s[0:1], 0
    s_load_dwordx8 s[52:59], s[0:1], 64
    s_load_dwordx4 s[60:63], s[0:1], 96
    s_load_dwordx2 s[64:65], s[0:1], 112
    v_lshrrev_b32 v13, 6, v0
    v_and_b32 v0, 63, v0
    v_readfirstlane_b32 s28, v13
    s_and_b32 s29, s2, 7
    s_lshr_b32 s30, s2, 3
    v_lshlrev_b32 v1, 4, v0
    s_getpc_b64 s[66:67]
L_pc:
    s_lshl_b32 s68, s30, 2
    s_add_u32 s68, s68, s28
    s_lshl_b32 s68, s68, 9
    v_and_b32 v12, 3, v0
    v_lshl_add_u32 v12, v12, 7, s68
    v_min_u32 v12, L_tab_end-L_pc-4, v12
    global_load_dword v11, v12, s[66:67]
    s_cmp_ge_u32 s30, 28
    s_cbranch_scc1 L_spare
    s_lshl_b32 s96, s29, 5
    s_add_u32 s96, s96, s30
    s_and_b32 s68, s30, 3
    s_lshr_b32 s34, s30, 2
    s_lshr_b32 s69, s29, 1
    s_lshl_b32 s69, s69, 2
    s_add_u32 s31, s69, s68
    s_and_b32 s69, s29, 1
    s_mul_i32 s69, s69, 7
    s_add_u32 s32, s69, s34
    s_mul_i32 s35, s29, 40
    v_lshrrev_b32 v13, 5, v0
    v_and_b32 v14, 31, v0
    v_mul_u32_u24 v15, 1280, v13
    v_lshl_add_u32 v76, v14, 4, v15
    v_lshl_add_u32 v77, v14, 3, v15
    s_mul_i32 s3, s96, 10240
    s_mul_i32 s69, s28, 2560
    s_add_u32 s3, s3, s69
    s_mul_i32 s69, s34, 23
    s_lshr_b32 s69, s69, 4
    s_mul_i32 s68, s68, 5
    s_lshr_b32 s68, s68, 1
    s_add_u32 s75, s69, s68
    s_sub_u32 s69, s75, 10
    s_cmp_ge_u32 s75, 10
    s_cselect_b32 s75, s69, s75
    v_lshrrev_b32 v13, 3, v0
    v_mul_u32_u24 v13, 1280, v13
    v_lshrrev_b32 v14, 4, v0
    v_and_b32 v15, 7, v0
    v_xor_b32 v15, v15, v14
    s_mul_i32 s68, s28, 40960
    v_lshl_add_u32 v13, v15, 4, v13
    v_add_u32 v16, s68, v13
    v_xor_b32 v13, 64, v16
    v_add_u32 v17, 10240, v13
    v_add_u32 v18, 20480, v16
    v_add_u32 v19, 30720, v13
    v_mul_u32_u24 v13, 3456, v14
    v_bfe_u32 v15, v0, 1, 3
    v_lshlrev_b32 v14, 1, v14
    v_xor_b32 v15, v15, v14
    v_lshl_add_u32 v13, v15, 5, v13
    v_and_b32 v15, 1, v0
    v_lshl_add_u32 v13, v15, 4, v13
    s_mul_i32 s68, s28, 55296
    v_add_u32 v20, s68, v13
    v_bfe_u32 v15, v0, 1, 3
    v_xor_b32 v15, v15, v14
    s_cmp_eq_u32 s32, 13
    s_cselect_b32 s68, 4, 0
    v_and_b32 v15, s68, v15
    v_lshl_add_u32 v20, v15, 26, v20
    v_add_u32 v21, 13824, v20
    v_add_u32 v22, 27648, v20
    v_add_u32 v23, 41472, v20
    s_mul_i32 s78, s31, 163840
    s_lshl_b32 s79, s32, 8
    s_lshl_b32 s97, s28, 12
    s_waitcnt lgkmcnt(0)
    s_mov_b32 s4, s36
    s_mov_b32 s5, s37
    s_mov_b32 s6, 2621440
    s_mov_b32 s7, 0x20000
    buffer_load_dwordx4 v[40:43], v76, s[4:7], s3 offen
    buffer_load_dwordx4 v[44:47], v76, s[4:7], s3 offen offset:512
    buffer_load_dwordx2 v[48:49], v77, s[4:7], s3 offen offset:1024
    s_mov_b32 s8, s52
    s_mov_b32 s9, s53
    s_mov_b32 s10, 2211840
    s_mov_b32 s11, 0x20000
    s_and_b32 s52, s28, 1
    s_lshr_b32 s53, s28, 1
    s_add_u32 s35, s35, s30
    s_lshl_b32 s68, s35, 1
    s_add_u32 s68, s68, s53
    s_lshl_b32 s74, s68, 1
    s_lshl_b32 s68, s68, 8
    s_lshl_b32 s69, s52, 7
    s_add_u32 s68, s68, s69
    v_lshl_add_u32 v100, v0, 1, s68
    v_mov_b32 v101, s74
    global_load_ushort v176, v100, s[38:39]
    global_load_ushort v177, v100, s[40:41]
    global_load_ushort v178, v100, s[42:43]
    global_load_ushort v179, v100, s[44:45]
    global_load_ushort v180, v101, s[46:47]
    global_load_ushort v181, v101, s[48:49]
    s_lshl_b32 s68, s2, 2
    s_add_u32 s68, s68, s28
    s_lshl_b32 s68, s68, 7
    s_add_u32 s98, s68, L_sc-L_pc
    s_load_dwordx16 s[80:95], s[66:67], s98
    s_add_u32 s98, s98, 64
    s_mov_b32 s12, s64
    s_mov_b32 s13, s65
    s_mov_b32 s14, 33554432
    s_mov_b32 s15, 0x20000
    s_mov_b32 s24, s60
    s_mov_b32 s25, s61
    s_mov_b32 s26, 2621440
    s_mov_b32 s27, 0x20000
    s_lshl_b32 s68, s35, 2
    s_load_dword s61, s[58:59], s68
    s_load_dwordx16 s[36:51], s[66:67], s98
    s_lshl_b32 s72, s75, 7
    s_add_u32 s72, s72, s78
    s_mul_i32 s73, s75, 221184
    s_add_u32 s73, s73, s79
    s_add_u32 s75, s75, 1
    s_cmp_eq_u32 s75, 10
    s_cselect_b32 s75, 0, s75
    s_add_u32 m0, s97, 0
    s_nop 0
    buffer_load_dwordx4 v16, s[4:7], s72 offen lds
    s_add_u32 m0, s97, 16384
    s_nop 0
    buffer_load_dwordx4 v20, s[8:11], s73 offen lds
    s_add_u32 m0, s97, 1024
    s_nop 0
    buffer_load_dwordx4 v17, s[4:7], s72 offen lds
    s_add_u32 m0, s97, 17408
    s_nop 0
    buffer_load_dwordx4 v21, s[8:11], s73 offen lds
    v_lshrrev_b32 v14, 4, v0
    v_mul_u32_u24 v13, 1280, v14
    v_bfe_u32 v15, v0, 1, 3
    v_xor_b32 v15, v15, v14
    v_lshl_add_u32 v13, v15, 5, v13
    v_and_b32 v15, 1, v0
    v_lshl_add_u32 v13, v15, 4, v13
    s_mul_i32 s68, s28, 10240
    v_add_u32 v254, s68, v13
    v_xor_b32 v13, 128, v254
    v_add_u32 v255, 5120, v13
    s_mov_b32 s16, s56
    s_mov_b32 s17, s57
    s_mov_b32 s18, 2211840
    s_mov_b32 s19, 0x20000
    s_lshl_b32 s99, s28, 11
    s_mul_i32 s69, s2, 52429
    s_lshr_b32 s69, s69, 18
    s_mul_i32 s68, s69, 5
    s_sub_u32 s68, s2, s68
    s_mul_i32 s69, s69, 40960
    s_lshl_b32 s68, s68, 8
    s_add_u32 s35, s69, s68
    s_add_u32 m0, s97, 2048
    s_nop 0
    buffer_load_dwordx4 v18, s[4:7], s72 offen lds
    s_add_u32 m0, s97, 18432
    s_nop 0
    buffer_load_dwordx4 v22, s[8:11], s73 offen lds
    s_add_u32 m0, s97, 3072
    s_nop 0
    buffer_load_dwordx4 v19, s[4:7], s72 offen lds
    s_add_u32 m0, s97, 19456
    s_nop 0
    buffer_load_dwordx4 v23, s[8:11], s73 offen lds
    s_mul_i32 s68, s28, 2688
    s_add_u32 s68, s68, 131072
    v_lshrrev_b32 v13, 5, v0
    v_lshlrev_b32 v15, 6, v13
    v_add3_u32 v78, v76, v15, s68
    v_add3_u32 v79, v77, v15, s68
    v_lshlrev_b32 v214, 3, v13
    v_bfe_u32 v14, v0, 2, 2
    v_mul_u32_u24 v14, 1344, v14
    v_and_b32 v15, 3, v0
    v_lshl_add_u32 v14, v15, 3, v14
    v_lshrrev_b32 v15, 4, v0
    s_lshl_b32 s68, s28, 7
    s_add_u32 s68, s68, 131072
    v_lshl_add_u32 v13, v15, 5, v14
    v_add_u32 v212, s68, v13
    v_and_b32 v15, 1, v15
    s_lshl_b32 s68, s28, 6
    s_add_u32 s68, s68, 132096
    v_lshl_add_u32 v13, v15, 5, v14
    v_add_u32 v213, s68, v13
    s_lshl_b32 s68, s96, 6
    s_lshl_b32 s69, s28, 4
    s_add_u32 s68, s68, s69
    s_add_u32 s76, s68, 65536
    s_mul_i32 s68, s96, 10240
    s_add_u32 s68, s68, 1048576
    s_lshl_b32 s69, s28, 10
    s_add_u32 s77, s69, s68
    s_lshl_b32 s69, s28, 9
    s_add_u32 s69, s69, s68
    s_add_u32 s60, s69, 8192
    v_mov_b32 v229, 0
    v_add_u32 v215, 4096, v1
    v_bfe_u32 v13, v0, 2, 3
    s_lshl_b32 s68, s28, 1
    v_xor_b32 v15, s68, v13
    v_lshrrev_b32 v14, 5, v0
    v_lshl_add_u32 v13, v14, 4, v13
    v_lshlrev_b32 v13, 8, v13
    v_lshl_add_u32 v13, v15, 5, v13
    v_and_b32 v15, 3, v0
    v_lshl_add_u32 v13, v15, 3, v13
    v_add_u32 v253, 141824, v13
    v_xor_b32 v230, 32, v253
    v_and_b32 v13, 31, v0
    v_bfe_u32 v15, v0, 1, 3
    v_lshrrev_b32 v14, 5, v0
    v_xor_b32 v15, v15, v14
    v_lshlrev_b32 v13, 7, v13
    v_lshl_add_u32 v13, v15, 4, v13
    s_lshl_b32 s69, s53, 13
    v_add_u32 v24, s69, v13
    v_xor_b32 v25, 32, v24
    v_xor_b32 v26, 64, v24
    v_xor_b32 v27, 96, v24
    v_bfe_u32 v13, v0, 2, 2
    v_bfe_u32 v15, v0, 4, 1
    v_lshl_or_b32 v15, v13, 1, v15
    v_lshl_add_u32 v13, v14, 3, v13
    v_lshlrev_b32 v13, 8, v13
    s_lshl_b32 s69, s52, 2
    s_lshl_b32 s68, s53, 1
    s_or_b32 s69, s69, s68
    v_xor_b32 v15, s69, v15
    v_lshl_add_u32 v13, v15, 5, v13
    v_and_b32 v15, 3, v0
    v_lshl_add_u32 v13, v15, 3, v13
    v_add_u32 v28, 16384, v13
    v_xor_b32 v29, 64, v28
    v_add_u32 v30, 0x10000, v24
    v_add_u32 v31, 0x10000, v25
    v_add_u32 v32, 0x10000, v26
    v_add_u32 v33, 0x10000, v27
    v_add_u32 v34, 0x10000, v28
    v_add_u32 v35, 0x10000, v29
    v_lshrrev_b32 v13, 4, v0
    v_xor_b32 v13, v13, v0
    v_and_b32 v13, 1, v13
    v_add_u32 v13, -1, v13
    v_and_b32 v36, 0x3f803f80, v13
    v_mov_b32 v37, v36
    v_mov_b32 v38, v36
    v_mov_b32 v39, v36
    v_bfe_u32 v13, v0, 4, 1
    v_mul_u32_u24 v13, 55296, v13
    v_lshrrev_b32 v14, 5, v0
    v_lshl_add_u32 v13, v14, 8, v13
    v_and_b32 v15, 15, v0
    v_lshl_add_u32 v247, v15, 4, v13
    s_lshl_b32 s68, s52, 8
    s_add_u32 s68, s68, 158016
    v_and_b32 v13, 31, v0
    v_lshl_add_u32 v248, v13, 3, s68
    s_lshl_b32 s69, s53, 7
    s_add_u32 s68, s68, s69
    v_lshl_add_u32 v250, v14, 4, s68
    v_and_b32 v15, 1, v0
    v_lshlrev_b32 v15, 6, v15
    v_lshrrev_b32 v14, 4, v0
    v_lshl_add_u32 v15, v14, 4, v15
    v_add_u32 v249, s68, v15
    v_lshlrev_b32 v251, 3, v13
    v_and_b32 v13, 15, v0
    v_lshrrev_b32 v14, 4, v0
    v_lshlrev_b32 v14, 3, v14
    v_sub_u32 v15, v14, v13
    v_add_u32 v15, 15, v15
    v_min_u32 v15, 31, v15
    s_mov_b32 s68, 65011712
    v_lshrrev_b32 v14, v15, s68
    v_bfe_u32 v192, v14, 0, 2
    v_lshl_or_b32 v192, v192, 15, v192
    v_and_b32 v192, 0x10001, v192
    v_mul_u32_u24 v192, 0x3f80, v192
    v_bfe_u32 v193, v14, 2, 2
    v_lshl_or_b32 v193, v193, 15, v193
    v_and_b32 v193, 0x10001, v193
    v_mul_u32_u24 v193, 0x3f80, v193
    v_bfe_u32 v194, v14, 4, 2
    v_lshl_or_b32 v194, v194, 15, v194
    v_and_b32 v194, 0x10001, v194
    v_mul_u32_u24 v194, 0x3f80, v194
    v_bfe_u32 v195, v14, 6, 2
    v_lshl_or_b32 v195, v195, 15, v195
    v_and_b32 v195, 0x10001, v195
    v_mul_u32_u24 v195, 0x3f80, v195
    s_mov_b32 s68, 469762048
    v_lshrrev_b32 v14, v15, s68
    v_bfe_u32 v196, v14, 0, 2
    v_lshl_or_b32 v196, v196, 15, v196
    v_and_b32 v196, 0x10001, v196
    v_mul_u32_u24 v196, 0x3f80, v196
    v_bfe_u32 v197, v14, 2, 2
    v_lshl_or_b32 v197, v197, 15, v197
    v_and_b32 v197, 0x10001, v197
    v_mul_u32_u24 v197, 0x3f80, v197
    v_bfe_u32 v198, v14, 4, 2
    v_lshl_or_b32 v198, v198, 15, v198
    v_and_b32 v198, 0x10001, v198
    v_mul_u32_u24 v198, 0x3f80, v198
    v_bfe_u32 v199, v14, 6, 2
    v_lshl_or_b32 v199, v199, 15, v199
    v_and_b32 v199, 0x10001, v199
    v_mul_u32_u24 v199, 0x3f80, v199
    s_mov_b32 s68, 1835008
    v_lshrrev_b32 v14, v15, s68
    v_bfe_u32 v200, v14, 0, 2
    v_lshl_or_b32 v200, v200, 15, v200
    v_and_b32 v200, 0x10001, v200
    v_mul_u32_u24 v200, 0x3f80, v200
    v_bfe_u32 v201, v14, 2, 2
    v_lshl_or_b32 v201, v201, 15, v201
    v_and_b32 v201, 0x10001, v201
    v_mul_u32_u24 v201, 0x3f80, v201
    v_bfe_u32 v202, v14, 4, 2
    v_lshl_or_b32 v202, v202, 15, v202
    v_and_b32 v202, 0x10001, v202
    v_mul_u32_u24 v202, 0x3f80, v202
    v_bfe_u32 v203, v14, 6, 2
    v_lshl_or_b32 v203, v203, 15, v203
    v_and_b32 v203, 0x10001, v203
    v_mul_u32_u24 v203, 0x3f80, v203
    s_mov_b32 s68, 267911168
    v_lshrrev_b32 v14, v15, s68
    v_bfe_u32 v204, v14, 0, 2
    v_lshl_or_b32 v204, v204, 15, v204
    v_and_b32 v204, 0x10001, v204
    v_mul_u32_u24 v204, 0x3f80, v204
    v_bfe_u32 v205, v14, 2, 2
    v_lshl_or_b32 v205, v205, 15, v205
    v_and_b32 v205, 0x10001, v205
    v_mul_u32_u24 v205, 0x3f80, v205
    v_bfe_u32 v206, v14, 4, 2
    v_lshl_or_b32 v206, v206, 15, v206
    v_and_b32 v206, 0x10001, v206
    v_mul_u32_u24 v206, 0x3f80, v206
    v_bfe_u32 v207, v14, 6, 2
    v_lshl_or_b32 v207, v207, 15, v207
    v_and_b32 v207, 0x10001, v207
    v_mul_u32_u24 v207, 0x3f80, v207
    s_mov_b32 s68, 133169152
    v_lshrrev_b32 v14, v15, s68
    v_bfe_u32 v208, v14, 0, 2
    v_lshl_or_b32 v208, v208, 15, v208
    v_and_b32 v208, 0x10001, v208
    v_mul_u32_u24 v208, 0x3f80, v208
    v_bfe_u32 v209, v14, 2, 2
    v_lshl_or_b32 v209, v209, 15, v209
    v_and_b32 v209, 0x10001, v209
    v_mul_u32_u24 v209, 0x3f80, v209
    v_bfe_u32 v210, v14, 4, 2
    v_lshl_or_b32 v210, v210, 15, v210
    v_and_b32 v210, 0x10001, v210
    v_mul_u32_u24 v210, 0x3f80, v210
    v_bfe_u32 v211, v14, 6, 2
    v_lshl_or_b32 v211, v211, 15, v211
    v_and_b32 v211, 0x10001, v211
    v_mul_u32_u24 v211, 0x3f80, v211
    s_waitcnt vmcnt(14)
    v_lshlrev_b32 v52, 16, v40
    v_and_b32 v53, 0xffff0000, v40
    v_lshlrev_b32 v54, 16, v41
    v_and_b32 v55, 0xffff0000, v41
    v_lshlrev_b32 v56, 16, v42
    s_lshl_b32 s72, s75, 7
    s_add_u32 s72, s72, s78
    s_mul_i32 s73, s75, 221184
    s_add_u32 s73, s73, s79
    s_add_u32 s75, s75, 1
    s_cmp_eq_u32 s75, 10
    s_cselect_b32 s75, 0, s75
    s_add_u32 m0, s97, 32768
    s_nop 0
    buffer_load_dwordx4 v16, s[4:7], s72 offen lds
    v_and_b32 v57, 0xffff0000, v42
    v_lshlrev_b32 v58, 16, v43
    v_and_b32 v59, 0xffff0000, v43
    v_lshlrev_b32 v60, 16, v44
    v_and_b32 v61, 0xffff0000, v44
    v_lshlrev_b32 v62, 16, v45
    v_and_b32 v63, 0xffff0000, v45
    v_lshlrev_b32 v64, 16, v46
    v_and_b32 v65, 0xffff0000, v46
    v_lshlrev_b32 v66, 16, v47
    v_and_b32 v67, 0xffff0000, v47
    v_lshlrev_b32 v68, 16, v48
    v_and_b32 v69, 0xffff0000, v48
    v_lshlrev_b32 v70, 16, v49
    v_and_b32 v71, 0xffff0000, v49
    v_pk_add_f32 v[72:73], v[52:53], v[54:55]
    v_pk_add_f32 v[74:75], v[56:57], v[58:59]
    v_pk_add_f32 v[72:73], v[72:73], v[60:61]
    v_pk_add_f32 v[74:75], v[74:75], v[62:63]
    s_add_u32 m0, s97, 49152
    s_nop 0
    buffer_load_dwordx4 v20, s[8:11], s73 offen lds
    v_pk_add_f32 v[72:73], v[72:73], v[64:65]
    v_pk_add_f32 v[74:75], v[74:75], v[66:67]
    v_pk_add_f32 v[72:73], v[72:73], v[68:69]
    v_pk_add_f32 v[74:75], v[74:75], v[70:71]
    v_pk_add_f32 v[72:73], v[72:73], v[74:75]
    v_add_f32 v72, v72, v73
    s_nop 1
    v_add_f32_dpp v72, v72, v72 quad_perm:[1,0,3,2] row_mask:0xf bank_mask:0xf
    s_nop 1
    v_add_f32_dpp v72, v72, v72 quad_perm:[2,3,0,1] row_mask:0xf bank_mask:0xf
    s_nop 1
    v_add_f32_dpp v72, v72, v72 row_half_mirror row_mask:0xf bank_mask:0xf
    s_nop 1
    v_add_f32_dpp v72, v72, v72 row_mirror row_mask:0xf bank_mask:0xf
    v_mov_b32 v73, v72
    s_nop 1
    v_permlane16_swap_b32 v72, v73
    v_add_f32 v72, v72, v73
    v_mul_f32 v72, 0x3acccccd, v72
    v_pk_add_f32 v[52:53], v[52:53], v[72:73] op_sel_hi:[1,0] neg_lo:[0,1] neg_hi:[0,1]
    v_pk_add_f32 v[54:55], v[54:55], v[72:73] op_sel_hi:[1,0] neg_lo:[0,1] neg_hi:[0,1]
    v_pk_add_f32 v[56:57], v[56:57], v[72:73] op_sel_hi:[1,0] neg_lo:[0,1] neg_hi:[0,1]
    v_pk_add_f32 v[58:59], v[58:59], v[72:73] op_sel_hi:[1,0] neg_lo:[0,1] neg_hi:[0,1]
    v_pk_add_f32 v[60:61], v[60:61], v[72:73] op_sel_hi:[1,0] neg_lo:[0,1] neg_hi:[0,1]
    s_add_u32 m0, s97, 33792
    s_nop 0
    buffer_load_dwordx4 v17, s[4:7], s72 offen lds
    v_pk_add_f32 v[62:63], v[62:63], v[72:73] op_sel_hi:[1,0] neg_lo:[0,1] neg_hi:[0,1]
    v_pk_add_f32 v[64:65], v[64:65], v[72:73] op_sel_hi:[1,0] neg_lo:[0,1] neg_hi:[0,1]
    v_pk_add_f32 v[66:67], v[66:67], v[72:73] op_sel_hi:[1,0] neg_lo:[0,1] neg_hi:[0,1]
    v_pk_add_f32 v[68:69], v[68:69], v[72:73] op_sel_hi:[1,0] neg_lo:[0,1] neg_hi:[0,1]
    v_pk_add_f32 v[70:71], v[70:71], v[72:73] op_sel_hi:[1,0] neg_lo:[0,1] neg_hi:[0,1]
    v_pk_mul_f32 v[74:75], v[52:53], v[52:53]
    v_pk_mul_f32 v[50:51], v[54:55], v[54:55]
    v_pk_fma_f32 v[74:75], v[56:57], v[56:57], v[74:75]
    v_pk_fma_f32 v[50:51], v[58:59], v[58:59], v[50:51]
    v_pk_fma_f32 v[74:75], v[60:61], v[60:61], v[74:75]
    v_pk_fma_f32 v[50:51], v[62:63], v[62:63], v[50:51]
    v_pk_fma_f32 v[74:75], v[64:65], v[64:65], v[74:75]
    v_pk_fma_f32 v[50:51], v[66:67], v[66:67], v[50:51]
    v_pk_fma_f32 v[74:75], v[68:69], v[68:69], v[74:75]
    v_pk_fma_f32 v[50:51], v[70:71], v[70:71], v[50:51]
    v_pk_add_f32 v[74:75], v[74:75], v[50:51]
    v_add_f32 v74, v74, v75
    s_nop 1
    v_add_f32_dpp v74, v74, v74 quad_perm:[1,0,3,2] row_mask:0xf bank_mask:0xf
    s_nop 1
    v_add_f32_dpp v74, v74, v74 quad_perm:[2,3,0,1] row_mask:0xf bank_mask:0xf
    s_add_u32 m0, s97, 50176
    s_nop 0
    buffer_load_dwordx4 v21, s[8:11], s73 offen lds
    v_add_f32_dpp v74, v74, v74 row_half_mirror row_mask:0xf bank_mask:0xf
    s_nop 1
    v_add_f32_dpp v74, v74, v74 row_mirror row_mask:0xf bank_mask:0xf
    v_mov_b32 v75, v74
    s_nop 1
    v_permlane16_swap_b32 v74, v75
    v_add_f32 v74, v74, v75
    v_mul_f32 v74, 0x3acccccd, v74
    v_add_f32 v75, 0x3727c5ac, v74
    v_rsq_f32 v50, v75
    s_nop 0
    v_pk_mul_f32 v[52:53], v[52:53], v[50:51] op_sel_hi:[1,0]
    v_pk_mul_f32 v[54:55], v[54:55], v[50:51] op_sel_hi:[1,0]
    v_pk_mul_f32 v[56:57], v[56:57], v[50:51] op_sel_hi:[1,0]
    v_pk_mul_f32 v[58:59], v[58:59], v[50:51] op_sel_hi:[1,0]
    v_pk_mul_f32 v[60:61], v[60:61], v[50:51] op_sel_hi:[1,0]
    v_pk_mul_f32 v[62:63], v[62:63], v[50:51] op_sel_hi:[1,0]
    v_pk_mul_f32 v[64:65], v[64:65], v[50:51] op_sel_hi:[1,0]
    v_pk_mul_f32 v[66:67], v[66:67], v[50:51] op_sel_hi:[1,0]
    v_pk_mul_f32 v[68:69], v[68:69], v[50:51] op_sel_hi:[1,0]
    v_pk_mul_f32 v[70:71], v[70:71], v[50:51] op_sel_hi:[1,0]
    v_cvt_pk_bf16_f32 v40, v52, v53
    v_cvt_pk_bf16_f32 v41, v54, v55
    v_cvt_pk_bf16_f32 v42, v56, v57
    v_cvt_pk_bf16_f32 v43, v58, v59
    v_cvt_pk_bf16_f32 v44, v60, v61
    v_cvt_pk_bf16_f32 v45, v62, v63
    v_cvt_pk_bf16_f32 v46, v64, v65
    v_cvt_pk_bf16_f32 v47, v66, v67
    v_cvt_pk_bf16_f32 v48, v68, v69
    v_cvt_pk_bf16_f32 v49, v70, v71
    ds_write_b128 v78, v[40:43]
    ds_write_b128 v78, v[44:47] offset:512
    ds_write_b64 v79, v[48:49] offset:1024
    v_mul_f32 v74, v74, v50
    v_mul_f32 v74, v74, v50
    v_add_f32 v74, 0x3727c5ac, v74
    v_rsq_f32 v74, v74
    s_nop 0
    v_mul_f32 v216, v74, v50
    v_mul_f32 v217, v216, v72
    s_waitcnt lgkmcnt(0)
    s_barrier
    ds_read_b64_tr_b16 v[52:53], v212 offset:0
    ds_read_b64_tr_b16 v[54:55], v212 offset:5376
    ds_read_b64_tr_b16 v[56:57], v212 offset:512
    ds_read_b64_tr_b16 v[58:59], v212 offset:5888
    ds_read_b64_tr_b16 v[60:61], v213 offset:0
    ds_read_b64_tr_b16 v[62:63], v213 offset:5376
    s_waitcnt vmcnt(17)
    v_lshlrev_b32 v176, 16, v176
    s_waitcnt vmcnt(16)
    v_lshlrev_b32 v177, 16, v177
    s_waitcnt vmcnt(15)
    v_lshlrev_b32 v178, 16, v178
    s_add_u32 m0, s97, 34816
    s_nop 0
    buffer_load_dwordx4 v18, s[4:7], s72 offen lds
    s_waitcnt vmcnt(15)
    v_lshlrev_b32 v179, 16, v179
    s_waitcnt vmcnt(14)
    v_lshlrev_b32 v180, 16, v180
    s_waitcnt vmcnt(13)
    v_lshlrev_b32 v181, 16, v181
    v_mul_f32 v189, 0x3fb8aa3b, v180
    v_mul_f32 v190, 0x3fb8aa3b, v176
    v_exp_f32 v189, v189
    v_exp_f32 v190, v190
    s_cmp_eq_u32 s52, 0
    s_cselect_b64 vcc, 1, 0
    v_cndmask_b32 v12, 0, v181, vcc
    v_cvt_pk_bf16_f32 v189, v189, v190
    v_lshlrev_b32 v186, 16, v189
    v_and_b32 v190, 0xffff0000, v189
    v_mul_f32 v190, v190, v186
    v_mul_f32 v185, v177, v186
    v_mul_f32 v184, 0xbfb8aa3b, v190
    v_mul_f32 v185, 0x3e22f983, v185
    s_add_u32 m0, s97, 51200
    s_nop 0
    buffer_load_dwordx4 v22, s[8:11], s73 offen lds
    v_add_f32 v186, v186, v186
    v_mul_f32 v166, v178, v186
    v_mul_f32 v167, v179, v186
    v_fract_f32 v190, v185
    v_exp_f32 v189, v184
    v_cos_f32 v168, v190
    v_sin_f32 v169, v190
    v_mul_f32 v168, v168, v189
    v_mul_f32 v169, v169, v189
    v_mul_f32 v190, 0x41800000, v185
    v_mul_f32 v189, 0x41800000, v184
    v_fract_f32 v190, v190
    v_exp_f32 v189, v189
    v_cos_f32 v170, v190
    v_sin_f32 v171, v190
    s_add_u32 m0, s97, 35840
    s_nop 0
    buffer_load_dwordx4 v19, s[4:7], s72 offen lds
    v_mul_f32 v170, v170, v189
    v_mul_f32_e64 v171, -v171, v189
    v_mul_f32 v190, 0x43800000, v185
    v_mul_f32 v189, 0x43800000, v184
    v_fract_f32 v190, v190
    v_exp_f32 v189, v189
    v_cos_f32 v172, v190
    v_sin_f32 v173, v190
    v_mul_f32 v172, v172, v189
    v_mul_f32 v173, v173, v189
    v_mov_b32 v149, 0x3f80
    v_cvt_pk_bf16_f32 v108, v166, v167
    v_cvt_pk_bf16_f32 v150, v170, v171
    v_pk_mul_f32 v[178:179], v[166:167], v[168:169] op_sel:[0,0] op_sel_hi:[0,1]
    v_pk_mul_f32 v[190:191], v[170:171], v[170:171] op_sel:[0,0] op_sel_hi:[0,1]
    s_add_u32 m0, s97, 52224
    s_nop 0
    buffer_load_dwordx4 v23, s[8:11], s73 offen lds
    v_pk_fma_f32 v[178:179], v[166:167], v[168:169], v[178:179] op_sel:[1,1,0] op_sel_hi:[1,0,1] neg_lo:[1,0,0]
    v_pk_fma_f32 v[190:191], v[170:171], v[170:171], v[190:191] op_sel:[1,1,0] op_sel_hi:[1,0,1] neg_lo:[1,0,0]
    v_cvt_pk_bf16_f32 v109, v178, v179
    v_cvt_pk_bf16_f32 v151, v190, v191
    v_pk_mul_f32 v[176:177], v[178:179], v[168:169] op_sel:[0,0] op_sel_hi:[0,1]
    v_pk_mul_f32 v[188:189], v[190:191], v[170:171] op_sel:[0,0] op_sel_hi:[0,1]
    v_pk_fma_f32 v[176:177], v[178:179], v[168:169], v[176:177] op_sel:[1,1,0] op_sel_hi:[1,0,1] neg_lo:[1,0,0]
    v_pk_fma_f32 v[188:189], v[190:191], v[170:171], v[188:189] op_sel:[1,1,0] op_sel_hi:[1,0,1] neg_lo:[1,0,0]
    v_cvt_pk_bf16_f32 v110, v176, v177
    v_cvt_pk_bf16_f32 v152, v188, v189
    v_pk_mul_f32 v[178:179], v[176:177], v[168:169] op_sel:[0,0] op_sel_hi:[0,1]
    v_pk_mul_f32 v[190:191], v[188:189], v[170:171] op_sel:[0,0] op_sel_hi:[0,1]
    v_pk_fma_f32 v[178:179], v[176:177], v[168:169], v[178:179] op_sel:[1,1,0] op_sel_hi:[1,0,1] neg_lo:[1,0,0]
    v_pk_fma_f32 v[190:191], v[188:189], v[170:171], v[190:191] op_sel:[1,1,0] op_sel_hi:[1,0,1] neg_lo:[1,0,0]
    v_cvt_pk_bf16_f32 v111, v178, v179
    s_lshl_b32 s72, s75, 7
    s_add_u32 s72, s72, s78
    s_mul_i32 s73, s75, 221184
    s_add_u32 s73, s73, s79
    s_add_u32 s75, s75, 1
    s_cmp_eq_u32 s75, 10
    s_cselect_b32 s75, 0, s75
    s_add_u32 m0, s97, 65536
    s_nop 0
    buffer_load_dwordx4 v16, s[4:7], s72 offen lds
    v_cvt_pk_bf16_f32 v153, v190, v191
    v_pk_mul_f32 v[176:177], v[178:179], v[168:169] op_sel:[0,0] op_sel_hi:[0,1]
    v_pk_mul_f32 v[188:189], v[190:191], v[170:171] op_sel:[0,0] op_sel_hi:[0,1]
    v_pk_fma_f32 v[176:177], v[178:179], v[168:169], v[176:177] op_sel:[1,1,0] op_sel_hi:[1,0,1] neg_lo:[1,0,0]
    v_pk_fma_f32 v[188:189], v[190:191], v[170:171], v[188:189] op_sel:[1,1,0] op_sel_hi:[1,0,1] neg_lo:[1,0,0]
    v_cvt_pk_bf16_f32 v112, v176, v177
    v_cvt_pk_bf16_f32 v154, v188, v189
    v_pk_mul_f32 v[178:179], v[176:177], v[168:169] op_sel:[0,0] op_sel_hi:[0,1]
    v_pk_mul_f32 v[190:191], v[188:189], v[170:171] op_sel:[0,0] op_sel_hi:[0,1]
    v_pk_fma_f32 v[178:179], v[176:177], v[168:169], v[178:179] op_sel:[1,1,0] op_sel_hi:[1,0,1] neg_lo:[1,0,0]
    v_pk_fma_f32 v[190:191], v[188:189], v[170:171], v[190:191] op_sel:[1,1,0] op_sel_hi:[1,0,1] neg_lo:[1,0,0]
    v_cvt_pk_bf16_f32 v113, v178, v179
    v_cvt_pk_bf16_f32 v155, v190, v191
    v_pk_mul_f32 v[176:177], v[178:179], v[168:169] op_sel:[0,0] op_sel_hi:[0,1]
    v_pk_mul_f32 v[188:189], v[190:191], v[170:171] op_sel:[0,0] op_sel_hi:[0,1]
    s_add_u32 m0, s97, 81920
    s_nop 0
    buffer_load_dwordx4 v20, s[8:11], s73 offen lds
    v_pk_fma_f32 v[176:177], v[178:179], v[168:169], v[176:177] op_sel:[1,1,0] op_sel_hi:[1,0,1] neg_lo:[1,0,0]
    v_pk_fma_f32 v[188:189], v[190:191], v[170:171], v[188:189] op_sel:[1,1,0] op_sel_hi:[1,0,1] neg_lo:[1,0,0]
    v_cvt_pk_bf16_f32 v114, v176, v177
    v_cvt_pk_bf16_f32 v156, v188, v189
    v_pk_mul_f32 v[178:179], v[176:177], v[168:169] op_sel:[0,0] op_sel_hi:[0,1]
    v_pk_mul_f32 v[190:191], v[188:189], v[170:171] op_sel:[0,0] op_sel_hi:[0,1]
    v_pk_fma_f32 v[178:179], v[176:177], v[168:169], v[178:179] op_sel:[1,1,0] op_sel_hi:[1,0,1] neg_lo:[1,0,0]
    v_pk_fma_f32 v[190:191], v[188:189], v[170:171], v[190:191] op_sel:[1,1,0] op_sel_hi:[1,0,1] neg_lo:[1,0,0]
    v_cvt_pk_bf16_f32 v115, v178, v179
    v_cvt_pk_bf16_f32 v157, v190, v191
    v_pk_mul_f32 v[176:177], v[178:179], v[168:169] op_sel:[0,0] op_sel_hi:[0,1]
    v_pk_mul_f32 v[188:189], v[190:191], v[170:171] op_sel:[0,0] op_sel_hi:[0,1]
    v_pk_fma_f32 v[176:177], v[178:179], v[168:169], v[176:177] op_sel:[1,1,0] op_sel_hi:[1,0,1] neg_lo:[1,0,0]
    v_pk_fma_f32 v[188:189], v[190:191], v[170:171], v[188:189] op_sel:[1,1,0] op_sel_hi:[1,0,1] neg_lo:[1,0,0]
    v_cvt_pk_bf16_f32 v116, v176, v177
    s_add_u32 m0, s99, 141824
    s_nop 0
    buffer_load_dwordx4 v254, s[16:19], s35 offen lds
    v_cvt_pk_bf16_f32 v158, v188, v189
    v_pk_mul_f32 v[178:179], v[176:177], v[168:169] op_sel:[0,0] op_sel_hi:[0,1]
    v_pk_mul_f32 v[190:191], v[188:189], v[170:171] op_sel:[0,0] op_sel_hi:[0,1]
    v_pk_fma_f32 v[178:179], v[176:177], v[168:169], v[178:179] op_sel:[1,1,0] op_sel_hi:[1,0,1] neg_lo:[1,0,0]
    v_pk_fma_f32 v[190:191], v[188:189], v[170:171], v[190:191] op_sel:[1,1,0] op_sel_hi:[1,0,1] neg_lo:[1,0,0]
    v_cvt_pk_bf16_f32 v117, v178, v179
    v_cvt_pk_bf16_f32 v159, v190, v191
    v_pk_mul_f32 v[176:177], v[178:179], v[168:169] op_sel:[0,0] op_sel_hi:[0,1]
    v_pk_mul_f32 v[188:189], v[190:191], v[170:171] op_sel:[0,0] op_sel_hi:[0,1]
    v_pk_fma_f32 v[176:177], v[178:179], v[168:169], v[176:177] op_sel:[1,1,0] op_sel_hi:[1,0,1] neg_lo:[1,0,0]
    v_pk_fma_f32 v[188:189], v[190:191], v[170:171], v[188:189] op_sel:[1,1,0] op_sel_hi:[1,0,1] neg_lo:[1,0,0]
    v_cvt_pk_bf16_f32 v118, v176, v177
    v_cvt_pk_bf16_f32 v160, v188, v189
    v_pk_mul_f32 v[178:179], v[176:177], v[168:169] op_sel:[0,0] op_sel_hi:[0,1]
    v_pk_mul_f32 v[190:191], v[188:189], v[170:171] op_sel:[0,0] op_sel_hi:[0,1]
    s_add_u32 m0, s99, 142848
    s_nop 0
    buffer_load_dwordx4 v255, s[16:19], s35 offen lds
    v_pk_fma_f32 v[178:179], v[176:177], v[168:169], v[178:179] op_sel:[1,1,0] op_sel_hi:[1,0,1] neg_lo:[1,0,0]
    v_pk_fma_f32 v[190:191], v[188:189], v[170:171], v[190:191] op_sel:[1,1,0] op_sel_hi:[1,0,1] neg_lo:[1,0,0]
    v_cvt_pk_bf16_f32 v119, v178, v179
    v_cvt_pk_bf16_f32 v161, v190, v191
    v_pk_mul_f32 v[176:177], v[178:179], v[168:169] op_sel:[0,0] op_sel_hi:[0,1]
    v_pk_mul_f32 v[188:189], v[190:191], v[170:171] op_sel:[0,0] op_sel_hi:[0,1]
    v_pk_fma_f32 v[176:177], v[178:179], v[168:169], v[176:177] op_sel:[1,1,0] op_sel_hi:[1,0,1] neg_lo:[1,0,0]
    v_pk_fma_f32 v[188:189], v[190:191], v[170:171], v[188:189] op_sel:[1,1,0] op_sel_hi:[1,0,1] neg_lo:[1,0,0]
    v_cvt_pk_bf16_f32 v120, v176, v177
    v_cvt_pk_bf16_f32 v162, v188, v189
    v_pk_mul_f32 v[178:179], v[176:177], v[168:169] op_sel:[0,0] op_sel_hi:[0,1]
    v_pk_mul_f32 v[190:191], v[188:189], v[170:171] op_sel:[0,0] op_sel_hi:[0,1]
    v_pk_fma_f32 v[178:179], v[176:177], v[168:169], v[178:179] op_sel:[1,1,0] op_sel_hi:[1,0,1] neg_lo:[1,0,0]
    v_pk_fma_f32 v[190:191], v[188:189], v[170:171], v[190:191] op_sel:[1,1,0] op_sel_hi:[1,0,1] neg_lo:[1,0,0]
    v_cvt_pk_bf16_f32 v121, v178, v179
    s_mov_b32 exec_lo, 1
    s_mov_b32 exec_hi, 1
    buffer_store_dwordx2 v[216:217], v214, s[12:15], s76 offen sc1
    s_mov_b64 exec, -1
    v_cvt_pk_bf16_f32 v163, v190, v191
    v_pk_mul_f32 v[176:177], v[178:179], v[168:169] op_sel:[0,0] op_sel_hi:[0,1]
    v_pk_mul_f32 v[188:189], v[190:191], v[170:171] op_sel:[0,0] op_sel_hi:[0,1]
    v_pk_fma_f32 v[176:177], v[178:179], v[168:169], v[176:177] op_sel:[1,1,0] op_sel_hi:[1,0,1] neg_lo:[1,0,0]
    v_pk_fma_f32 v[188:189], v[190:191], v[170:171], v[188:189] op_sel:[1,1,0] op_sel_hi:[1,0,1] neg_lo:[1,0,0]
    v_cvt_pk_bf16_f32 v122, v176, v177
    v_cvt_pk_bf16_f32 v164, v188, v189
    v_pk_mul_f32 v[178:179], v[176:177], v[168:169] op_sel:[0,0] op_sel_hi:[0,1]
    v_pk_fma_f32 v[178:179], v[176:177], v[168:169], v[178:179] op_sel:[1,1,0] op_sel_hi:[1,0,1] neg_lo:[1,0,0]
    v_cvt_pk_bf16_f32 v123, v178, v179
    v_pk_mul_f32 v[174:175], v[168:169], v[168:169] op_sel:[0,0] op_sel_hi:[0,1]
    v_pk_mul_f32 v[184:185], v[166:167], v[172:173] op_sel:[0,0] op_sel_hi:[0,1]
    v_pk_fma_f32 v[174:175], v[168:169], v[168:169], v[174:175] op_sel:[1,1,0] op_sel_hi:[1,0,1] neg_lo:[1,0,0]
    v_pk_fma_f32 v[184:185], v[166:167], v[172:173], v[184:185] op_sel:[1,1,0] op_sel_hi:[1,0,1] neg_lo:[1,0,0]
    v_pk_mul_f32 v[182:183], v[174:175], v[174:175] op_sel:[0,0] op_sel_hi:[0,1]
    s_waitcnt lgkmcnt(4)
    buffer_store_dwordx4 v[52:55], v1, s[12:15], s77 offen sc1
    v_pk_mul_f32 v[186:187], v[184:185], v[172:173] op_sel:[0,0] op_sel_hi:[0,1]
    v_pk_fma_f32 v[182:183], v[174:175], v[174:175], v[182:183] op_sel:[1,1,0] op_sel_hi:[1,0,1] neg_lo:[1,0,0]
    v_pk_fma_f32 v[186:187], v[184:185], v[172:173], v[186:187] op_sel:[1,1,0] op_sel_hi:[1,0,1] neg_lo:[1,0,0]
    v_pk_mul_f32 v[180:181], v[182:183], v[182:183] op_sel:[0,0] op_sel_hi:[0,1]
    v_pk_mul_f32 v[166:167], v[186:187], v[172:173] op_sel:[0,0] op_sel_hi:[0,1]
    v_pk_fma_f32 v[180:181], v[182:183], v[182:183], v[180:181] op_sel:[1,1,0] op_sel_hi:[1,0,1] neg_lo:[1,0,0]
    v_pk_fma_f32 v[166:167], v[186:187], v[172:173], v[166:167] op_sel:[1,1,0] op_sel_hi:[1,0,1] neg_lo:[1,0,0]
    v_cvt_pk_bf16_f32 v124, v184, v185
    v_cvt_pk_bf16_f32 v132, v186, v187
    v_pk_mul_f32 v[190:191], v[184:185], v[174:175] op_sel:[0,0] op_sel_hi:[0,1]
    v_pk_mul_f32 v[178:179], v[186:187], v[182:183] op_sel:[0,0] op_sel_hi:[0,1]
    v_pk_fma_f32 v[190:191], v[184:185], v[174:175], v[190:191] op_sel:[1,1,0] op_sel_hi:[1,0,1] neg_lo:[1,0,0]
    v_pk_fma_f32 v[178:179], v[186:187], v[182:183], v[178:179] op_sel:[1,1,0] op_sel_hi:[1,0,1] neg_lo:[1,0,0]
    v_cvt_pk_bf16_f32 v125, v190, v191
    v_cvt_pk_bf16_f32 v133, v178, v179
    s_waitcnt lgkmcnt(2)
    buffer_store_dwordx4 v[56:59], v215, s[12:15], s77 offen sc1
    v_pk_mul_f32 v[188:189], v[190:191], v[174:175] op_sel:[0,0] op_sel_hi:[0,1]
    v_pk_mul_f32 v[176:177], v[178:179], v[182:183] op_sel:[0,0] op_sel_hi:[0,1]
    v_pk_fma_f32 v[188:189], v[190:191], v[174:175], v[188:189] op_sel:[1,1,0] op_sel_hi:[1,0,1] neg_lo:[1,0,0]
    v_pk_fma_f32 v[176:177], v[178:179], v[182:183], v[176:177] op_sel:[1,1,0] op_sel_hi:[1,0,1] neg_lo:[1,0,0]
    v_cvt_pk_bf16_f32 v126, v188, v189
    v_cvt_pk_bf16_f32 v134, v176, v177
    v_pk_mul_f32 v[190:191], v[188:189], v[174:175] op_sel:[0,0] op_sel_hi:[0,1]
    v_pk_mul_f32 v[178:179], v[176:177], v[182:183] op_sel:[0,0] op_sel_hi:[0,1]
    v_pk_fma_f32 v[190:191], v[188:189], v[174:175], v[190:191] op_sel:[1,1,0] op_sel_hi:[1,0,1] neg_lo:[1,0,0]
    v_pk_fma_f32 v[178:179], v[176:177], v[182:183], v[178:179] op_sel:[1,1,0] op_sel_hi:[1,0,1] neg_lo:[1,0,0]
    v_cvt_pk_bf16_f32 v127, v190, v191
    v_cvt_pk_bf16_f32 v135, v178, v179
    v_pk_mul_f32 v[188:189], v[190:191], v[174:175] op_sel:[0,0] op_sel_hi:[0,1]
    v_cvt_pk_bf16_f32 v136, v166, v167
    v_pk_fma_f32 v[188:189], v[190:191], v[174:175], v[188:189] op_sel:[1,1,0] op_sel_hi:[1,0,1] neg_lo:[1,0,0]
    s_mov_b32 exec_hi, 0
    s_waitcnt lgkmcnt(0)
    buffer_store_dwordx4 v[60:63], v1, s[12:15], s60 offen sc1
    s_mov_b32 exec_hi, -1
    v_pk_mul_f32 v[178:179], v[166:167], v[182:183] op_sel:[0,0] op_sel_hi:[0,1]
    v_cvt_pk_bf16_f32 v128, v188, v189
    v_pk_fma_f32 v[178:179], v[166:167], v[182:183], v[178:179] op_sel:[1,1,0] op_sel_hi:[1,0,1] neg_lo:[1,0,0]
    v_pk_mul_f32 v[190:191], v[188:189], v[174:175] op_sel:[0,0] op_sel_hi:[0,1]
    v_cvt_pk_bf16_f32 v137, v178, v179
    v_pk_fma_f32 v[190:191], v[188:189], v[174:175], v[190:191] op_sel:[1,1,0] op_sel_hi:[1,0,1] neg_lo:[1,0,0]
    v_pk_mul_f32 v[176:177], v[178:179], v[182:183] op_sel:[0,0] op_sel_hi:[0,1]
    v_cvt_pk_bf16_f32 v129, v190, v191
    v_pk_fma_f32 v[176:177], v[178:179], v[182:183], v[176:177] op_sel:[1,1,0] op_sel_hi:[1,0,1] neg_lo:[1,0,0]
    v_pk_mul_f32 v[188:189], v[190:191], v[174:175] op_sel:[0,0] op_sel_hi:[0,1]
    v_cvt_pk_bf16_f32 v138, v176, v177
    v_pk_fma_f32 v[188:189], v[190:191], v[174:175], v[188:189] op_sel:[1,1,0] op_sel_hi:[1,0,1] neg_lo:[1,0,0]
    v_pk_mul_f32 v[178:179], v[176:177], v[182:183] op_sel:[0,0] op_sel_hi:[0,1]
    v_cvt_pk_bf16_f32 v130, v188, v189
    v_pk_fma_f32 v[178:179], v[176:177], v[182:183], v[178:179] op_sel:[1,1,0] op_sel_hi:[1,0,1] neg_lo:[1,0,0]
    v_lshl_add_u32 v92, v0, 8, s43
    v_mov_b32 v93, 0
    s_add_u32 s74, s38, 131072
    v_writelane_b32 v92, s38, 1
    v_writelane_b32 v92, s74, 2
    s_mov_b64 exec, 7
    buffer_store_dword v93, v92, s[12:15], 0 offen sc1
    s_mov_b64 exec, -1
    v_pk_mul_f32 v[190:191], v[188:189], v[174:175] op_sel:[0,0] op_sel_hi:[0,1]
    v_cvt_pk_bf16_f32 v139, v178, v179
    v_pk_fma_f32 v[190:191], v[188:189], v[174:175], v[190:191] op_sel:[1,1,0] op_sel_hi:[1,0,1] neg_lo:[1,0,0]
    v_cvt_pk_bf16_f32 v131, v190, v191
    v_pk_mul_f32 v[168:169], v[166:167], v[172:173] op_sel:[0,0] op_sel_hi:[0,1]
    v_pk_fma_f32 v[168:169], v[166:167], v[172:173], v[168:169] op_sel:[1,1,0] op_sel_hi:[1,0,1] neg_lo:[1,0,0]
    v_cvt_pk_bf16_f32 v140, v168, v169
    v_pk_mul_f32 v[170:171], v[168:169], v[172:173] op_sel:[0,0] op_sel_hi:[0,1]
    v_pk_mul_f32 v[176:177], v[168:169], v[180:181] op_sel:[0,0] op_sel_hi:[0,1]
    v_pk_fma_f32 v[170:171], v[168:169], v[172:173], v[170:171] op_sel:[1,1,0] op_sel_hi:[1,0,1] neg_lo:[1,0,0]
    v_pk_fma_f32 v[176:177], v[168:169], v[180:181], v[176:177] op_sel:[1,1,0] op_sel_hi:[1,0,1] neg_lo:[1,0,0]
    v_cvt_pk_bf16_f32 v142, v170, v171
    v_cvt_pk_bf16_f32 v141, v176, v177
    v_pk_mul_f32 v[174:175], v[170:171], v[172:173] op_sel:[0,0] op_sel_hi:[0,1]
    v_pk_mul_f32 v[178:179], v[170:171], v[180:181] op_sel:[0,0] op_sel_hi:[0,1]
    global_load_dword v228, v229, s[62:63] sc1
    v_pk_fma_f32 v[174:175], v[170:171], v[172:173], v[174:175] op_sel:[1,1,0] op_sel_hi:[1,0,1] neg_lo:[1,0,0]
    v_pk_fma_f32 v[178:179], v[170:171], v[180:181], v[178:179] op_sel:[1,1,0] op_sel_hi:[1,0,1] neg_lo:[1,0,0]
    v_cvt_pk_bf16_f32 v144, v174, v175
    v_cvt_pk_bf16_f32 v143, v178, v179
    v_pk_mul_f32 v[182:183], v[174:175], v[172:173] op_sel:[0,0] op_sel_hi:[0,1]
    v_pk_mul_f32 v[176:177], v[174:175], v[180:181] op_sel:[0,0] op_sel_hi:[0,1]
    v_pk_fma_f32 v[182:183], v[174:175], v[172:173], v[182:183] op_sel:[1,1,0] op_sel_hi:[1,0,1] neg_lo:[1,0,0]
    v_pk_fma_f32 v[176:177], v[174:175], v[180:181], v[176:177] op_sel:[1,1,0] op_sel_hi:[1,0,1] neg_lo:[1,0,0]
    v_cvt_pk_bf16_f32 v146, v182, v183
    v_cvt_pk_bf16_f32 v145, v176, v177
    v_pk_mul_f32 v[184:185], v[182:183], v[172:173] op_sel:[0,0] op_sel_hi:[0,1]
    v_pk_mul_f32 v[178:179], v[182:183], v[180:181] op_sel:[0,0] op_sel_hi:[0,1]
    v_pk_fma_f32 v[184:185], v[182:183], v[172:173], v[184:185] op_sel:[1,1,0] op_sel_hi:[1,0,1] neg_lo:[1,0,0]
    v_pk_fma_f32 v[178:179], v[182:183], v[180:181], v[178:179] op_sel:[1,1,0] op_sel_hi:[1,0,1] neg_lo:[1,0,0]
    v_cvt_pk_bf16_f32 v148, v184, v185
    v_cvt_pk_bf16_f32 v147, v178, v179
L_mk_g1_0:
    s_waitcnt vmcnt(18)
    s_barrier
    ds_read_b64_tr_b16 a[192:193], v28 offset:0
    ds_read_b64_tr_b16 a[194:195], v28 offset:1024
    ds_read_b128 a[200:203], v24 offset:0
    ds_read_b64_tr_b16 a[196:197], v29 offset:0
    ds_read_b64_tr_b16 a[198:199], v29 offset:1024
    ds_read_b128 a[204:207], v24 offset:4096
    ds_read_b64_tr_b16 a[208:209], v28 offset:4096
    ds_read_b64_tr_b16 a[210:211], v28 offset:5120
    ds_read_b128 a[216:219], v25 offset:0
    ds_read_b64_tr_b16 a[212:213], v29 offset:4096
    ds_read_b64_tr_b16 a[214:215], v29 offset:5120
    ds_read_b128 a[220:223], v25 offset:4096
    s_add_u32 m0, s97, 66560
    s_nop 0
    buffer_load_dwordx4 v17, s[4:7], s72 offen lds
    s_add_u32 m0, s97, 82944
    s_nop 0
    buffer_load_dwordx4 v21, s[8:11], s73 offen lds
    s_waitcnt lgkmcnt(9)
    v_mfma_f32_32x32x16_bf16 v[40:55], a[192:195], a[200:203], 0
    s_add_u32 m0, s97, 67584
    ds_read_b64_tr_b16 a[224:225], v28 offset:8192
    ds_read_b64_tr_b16 a[226:227], v28 offset:9216
    s_lshl_b32 s69, s52, 10
    s_add_u32 s69, s69, L_tab-L_pc
    s_waitcnt lgkmcnt(9)
    v_mfma_f32_32x32x16_bf16 v[72:87], a[196:199], a[200:203], 0
    buffer_load_dwordx4 v18, s[4:7], s72 offen lds
    ds_read_b128 a[232:235], v26 offset:0
    ds_read_b64_tr_b16 a[228:229], v29 offset:8192
    v_add_u32 v13, s69, v1
    global_load_dwordx4 v[2:5], v13, s[66:67]
    v_mfma_f32_16x16x32_bf16 v[104:107], a[192:195], v[36:39], 0
    s_add_u32 m0, s97, 83968
    ds_read_b64_tr_b16 a[230:231], v29 offset:9216
    s_waitcnt lgkmcnt(11)
    v_mfma_f32_32x32x16_bf16 v[56:71], a[192:195], a[204:207], 0
    buffer_load_dwordx4 v22, s[8:11], s73 offen lds
    s_add_u32 m0, s97, 68608
    ds_read_b128 a[236:239], v26 offset:4096
    s_lshl_b32 s69, s52, 8
    s_add_u32 s69, s69, L_tab-L_pc+2048
    v_mfma_f32_32x32x16_bf16 v[88:103], a[196:199], a[204:207], 0
    buffer_load_dwordx4 v19, s[4:7], s72 offen lds
    s_add_u32 m0, s97, 84992
    ds_read_b64_tr_b16 a[240:241], v28 offset:12288
    v_lshl_add_u32 v13, v0, 2, s69
    global_load_dword v6, v13, s[66:67]
    s_waitcnt lgkmcnt(10)
    v_mfma_f32_32x32x16_bf16 v[40:55], a[208:211], a[216:219], v[40:55]
    buffer_load_dwordx4 v23, s[8:11], s73 offen lds
    s_lshl_b32 s72, s75, 7
    s_add_u32 s72, s72, s78
    s_mul_i32 s73, s75, 221184
    s_add_u32 s73, s73, s79
    s_add_u32 s75, s75, 1
    s_cmp_eq_u32 s75, 10
    s_cselect_b32 s75, 0, s75
    s_add_u32 m0, s97, 98304
    s_waitcnt lgkmcnt(8)
    v_mfma_f32_32x32x16_bf16 v[72:87], a[212:215], a[216:219], v[72:87]
    buffer_load_dwordx4 v16, s[4:7], s72 offen lds
    ds_read_b64_tr_b16 a[242:243], v28 offset:13312
    ds_read_b128 a[248:251], v27 offset:0
    s_add_u32 s20, s64, s44
    s_addc_u32 s21, s65, 0
    v_mfma_f32_16x16x32_bf16 v[104:107], a[208:211], v[36:39], v[104:107]
    s_add_u32 m0, s97, 114688
    ds_read_b64_tr_b16 a[244:245], v29 offset:12288
    s_waitcnt lgkmcnt(10)
    v_mfma_f32_32x32x16_bf16 v[56:71], a[208:211], a[220:223], v[56:71]
    buffer_load_dwordx4 v20, s[8:11], s73 offen lds
    ds_read_b64_tr_b16 a[246:247], v29 offset:13312
    ds_read_b128 a[252:255], v27 offset:4096
    s_mov_b32 s22, 276480
    s_mov_b32 s23, 0x20000
    v_mfma_f32_32x32x16_bf16 v[88:103], a[212:215], a[220:223], v[88:103]
L_mk_g1_1:
    s_waitcnt vmcnt(16) lgkmcnt(0)
    s_barrier
    v_mfma_f32_32x32x16_bf16 v[40:55], a[224:227], a[232:235], v[40:55]
    s_add_u32 m0, s97, 99328
    ds_read_b64_tr_b16 a[192:193], v28 offset:32768
    ds_read_b64_tr_b16 a[194:195], v28 offset:33792
    v_mov_b32 v220, v1
    v_add_u32 v221, 4096, v1
    v_mfma_f32_32x32x16_bf16 v[72:87], a[228:231], a[232:235], v[72:87]
    buffer_load_dwordx4 v17, s[4:7], s72 offen lds
    ds_read_b128 a[200:203], v24 offset:32768
    ds_read_b64_tr_b16 a[196:197], v29 offset:32768
    s_add_u32 s16, s64, s45
    s_addc_u32 s17, s65, 0
    v_mfma_f32_16x16x32_bf16 v[104:107], a[224:227], v[36:39], v[104:107]
    ds_read_b64_tr_b16 a[198:199], v29 offset:33792
    ds_read_b128 a[204:207], v24 offset:36864
    v_mfma_f32_32x32x16_bf16 v[56:71], a[224:227], a[236:239], v[56:71]
    s_add_u32 m0, s97, 115712
    ds_read_b64_tr_b16 a[208:209], v28 offset:36864
    ds_read_b64_tr_b16 a[210:211], v28 offset:37888
    s_mov_b32 s18, 442368
    s_mov_b32 s19, 0x20000
    v_mfma_f32_32x32x16_bf16 v[88:103], a[228:231], a[236:239], v[88:103]
    buffer_load_dwordx4 v21, s[8:11], s73 offen lds
    ds_read_b128 a[216:219], v25 offset:32768
    ds_read_b64_tr_b16 a[212:213], v29 offset:36864
    v_and_b32 v13, 31, v0
    v_lshl_add_u32 v15, v13, 2, s51
    v_mfma_f32_32x32x16_bf16 v[40:55], a[240:243], a[248:251], v[40:55]
    s_add_u32 m0, s97, 100352
    ds_read_b64_tr_b16 a[214:215], v29 offset:37888
    ds_read_b128 a[220:223], v25 offset:36864
    global_load_dword v252, v15, s[54:55]
    v_and_b32 v13, 15, v0
    v_mfma_f32_32x32x16_bf16 v[72:87], a[244:247], a[248:251], v[72:87]
    buffer_load_dwordx4 v18, s[4:7], s72 offen lds
    ds_read_b64_tr_b16 v[166:167], v253 offset:0
    ds_read_b64_tr_b16 v[168:169], v253 offset:2048
    v_lshrrev_b32 v14, 4, v0
    s_mul_i32 s68, s53, 31008
    v_mfma_f32_16x16x32_bf16 v[104:107], a[240:243], v[36:39], v[104:107]
    ds_read_b64_tr_b16 v[170:171], v230 offset:0
    ds_read_b64_tr_b16 v[172:173], v230 offset:2048
    v_mfma_f32_32x32x16_bf16 v[56:71], a[240:243], a[252:255], v[56:71]
    s_add_u32 m0, s97, 116736
    s_add_u32 s68, s68, 65536
    s_lshl_b32 s70, s52, 8
    s_add_u32 s70, s70, s68
    v_lshl_add_u32 v222, v0, 2, s70
    v_mfma_f32_32x32x16_bf16 v[88:103], a[244:247], a[252:255], v[88:103]
    buffer_load_dwordx4 v22, s[8:11], s73 offen lds
    v_mul_u32_u24 v15, 544, v13
    v_lshl_add_u32 v15, v14, 4, v15
    s_mul_i32 s70, s52, 8704
    s_add_u32 s70, s70, s68
    s_waitcnt lgkmcnt(13)
    v_mfma_f32_32x32x16_bf16 v[40:55], a[192:195], a[200:203], v[40:55]
    s_add_u32 m0, s97, 101376
    s_waitcnt lgkmcnt(2)
    buffer_store_dwordx4 v[166:169], v1, s[12:15], s50 offen sc1
    ds_read_b64_tr_b16 a[224:225], v28 offset:40960
    v_add_u32 v223, s70, v15
    s_add_u32 s68, s68, 17408
    v_mfma_f32_32x32x16_bf16 v[72:87], a[196:199], a[200:203], v[72:87]
    buffer_load_dwordx4 v19, s[4:7], s72 offen lds
    ds_read_b64_tr_b16 a[226:227], v28 offset:41984
    ds_read_b128 a[232:235], v26 offset:32768
    v_add_u32 v224, s68, v15
    s_mul_i32 s68, s53, 1536
    v_mfma_f32_16x16x32_bf16 v[104:107], a[192:195], v[36:39], v[104:107]
    s_add_u32 m0, s97, 117760
    ds_read_b64_tr_b16 a[228:229], v29 offset:40960
    v_mfma_f32_32x32x16_bf16 v[56:71], a[192:195], a[204:207], v[56:71]
    buffer_load_dwordx4 v23, s[8:11], s73 offen lds
    ds_read_b64_tr_b16 a[230:231], v29 offset:41984
    ds_read_b128 a[236:239], v26 offset:36864
    s_add_u32 s68, s68, 148800
    v_mov_b32 v227, s68
    v_mfma_f32_32x32x16_bf16 v[88:103], a[196:199], a[204:207], v[88:103]
    s_lshl_b32 s72, s75, 7
    s_add_u32 s72, s72, s78
    s_mul_i32 s73, s75, 221184
    s_add_u32 s73, s73, s79
    s_add_u32 s75, s75, 1
    s_cmp_eq_u32 s75, 10
    s_cselect_b32 s75, 0, s75
    s_add_u32 m0, s97, 0
    s_waitcnt lgkmcnt(6)
    buffer_store_dwordx4 v[170:173], v1, s[12:15], s95 offen sc1
    v_mfma_f32_32x32x16_bf16 v[40:55], a[208:211], a[216:219], v[40:55]
    buffer_load_dwordx4 v16, s[4:7], s72 offen lds
    ds_read_b64_tr_b16 a[240:241], v28 offset:45056
    ds_read_b64_tr_b16 a[242:243], v28 offset:46080
    v_lshlrev_b32 v15, 4, v13
    v_lshl_add_u32 v225, v14, 3, v15
    v_mfma_f32_32x32x16_bf16 v[72:87], a[212:215], a[216:219], v[72:87]
    ds_read_b128 a[248:251], v27 offset:32768
    ds_read_b64_tr_b16 a[244:245], v29 offset:45056
    ds_read_b64_tr_b16 a[246:247], v29 offset:46080
    v_lshlrev_b32 v15, 3, v13
    v_lshl_add_u32 v226, v14, 7, v15
    v_mfma_f32_16x16x32_bf16 v[104:107], a[208:211], v[36:39], v[104:107]
    s_add_u32 m0, s97, 16384
    ds_read_b128 a[252:255], v27 offset:36864
    v_mfma_f32_32x32x16_bf16 v[56:71], a[208:211], a[220:223], v[56:71]
    buffer_load_dwordx4 v20, s[8:11], s73 offen lds
    v_cmp_gt_u32 vcc, 2, v14
    v_lshlrev_b32 v15, 5, v13
    v_lshl_add_u32 v15, v14, 3, v15
    v_cndmask_b32 v225, v226, v225, vcc
    v_mfma_f32_32x32x16_bf16 v[88:103], a[212:215], a[220:223], v[88:103]
L_mk_g1_2:
    s_waitcnt vmcnt(13) lgkmcnt(0)
    s_barrier
    v_mfma_f32_32x32x16_bf16 v[40:55], a[224:227], a[232:235], v[40:55]
    s_add_u32 m0, s97, 1024
    ds_read_b64_tr_b16 a[192:193], v34 offset:0
    ds_read_b64_tr_b16 a[194:195], v34 offset:1024
    v_add_u32 v225, 512, v225
    v_mfma_f32_32x32x16_bf16 v[72:87], a[228:231], a[232:235], v[72:87]
    buffer_load_dwordx4 v17, s[4:7], s72 offen lds
    ds_read_b128 a[200:203], v30 offset:0
    ds_read_b64_tr_b16 a[196:197], v35 offset:0
    v_mfma_f32_16x16x32_bf16 v[104:107], a[224:227], v[36:39], v[104:107]
    ds_read_b64_tr_b16 a[198:199], v35 offset:1024
    ds_read_b128 a[204:207], v30 offset:4096
    v_mfma_f32_32x32x16_bf16 v[56:71], a[224:227], a[236:239], v[56:71]
    s_add_u32 m0, s97, 17408
    ds_read_b64_tr_b16 a[208:209], v34 offset:4096
    ds_read_b64_tr_b16 a[210:211], v34 offset:5120
    v_mfma_f32_32x32x16_bf16 v[88:103], a[228:231], a[236:239], v[88:103]
    buffer_load_dwordx4 v21, s[8:11], s73 offen lds
    ds_read_b128 a[216:219], v31 offset:0
    ds_read_b64_tr_b16 a[212:213], v35 offset:4096
    v_mfma_f32_32x32x16_bf16 v[40:55], a[240:243], a[248:251], v[40:55]
    s_add_u32 m0, s97, 2048
    ds_read_b64_tr_b16 a[214:215], v35 offset:5120
    ds_read_b128 a[220:223], v31 offset:4096
    v_mfma_f32_32x32x16_bf16 v[72:87], a[244:247], a[248:251], v[72:87]
    buffer_load_dwordx4 v18, s[4:7], s72 offen lds
    s_cmp_eq_u32 s52, 0
    s_cselect_b64 s[70:71], -1, 0
    v_cndmask_b32 v225, v225, v15, s[70:71]
    v_add_u32 v225, s68, v225
    v_mfma_f32_16x16x32_bf16 v[104:107], a[240:243], v[36:39], v[104:107]
    v_lshlrev_b32 v15, 2, v13
    v_lshl_add_u32 v15, v14, 7, v15
    v_mfma_f32_32x32x16_bf16 v[56:71], a[240:243], a[252:255], v[56:71]
    s_add_u32 m0, s97, 18432
    v_add_u32 v15, 1024, v15
    v_mov_b32 v226, 1296
    v_mfma_f32_32x32x16_bf16 v[88:103], a[244:247], a[252:255], v[88:103]
    buffer_load_dwordx4 v22, s[8:11], s73 offen lds
    v_cmp_gt_u32 vcc, 2, v14
    s_nop 1
    v_cndmask_b32 v226, v226, v15, vcc
    s_waitcnt lgkmcnt(9)
    v_mfma_f32_32x32x16_bf16 v[40:55], a[192:195], a[200:203], v[40:55]
    s_add_u32 m0, s97, 3072
    ds_read_b64_tr_b16 a[224:225], v34 offset:8192
    ds_read_b64_tr_b16 a[226:227], v34 offset:9216
    s_waitcnt lgkmcnt(9)
    v_mfma_f32_32x32x16_bf16 v[72:87], a[196:199], a[200:203], v[72:87]
    buffer_load_dwordx4 v19, s[4:7], s72 offen lds
    ds_read_b128 a[232:235], v32 offset:0
    ds_read_b64_tr_b16 a[228:229], v35 offset:8192
    v_mfma_f32_16x16x32_bf16 v[104:107], a[192:195], v[36:39], v[104:107]
    s_add_u32 m0, s97, 19456
    ds_read_b64_tr_b16 a[230:231], v35 offset:9216
    s_waitcnt lgkmcnt(11)
    v_mfma_f32_32x32x16_bf16 v[56:71], a[192:195], a[204:207], v[56:71]
    buffer_load_dwordx4 v23, s[8:11], s73 offen lds
    ds_read_b128 a[236:239], v32 offset:4096
    ds_read_b64_tr_b16 a[240:241], v34 offset:12288
    v_mfma_f32_32x32x16_bf16 v[88:103], a[196:199], a[204:207], v[88:103]
    s_lshl_b32 s72, s75, 7
    s_add_u32 s72, s72, s78
    s_mul_i32 s73, s75, 221184
    s_add_u32 s73, s73, s79
    s_add_u32 s75, s75, 1
    s_cmp_eq_u32 s75, 10
    s_cselect_b32 s75, 0, s75
    s_add_u32 m0, s97, 32768
    s_waitcnt lgkmcnt(10)
    v_mfma_f32_32x32x16_bf16 v[40:55], a[208:211], a[216:219], v[40:55]
    buffer_load_dwordx4 v16, s[4:7], s72 offen lds
    ds_read_b64_tr_b16 a[242:243], v34 offset:13312
    ds_read_b128 a[248:251], v33 offset:0
    s_waitcnt lgkmcnt(10)
    v_mfma_f32_32x32x16_bf16 v[72:87], a[212:215], a[216:219], v[72:87]
    ds_read_b64_tr_b16 a[244:245], v35 offset:12288
    ds_read_b64_tr_b16 a[246:247], v35 offset:13312
    ds_read_b128 a[252:255], v33 offset:4096
    v_mfma_f32_16x16x32_bf16 v[104:107], a[208:211], v[36:39], v[104:107]
    s_add_u32 m0, s97, 49152
    s_waitcnt lgkmcnt(12)
    v_mfma_f32_32x32x16_bf16 v[56:71], a[208:211], a[220:223], v[56:71]
    buffer_load_dwordx4 v20, s[8:11], s73 offen lds
    v_cmp_eq_u32 vcc, 32, v0
    v_mov_b32 v15, 1280
    s_nop 0
    v_cndmask_b32 v226, v226, v15, vcc
    v_mfma_f32_32x32x16_bf16 v[88:103], a[212:215], a[220:223], v[88:103]
L_mk_g1_3:
    s_waitcnt vmcnt(10) lgkmcnt(0)
    s_barrier
    s_cmp_lg_u32 s28, 0
    s_cbranch_scc1 L_pub_skip_1
    v_cmp_ne_u32 vcc, 1, v228
    s_cbranch_vccz L_rdy_ok_2
    s_mov_b32 s74, 20000
L_rdy_spin_3:
    s_mov_b64 exec, vcc
    s_sleep 1
    global_load_dword v228, v229, s[62:63] sc1
    s_waitcnt vmcnt(0)
    v_cmp_ne_u32 vcc, 1, v228
    s_mov_b64 exec, -1
    s_cbranch_vccz L_rdy_ok_2
    s_sub_u32 s74, s74, 1
    s_cmp_lg_u32 s74, 0
    s_cbranch_scc1 L_rdy_spin_3
L_rdy_ok_2:
    s_lshl_b32 s96, s96, 7
    s_add_u32 s96, s96, 131072
    s_getreg_b32 s74, hwreg(HW_REG_XCC_ID, 0, 4)
    s_lshl_b32 s74, s74, 1
    s_or_b32 s74, s74, 1
    v_mov_b32 v11, s74
    s_mov_b64 exec, 1
    buffer_store_dword v11, off, s[12:15], s96 offset:0 sc1
    s_mov_b64 exec, -1
L_pub_skip_1:
    v_mfma_f32_32x32x16_bf16 v[40:55], a[224:227], a[232:235], v[40:55]
    s_add_u32 m0, s97, 33792
    ds_read_b64_tr_b16 a[192:193], v34 offset:32768
    ds_read_b64_tr_b16 a[194:195], v34 offset:33792
    v_add_u32 v226, s68, v226
    s_mul_i32 s68, s53, 4224
    v_mfma_f32_32x32x16_bf16 v[72:87], a[228:231], a[232:235], v[72:87]
    buffer_load_dwordx4 v17, s[4:7], s72 offen lds
    ds_read_b128 a[200:203], v30 offset:32768
    ds_read_b64_tr_b16 a[196:197], v35 offset:32768
    s_add_u32 s68, s68, 131072
    s_lshl_b32 s69, s52, 10
    v_mfma_f32_16x16x32_bf16 v[104:107], a[224:227], v[36:39], v[104:107]
    ds_read_b64_tr_b16 a[198:199], v35 offset:33792
    ds_read_b128 a[204:207], v30 offset:36864
    v_mfma_f32_32x32x16_bf16 v[56:71], a[224:227], a[236:239], v[56:71]
    s_add_u32 m0, s97, 50176
    ds_read_b64_tr_b16 a[208:209], v34 offset:36864
    ds_read_b64_tr_b16 a[210:211], v34 offset:37888
    s_add_u32 s69, s69, s68
    v_add_u32 v236, s69, v1
    v_mfma_f32_32x32x16_bf16 v[88:103], a[228:231], a[236:239], v[88:103]
    buffer_load_dwordx4 v21, s[8:11], s73 offen lds
    ds_read_b128 a[216:219], v31 offset:32768
    ds_read_b64_tr_b16 a[212:213], v35 offset:36864
    v_sub_u32 v15, 15, v13
    v_and_b32 v239, 1, v15
    v_mfma_f32_32x32x16_bf16 v[40:55], a[240:243], a[248:251], v[40:55]
    s_add_u32 m0, s97, 34816
    ds_read_b64_tr_b16 a[214:215], v35 offset:37888
    ds_read_b128 a[220:223], v31 offset:36864
    v_mul_u32_u24 v239, 2110, v239
    v_lshl_add_u32 v15, v15, 1, v239
    v_mfma_f32_32x32x16_bf16 v[72:87], a[244:247], a[248:251], v[72:87]
    buffer_load_dwordx4 v18, s[4:7], s72 offen lds
    v_add_u32 v15, s68, v15
    v_lshl_add_u32 v237, v14, 4, v15
    v_add_u32 v238, 1024, v237
    v_lshl_add_u32 v239, v14, 3, v15
    v_mfma_f32_16x16x32_bf16 v[104:107], a[240:243], v[36:39], v[104:107]
    v_add_u32 v239, 1024, v239
    s_mul_i32 s68, s53, 4640
    v_mfma_f32_32x32x16_bf16 v[56:71], a[240:243], a[252:255], v[56:71]
    s_add_u32 m0, s97, 51200
    s_add_u32 s68, s68, 139520
    v_min_u32 v15, 33, v0
    v_lshl_add_u32 v243, v15, 4, s68
    s_add_u32 s68, s68, 0
    v_mfma_f32_32x32x16_bf16 v[88:103], a[244:247], a[252:255], v[88:103]
    buffer_load_dwordx4 v22, s[8:11], s73 offen lds
    v_lshlrev_b32 v15, 5, v13
    v_lshl_add_u32 v240, v14, 4, v15
    v_add_u32 v240, s68, v240
    v_and_b32 v246, 1, v14
    s_waitcnt lgkmcnt(9)
    v_mfma_f32_32x32x16_bf16 v[40:55], a[192:195], a[200:203], v[40:55]
    s_add_u32 m0, s97, 35840
    ds_read_b64_tr_b16 a[224:225], v34 offset:40960
    ds_read_b64_tr_b16 a[226:227], v34 offset:41984
    v_lshl_add_u32 v246, v246, 9, v15
    v_lshrrev_b32 v15, 1, v14
    s_waitcnt lgkmcnt(9)
    v_mfma_f32_32x32x16_bf16 v[72:87], a[196:199], a[200:203], v[72:87]
    buffer_load_dwordx4 v19, s[4:7], s72 offen lds
    ds_read_b128 a[232:235], v32 offset:32768
    ds_read_b64_tr_b16 a[228:229], v35 offset:40960
    v_lshl_add_u32 v246, v15, 4, v246
    v_lshrrev_b32 v13, 1, v0
    v_mfma_f32_16x16x32_bf16 v[104:107], a[192:195], v[36:39], v[104:107]
    s_add_u32 m0, s97, 52224
    ds_read_b64_tr_b16 a[230:231], v35 offset:41984
    s_waitcnt lgkmcnt(11)
    v_mfma_f32_32x32x16_bf16 v[56:71], a[192:195], a[204:207], v[56:71]
    buffer_load_dwordx4 v23, s[8:11], s73 offen lds
    ds_read_b128 a[236:239], v32 offset:36864
    ds_read_b64_tr_b16 a[240:241], v34 offset:45056
    v_and_b32 v14, 1, v0
    v_mul_u32_u24 v15, 10240, v13
    v_mfma_f32_32x32x16_bf16 v[88:103], a[196:199], a[204:207], v[88:103]
    s_lshl_b32 s72, s75, 7
    s_add_u32 s72, s72, s78
    s_mul_i32 s73, s75, 221184
    s_add_u32 s73, s73, s79
    s_add_u32 s75, s75, 1
    s_cmp_eq_u32 s75, 10
    s_cselect_b32 s75, 0, s75
    s_add_u32 m0, s97, 65536
    s_waitcnt lgkmcnt(10)
    v_mfma_f32_32x32x16_bf16 v[40:55], a[208:211], a[216:219], v[40:55]
    buffer_load_dwordx4 v16, s[4:7], s72 offen lds
    ds_read_b64_tr_b16 a[242:243], v34 offset:46080
    ds_read_b128 a[248:251], v33 offset:32768
    v_lshl_add_u32 v241, v14, 4, v15
    v_mul_u32_u24 v14, 4640, v14
    s_waitcnt lgkmcnt(10)
    v_mfma_f32_32x32x16_bf16 v[72:87], a[212:215], a[216:219], v[72:87]
    ds_read_b64_tr_b16 a[244:245], v35 offset:45056
    ds_read_b64_tr_b16 a[246:247], v35 offset:46080
    ds_read_b128 a[252:255], v33 offset:36864
    v_lshl_add_u32 v13, v13, 4, v14
    s_lshl_b32 s68, s28, 10
    v_mfma_f32_16x16x32_bf16 v[104:107], a[208:211], v[36:39], v[104:107]
    s_add_u32 m0, s97, 81920
    s_add_u32 s68, s68, 140064
    s_waitcnt lgkmcnt(12)
    v_mfma_f32_32x32x16_bf16 v[56:71], a[208:211], a[220:223], v[56:71]
    buffer_load_dwordx4 v20, s[8:11], s73 offen lds
    v_add_u32 v242, s68, v13
    s_lshl_b32 s68, s53, 13
    s_lshl_b32 s69, s52, 12
    s_add_u32 s68, s68, s69
    v_mfma_f32_32x32x16_bf16 v[88:103], a[212:215], a[220:223], v[88:103]
L_mk_g1_4:
    s_waitcnt vmcnt(10) lgkmcnt(0)
    s_barrier
    v_mfma_f32_32x32x16_bf16 v[40:55], a[224:227], a[232:235], v[40:55]
    s_add_u32 m0, s97, 66560
    ds_read_b64_tr_b16 a[192:193], v28 offset:0
    ds_read_b64_tr_b16 a[194:195], v28 offset:1024
    v_add_u32 v244, s68, v1
    v_xor_b32 v245, 4096, v244
    v_mfma_f32_32x32x16_bf16 v[72:87], a[228:231], a[232:235], v[72:87]
    buffer_load_dwordx4 v17, s[4:7], s72 offen lds
    ds_read_b128 a[200:203], v24 offset:0
    ds_read_b64_tr_b16 a[196:197], v29 offset:0
    s_mul_i32 s68, s53, 1536
    s_add_u32 s68, s68, 148800
    v_mfma_f32_16x16x32_bf16 v[104:107], a[224:227], v[36:39], v[104:107]
    ds_read_b64_tr_b16 a[198:199], v29 offset:1024
    ds_read_b128 a[204:207], v24 offset:4096
    v_mfma_f32_32x32x16_bf16 v[56:71], a[224:227], a[236:239], v[56:71]
    s_add_u32 m0, s97, 82944
    ds_read_b64_tr_b16 a[208:209], v28 offset:4096
    ds_read_b64_tr_b16 a[210:211], v28 offset:5120
    v_add_u32_sdwa v10, s68, v6 dst_sel:DWORD dst_unused:UNUSED_PAD src0_sel:DWORD src1_sel:WORD_0
    v_add_u32_sdwa v9, s68, v5 dst_sel:DWORD dst_unused:UNUSED_PAD src0_sel:DWORD src1_sel:WORD_1
    v_mfma_f32_32x32x16_bf16 v[88:103], a[228:231], a[236:239], v[88:103]
    buffer_load_dwordx4 v21, s[8:11], s73 offen lds
    ds_read_b128 a[216:219], v25 offset:0
    ds_read_b64_tr_b16 a[212:213], v29 offset:4096
    v_add_u32_sdwa v8, s68, v5 dst_sel:DWORD dst_unused:UNUSED_PAD src0_sel:DWORD src1_sel:WORD_0
    v_add_u32_sdwa v7, s68, v4 dst_sel:DWORD dst_unused:UNUSED_PAD src0_sel:DWORD src1_sel:WORD_1
    v_mfma_f32_32x32x16_bf16 v[40:55], a[240:243], a[248:251], v[40:55]
    s_add_u32 m0, s97, 67584
    ds_read_b64_tr_b16 a[214:215], v29 offset:5120
    ds_read_b128 a[220:223], v25 offset:4096
    v_add_u32_sdwa v6, s68, v4 dst_sel:DWORD dst_unused:UNUSED_PAD src0_sel:DWORD src1_sel:WORD_0
    v_add_u32_sdwa v5, s68, v3 dst_sel:DWORD dst_unused:UNUSED_PAD src0_sel:DWORD src1_sel:WORD_1
    v_mfma_f32_32x32x16_bf16 v[72:87], a[244:247], a[248:251], v[72:87]
    buffer_load_dwordx4 v18, s[4:7], s72 offen lds
    v_add_u32_sdwa v4, s68, v3 dst_sel:DWORD dst_unused:UNUSED_PAD src0_sel:DWORD src1_sel:WORD_0
    v_add_u32_sdwa v3, s68, v2 dst_sel:DWORD dst_unused:UNUSED_PAD src0_sel:DWORD src1_sel:WORD_1
    v_add_u32_sdwa v2, s68, v2 dst_sel:DWORD dst_unused:UNUSED_PAD src0_sel:DWORD src1_sel:WORD_0
    v_mfma_f32_16x16x32_bf16 v[104:107], a[240:243], v[36:39], v[104:107]
    v_mfma_f32_32x32x16_bf16 v[56:71], a[240:243], a[252:255], v[56:71]
    s_add_u32 m0, s97, 83968
    v_mfma_f32_32x32x16_bf16 v[88:103], a[244:247], a[252:255], v[88:103]
    buffer_load_dwordx4 v22, s[8:11], s73 offen lds
    s_waitcnt lgkmcnt(9)
    v_mfma_f32_32x32x16_bf16 v[40:55], a[192:195], a[200:203], v[40:55]
    s_add_u32 m0, s97, 68608
    ds_read_b64_tr_b16 a[224:225], v28 offset:8192
    ds_read_b64_tr_b16 a[226:227], v28 offset:9216
    s_waitcnt lgkmcnt(9)
    v_mfma_f32_32x32x16_bf16 v[72:87], a[196:199], a[200:203], v[72:87]
    buffer_load_dwordx4 v19, s[4:7], s72 offen lds
    ds_read_b128 a[232:235], v26 offset:0
    ds_read_b64_tr_b16 a[228:229], v29 offset:8192
    v_mfma_f32_16x16x32_bf16 v[104:107], a[192:195], v[36:39], v[104:107]
    s_add_u32 m0, s97, 84992
    ds_read_b64_tr_b16 a[230:231], v29 offset:9216
    s_waitcnt lgkmcnt(11)
    v_mfma_f32_32x32x16_bf16 v[56:71], a[192:195], a[204:207], v[56:71]
    buffer_load_dwordx4 v23, s[8:11], s73 offen lds
    ds_read_b128 a[236:239], v26 offset:4096
    ds_read_b64_tr_b16 a[240:241], v28 offset:12288
    v_mfma_f32_32x32x16_bf16 v[88:103], a[196:199], a[204:207], v[88:103]
    s_lshl_b32 s72, s75, 7
    s_add_u32 s72, s72, s78
    s_mul_i32 s73, s75, 221184
    s_add_u32 s73, s73, s79
    s_add_u32 s75, s75, 1
    s_cmp_eq_u32 s75, 10
    s_cselect_b32 s75, 0, s75
    s_add_u32 m0, s97, 98304
    s_waitcnt lgkmcnt(10)
    v_mfma_f32_32x32x16_bf16 v[40:55], a[208:211], a[216:219], v[40:55]
    buffer_load_dwordx4 v16, s[4:7], s72 offen lds
    ds_read_b64_tr_b16 a[242:243], v28 offset:13312
    ds_read_b128 a[248:251], v27 offset:0
    s_waitcnt lgkmcnt(10)
    v_mfma_f32_32x32x16_bf16 v[72:87], a[212:215], a[216:219], v[72:87]
    ds_read_b64_tr_b16 a[244:245], v29 offset:12288
    ds_read_b64_tr_b16 a[246:247], v29 offset:13312
    ds_read_b128 a[252:255], v27 offset:4096
    v_mfma_f32_16x16x32_bf16 v[104:107], a[208:211], v[36:39], v[104:107]
    s_add_u32 m0, s97, 114688
    s_waitcnt lgkmcnt(12)
    v_mfma_f32_32x32x16_bf16 v[56:71], a[208:211], a[220:223], v[56:71]
    buffer_load_dwordx4 v20, s[8:11], s73 offen lds
    v_mfma_f32_32x32x16_bf16 v[88:103], a[212:215], a[220:223], v[88:103]
L_mk_g1_5:
    s_waitcnt vmcnt(10) lgkmcnt(0)
    s_barrier
    v_mfma_f32_32x32x16_bf16 v[40:55], a[224:227], a[232:235], v[40:55]
    s_add_u32 m0, s97, 99328
    ds_read_b64_tr_b16 a[192:193], v28 offset:32768
    ds_read_b64_tr_b16 a[194:195], v28 offset:33792
    v_mfma_f32_32x32x16_bf16 v[72:87], a[228:231], a[232:235], v[72:87]
    buffer_load_dwordx4 v17, s[4:7], s72 offen lds
    ds_read_b128 a[200:203], v24 offset:32768
    ds_read_b64_tr_b16 a[196:197], v29 offset:32768
    v_mfma_f32_16x16x32_bf16 v[104:107], a[224:227], v[36:39], v[104:107]
    ds_read_b64_tr_b16 a[198:199], v29 offset:33792
    ds_read_b128 a[204:207], v24 offset:36864
    v_mfma_f32_32x32x16_bf16 v[56:71], a[224:227], a[236:239], v[56:71]
    s_add_u32 m0, s97, 115712
    ds_read_b64_tr_b16 a[208:209], v28 offset:36864
    ds_read_b64_tr_b16 a[210:211], v28 offset:37888
    v_mfma_f32_32x32x16_bf16 v[88:103], a[228:231], a[236:239], v[88:103]
    buffer_load_dwordx4 v21, s[8:11], s73 offen lds
    ds_read_b128 a[216:219], v25 offset:32768
    ds_read_b64_tr_b16 a[212:213], v29 offset:36864
    v_mfma_f32_32x32x16_bf16 v[40:55], a[240:243], a[248:251], v[40:55]
    s_add_u32 m0, s97, 100352
    ds_read_b64_tr_b16 a[214:215], v29 offset:37888
    ds_read_b128 a[220:223], v25 offset:36864
    v_mfma_f32_32x32x16_bf16 v[72:87], a[244:247], a[248:251], v[72:87]
    buffer_load_dwordx4 v18, s[4:7], s72 offen lds
    v_mfma_f32_16x16x32_bf16 v[104:107], a[240:243], v[36:39], v[104:107]
    v_mfma_f32_32x32x16_bf16 v[56:71], a[240:243], a[252:255], v[56:71]
    s_add_u32 m0, s97, 116736
    v_mfma_f32_32x32x16_bf16 v[88:103], a[244:247], a[252:255], v[88:103]
    buffer_load_dwordx4 v22, s[8:11], s73 offen lds
    s_waitcnt lgkmcnt(9)
    v_mfma_f32_32x32x16_bf16 v[40:55], a[192:195], a[200:203], v[40:55]
    s_add_u32 m0, s97, 101376
    ds_read_b64_tr_b16 a[224:225], v28 offset:40960
    ds_read_b64_tr_b16 a[226:227], v28 offset:41984
    s_waitcnt lgkmcnt(9)
    v_mfma_f32_32x32x16_bf16 v[72:87], a[196:199], a[200:203], v[72:87]
    buffer_load_dwordx4 v19, s[4:7], s72 offen lds
    ds_read_b128 a[232:235], v26 offset:32768
    ds_read_b64_tr_b16 a[228:229], v29 offset:40960
    v_mfma_f32_16x16x32_bf16 v[104:107], a[192:195], v[36:39], v[104:107]
    s_add_u32 m0, s97, 117760
    ds_read_b64_tr_b16 a[230:231], v29 offset:41984
    s_waitcnt lgkmcnt(11)
    v_mfma_f32_32x32x16_bf16 v[56:71], a[192:195], a[204:207], v[56:71]
    buffer_load_dwordx4 v23, s[8:11], s73 offen lds
    ds_read_b128 a[236:239], v26 offset:36864
    ds_read_b64_tr_b16 a[240:241], v28 offset:45056
    v_mfma_f32_32x32x16_bf16 v[88:103], a[196:199], a[204:207], v[88:103]
    s_lshl_b32 s72, s75, 7
    s_add_u32 s72, s72, s78
    s_mul_i32 s73, s75, 221184
    s_add_u32 s73, s73, s79
    s_add_u32 s75, s75, 1
    s_cmp_eq_u32 s75, 10
    s_cselect_b32 s75, 0, s75
    s_add_u32 m0, s97, 0
    s_waitcnt lgkmcnt(10)
    v_mfma_f32_32x32x16_bf16 v[40:55], a[208:211], a[216:219], v[40:55]
    buffer_load_dwordx4 v16, s[4:7], s72 offen lds
    ds_read_b64_tr_b16 a[242:243], v28 offset:46080
    ds_read_b128 a[248:251], v27 offset:32768
    s_waitcnt lgkmcnt(10)
    v_mfma_f32_32x32x16_bf16 v[72:87], a[212:215], a[216:219], v[72:87]
    ds_read_b64_tr_b16 a[244:245], v29 offset:45056
    ds_read_b64_tr_b16 a[246:247], v29 offset:46080
    ds_read_b128 a[252:255], v27 offset:36864
    v_mfma_f32_16x16x32_bf16 v[104:107], a[208:211], v[36:39], v[104:107]
    s_add_u32 m0, s97, 16384
    s_waitcnt lgkmcnt(12)
    v_mfma_f32_32x32x16_bf16 v[56:71], a[208:211], a[220:223], v[56:71]
    buffer_load_dwordx4 v20, s[8:11], s73 offen lds
    v_mfma_f32_32x32x16_bf16 v[88:103], a[212:215], a[220:223], v[88:103]
L_mk_g1_6:
    s_waitcnt vmcnt(10) lgkmcnt(0)
    s_barrier
    v_mfma_f32_32x32x16_bf16 v[40:55], a[224:227], a[232:235], v[40:55]
    s_add_u32 m0, s97, 1024
    ds_read_b64_tr_b16 a[192:193], v34 offset:0
    ds_read_b64_tr_b16 a[194:195], v34 offset:1024
    v_mfma_f32_32x32x16_bf16 v[72:87], a[228:231], a[232:235], v[72:87]
    buffer_load_dwordx4 v17, s[4:7], s72 offen lds
    ds_read_b128 a[200:203], v30 offset:0
    ds_read_b64_tr_b16 a[196:197], v35 offset:0
    v_mfma_f32_16x16x32_bf16 v[104:107], a[224:227], v[36:39], v[104:107]
    ds_read_b64_tr_b16 a[198:199], v35 offset:1024
    ds_read_b128 a[204:207], v30 offset:4096
    v_mfma_f32_32x32x16_bf16 v[56:71], a[224:227], a[236:239], v[56:71]
    s_add_u32 m0, s97, 17408
    ds_read_b64_tr_b16 a[208:209], v34 offset:4096
    ds_read_b64_tr_b16 a[210:211], v34 offset:5120
    v_mfma_f32_32x32x16_bf16 v[88:103], a[228:231], a[236:239], v[88:103]
    buffer_load_dwordx4 v21, s[8:11], s73 offen lds
    ds_read_b128 a[216:219], v31 offset:0
    ds_read_b64_tr_b16 a[212:213], v35 offset:4096
    v_mfma_f32_32x32x16_bf16 v[40:55], a[240:243], a[248:251], v[40:55]
    s_add_u32 m0, s97, 2048
    ds_read_b64_tr_b16 a[214:215], v35 offset:5120
    ds_read_b128 a[220:223], v31 offset:4096
    v_mfma_f32_32x32x16_bf16 v[72:87], a[244:247], a[248:251], v[72:87]
    buffer_load_dwordx4 v18, s[4:7], s72 offen lds
    v_mfma_f32_16x16x32_bf16 v[104:107], a[240:243], v[36:39], v[104:107]
    v_mfma_f32_32x32x16_bf16 v[56:71], a[240:243], a[252:255], v[56:71]
    s_add_u32 m0, s97, 18432
    v_mfma_f32_32x32x16_bf16 v[88:103], a[244:247], a[252:255], v[88:103]
    buffer_load_dwordx4 v22, s[8:11], s73 offen lds
    s_waitcnt lgkmcnt(9)
    v_mfma_f32_32x32x16_bf16 v[40:55], a[192:195], a[200:203], v[40:55]
    s_add_u32 m0, s97, 3072
    s_lshl_b32 s74, s28, 13
    s_add_u32 s74, s74, 131072
    v_lshl_add_u32 v213, v0, 7, s74
    buffer_load_dword v212, v213, s[12:15], 0 offen sc1
    s_waitcnt lgkmcnt(7)
    v_mfma_f32_32x32x16_bf16 v[72:87], a[196:199], a[200:203], v[72:87]
    buffer_load_dwordx4 v19, s[4:7], s72 offen lds
    ds_read_b64_tr_b16 a[224:225], v34 offset:8192
    ds_read_b64_tr_b16 a[226:227], v34 offset:9216
    v_mfma_f32_16x16x32_bf16 v[104:107], a[192:195], v[36:39], v[104:107]
    s_add_u32 m0, s97, 19456
    ds_read_b128 a[232:235], v32 offset:0
    s_waitcnt lgkmcnt(9)
    v_mfma_f32_32x32x16_bf16 v[56:71], a[192:195], a[204:207], v[56:71]
    buffer_load_dwordx4 v23, s[8:11], s73 offen lds
    ds_read_b64_tr_b16 a[228:229], v35 offset:8192
    ds_read_b64_tr_b16 a[230:231], v35 offset:9216
    v_mfma_f32_32x32x16_bf16 v[88:103], a[196:199], a[204:207], v[88:103]
    s_lshl_b32 s72, s75, 7
    s_add_u32 s72, s72, s78
    s_mul_i32 s73, s75, 221184
    s_add_u32 s73, s73, s79
    s_add_u32 s75, s75, 1
    s_cmp_eq_u32 s75, 10
    s_cselect_b32 s75, 0, s75
    s_add_u32 m0, s97, 32768
    s_waitcnt lgkmcnt(8)
    v_mfma_f32_32x32x16_bf16 v[40:55], a[208:211], a[216:219], v[40:55]
    buffer_load_dwordx4 v16, s[4:7], s72 offen lds
    ds_read_b128 a[236:239], v32 offset:4096
    ds_read_b64_tr_b16 a[240:241], v34 offset:12288
    s_waitcnt lgkmcnt(8)
    v_mfma_f32_32x32x16_bf16 v[72:87], a[212:215], a[216:219], v[72:87]
    ds_read_b64_tr_b16 a[242:243], v34 offset:13312
    ds_read_b128 a[248:251], v33 offset:0
    ds_read_b64_tr_b16 a[244:245], v35 offset:12288
    v_mfma_f32_16x16x32_bf16 v[104:107], a[208:211], v[36:39], v[104:107]
    s_add_u32 m0, s97, 49152
    ds_read_b64_tr_b16 a[246:247], v35 offset:13312
    s_waitcnt lgkmcnt(11)
    v_mfma_f32_32x32x16_bf16 v[56:71], a[208:211], a[220:223], v[56:71]
    buffer_load_dwordx4 v20, s[8:11], s73 offen lds
    ds_read_b128 a[252:255], v33 offset:4096
    v_mfma_f32_32x32x16_bf16 v[88:103], a[212:215], a[220:223], v[88:103]
L_mk_g1_7:
    s_waitcnt vmcnt(11) lgkmcnt(0)
    s_barrier
    v_mfma_f32_32x32x16_bf16 v[40:55], a[224:227], a[232:235], v[40:55]
    s_add_u32 m0, s97, 33792
    ds_read_b64_tr_b16 a[192:193], v34 offset:32768
    ds_read_b64_tr_b16 a[194:195], v34 offset:33792
    v_mfma_f32_32x32x16_bf16 v[72:87], a[228:231], a[232:235], v[72:87]
    buffer_load_dwordx4 v17, s[4:7], s72 offen lds
    ds_read_b128 a[200:203], v30 offset:32768
    ds_read_b64_tr_b16 a[196:197], v35 offset:32768
    v_mfma_f32_16x16x32_bf16 v[104:107], a[224:227], v[36:39], v[104:107]
    ds_read_b64_tr_b16 a[198:199], v35 offset:33792
    ds_read_b128 a[204:207], v30 offset:36864
    v_mfma_f32_32x32x16_bf16 v[56:71], a[224:227], a[236:239], v[56:71]
    s_add_u32 m0, s97, 50176
    ds_read_b64_tr_b16 a[208:209], v34 offset:36864
    ds_read_b64_tr_b16 a[210:211], v34 offset:37888
    v_mfma_f32_32x32x16_bf16 v[88:103], a[228:231], a[236:239], v[88:103]
    buffer_load_dwordx4 v21, s[8:11], s73 offen lds
    ds_read_b128 a[216:219], v31 offset:32768
    ds_read_b64_tr_b16 a[212:213], v35 offset:36864
    v_mfma_f32_32x32x16_bf16 v[40:55], a[240:243], a[248:251], v[40:55]
    ds_read_b64_tr_b16 a[214:215], v35 offset:37888
    ds_read_b128 a[220:223], v31 offset:36864
    v_mfma_f32_32x32x16_bf16 v[72:87], a[244:247], a[248:251], v[72:87]
    v_mfma_f32_16x16x32_bf16 v[104:107], a[240:243], v[36:39], v[104:107]
    s_add_u32 m0, s97, 34816
    v_mfma_f32_32x32x16_bf16 v[56:71], a[240:243], a[252:255], v[56:71]
    buffer_load_dwordx4 v18, s[4:7], s72 offen lds
    v_mfma_f32_32x32x16_bf16 v[88:103], a[244:247], a[252:255], v[88:103]
    s_waitcnt lgkmcnt(9)
    v_mfma_f32_32x32x16_bf16 v[40:55], a[192:195], a[200:203], v[40:55]
    s_add_u32 m0, s97, 51200
    ds_read_b64_tr_b16 a[224:225], v34 offset:40960
    ds_read_b64_tr_b16 a[226:227], v34 offset:41984
    s_waitcnt lgkmcnt(9)
    v_mfma_f32_32x32x16_bf16 v[72:87], a[196:199], a[200:203], v[72:87]
    buffer_load_dwordx4 v22, s[8:11], s73 offen lds
    ds_read_b128 a[232:235], v32 offset:32768
    ds_read_b64_tr_b16 a[228:229], v35 offset:40960
    v_mfma_f32_16x16x32_bf16 v[104:107], a[192:195], v[36:39], v[104:107]
    ds_read_b64_tr_b16 a[230:231], v35 offset:41984
    ds_read_b128 a[236:239], v32 offset:36864
    s_waitcnt lgkmcnt(12)
    v_mfma_f32_32x32x16_bf16 v[56:71], a[192:195], a[204:207], v[56:71]
    s_add_u32 m0, s97, 35840
    ds_read_b64_tr_b16 a[240:241], v34 offset:45056
    ds_read_b64_tr_b16 a[242:243], v34 offset:46080
    v_mfma_f32_32x32x16_bf16 v[88:103], a[196:199], a[204:207], v[88:103]
    buffer_load_dwordx4 v19, s[4:7], s72 offen lds
    ds_read_b128 a[248:251], v33 offset:32768
    ds_read_b64_tr_b16 a[244:245], v35 offset:45056
    s_waitcnt lgkmcnt(13)
    v_mfma_f32_32x32x16_bf16 v[40:55], a[208:211], a[216:219], v[40:55]
    s_add_u32 m0, s97, 52224
    ds_read_b64_tr_b16 a[246:247], v35 offset:46080
    ds_read_b128 a[252:255], v33 offset:36864
    s_waitcnt lgkmcnt(13)
    v_mfma_f32_32x32x16_bf16 v[72:87], a[212:215], a[216:219], v[72:87]
    buffer_load_dwordx4 v23, s[8:11], s73 offen lds
    v_mfma_f32_16x16x32_bf16 v[104:107], a[208:211], v[36:39], v[104:107]
    s_waitcnt lgkmcnt(12)
    v_mfma_f32_32x32x16_bf16 v[56:71], a[208:211], a[220:223], v[56:71]
    v_mfma_f32_32x32x16_bf16 v[88:103], a[212:215], a[220:223], v[88:103]
    s_waitcnt vmcnt(10)
    v_and_b32 v212, 1, v212
    v_cmp_ne_u32 vcc, 1, v212
    s_cbranch_vccz L_faall_ok_4
    s_mov_b32 s74, 20000
L_faall_spin_5:
    s_mov_b64 exec, vcc
    s_sleep 2
    buffer_load_dword v212, v213, s[12:15], 0 offen sc1
    s_waitcnt vmcnt(0)
    v_and_b32 v212, 1, v212
    v_cmp_ne_u32 vcc, 1, v212
    s_mov_b64 exec, -1
    s_cbranch_vccz L_faall_ok_4
    s_sub_u32 s74, s74, 1
    s_cmp_lg_u32 s74, 0
    s_cbranch_scc1 L_faall_spin_5
L_faall_ok_4:
L_mk_g1_8:
    s_waitcnt vmcnt(8) lgkmcnt(0)
    s_barrier
    v_mfma_f32_32x32x16_bf16 v[40:55], a[224:227], a[232:235], v[40:55]
    buffer_load_dwordx2 v[232:233], v251, s[12:15], s39 offen offset:0 sc1
    ds_read_b64_tr_b16 a[192:193], v28 offset:0
    ds_read_b64_tr_b16 a[194:195], v28 offset:1024
    v_mfma_f32_32x32x16_bf16 v[72:87], a[228:231], a[232:235], v[72:87]
    buffer_load_dwordx2 v[234:235], v251, s[12:15], s39 offen offset:256 sc1
    ds_read_b128 a[200:203], v24 offset:0
    ds_read_b64_tr_b16 a[196:197], v29 offset:0
    v_mfma_f32_16x16x32_bf16 v[104:107], a[224:227], v[36:39], v[104:107]
    ds_read_b64_tr_b16 a[198:199], v29 offset:1024
    ds_read_b128 a[204:207], v24 offset:4096
    v_mfma_f32_32x32x16_bf16 v[56:71], a[224:227], a[236:239], v[56:71]
    s_mul_i32 s76, s80, 5
    buffer_load_dwordx4 a[0:3], v220, s[20:23], s76 offen offset:0 sc1
    ds_read_b64_tr_b16 a[208:209], v28 offset:4096
    v_mfma_f32_32x32x16_bf16 v[88:103], a[228:231], a[236:239], v[88:103]
    buffer_load_dwordx4 a[4:7], v220, s[20:23], s76 offen offset:1024 sc1
    ds_read_b64_tr_b16 a[210:211], v28 offset:5120
    ds_read_b128 a[216:219], v25 offset:0
    v_mfma_f32_32x32x16_bf16 v[40:55], a[240:243], a[248:251], v[40:55]
    buffer_load_dwordx4 a[8:11], v220, s[20:23], s76 offen offset:2048 sc1
    ds_read_b64_tr_b16 a[212:213], v29 offset:4096
    ds_read_b64_tr_b16 a[214:215], v29 offset:5120
    v_mfma_f32_32x32x16_bf16 v[72:87], a[244:247], a[248:251], v[72:87]
    buffer_load_dwordx4 a[12:15], v220, s[20:23], s76 offen offset:3072 sc1
    ds_read_b128 a[220:223], v25 offset:4096
    v_mfma_f32_16x16x32_bf16 v[104:107], a[240:243], v[36:39], v[104:107]
    v_mfma_f32_32x32x16_bf16 v[56:71], a[240:243], a[252:255], v[56:71]
    buffer_load_dwordx4 a[16:19], v221, s[20:23], s76 offen offset:0 sc1
    v_mfma_f32_32x32x16_bf16 v[88:103], a[244:247], a[252:255], v[88:103]
    s_waitcnt lgkmcnt(9)
    v_mfma_f32_32x32x16_bf16 v[40:55], a[192:195], a[200:203], v[40:55]
    s_mul_i32 s77, s81, 5
    buffer_load_dwordx4 a[20:23], v220, s[20:23], s77 offen offset:0 sc1
    ds_read_b64_tr_b16 a[224:225], v28 offset:8192
    s_waitcnt lgkmcnt(8)
    v_mfma_f32_32x32x16_bf16 v[72:87], a[196:199], a[200:203], v[72:87]
    buffer_load_dwordx4 a[24:27], v220, s[20:23], s77 offen offset:1024 sc1
    ds_read_b64_tr_b16 a[226:227], v28 offset:9216
    ds_read_b128 a[232:235], v26 offset:0
    v_mfma_f32_16x16x32_bf16 v[104:107], a[192:195], v[36:39], v[104:107]
    ds_read_b64_tr_b16 a[228:229], v29 offset:8192
    ds_read_b64_tr_b16 a[230:231], v29 offset:9216
    s_waitcnt lgkmcnt(11)
    v_mfma_f32_32x32x16_bf16 v[56:71], a[192:195], a[204:207], v[56:71]
    buffer_load_dwordx4 a[28:31], v220, s[20:23], s77 offen offset:2048 sc1
    ds_read_b128 a[236:239], v26 offset:4096
    ds_read_b64_tr_b16 a[240:241], v28 offset:12288
    v_mfma_f32_32x32x16_bf16 v[88:103], a[196:199], a[204:207], v[88:103]
    ds_read_b64_tr_b16 a[242:243], v28 offset:13312
    ds_read_b128 a[248:251], v27 offset:0
    ds_read_b64_tr_b16 a[244:245], v29 offset:12288
    s_waitcnt lgkmcnt(13)
    v_mfma_f32_32x32x16_bf16 v[40:55], a[208:211], a[216:219], v[40:55]
    buffer_load_dwordx4 a[32:35], v220, s[20:23], s77 offen offset:3072 sc1
    ds_read_b64_tr_b16 a[246:247], v29 offset:13312
    ds_read_b128 a[252:255], v27 offset:4096
    s_waitcnt lgkmcnt(13)
    v_mfma_f32_32x32x16_bf16 v[72:87], a[212:215], a[216:219], v[72:87]
    buffer_load_dwordx4 a[36:39], v221, s[20:23], s77 offen offset:0 sc1
    v_mfma_f32_16x16x32_bf16 v[104:107], a[208:211], v[36:39], v[104:107]
    s_waitcnt lgkmcnt(12)
    v_mfma_f32_32x32x16_bf16 v[56:71], a[208:211], a[220:223], v[56:71]
    v_mfma_f32_32x32x16_bf16 v[88:103], a[212:215], a[220:223], v[88:103]
L_mk_g1_9:
    s_waitcnt vmcnt(12) lgkmcnt(0)
    s_barrier
    v_mfma_f32_32x32x16_bf16 v[40:55], a[224:227], a[232:235], v[40:55]
    s_mul_i32 s76, s82, 5
    buffer_load_dwordx4 a[40:43], v220, s[20:23], s76 offen offset:0 sc1
    ds_read_b64_tr_b16 a[192:193], v28 offset:32768
    v_mfma_f32_32x32x16_bf16 v[72:87], a[228:231], a[232:235], v[72:87]
    buffer_load_dwordx4 a[44:47], v220, s[20:23], s76 offen offset:1024 sc1
    ds_read_b64_tr_b16 a[194:195], v28 offset:33792
    ds_read_b128 a[200:203], v24 offset:32768
    v_mfma_f32_16x16x32_bf16 v[104:107], a[224:227], v[36:39], v[104:107]
    ds_read_b64_tr_b16 a[196:197], v29 offset:32768
    ds_read_b64_tr_b16 a[198:199], v29 offset:33792
    v_mfma_f32_32x32x16_bf16 v[56:71], a[224:227], a[236:239], v[56:71]
    ds_read_b128 a[204:207], v24 offset:36864
    ds_read_b64_tr_b16 a[208:209], v28 offset:36864
    ds_read_b64_tr_b16 a[210:211], v28 offset:37888
    v_mfma_f32_32x32x16_bf16 v[88:103], a[228:231], a[236:239], v[88:103]
    buffer_load_dwordx4 a[48:51], v220, s[20:23], s76 offen offset:2048 sc1
    ds_read_b128 a[216:219], v25 offset:32768
    ds_read_b64_tr_b16 a[212:213], v29 offset:36864
    v_mfma_f32_32x32x16_bf16 v[40:55], a[240:243], a[248:251], v[40:55]
    buffer_load_dwordx4 a[52:55], v220, s[20:23], s76 offen offset:3072 sc1
    ds_read_b64_tr_b16 a[214:215], v29 offset:37888
    ds_read_b128 a[220:223], v25 offset:36864
    v_mfma_f32_32x32x16_bf16 v[72:87], a[244:247], a[248:251], v[72:87]
    s_mul_i32 s68, s53, 31008
    s_lshl_b32 s69, s52, 8
    s_add_u32 s68, s68, s69
    s_add_u32 m0, s68, 32768
    v_lshlrev_b32 v14, 16, v252
    v_mfma_f32_16x16x32_bf16 v[104:107], a[240:243], v[36:39], v[104:107]
    v_and_b32 v15, 0xffff0000, v252
    ds_write_b64 v248, v[14:15]
    v_mfma_f32_32x32x16_bf16 v[56:71], a[240:243], a[252:255], v[56:71]
    buffer_load_dwordx4 a[56:59], v221, s[20:23], s76 offen offset:0 sc1
    ds_write_addtid_b32 v108 offset:32768
    ds_write_addtid_b32 v109 offset:33312
    ds_write_addtid_b32 v110 offset:33856
    ds_write_addtid_b32 v111 offset:34400
    v_mfma_f32_32x32x16_bf16 v[88:103], a[244:247], a[252:255], v[88:103]
    ds_write_addtid_b32 v112 offset:34944
    ds_write_addtid_b32 v113 offset:35488
    ds_write_addtid_b32 v114 offset:36032
    ds_write_addtid_b32 v115 offset:36576
    ds_write_addtid_b32 v116 offset:37120
    s_waitcnt lgkmcnt(15)
    v_mfma_f32_32x32x16_bf16 v[40:55], a[192:195], a[200:203], v[40:55]
    s_mul_i32 s77, s83, 5
    buffer_load_dwordx4 a[60:63], v220, s[20:23], s77 offen offset:0 sc1
    ds_read_b64_tr_b16 a[224:225], v28 offset:40960
    ds_write_addtid_b32 v117 offset:37664
    ds_write_addtid_b32 v118 offset:38208
    v_mfma_f32_32x32x16_bf16 v[72:87], a[196:199], a[200:203], v[72:87]
    buffer_load_dwordx4 a[64:67], v220, s[20:23], s77 offen offset:1024 sc1
    ds_read_b64_tr_b16 a[226:227], v28 offset:41984
    ds_read_b128 a[232:235], v26 offset:32768
    ds_write_addtid_b32 v119 offset:38752
    ds_write_addtid_b32 v120 offset:39296
    v_mfma_f32_16x16x32_bf16 v[104:107], a[192:195], v[36:39], v[104:107]
    ds_read_b64_tr_b16 a[228:229], v29 offset:40960
    ds_read_b64_tr_b16 a[230:231], v29 offset:41984
    v_mfma_f32_32x32x16_bf16 v[56:71], a[192:195], a[204:207], v[56:71]
    buffer_load_dwordx4 a[68:71], v220, s[20:23], s77 offen offset:2048 sc1
    ds_read_b128 a[236:239], v26 offset:36864
    ds_read_b64_tr_b16 a[240:241], v28 offset:45056
    ds_write_addtid_b32 v121 offset:39840
    ds_write_addtid_b32 v122 offset:40384
    v_mfma_f32_32x32x16_bf16 v[88:103], a[196:199], a[204:207], v[88:103]
    ds_read_b64_tr_b16 a[242:243], v28 offset:46080
    ds_read_b128 a[248:251], v27 offset:32768
    ds_read_b64_tr_b16 a[244:245], v29 offset:45056
    ds_write_addtid_b32 v123 offset:40928
    ds_write_addtid_b32 v124 offset:41472
    s_waitcnt lgkmcnt(15)
    v_mfma_f32_32x32x16_bf16 v[40:55], a[208:211], a[216:219], v[40:55]
    buffer_load_dwordx4 a[72:75], v220, s[20:23], s77 offen offset:3072 sc1
    ds_read_b64_tr_b16 a[246:247], v29 offset:46080
    ds_read_b128 a[252:255], v27 offset:36864
    ds_write_addtid_b32 v125 offset:42016
    ds_write_addtid_b32 v126 offset:42560
    v_mfma_f32_32x32x16_bf16 v[72:87], a[212:215], a[216:219], v[72:87]
    buffer_load_dwordx4 a[76:79], v221, s[20:23], s77 offen offset:0 sc1
    ds_write_addtid_b32 v127 offset:43104
    ds_write_addtid_b32 v128 offset:43648
    ds_write_addtid_b32 v129 offset:44192
    ds_write_addtid_b32 v130 offset:44736
    v_mfma_f32_16x16x32_bf16 v[104:107], a[208:211], v[36:39], v[104:107]
    ds_write_addtid_b32 v131 offset:45280
    ds_write_addtid_b32 v132 offset:45824
    v_mfma_f32_32x32x16_bf16 v[56:71], a[208:211], a[220:223], v[56:71]
    ds_write_addtid_b32 v133 offset:46368
    ds_write_addtid_b32 v134 offset:46912
    ds_write_addtid_b32 v135 offset:47456
    ds_write_addtid_b32 v136 offset:48000
    ds_write_addtid_b32 v137 offset:48544
    v_mfma_f32_32x32x16_bf16 v[88:103], a[212:215], a[220:223], v[88:103]
    s_waitcnt lgkmcnt(15)
    v_mfma_f32_32x32x16_bf16 v[40:55], a[224:227], a[232:235], v[40:55]
    s_mul_i32 s76, s84, 5
    buffer_load_dwordx4 a[80:83], v220, s[20:23], s76 offen offset:0 sc1
    ds_write_addtid_b32 v138 offset:49088
    ds_write_addtid_b32 v139 offset:49632
    ds_write_addtid_b32 v140 offset:50176
    v_mfma_f32_32x32x16_bf16 v[72:87], a[228:231], a[232:235], v[72:87]
    buffer_load_dwordx4 a[84:87], v220, s[20:23], s76 offen offset:1024 sc1
    ds_write_addtid_b32 v141 offset:50720
    ds_write_addtid_b32 v142 offset:51264
    ds_write_addtid_b32 v143 offset:51808
    ds_write_addtid_b32 v144 offset:52352
    v_mfma_f32_16x16x32_bf16 v[104:107], a[224:227], v[36:39], v[104:107]
    ds_write_addtid_b32 v145 offset:52896
    ds_write_addtid_b32 v146 offset:53440
    v_mfma_f32_32x32x16_bf16 v[56:71], a[224:227], a[236:239], v[56:71]
    ds_write_addtid_b32 v147 offset:53984
    ds_write_addtid_b32 v148 offset:54528
    ds_write_addtid_b32 v149 offset:55072
    ds_write_addtid_b32 v150 offset:55616
    ds_write_addtid_b32 v151 offset:56160
    v_mfma_f32_32x32x16_bf16 v[88:103], a[228:231], a[236:239], v[88:103]
    buffer_load_dwordx4 a[88:91], v220, s[20:23], s76 offen offset:2048 sc1
    ds_write_addtid_b32 v152 offset:56704
    ds_write_addtid_b32 v153 offset:57248
    ds_write_addtid_b32 v154 offset:57792
    ds_write_addtid_b32 v155 offset:58336
    v_mfma_f32_32x32x16_bf16 v[40:55], a[240:243], a[248:251], v[40:55]
    buffer_load_dwordx4 a[92:95], v220, s[20:23], s76 offen offset:3072 sc1
    ds_write_addtid_b32 v156 offset:58880
    ds_write_addtid_b32 v157 offset:59424
    ds_write_addtid_b32 v158 offset:59968
    ds_write_addtid_b32 v159 offset:60512
    s_waitcnt lgkmcnt(15)
    v_mfma_f32_32x32x16_bf16 v[72:87], a[244:247], a[248:251], v[72:87]
    ds_write_addtid_b32 v160 offset:61056
    ds_write_addtid_b32 v161 offset:61600
    ds_write_addtid_b32 v162 offset:62144
    ds_write_addtid_b32 v163 offset:62688
    ds_write_addtid_b32 v164 offset:63232
    v_mfma_f32_16x16x32_bf16 v[104:107], a[240:243], v[36:39], v[104:107]
    v_mfma_f32_32x32x16_bf16 v[56:71], a[240:243], a[252:255], v[56:71]
    buffer_load_dwordx4 a[96:99], v221, s[20:23], s76 offen offset:0 sc1
    v_mfma_f32_32x32x16_bf16 v[88:103], a[244:247], a[252:255], v[88:103]
L_mk_gelu:
    s_mov_b32 exec_lo, 0x30003
    s_mov_b32 exec_hi, 0x30003
    s_nop 2
    ds_write_b128 v249, v[104:107] offset:512
    s_mov_b64 exec, -1
    ds_read_b128 v[108:111], v250 offset:0
    ds_read_b128 v[124:127], v250 offset:512
    ds_read_b128 v[112:115], v250 offset:32
    ds_read_b128 v[128:131], v250 offset:544
    ds_read_b128 v[116:119], v250 offset:64
    ds_read_b128 v[132:135], v250 offset:576
    ds_read_b128 v[120:123], v250 offset:96
    ds_read_b128 v[136:139], v250 offset:608
    v_mov_b32 v172, 0xbdd2d3e8
    v_mov_b32 v173, 0xc0135761
    v_xor_b32 v250, 128, v250
    s_waitcnt vmcnt(26) lgkmcnt(6)
    v_pk_fma_f32 v[16:17], v[124:125], v[232:233], v[108:109] op_sel:[0,1,0] op_sel_hi:[1,1,1] neg_lo:[0,1,0] neg_hi:[0,1,0]
    v_pk_fma_f32 v[18:19], v[126:127], v[232:233], v[110:111] op_sel:[0,1,0] op_sel_hi:[1,1,1] neg_lo:[0,1,0] neg_hi:[0,1,0]
    s_waitcnt lgkmcnt(4)
    v_pk_fma_f32 v[20:21], v[128:129], v[232:233], v[112:113] op_sel:[0,1,0] op_sel_hi:[1,1,1] neg_lo:[0,1,0] neg_hi:[0,1,0]
    v_pk_fma_f32 v[22:23], v[130:131], v[232:233], v[114:115] op_sel:[0,1,0] op_sel_hi:[1,1,1] neg_lo:[0,1,0] neg_hi:[0,1,0]
    v_pk_fma_f32 v[16:17], v[40:41], v[232:233], v[16:17] op_sel_hi:[1,0,1]
    v_pk_fma_f32 v[18:19], v[42:43], v[232:233], v[18:19] op_sel_hi:[1,0,1]
    v_pk_fma_f32 v[20:21], v[44:45], v[232:233], v[20:21] op_sel_hi:[1,0,1]
    v_pk_fma_f32 v[22:23], v[46:47], v[232:233], v[22:23] op_sel_hi:[1,0,1]
    v_pk_mul_f32 v[24:25], v[16:17], v[16:17]
    v_pk_mul_f32 v[26:27], v[18:19], v[18:19]
    v_pk_mul_f32 v[28:29], v[20:21], v[20:21]
    v_pk_mul_f32 v[30:31], v[22:23], v[22:23]
    v_pk_fma_f32 v[24:25], v[24:25], v[172:173], v[172:173] op_sel:[0,0,1] op_sel_hi:[1,0,1]
    v_pk_fma_f32 v[26:27], v[26:27], v[172:173], v[172:173] op_sel:[0,0,1] op_sel_hi:[1,0,1]
    v_pk_fma_f32 v[28:29], v[28:29], v[172:173], v[172:173] op_sel:[0,0,1] op_sel_hi:[1,0,1]
    v_pk_fma_f32 v[30:31], v[30:31], v[172:173], v[172:173] op_sel:[0,0,1] op_sel_hi:[1,0,1]
    v_pk_mul_f32 v[24:25], v[24:25], v[16:17]
    v_pk_mul_f32 v[26:27], v[26:27], v[18:19]
    v_pk_mul_f32 v[28:29], v[28:29], v[20:21]
    v_pk_mul_f32 v[30:31], v[30:31], v[22:23]
    v_exp_f32 v24, v24
    v_exp_f32 v25, v25
    v_exp_f32 v26, v26
    v_exp_f32 v27, v27
    v_exp_f32 v28, v28
    v_exp_f32 v29, v29
    v_exp_f32 v30, v30
    v_exp_f32 v31, v31
    v_pk_add_f32 v[24:25], v[24:25], 1.0 op_sel_hi:[1,0]
    v_pk_add_f32 v[26:27], v[26:27], 1.0 op_sel_hi:[1,0]
    v_pk_add_f32 v[28:29], v[28:29], 1.0 op_sel_hi:[1,0]
    v_pk_add_f32 v[30:31], v[30:31], 1.0 op_sel_hi:[1,0]
    v_rcp_f32 v24, v24
    v_rcp_f32 v25, v25
    v_rcp_f32 v26, v26
    v_rcp_f32 v27, v27
    v_rcp_f32 v28, v28
    v_rcp_f32 v29, v29
    v_rcp_f32 v30, v30
    v_rcp_f32 v31, v31
    v_pk_mul_f32 v[24:25], v[24:25], v[16:17]
    v_pk_mul_f32 v[26:27], v[26:27], v[18:19]
    v_pk_mul_f32 v[28:29], v[28:29], v[20:21]
    v_pk_mul_f32 v[30:31], v[30:31], v[22:23]
    v_cvt_pk_bf16_f32 v32, v24, v25
    v_cvt_pk_bf16_f32 v33, v26, v27
    v_cvt_pk_bf16_f32 v34, v28, v29
    v_cvt_pk_bf16_f32 v35, v30, v31
    buffer_store_dwordx4 v[32:35], v247, s[16:19], s36 offen offset:0 sc1
    s_waitcnt lgkmcnt(0)
    s_barrier
    ds_read_b128 v[140:143], v250 offset:0
    ds_read_b128 v[156:159], v250 offset:512
    ds_read_b128 v[144:147], v250 offset:32
    ds_read_b128 v[160:163], v250 offset:544
    ds_read_b128 v[148:151], v250 offset:64
    ds_read_b128 v[164:167], v250 offset:576
    ds_read_b128 v[152:155], v250 offset:96
    ds_read_b128 v[168:171], v250 offset:608
    v_pk_fma_f32 v[16:17], v[132:133], v[232:233], v[116:117] op_sel:[0,1,0] op_sel_hi:[1,1,1] neg_lo:[0,1,0] neg_hi:[0,1,0]
    v_pk_fma_f32 v[18:19], v[134:135], v[232:233], v[118:119] op_sel:[0,1,0] op_sel_hi:[1,1,1] neg_lo:[0,1,0] neg_hi:[0,1,0]
    v_pk_fma_f32 v[20:21], v[136:137], v[232:233], v[120:121] op_sel:[0,1,0] op_sel_hi:[1,1,1] neg_lo:[0,1,0] neg_hi:[0,1,0]
    v_pk_fma_f32 v[22:23], v[138:139], v[232:233], v[122:123] op_sel:[0,1,0] op_sel_hi:[1,1,1] neg_lo:[0,1,0] neg_hi:[0,1,0]
    v_pk_fma_f32 v[16:17], v[48:49], v[232:233], v[16:17] op_sel_hi:[1,0,1]
    v_pk_fma_f32 v[18:19], v[50:51], v[232:233], v[18:19] op_sel_hi:[1,0,1]
    v_pk_fma_f32 v[20:21], v[52:53], v[232:233], v[20:21] op_sel_hi:[1,0,1]
    v_pk_fma_f32 v[22:23], v[54:55], v[232:233], v[22:23] op_sel_hi:[1,0,1]
    v_pk_mul_f32 v[24:25], v[16:17], v[16:17]
    v_pk_mul_f32 v[26:27], v[18:19], v[18:19]
    v_pk_mul_f32 v[28:29], v[20:21], v[20:21]
    v_pk_mul_f32 v[30:31], v[22:23], v[22:23]
    v_pk_fma_f32 v[24:25], v[24:25], v[172:173], v[172:173] op_sel:[0,0,1] op_sel_hi:[1,0,1]
    v_pk_fma_f32 v[26:27], v[26:27], v[172:173], v[172:173] op_sel:[0,0,1] op_sel_hi:[1,0,1]
    v_pk_fma_f32 v[28:29], v[28:29], v[172:173], v[172:173] op_sel:[0,0,1] op_sel_hi:[1,0,1]
    v_pk_fma_f32 v[30:31], v[30:31], v[172:173], v[172:173] op_sel:[0,0,1] op_sel_hi:[1,0,1]
    v_pk_mul_f32 v[24:25], v[24:25], v[16:17]
    v_pk_mul_f32 v[26:27], v[26:27], v[18:19]
    v_pk_mul_f32 v[28:29], v[28:29], v[20:21]
    v_pk_mul_f32 v[30:31], v[30:31], v[22:23]
    v_exp_f32 v24, v24
    v_exp_f32 v25, v25
    v_exp_f32 v26, v26
    v_exp_f32 v27, v27
    v_exp_f32 v28, v28
    v_exp_f32 v29, v29
    v_exp_f32 v30, v30
    v_exp_f32 v31, v31
    v_pk_add_f32 v[24:25], v[24:25], 1.0 op_sel_hi:[1,0]
    v_pk_add_f32 v[26:27], v[26:27], 1.0 op_sel_hi:[1,0]
    v_pk_add_f32 v[28:29], v[28:29], 1.0 op_sel_hi:[1,0]
    v_pk_add_f32 v[30:31], v[30:31], 1.0 op_sel_hi:[1,0]
    v_rcp_f32 v24, v24
    v_rcp_f32 v25, v25
    v_rcp_f32 v26, v26
    v_rcp_f32 v27, v27
    v_rcp_f32 v28, v28
    v_rcp_f32 v29, v29
    v_rcp_f32 v30, v30
    v_rcp_f32 v31, v31
    v_pk_mul_f32 v[24:25], v[24:25], v[16:17]
    v_pk_mul_f32 v[26:27], v[26:27], v[18:19]
    v_pk_mul_f32 v[28:29], v[28:29], v[20:21]
    v_pk_mul_f32 v[30:31], v[30:31], v[22:23]
    v_cvt_pk_bf16_f32 v36, v24, v25
    v_cvt_pk_bf16_f32 v37, v26, v27
    v_cvt_pk_bf16_f32 v38, v28, v29
    v_cvt_pk_bf16_f32 v39, v30, v31
    buffer_store_dwordx4 v[36:39], v247, s[16:19], s36 offen offset:512 sc1
    s_add_u32 s36, s36, 110592
    s_waitcnt vmcnt(27)
    v_pk_fma_f32 v[16:17], v[124:125], v[234:235], v[108:109] op_sel:[0,1,0] op_sel_hi:[1,1,1] neg_lo:[0,1,0] neg_hi:[0,1,0]
    v_pk_fma_f32 v[18:19], v[126:127], v[234:235], v[110:111] op_sel:[0,1,0] op_sel_hi:[1,1,1] neg_lo:[0,1,0] neg_hi:[0,1,0]
    v_pk_fma_f32 v[20:21], v[128:129], v[234:235], v[112:113] op_sel:[0,1,0] op_sel_hi:[1,1,1] neg_lo:[0,1,0] neg_hi:[0,1,0]
    v_pk_fma_f32 v[22:23], v[130:131], v[234:235], v[114:115] op_sel:[0,1,0] op_sel_hi:[1,1,1] neg_lo:[0,1,0] neg_hi:[0,1,0]
    v_pk_fma_f32 v[16:17], v[56:57], v[234:235], v[16:17] op_sel_hi:[1,0,1]
    v_pk_fma_f32 v[18:19], v[58:59], v[234:235], v[18:19] op_sel_hi:[1,0,1]
    v_pk_fma_f32 v[20:21], v[60:61], v[234:235], v[20:21] op_sel_hi:[1,0,1]
    v_pk_fma_f32 v[22:23], v[62:63], v[234:235], v[22:23] op_sel_hi:[1,0,1]
    v_pk_mul_f32 v[24:25], v[16:17], v[16:17]
    v_pk_mul_f32 v[26:27], v[18:19], v[18:19]
    v_pk_mul_f32 v[28:29], v[20:21], v[20:21]
    v_pk_mul_f32 v[30:31], v[22:23], v[22:23]
    v_pk_fma_f32 v[24:25], v[24:25], v[172:173], v[172:173] op_sel:[0,0,1] op_sel_hi:[1,0,1]
    v_pk_fma_f32 v[26:27], v[26:27], v[172:173], v[172:173] op_sel:[0,0,1] op_sel_hi:[1,0,1]
    v_pk_fma_f32 v[28:29], v[28:29], v[172:173], v[172:173] op_sel:[0,0,1] op_sel_hi:[1,0,1]
    v_pk_fma_f32 v[30:31], v[30:31], v[172:173], v[172:173] op_sel:[0,0,1] op_sel_hi:[1,0,1]
    v_pk_mul_f32 v[24:25], v[24:25], v[16:17]
    v_pk_mul_f32 v[26:27], v[26:27], v[18:19]
    v_pk_mul_f32 v[28:29], v[28:29], v[20:21]
    v_pk_mul_f32 v[30:31], v[30:31], v[22:23]
    v_exp_f32 v24, v24
    v_exp_f32 v25, v25
    v_exp_f32 v26, v26
    v_exp_f32 v27, v27
    v_exp_f32 v28, v28
    v_exp_f32 v29, v29
    v_exp_f32 v30, v30
    v_exp_f32 v31, v31
    v_pk_add_f32 v[24:25], v[24:25], 1.0 op_sel_hi:[1,0]
    v_pk_add_f32 v[26:27], v[26:27], 1.0 op_sel_hi:[1,0]
    v_pk_add_f32 v[28:29], v[28:29], 1.0 op_sel_hi:[1,0]
    v_pk_add_f32 v[30:31], v[30:31], 1.0 op_sel_hi:[1,0]
    v_rcp_f32 v24, v24
    v_rcp_f32 v25, v25
    v_rcp_f32 v26, v26
    v_rcp_f32 v27, v27
    v_rcp_f32 v28, v28
    v_rcp_f32 v29, v29
    v_rcp_f32 v30, v30
    v_rcp_f32 v31, v31
    v_pk_mul_f32 v[24:25], v[24:25], v[16:17]
    v_pk_mul_f32 v[26:27], v[26:27], v[18:19]
    v_pk_mul_f32 v[28:29], v[28:29], v[20:21]
    v_pk_mul_f32 v[30:31], v[30:31], v[22:23]
    v_cvt_pk_bf16_f32 v32, v24, v25
    v_cvt_pk_bf16_f32 v33, v26, v27
    v_cvt_pk_bf16_f32 v34, v28, v29
    v_cvt_pk_bf16_f32 v35, v30, v31
    buffer_store_dwordx4 v[32:35], v247, s[16:19], s36 offen offset:0 sc1
    v_pk_fma_f32 v[16:17], v[132:133], v[234:235], v[116:117] op_sel:[0,1,0] op_sel_hi:[1,1,1] neg_lo:[0,1,0] neg_hi:[0,1,0]
    v_pk_fma_f32 v[18:19], v[134:135], v[234:235], v[118:119] op_sel:[0,1,0] op_sel_hi:[1,1,1] neg_lo:[0,1,0] neg_hi:[0,1,0]
    v_pk_fma_f32 v[20:21], v[136:137], v[234:235], v[120:121] op_sel:[0,1,0] op_sel_hi:[1,1,1] neg_lo:[0,1,0] neg_hi:[0,1,0]
    v_pk_fma_f32 v[22:23], v[138:139], v[234:235], v[122:123] op_sel:[0,1,0] op_sel_hi:[1,1,1] neg_lo:[0,1,0] neg_hi:[0,1,0]
    v_pk_fma_f32 v[16:17], v[64:65], v[234:235], v[16:17] op_sel_hi:[1,0,1]
    v_pk_fma_f32 v[18:19], v[66:67], v[234:235], v[18:19] op_sel_hi:[1,0,1]
    v_pk_fma_f32 v[20:21], v[68:69], v[234:235], v[20:21] op_sel_hi:[1,0,1]
    v_pk_fma_f32 v[22:23], v[70:71], v[234:235], v[22:23] op_sel_hi:[1,0,1]
    v_pk_mul_f32 v[24:25], v[16:17], v[16:17]
    v_pk_mul_f32 v[26:27], v[18:19], v[18:19]
    v_pk_mul_f32 v[28:29], v[20:21], v[20:21]
    v_pk_mul_f32 v[30:31], v[22:23], v[22:23]
    v_pk_fma_f32 v[24:25], v[24:25], v[172:173], v[172:173] op_sel:[0,0,1] op_sel_hi:[1,0,1]
    v_pk_fma_f32 v[26:27], v[26:27], v[172:173], v[172:173] op_sel:[0,0,1] op_sel_hi:[1,0,1]
    v_pk_fma_f32 v[28:29], v[28:29], v[172:173], v[172:173] op_sel:[0,0,1] op_sel_hi:[1,0,1]
    v_pk_fma_f32 v[30:31], v[30:31], v[172:173], v[172:173] op_sel:[0,0,1] op_sel_hi:[1,0,1]
    v_pk_mul_f32 v[24:25], v[24:25], v[16:17]
    v_pk_mul_f32 v[26:27], v[26:27], v[18:19]
    v_pk_mul_f32 v[28:29], v[28:29], v[20:21]
    v_pk_mul_f32 v[30:31], v[30:31], v[22:23]
    v_exp_f32 v24, v24
    v_exp_f32 v25, v25
    v_exp_f32 v26, v26
    v_exp_f32 v27, v27
    v_exp_f32 v28, v28
    v_exp_f32 v29, v29
    v_exp_f32 v30, v30
    v_exp_f32 v31, v31
    v_pk_add_f32 v[24:25], v[24:25], 1.0 op_sel_hi:[1,0]
    v_pk_add_f32 v[26:27], v[26:27], 1.0 op_sel_hi:[1,0]
    v_pk_add_f32 v[28:29], v[28:29], 1.0 op_sel_hi:[1,0]
    v_pk_add_f32 v[30:31], v[30:31], 1.0 op_sel_hi:[1,0]
    v_rcp_f32 v24, v24
    v_rcp_f32 v25, v25
    v_rcp_f32 v26, v26
    v_rcp_f32 v27, v27
    v_rcp_f32 v28, v28
    v_rcp_f32 v29, v29
    v_rcp_f32 v30, v30
    v_rcp_f32 v31, v31
    v_pk_mul_f32 v[24:25], v[24:25], v[16:17]
    v_pk_mul_f32 v[26:27], v[26:27], v[18:19]
    v_pk_mul_f32 v[28:29], v[28:29], v[20:21]
    v_pk_mul_f32 v[30:31], v[30:31], v[22:23]
    v_cvt_pk_bf16_f32 v36, v24, v25
    v_cvt_pk_bf16_f32 v37, v26, v27
    v_cvt_pk_bf16_f32 v38, v28, v29
    v_cvt_pk_bf16_f32 v39, v30, v31
    buffer_store_dwordx4 v[36:39], v247, s[16:19], s36 offen offset:512 sc1
    s_waitcnt lgkmcnt(6)
    v_pk_fma_f32 v[16:17], v[156:157], v[232:233], v[140:141] op_sel:[0,1,0] op_sel_hi:[1,1,1] neg_lo:[0,1,0] neg_hi:[0,1,0]
    v_pk_fma_f32 v[18:19], v[158:159], v[232:233], v[142:143] op_sel:[0,1,0] op_sel_hi:[1,1,1] neg_lo:[0,1,0] neg_hi:[0,1,0]
    s_waitcnt lgkmcnt(4)
    v_pk_fma_f32 v[20:21], v[160:161], v[232:233], v[144:145] op_sel:[0,1,0] op_sel_hi:[1,1,1] neg_lo:[0,1,0] neg_hi:[0,1,0]
    v_pk_fma_f32 v[22:23], v[162:163], v[232:233], v[146:147] op_sel:[0,1,0] op_sel_hi:[1,1,1] neg_lo:[0,1,0] neg_hi:[0,1,0]
    v_pk_fma_f32 v[16:17], v[72:73], v[232:233], v[16:17] op_sel_hi:[1,0,1]
    v_pk_fma_f32 v[18:19], v[74:75], v[232:233], v[18:19] op_sel_hi:[1,0,1]
    v_pk_fma_f32 v[20:21], v[76:77], v[232:233], v[20:21] op_sel_hi:[1,0,1]
    v_pk_fma_f32 v[22:23], v[78:79], v[232:233], v[22:23] op_sel_hi:[1,0,1]
    v_pk_mul_f32 v[24:25], v[16:17], v[16:17]
    v_pk_mul_f32 v[26:27], v[18:19], v[18:19]
    v_pk_mul_f32 v[28:29], v[20:21], v[20:21]
    v_pk_mul_f32 v[30:31], v[22:23], v[22:23]
    v_pk_fma_f32 v[24:25], v[24:25], v[172:173], v[172:173] op_sel:[0,0,1] op_sel_hi:[1,0,1]
    v_pk_fma_f32 v[26:27], v[26:27], v[172:173], v[172:173] op_sel:[0,0,1] op_sel_hi:[1,0,1]
    v_pk_fma_f32 v[28:29], v[28:29], v[172:173], v[172:173] op_sel:[0,0,1] op_sel_hi:[1,0,1]
    v_pk_fma_f32 v[30:31], v[30:31], v[172:173], v[172:173] op_sel:[0,0,1] op_sel_hi:[1,0,1]
    v_pk_mul_f32 v[24:25], v[24:25], v[16:17]
    v_pk_mul_f32 v[26:27], v[26:27], v[18:19]
    v_pk_mul_f32 v[28:29], v[28:29], v[20:21]
    v_pk_mul_f32 v[30:31], v[30:31], v[22:23]
    v_exp_f32 v24, v24
    v_exp_f32 v25, v25
    v_exp_f32 v26, v26
    v_exp_f32 v27, v27
    v_exp_f32 v28, v28
    v_exp_f32 v29, v29
    v_exp_f32 v30, v30
    v_exp_f32 v31, v31
    v_pk_add_f32 v[24:25], v[24:25], 1.0 op_sel_hi:[1,0]
    v_pk_add_f32 v[26:27], v[26:27], 1.0 op_sel_hi:[1,0]
    v_pk_add_f32 v[28:29], v[28:29], 1.0 op_sel_hi:[1,0]
    v_pk_add_f32 v[30:31], v[30:31], 1.0 op_sel_hi:[1,0]
    v_rcp_f32 v24, v24
    v_rcp_f32 v25, v25
    v_rcp_f32 v26, v26
    v_rcp_f32 v27, v27
    v_rcp_f32 v28, v28
    v_rcp_f32 v29, v29
    v_rcp_f32 v30, v30
    v_rcp_f32 v31, v31
    v_pk_mul_f32 v[24:25], v[24:25], v[16:17]
    v_pk_mul_f32 v[26:27], v[26:27], v[18:19]
    v_pk_mul_f32 v[28:29], v[28:29], v[20:21]
    v_pk_mul_f32 v[30:31], v[30:31], v[22:23]
    v_cvt_pk_bf16_f32 v32, v24, v25
    v_cvt_pk_bf16_f32 v33, v26, v27
    v_cvt_pk_bf16_f32 v34, v28, v29
    v_cvt_pk_bf16_f32 v35, v30, v31
    buffer_store_dwordx4 v[32:35], v247, s[16:19], s37 offen offset:0 sc1
    s_waitcnt lgkmcnt(2)
    v_pk_fma_f32 v[16:17], v[164:165], v[232:233], v[148:149] op_sel:[0,1,0] op_sel_hi:[1,1,1] neg_lo:[0,1,0] neg_hi:[0,1,0]
    v_pk_fma_f32 v[18:19], v[166:167], v[232:233], v[150:151] op_sel:[0,1,0] op_sel_hi:[1,1,1] neg_lo:[0,1,0] neg_hi:[0,1,0]
    s_waitcnt lgkmcnt(0)
    v_pk_fma_f32 v[20:21], v[168:169], v[232:233], v[152:153] op_sel:[0,1,0] op_sel_hi:[1,1,1] neg_lo:[0,1,0] neg_hi:[0,1,0]
    v_pk_fma_f32 v[22:23], v[170:171], v[232:233], v[154:155] op_sel:[0,1,0] op_sel_hi:[1,1,1] neg_lo:[0,1,0] neg_hi:[0,1,0]
    v_pk_fma_f32 v[16:17], v[80:81], v[232:233], v[16:17] op_sel_hi:[1,0,1]
    v_pk_fma_f32 v[18:19], v[82:83], v[232:233], v[18:19] op_sel_hi:[1,0,1]
    v_pk_fma_f32 v[20:21], v[84:85], v[232:233], v[20:21] op_sel_hi:[1,0,1]
    buffer_load_dwordx4 v[184:187], v241, s[12:15], s40 offen sc1
    v_pk_fma_f32 v[22:23], v[86:87], v[232:233], v[22:23] op_sel_hi:[1,0,1]
    v_pk_mul_f32 v[24:25], v[16:17], v[16:17]
    v_pk_mul_f32 v[26:27], v[18:19], v[18:19]
    v_pk_mul_f32 v[28:29], v[20:21], v[20:21]
    v_pk_mul_f32 v[30:31], v[22:23], v[22:23]
    v_pk_fma_f32 v[24:25], v[24:25], v[172:173], v[172:173] op_sel:[0,0,1] op_sel_hi:[1,0,1]
    v_pk_fma_f32 v[26:27], v[26:27], v[172:173], v[172:173] op_sel:[0,0,1] op_sel_hi:[1,0,1]
    v_pk_fma_f32 v[28:29], v[28:29], v[172:173], v[172:173] op_sel:[0,0,1] op_sel_hi:[1,0,1]
    v_pk_fma_f32 v[30:31], v[30:31], v[172:173], v[172:173] op_sel:[0,0,1] op_sel_hi:[1,0,1]
    v_pk_mul_f32 v[24:25], v[24:25], v[16:17]
    v_pk_mul_f32 v[26:27], v[26:27], v[18:19]
    v_pk_mul_f32 v[28:29], v[28:29], v[20:21]
    v_pk_mul_f32 v[30:31], v[30:31], v[22:23]
    v_exp_f32 v24, v24
    v_exp_f32 v25, v25
    v_exp_f32 v26, v26
    v_exp_f32 v27, v27
    v_exp_f32 v28, v28
    v_exp_f32 v29, v29
    v_exp_f32 v30, v30
    v_exp_f32 v31, v31
    v_pk_add_f32 v[24:25], v[24:25], 1.0 op_sel_hi:[1,0]
    buffer_load_dwordx4 v[188:191], v241, s[12:15], s41 offen sc1
    v_pk_add_f32 v[26:27], v[26:27], 1.0 op_sel_hi:[1,0]
    v_pk_add_f32 v[28:29], v[28:29], 1.0 op_sel_hi:[1,0]
    v_pk_add_f32 v[30:31], v[30:31], 1.0 op_sel_hi:[1,0]
    v_rcp_f32 v24, v24
    v_rcp_f32 v25, v25
    v_rcp_f32 v26, v26
    v_rcp_f32 v27, v27
    v_rcp_f32 v28, v28
    v_rcp_f32 v29, v29
    v_rcp_f32 v30, v30
    v_rcp_f32 v31, v31
    v_pk_mul_f32 v[24:25], v[24:25], v[16:17]
    v_pk_mul_f32 v[26:27], v[26:27], v[18:19]
    v_pk_mul_f32 v[28:29], v[28:29], v[20:21]
    v_pk_mul_f32 v[30:31], v[30:31], v[22:23]
    v_cvt_pk_bf16_f32 v36, v24, v25
    v_cvt_pk_bf16_f32 v37, v26, v27
    v_cvt_pk_bf16_f32 v38, v28, v29
    v_cvt_pk_bf16_f32 v39, v30, v31
    buffer_store_dwordx4 v[36:39], v247, s[16:19], s37 offen offset:512 sc1
    s_add_u32 s37, s37, 110592
    s_waitcnt vmcnt(4)
    v_mov_b32 v11, 1
    s_mov_b64 exec, 1
    buffer_store_dword v11, off, s[12:15], s38 offset:0 sc1
    s_mov_b64 exec, -1
    s_add_u32 s38, s38, 131072
    v_pk_fma_f32 v[16:17], v[156:157], v[234:235], v[140:141] op_sel:[0,1,0] op_sel_hi:[1,1,1] neg_lo:[0,1,0] neg_hi:[0,1,0]
    v_pk_fma_f32 v[18:19], v[158:159], v[234:235], v[142:143] op_sel:[0,1,0] op_sel_hi:[1,1,1] neg_lo:[0,1,0] neg_hi:[0,1,0]
    v_pk_fma_f32 v[20:21], v[160:161], v[234:235], v[144:145] op_sel:[0,1,0] op_sel_hi:[1,1,1] neg_lo:[0,1,0] neg_hi:[0,1,0]
    v_pk_fma_f32 v[22:23], v[162:163], v[234:235], v[146:147] op_sel:[0,1,0] op_sel_hi:[1,1,1] neg_lo:[0,1,0] neg_hi:[0,1,0]
    v_pk_fma_f32 v[16:17], v[88:89], v[234:235], v[16:17] op_sel_hi:[1,0,1]
    v_pk_fma_f32 v[18:19], v[90:91], v[234:235], v[18:19] op_sel_hi:[1,0,1]
    v_pk_fma_f32 v[20:21], v[92:93], v[234:235], v[20:21] op_sel_hi:[1,0,1]
    v_pk_fma_f32 v[22:23], v[94:95], v[234:235], v[22:23] op_sel_hi:[1,0,1]
    v_pk_mul_f32 v[24:25], v[16:17], v[16:17]
    v_pk_mul_f32 v[26:27], v[18:19], v[18:19]
    v_pk_mul_f32 v[28:29], v[20:21], v[20:21]
    v_pk_mul_f32 v[30:31], v[22:23], v[22:23]
    v_pk_fma_f32 v[24:25], v[24:25], v[172:173], v[172:173] op_sel:[0,0,1] op_sel_hi:[1,0,1]
    v_pk_fma_f32 v[26:27], v[26:27], v[172:173], v[172:173] op_sel:[0,0,1] op_sel_hi:[1,0,1]
    v_pk_fma_f32 v[28:29], v[28:29], v[172:173], v[172:173] op_sel:[0,0,1] op_sel_hi:[1,0,1]
    v_pk_fma_f32 v[30:31], v[30:31], v[172:173], v[172:173] op_sel:[0,0,1] op_sel_hi:[1,0,1]
    v_pk_mul_f32 v[24:25], v[24:25], v[16:17]
    v_pk_mul_f32 v[26:27], v[26:27], v[18:19]
    v_pk_mul_f32 v[28:29], v[28:29], v[20:21]
    v_pk_mul_f32 v[30:31], v[30:31], v[22:23]
    v_exp_f32 v24, v24
    v_exp_f32 v25, v25
    v_exp_f32 v26, v26
    v_exp_f32 v27, v27
    v_exp_f32 v28, v28
    v_exp_f32 v29, v29
    v_exp_f32 v30, v30
    v_exp_f32 v31, v31
    v_pk_add_f32 v[24:25], v[24:25], 1.0 op_sel_hi:[1,0]
    v_pk_add_f32 v[26:27], v[26:27], 1.0 op_sel_hi:[1,0]
    v_pk_add_f32 v[28:29], v[28:29], 1.0 op_sel_hi:[1,0]
    v_pk_add_f32 v[30:31], v[30:31], 1.0 op_sel_hi:[1,0]
    v_rcp_f32 v24, v24
    v_rcp_f32 v25, v25
    v_rcp_f32 v26, v26
    v_rcp_f32 v27, v27
    v_rcp_f32 v28, v28
    v_rcp_f32 v29, v29
    v_rcp_f32 v30, v30
    v_rcp_f32 v31, v31
    v_pk_mul_f32 v[24:25], v[24:25], v[16:17]
    v_pk_mul_f32 v[26:27], v[26:27], v[18:19]
    v_pk_mul_f32 v[28:29], v[28:29], v[20:21]
    v_pk_mul_f32 v[30:31], v[30:31], v[22:23]
    v_cvt_pk_bf16_f32 v32, v24, v25
    v_cvt_pk_bf16_f32 v33, v26, v27
    v_cvt_pk_bf16_f32 v34, v28, v29
    v_cvt_pk_bf16_f32 v35, v30, v31
    buffer_store_dwordx4 v[32:35], v247, s[16:19], s37 offen offset:0 sc1
    v_pk_fma_f32 v[16:17], v[164:165], v[234:235], v[148:149] op_sel:[0,1,0] op_sel_hi:[1,1,1] neg_lo:[0,1,0] neg_hi:[0,1,0]
    v_pk_fma_f32 v[18:19], v[166:167], v[234:235], v[150:151] op_sel:[0,1,0] op_sel_hi:[1,1,1] neg_lo:[0,1,0] neg_hi:[0,1,0]
    v_pk_fma_f32 v[20:21], v[168:169], v[234:235], v[152:153] op_sel:[0,1,0] op_sel_hi:[1,1,1] neg_lo:[0,1,0] neg_hi:[0,1,0]
    v_pk_fma_f32 v[22:23], v[170:171], v[234:235], v[154:155] op_sel:[0,1,0] op_sel_hi:[1,1,1] neg_lo:[0,1,0] neg_hi:[0,1,0]
    v_pk_fma_f32 v[16:17], v[96:97], v[234:235], v[16:17] op_sel_hi:[1,0,1]
    v_pk_fma_f32 v[18:19], v[98:99], v[234:235], v[18:19] op_sel_hi:[1,0,1]
    v_pk_fma_f32 v[20:21], v[100:101], v[234:235], v[20:21] op_sel_hi:[1,0,1]
    v_pk_fma_f32 v[22:23], v[102:103], v[234:235], v[22:23] op_sel_hi:[1,0,1]
    v_pk_mul_f32 v[24:25], v[16:17], v[16:17]
    v_pk_mul_f32 v[26:27], v[18:19], v[18:19]
    v_pk_mul_f32 v[28:29], v[20:21], v[20:21]
    v_pk_mul_f32 v[30:31], v[22:23], v[22:23]
    v_pk_fma_f32 v[24:25], v[24:25], v[172:173], v[172:173] op_sel:[0,0,1] op_sel_hi:[1,0,1]
    v_pk_fma_f32 v[26:27], v[26:27], v[172:173], v[172:173] op_sel:[0,0,1] op_sel_hi:[1,0,1]
    v_pk_fma_f32 v[28:29], v[28:29], v[172:173], v[172:173] op_sel:[0,0,1] op_sel_hi:[1,0,1]
    v_pk_fma_f32 v[30:31], v[30:31], v[172:173], v[172:173] op_sel:[0,0,1] op_sel_hi:[1,0,1]
    v_pk_mul_f32 v[24:25], v[24:25], v[16:17]
    v_pk_mul_f32 v[26:27], v[26:27], v[18:19]
    v_pk_mul_f32 v[28:29], v[28:29], v[20:21]
    v_pk_mul_f32 v[30:31], v[30:31], v[22:23]
    v_exp_f32 v24, v24
    v_exp_f32 v25, v25
    v_exp_f32 v26, v26
    v_exp_f32 v27, v27
    v_exp_f32 v28, v28
    v_exp_f32 v29, v29
    v_exp_f32 v30, v30
    v_exp_f32 v31, v31
    v_pk_add_f32 v[24:25], v[24:25], 1.0 op_sel_hi:[1,0]
    v_pk_add_f32 v[26:27], v[26:27], 1.0 op_sel_hi:[1,0]
    v_pk_add_f32 v[28:29], v[28:29], 1.0 op_sel_hi:[1,0]
    v_pk_add_f32 v[30:31], v[30:31], 1.0 op_sel_hi:[1,0]
    v_rcp_f32 v24, v24
    v_rcp_f32 v25, v25
    v_rcp_f32 v26, v26
    v_rcp_f32 v27, v27
    v_rcp_f32 v28, v28
    v_rcp_f32 v29, v29
    v_rcp_f32 v30, v30
    v_rcp_f32 v31, v31
    v_pk_mul_f32 v[24:25], v[24:25], v[16:17]
    v_pk_mul_f32 v[26:27], v[26:27], v[18:19]
    v_pk_mul_f32 v[28:29], v[28:29], v[20:21]
    v_pk_mul_f32 v[30:31], v[30:31], v[22:23]
    v_cvt_pk_bf16_f32 v36, v24, v25
    v_cvt_pk_bf16_f32 v37, v26, v27
    v_cvt_pk_bf16_f32 v38, v28, v29
    v_cvt_pk_bf16_f32 v39, v30, v31
    buffer_store_dwordx4 v[36:39], v247, s[16:19], s37 offen offset:512 sc1
    ds_read_b128 v[104:107], v224 offset:4896
    ds_read_b128 v[40:43], v223 offset:0
    ds_read_b128 v[72:75], v224 offset:0
    ds_read_b128 v[108:111], v224 offset:4960
    ds_read_b128 v[44:47], v223 offset:64
    ds_read_b128 v[76:79], v224 offset:64
    ds_read_b128 v[112:115], v224 offset:5024
    ds_read_b128 v[48:51], v223 offset:128
    ds_read_b128 v[80:83], v224 offset:128
    ds_read_b128 v[116:119], v224 offset:5088
    ds_read_b128 v[52:55], v223 offset:192
    ds_read_b128 v[84:87], v224 offset:192
    s_mul_i32 s77, s85, 5
    buffer_load_dwordx4 a[100:103], v220, s[20:23], s77 offen offset:0 sc1
    buffer_load_dwordx4 a[104:107], v220, s[20:23], s77 offen offset:1024 sc1
    buffer_load_dwordx4 a[108:111], v220, s[20:23], s77 offen offset:2048 sc1
    buffer_load_dwordx4 a[112:115], v220, s[20:23], s77 offen offset:3072 sc1
    buffer_load_dwordx4 a[116:119], v221, s[20:23], s77 offen offset:0 sc1
    s_mul_i32 s76, s86, 5
    buffer_load_dwordx4 a[120:123], v220, s[20:23], s76 offen offset:0 sc1
    buffer_load_dwordx4 a[124:127], v220, s[20:23], s76 offen offset:1024 sc1
    buffer_load_dwordx4 a[128:131], v220, s[20:23], s76 offen offset:2048 sc1
    s_waitcnt lgkmcnt(10)
    v_mfma_f32_16x16x32_bf16 v[16:19], v[40:43], v[104:107], 0
    ds_read_b128 v[120:123], v224 offset:5152
    ds_read_b128 v[56:59], v223 offset:256
    s_waitcnt lgkmcnt(11)
    v_mfma_f32_16x16x32_bf16 v[20:23], v[72:75], v[104:107], 0
    ds_read_b128 v[88:91], v224 offset:256
    s_waitcnt lgkmcnt(10)
    v_mfma_f32_16x16x32_bf16 v[16:19], v[44:47], v[108:111], v[16:19]
    ds_read_b128 v[124:127], v224 offset:5216
    ds_read_b128 v[60:63], v223 offset:320
    s_waitcnt lgkmcnt(11)
    v_mfma_f32_16x16x32_bf16 v[20:23], v[76:79], v[108:111], v[20:23]
    ds_read_b128 v[92:95], v224 offset:320
    s_waitcnt lgkmcnt(10)
    v_mfma_f32_16x16x32_bf16 v[16:19], v[48:51], v[112:115], v[16:19]
    ds_read_b128 v[128:131], v224 offset:5280
    ds_read_b128 v[64:67], v223 offset:384
    s_waitcnt lgkmcnt(11)
    v_mfma_f32_16x16x32_bf16 v[20:23], v[80:83], v[112:115], v[20:23]
    ds_read_b128 v[96:99], v224 offset:384
    s_waitcnt lgkmcnt(10)
    v_mfma_f32_16x16x32_bf16 v[16:19], v[52:55], v[116:119], v[16:19]
    ds_read_b128 v[132:135], v224 offset:5344
    ds_read_b128 v[68:71], v223 offset:448
    s_waitcnt lgkmcnt(11)
    v_mfma_f32_16x16x32_bf16 v[20:23], v[84:87], v[116:119], v[20:23]
    ds_read_b128 v[100:103], v224 offset:448
    s_waitcnt lgkmcnt(10)
    v_mfma_f32_16x16x32_bf16 v[16:19], v[56:59], v[120:123], v[16:19]
    s_waitcnt lgkmcnt(9)
    v_mfma_f32_16x16x32_bf16 v[20:23], v[88:91], v[120:123], v[20:23]
    s_waitcnt lgkmcnt(7)
    v_mfma_f32_16x16x32_bf16 v[16:19], v[60:63], v[124:127], v[16:19]
    s_waitcnt lgkmcnt(6)
    v_mfma_f32_16x16x32_bf16 v[20:23], v[92:95], v[124:127], v[20:23]
    s_waitcnt lgkmcnt(4)
    v_mfma_f32_16x16x32_bf16 v[16:19], v[64:67], v[128:131], v[16:19]
    s_waitcnt lgkmcnt(3)
    v_mfma_f32_16x16x32_bf16 v[20:23], v[96:99], v[128:131], v[20:23]
    s_waitcnt lgkmcnt(1)
    v_mfma_f32_16x16x32_bf16 v[16:19], v[68:71], v[132:135], v[16:19]
    s_waitcnt lgkmcnt(0)
    v_mfma_f32_16x16x32_bf16 v[20:23], v[100:103], v[132:135], v[20:23]
    v_mov_b32 v28, 0
    ds_write_b32 v227, v28 offset:1288
    s_nop 3
    v_add_f32 v16, v16, v12
    v_cvt_pk_bf16_f32 v25, v18, v19
    v_cvt_pk_bf16_f32 v24, v16, v17
    ds_write_b64 v225, v[24:25] offset:0
    v_cvt_pk_bf16_f32 v26, v20, v21
    v_cvt_pk_bf16_f32 v27, v22, v23
    ds_write_b32 v226, v26 offset:0
    ds_write_b32 v226, v27 offset:64
    v_mov_b32 v16, 0
    v_mov_b32 v17, 0
    v_mov_b32 v18, 0
    v_mov_b32 v19, 0
    ds_write_b128 v243, v[16:19]
    s_waitcnt lgkmcnt(0)
    s_barrier
    ds_read_u16 v30, v2 offset:0
    ds_read_u16 v31, v3 offset:0
    ds_read_u16 v32, v4 offset:0
    ds_read_u16 v33, v5 offset:0
    ds_read_u16 v34, v6 offset:0
    ds_read_u16 v35, v7 offset:0
    ds_read_u16 v36, v8 offset:0
    ds_read_u16 v37, v9 offset:0
    ds_read_u16 v38, v10 offset:0
    buffer_load_dwordx4 a[132:135], v220, s[20:23], s76 offen offset:3072 sc1
    buffer_load_dwordx4 a[136:139], v221, s[20:23], s76 offen offset:0 sc1
    s_mul_i32 s77, s87, 5
    buffer_load_dwordx4 a[140:143], v220, s[20:23], s77 offen offset:0 sc1
    buffer_load_dwordx4 a[144:147], v220, s[20:23], s77 offen offset:1024 sc1
    s_waitcnt vmcnt(17)
    ds_write_b128 v242, v[184:187]
    s_waitcnt vmcnt(16)
    ds_write_b128 v242, v[188:191] offset:512
    s_waitcnt lgkmcnt(9)
    v_lshl_or_b32 v40, v31, 16, v30
    s_waitcnt lgkmcnt(7)
    v_lshl_or_b32 v41, v33, 16, v32
    s_waitcnt lgkmcnt(5)
    v_lshl_or_b32 v42, v35, 16, v34
    s_waitcnt lgkmcnt(3)
    v_lshl_or_b32 v43, v37, 16, v36
    ds_write_b128 v236, v[40:43]
    v_lshl_or_b32 v44, v32, 16, v31
    v_lshl_or_b32 v45, v34, 16, v33
    v_lshl_or_b32 v46, v36, 16, v35
    s_waitcnt lgkmcnt(3)
    v_lshl_or_b32 v47, v38, 16, v37
    ds_write_b128 v236, v[44:47] offset:2112
    s_lshl_b32 s68, s53, 4
    s_lshr_b32 s68, s61, s68
    s_lshl_b32 s68, s68, 16
    v_mov_b32 v188, s68
    v_mov_b32 v189, s68
    v_mov_b32 v190, s68
    v_mov_b32 v191, s68
    s_waitcnt lgkmcnt(0)
    s_barrier
    s_cmp_eq_u32 s52, 1
    s_cbranch_scc1 L_roleB_6
    ds_read2_b32 v[48:49], v238 offset0:0 offset1:1
    ds_read2_b32 v[50:51], v238 offset0:2 offset1:3
    ds_read_b128 v[104:107], v240 offset:4096
    ds_read2_b32 v[52:53], v237 offset0:240 offset1:241
    ds_read2_b32 v[54:55], v237 offset0:242 offset1:243
    ds_read_b128 v[108:111], v240 offset:4032
    ds_read2_b32 v[56:57], v237 offset0:224 offset1:225
    ds_read2_b32 v[58:59], v237 offset0:226 offset1:227
    ds_read_b128 v[112:115], v240 offset:3968
    ds_read2_b32 v[60:61], v237 offset0:208 offset1:209
    ds_read2_b32 v[62:63], v237 offset0:210 offset1:211
    ds_read_b128 v[116:119], v240 offset:3904
    s_waitcnt lgkmcnt(9)
    v_mfma_f32_16x16x32_bf16 v[44:47], v[48:51], v[104:107], v[188:191]
    ds_read2_b32 v[64:65], v237 offset0:192 offset1:193
    ds_read2_b32 v[66:67], v237 offset0:194 offset1:195
    ds_read_b128 v[120:123], v240 offset:3840
    s_waitcnt lgkmcnt(9)
    v_mfma_f32_16x16x32_bf16 v[44:47], v[52:55], v[108:111], v[44:47]
    ds_read2_b32 v[68:69], v237 offset0:176 offset1:177
    ds_read2_b32 v[70:71], v237 offset0:178 offset1:179
    ds_read_b128 v[124:127], v240 offset:3776
    s_waitcnt lgkmcnt(9)
    v_mfma_f32_16x16x32_bf16 v[44:47], v[56:59], v[112:115], v[44:47]
    buffer_load_dwordx4 a[148:151], v220, s[20:23], s77 offen offset:2048 sc1
    ds_read2_b32 v[72:73], v237 offset0:160 offset1:161
    ds_read2_b32 v[74:75], v237 offset0:162 offset1:163
    ds_read_b128 v[128:131], v240 offset:3712
    s_waitcnt lgkmcnt(9)
    v_mfma_f32_16x16x32_bf16 v[44:47], v[60:63], v[116:119], v[44:47]
    ds_read2_b32 v[76:77], v237 offset0:144 offset1:145
    ds_read2_b32 v[78:79], v237 offset0:146 offset1:147
    ds_read_b128 v[132:135], v240 offset:3648
    s_waitcnt lgkmcnt(9)
    v_mfma_f32_16x16x32_bf16 v[44:47], v[64:67], v[120:123], v[44:47]
    buffer_load_dwordx4 a[152:155], v220, s[20:23], s77 offen offset:3072 sc1
    ds_read2_b32 v[80:81], v237 offset0:128 offset1:129
    ds_read2_b32 v[82:83], v237 offset0:130 offset1:131
    ds_read_b128 v[136:139], v240 offset:3584
    s_waitcnt lgkmcnt(9)
    v_mfma_f32_16x16x32_bf16 v[44:47], v[68:71], v[124:127], v[44:47]
    ds_read2_b32 v[84:85], v237 offset0:112 offset1:113
    ds_read2_b32 v[86:87], v237 offset0:114 offset1:115
    ds_read_b128 v[140:143], v240 offset:3520
    s_waitcnt lgkmcnt(9)
    v_mfma_f32_16x16x32_bf16 v[44:47], v[72:75], v[128:131], v[44:47]
    buffer_load_dwordx4 a[156:159], v221, s[20:23], s77 offen offset:0 sc1
    ds_read2_b32 v[88:89], v237 offset0:96 offset1:97
    ds_read2_b32 v[90:91], v237 offset0:98 offset1:99
    ds_read_b128 v[104:107], v240 offset:3456
    s_waitcnt lgkmcnt(9)
    v_mfma_f32_16x16x32_bf16 v[44:47], v[76:79], v[132:135], v[44:47]
    ds_read2_b32 v[92:93], v237 offset0:80 offset1:81
    ds_read2_b32 v[94:95], v237 offset0:82 offset1:83
    ds_read_b128 v[108:111], v240 offset:3392
    s_waitcnt lgkmcnt(9)
    v_mfma_f32_16x16x32_bf16 v[44:47], v[80:83], v[136:139], v[44:47]
    s_mul_i32 s76, s88, 5
    buffer_load_dwordx4 a[160:163], v220, s[20:23], s76 offen offset:0 sc1
    ds_read2_b32 v[96:97], v237 offset0:64 offset1:65
    ds_read2_b32 v[98:99], v237 offset0:66 offset1:67
    ds_read_b128 v[112:115], v240 offset:3328
    v_mfma_f32_16x16x32_bf16 v[40:43], v[48:51], v[136:139], v[188:191]
    s_waitcnt lgkmcnt(9)
    v_mfma_f32_16x16x32_bf16 v[44:47], v[84:87], v[140:143], v[44:47]
    buffer_load_dwordx4 a[164:167], v220, s[20:23], s76 offen offset:1024 sc1
    ds_read2_b32 v[100:101], v237 offset0:48 offset1:49
    ds_read2_b32 v[102:103], v237 offset0:50 offset1:51
    ds_read_b128 v[116:119], v240 offset:3264
    v_mfma_f32_16x16x32_bf16 v[40:43], v[52:55], v[140:143], v[40:43]
    s_waitcnt lgkmcnt(9)
    v_mfma_f32_16x16x32_bf16 v[44:47], v[88:91], v[104:107], v[44:47]
    buffer_load_dwordx4 a[168:171], v220, s[20:23], s76 offen offset:2048 sc1
    ds_read_b128 v[120:123], v240 offset:3200
    v_mfma_f32_16x16x32_bf16 v[40:43], v[56:59], v[104:107], v[40:43]
    s_waitcnt lgkmcnt(7)
    v_mfma_f32_16x16x32_bf16 v[44:47], v[92:95], v[108:111], v[44:47]
    buffer_load_dwordx4 a[172:175], v220, s[20:23], s76 offen offset:3072 sc1
    ds_read_b128 v[124:127], v240 offset:3136
    v_mfma_f32_16x16x32_bf16 v[40:43], v[60:63], v[108:111], v[40:43]
    s_waitcnt lgkmcnt(5)
    v_mfma_f32_16x16x32_bf16 v[44:47], v[96:99], v[112:115], v[44:47]
    ds_read_b128 v[128:131], v240 offset:3072
    v_mfma_f32_16x16x32_bf16 v[40:43], v[64:67], v[112:115], v[40:43]
    s_waitcnt lgkmcnt(3)
    v_mfma_f32_16x16x32_bf16 v[44:47], v[100:103], v[116:119], v[44:47]
    buffer_load_dwordx4 a[176:179], v221, s[20:23], s76 offen offset:0 sc1
    s_add_u32 s16, s64, s46
    s_addc_u32 s17, s65, 0
    s_mov_b32 s18, 221184
    s_mov_b32 s19, 0x20000
    v_min_u32 v229, 6, v0
    v_lshl_add_u32 v229, v229, 2, s28
    v_lshlrev_b32 v229, 7, v229
    ds_read_b128 v[132:135], v240 offset:3008
    v_mfma_f32_16x16x32_bf16 v[40:43], v[68:71], v[116:119], v[40:43]
    s_waitcnt lgkmcnt(3)
    v_mfma_f32_16x16x32_bf16 v[40:43], v[72:75], v[120:123], v[40:43]
    s_mul_i32 s77, s89, 5
    buffer_load_dwordx4 a[180:183], v220, s[20:23], s77 offen offset:0 sc1
    ds_read_b128 v[136:139], v240 offset:2944
    s_waitcnt lgkmcnt(3)
    v_mfma_f32_16x16x32_bf16 v[40:43], v[76:79], v[124:127], v[40:43]
    ds_read_b128 v[140:143], v240 offset:2880
    s_waitcnt lgkmcnt(3)
    v_mfma_f32_16x16x32_bf16 v[40:43], v[80:83], v[128:131], v[40:43]
    buffer_load_dwordx4 a[184:187], v220, s[20:23], s77 offen offset:1024 sc1
    s_add_u32 s68, s28, 1
    s_and_b32 s68, s68, 3
    s_mul_i32 s68, s68, 55296
    v_add_u32 v222, s68, v1
    s_add_u32 s68, s28, 2
    s_and_b32 s68, s68, 3
    s_mul_i32 s68, s68, 55296
    v_add_u32 v223, s68, v1
    s_add_u32 s68, s28, 3
    s_and_b32 s68, s68, 3
    s_mul_i32 s68, s68, 55296
    v_add_u32 v224, s68, v1
    s_add_u32 s68, s28, 4
    s_and_b32 s68, s68, 3
    s_mul_i32 s68, s68, 55296
    v_add_u32 v225, s68, v1
    ds_read_b128 v[104:107], v240 offset:2816
    v_mfma_f32_16x16x32_bf16 v[36:39], v[48:51], v[128:131], v[188:191]
    s_waitcnt lgkmcnt(3)
    v_mfma_f32_16x16x32_bf16 v[40:43], v[84:87], v[132:135], v[40:43]
    buffer_load_dwordx4 a[188:191], v220, s[20:23], s77 offen offset:2048 sc1
    ds_read_b128 v[108:111], v240 offset:2752
    v_mfma_f32_16x16x32_bf16 v[36:39], v[52:55], v[132:135], v[36:39]
    ds_write_b128 v244, v[44:47] offset:3072
    s_waitcnt lgkmcnt(4)
    v_mfma_f32_16x16x32_bf16 v[40:43], v[88:91], v[136:139], v[40:43]
    buffer_load_dwordx4 a[192:195], v220, s[20:23], s77 offen offset:3072 sc1
    buffer_load_dword v228, v229, s[12:15], s94 offen sc1
    ds_read_b128 v[112:115], v240 offset:2688
    v_mfma_f32_16x16x32_bf16 v[36:39], v[56:59], v[136:139], v[36:39]
    s_waitcnt lgkmcnt(4)
    v_mfma_f32_16x16x32_bf16 v[40:43], v[92:95], v[140:143], v[40:43]
    buffer_load_dwordx4 a[196:199], v221, s[20:23], s77 offen offset:0 sc1
    ds_read_b128 v[116:119], v240 offset:2624
    v_mfma_f32_16x16x32_bf16 v[36:39], v[60:63], v[140:143], v[36:39]
    s_waitcnt lgkmcnt(4)
    v_mfma_f32_16x16x32_bf16 v[40:43], v[96:99], v[104:107], v[40:43]
    s_mul_i32 s76, s90, 5
    buffer_load_dwordx4 a[200:203], v220, s[20:23], s76 offen offset:0 sc1
    ds_read_b128 v[120:123], v240 offset:2560
    v_mfma_f32_16x16x32_bf16 v[36:39], v[64:67], v[104:107], v[36:39]
    s_waitcnt lgkmcnt(4)
    v_mfma_f32_16x16x32_bf16 v[40:43], v[100:103], v[108:111], v[40:43]
    ds_read_b128 v[124:127], v240 offset:2496
    v_mfma_f32_16x16x32_bf16 v[36:39], v[68:71], v[108:111], v[36:39]
    buffer_load_dwordx4 a[204:207], v220, s[20:23], s76 offen offset:1024 sc1
    s_waitcnt lgkmcnt(3)
    v_mfma_f32_16x16x32_bf16 v[36:39], v[72:75], v[112:115], v[36:39]
    ds_read_b128 v[128:131], v240 offset:2432
    s_waitcnt lgkmcnt(3)
    v_mfma_f32_16x16x32_bf16 v[36:39], v[76:79], v[116:119], v[36:39]
    ds_read_b128 v[132:135], v240 offset:2368
    s_waitcnt lgkmcnt(3)
    v_mfma_f32_16x16x32_bf16 v[36:39], v[80:83], v[120:123], v[36:39]
    buffer_load_dwordx4 a[208:211], v220, s[20:23], s76 offen offset:2048 sc1
    ds_read_b128 v[136:139], v240 offset:2304
    v_mfma_f32_16x16x32_bf16 v[32:35], v[48:51], v[120:123], v[188:191]
    s_waitcnt lgkmcnt(3)
    v_mfma_f32_16x16x32_bf16 v[36:39], v[84:87], v[124:127], v[36:39]
    buffer_load_dwordx4 a[212:215], v220, s[20:23], s76 offen offset:3072 sc1
    ds_read_b128 v[140:143], v240 offset:2240
    v_mfma_f32_16x16x32_bf16 v[32:35], v[52:55], v[124:127], v[32:35]
    ds_write_b128 v244, v[40:43] offset:2048
    s_waitcnt lgkmcnt(4)
    v_mfma_f32_16x16x32_bf16 v[36:39], v[88:91], v[128:131], v[36:39]
    buffer_load_dwordx4 a[216:219], v221, s[20:23], s76 offen offset:0 sc1
    ds_read_b128 v[104:107], v240 offset:2176
    v_mfma_f32_16x16x32_bf16 v[32:35], v[56:59], v[128:131], v[32:35]
    s_waitcnt lgkmcnt(4)
    v_mfma_f32_16x16x32_bf16 v[36:39], v[92:95], v[132:135], v[36:39]
    s_mul_i32 s77, s91, 5
    buffer_load_dwordx4 a[220:223], v220, s[20:23], s77 offen offset:0 sc1
    ds_read_b128 v[108:111], v240 offset:2112
    v_mfma_f32_16x16x32_bf16 v[32:35], v[60:63], v[132:135], v[32:35]
    s_waitcnt lgkmcnt(4)
    v_mfma_f32_16x16x32_bf16 v[36:39], v[96:99], v[136:139], v[36:39]
    buffer_load_dwordx4 a[224:227], v220, s[20:23], s77 offen offset:1024 sc1
    ds_read_b128 v[112:115], v240 offset:2048
    v_mfma_f32_16x16x32_bf16 v[32:35], v[64:67], v[136:139], v[32:35]
    s_waitcnt lgkmcnt(4)
    v_mfma_f32_16x16x32_bf16 v[36:39], v[100:103], v[140:143], v[36:39]
    buffer_load_dwordx4 a[228:231], v220, s[20:23], s77 offen offset:2048 sc1
    ds_read_b128 v[116:119], v240 offset:1984
    v_mfma_f32_16x16x32_bf16 v[32:35], v[68:71], v[140:143], v[32:35]
    s_waitcnt lgkmcnt(3)
    v_mfma_f32_16x16x32_bf16 v[32:35], v[72:75], v[104:107], v[32:35]
    ds_read_b128 v[120:123], v240 offset:1920
    s_waitcnt lgkmcnt(3)
    v_mfma_f32_16x16x32_bf16 v[32:35], v[76:79], v[108:111], v[32:35]
    buffer_load_dwordx4 a[232:235], v220, s[20:23], s77 offen offset:3072 sc1
    ds_read_b128 v[124:127], v240 offset:1856
    s_waitcnt lgkmcnt(3)
    v_mfma_f32_16x16x32_bf16 v[32:35], v[80:83], v[112:115], v[32:35]
    ds_read_b128 v[128:131], v240 offset:1792
    v_mfma_f32_16x16x32_bf16 v[28:31], v[48:51], v[112:115], 0
    buffer_load_dwordx4 a[236:239], v221, s[20:23], s77 offen offset:0 sc1
    s_waitcnt lgkmcnt(3)
    v_mfma_f32_16x16x32_bf16 v[32:35], v[84:87], v[116:119], v[32:35]
    ds_read_b128 v[132:135], v240 offset:1728
    v_mfma_f32_16x16x32_bf16 v[28:31], v[52:55], v[116:119], v[28:31]
    ds_write_b128 v244, v[36:39] offset:1024
    s_waitcnt lgkmcnt(4)
    v_mfma_f32_16x16x32_bf16 v[32:35], v[88:91], v[120:123], v[32:35]
    s_mul_i32 s76, s92, 5
    buffer_load_dwordx4 a[240:243], v220, s[20:23], s76 offen offset:0 sc1
    ds_read_b128 v[136:139], v240 offset:1664
    v_mfma_f32_16x16x32_bf16 v[28:31], v[56:59], v[120:123], v[28:31]
    s_waitcnt lgkmcnt(4)
    v_mfma_f32_16x16x32_bf16 v[32:35], v[92:95], v[124:127], v[32:35]
    buffer_load_dwordx4 a[244:247], v220, s[20:23], s76 offen offset:1024 sc1
    ds_read_b128 v[140:143], v240 offset:1600
    v_mfma_f32_16x16x32_bf16 v[28:31], v[60:63], v[124:127], v[28:31]
    s_waitcnt lgkmcnt(4)
    v_mfma_f32_16x16x32_bf16 v[32:35], v[96:99], v[128:131], v[32:35]
    buffer_load_dwordx4 a[248:251], v220, s[20:23], s76 offen offset:2048 sc1
    ds_read_b128 v[104:107], v240 offset:1536
    v_mfma_f32_16x16x32_bf16 v[28:31], v[64:67], v[128:131], v[28:31]
    s_waitcnt lgkmcnt(4)
    v_mfma_f32_16x16x32_bf16 v[32:35], v[100:103], v[132:135], v[32:35]
    buffer_load_dwordx4 a[252:255], v220, s[20:23], s76 offen offset:3072 sc1
    ds_read_b128 v[108:111], v240 offset:1472
    v_mfma_f32_16x16x32_bf16 v[28:31], v[68:71], v[132:135], v[28:31]
    s_waitcnt lgkmcnt(3)
    v_mfma_f32_16x16x32_bf16 v[28:31], v[72:75], v[136:139], v[28:31]
    ds_read_b128 v[112:115], v240 offset:1408
    s_waitcnt lgkmcnt(3)
    v_mfma_f32_16x16x32_bf16 v[28:31], v[76:79], v[140:143], v[28:31]
    ds_read_b128 v[116:119], v240 offset:1344
    s_waitcnt lgkmcnt(3)
    v_mfma_f32_16x16x32_bf16 v[28:31], v[80:83], v[104:107], v[28:31]
    ds_read_b128 v[120:123], v240 offset:1280
    v_mfma_f32_16x16x32_bf16 v[24:27], v[48:51], v[104:107], 0
    s_waitcnt lgkmcnt(3)
    v_mfma_f32_16x16x32_bf16 v[28:31], v[84:87], v[108:111], v[28:31]
    ds_read_b128 v[124:127], v240 offset:1216
    v_mfma_f32_16x16x32_bf16 v[24:27], v[52:55], v[108:111], v[24:27]
    ds_write_b128 v244, v[32:35] offset:0
    s_waitcnt lgkmcnt(4)
    v_mfma_f32_16x16x32_bf16 v[28:31], v[88:91], v[112:115], v[28:31]
    ds_read_b128 v[128:131], v240 offset:1152
    v_mfma_f32_16x16x32_bf16 v[24:27], v[56:59], v[112:115], v[24:27]
    s_waitcnt lgkmcnt(4)
    v_mfma_f32_16x16x32_bf16 v[28:31], v[92:95], v[116:119], v[28:31]
    ds_read_b128 v[132:135], v240 offset:1088
    v_mfma_f32_16x16x32_bf16 v[24:27], v[60:63], v[116:119], v[24:27]
    s_waitcnt lgkmcnt(4)
    v_mfma_f32_16x16x32_bf16 v[28:31], v[96:99], v[120:123], v[28:31]
    ds_read_b128 v[136:139], v240 offset:1024
    v_mfma_f32_16x16x32_bf16 v[24:27], v[64:67], v[120:123], v[24:27]
    s_waitcnt lgkmcnt(4)
    v_mfma_f32_16x16x32_bf16 v[28:31], v[100:103], v[124:127], v[28:31]
    s_waitcnt vmcnt(15)
    v_cmp_ne_u32 vcc, 1, v228
    s_cbranch_vccz L_fh0_ok_8
    s_mov_b32 s74, 20000
L_fh0_spin_9:
    s_mov_b64 exec, vcc
    s_sleep 1
    buffer_load_dword v228, v229, s[12:15], s94 offen sc1
    s_waitcnt vmcnt(0)
    v_cmp_ne_u32 vcc, 1, v228
    s_mov_b64 exec, -1
    s_cbranch_vccz L_fh0_ok_8
    s_sub_u32 s74, s74, 1
    s_cmp_lg_u32 s74, 0
    s_cbranch_scc1 L_fh0_spin_9
L_fh0_ok_8:
    ds_read_b128 v[140:143], v240 offset:960
    v_mfma_f32_16x16x32_bf16 v[24:27], v[68:71], v[124:127], v[24:27]
    buffer_load_dwordx4 v[176:179], v222, s[16:19], s80 offen sc1
    s_waitcnt lgkmcnt(3)
    v_mfma_f32_16x16x32_bf16 v[24:27], v[72:75], v[128:131], v[24:27]
    ds_read_b128 v[104:107], v240 offset:896
    s_waitcnt lgkmcnt(3)
    v_mfma_f32_16x16x32_bf16 v[24:27], v[76:79], v[132:135], v[24:27]
    ds_read_b128 v[108:111], v240 offset:832
    s_waitcnt lgkmcnt(3)
    v_mfma_f32_16x16x32_bf16 v[24:27], v[80:83], v[136:139], v[24:27]
    ds_read_b128 v[112:115], v240 offset:768
    v_mfma_f32_16x16x32_bf16 v[20:23], v[48:51], v[136:139], 0
    buffer_load_dwordx4 v[180:183], v223, s[16:19], s80 offen sc1
    s_waitcnt lgkmcnt(3)
    v_mfma_f32_16x16x32_bf16 v[24:27], v[84:87], v[140:143], v[24:27]
    ds_read_b128 v[116:119], v240 offset:704
    v_mfma_f32_16x16x32_bf16 v[20:23], v[52:55], v[140:143], v[20:23]
    s_waitcnt lgkmcnt(3)
    v_mfma_f32_16x16x32_bf16 v[24:27], v[88:91], v[104:107], v[24:27]
    ds_read_b128 v[120:123], v240 offset:640
    v_mfma_f32_16x16x32_bf16 v[20:23], v[56:59], v[104:107], v[20:23]
    buffer_load_dwordx4 v[184:187], v224, s[16:19], s80 offen sc1
    s_waitcnt lgkmcnt(3)
    v_mfma_f32_16x16x32_bf16 v[24:27], v[92:95], v[108:111], v[24:27]
    ds_read_b128 v[124:127], v240 offset:576
    v_mfma_f32_16x16x32_bf16 v[20:23], v[60:63], v[108:111], v[20:23]
    s_waitcnt lgkmcnt(3)
    v_mfma_f32_16x16x32_bf16 v[24:27], v[96:99], v[112:115], v[24:27]
    ds_read_b128 v[128:131], v240 offset:512
    v_mfma_f32_16x16x32_bf16 v[20:23], v[64:67], v[112:115], v[20:23]
    buffer_load_dwordx4 v[188:191], v225, s[16:19], s80 offen sc1
    s_waitcnt lgkmcnt(3)
    v_mfma_f32_16x16x32_bf16 v[24:27], v[100:103], v[116:119], v[24:27]
    ds_read_b128 v[132:135], v240 offset:448
    v_mfma_f32_16x16x32_bf16 v[20:23], v[68:71], v[116:119], v[20:23]
    s_waitcnt lgkmcnt(3)
    v_mfma_f32_16x16x32_bf16 v[20:23], v[72:75], v[120:123], v[20:23]
    ds_read_b128 v[136:139], v240 offset:384
    s_waitcnt lgkmcnt(3)
    v_mfma_f32_16x16x32_bf16 v[20:23], v[76:79], v[124:127], v[20:23]
    ds_read_b128 v[140:143], v240 offset:320
    s_waitcnt lgkmcnt(3)
    v_mfma_f32_16x16x32_bf16 v[20:23], v[80:83], v[128:131], v[20:23]
    ds_read_b128 v[104:107], v240 offset:256
    v_mfma_f32_16x16x32_bf16 v[16:19], v[48:51], v[128:131], 0
    s_waitcnt lgkmcnt(3)
    v_mfma_f32_16x16x32_bf16 v[20:23], v[84:87], v[132:135], v[20:23]
    ds_read_b128 v[108:111], v240 offset:192
    v_mfma_f32_16x16x32_bf16 v[16:19], v[52:55], v[132:135], v[16:19]
    s_waitcnt lgkmcnt(3)
    v_mfma_f32_16x16x32_bf16 v[20:23], v[88:91], v[136:139], v[20:23]
    ds_read_b128 v[112:115], v240 offset:128
    v_mfma_f32_16x16x32_bf16 v[16:19], v[56:59], v[136:139], v[16:19]
    v_mov_b32 v11, 1
    s_mov_b64 exec, 1
    buffer_store_dword v11, off, s[12:15], s38 offset:0 sc1
    s_mov_b64 exec, -1
    s_waitcnt lgkmcnt(3)
    v_mfma_f32_16x16x32_bf16 v[20:23], v[92:95], v[140:143], v[20:23]
    ds_read_b128 v[116:119], v240 offset:64
    v_mfma_f32_16x16x32_bf16 v[16:19], v[60:63], v[140:143], v[16:19]
    s_waitcnt lgkmcnt(3)
    v_mfma_f32_16x16x32_bf16 v[20:23], v[96:99], v[104:107], v[20:23]
    v_mfma_f32_16x16x32_bf16 v[16:19], v[64:67], v[104:107], v[16:19]
    s_waitcnt lgkmcnt(2)
    v_mfma_f32_16x16x32_bf16 v[20:23], v[100:103], v[108:111], v[20:23]
    v_mfma_f32_16x16x32_bf16 v[16:19], v[68:71], v[108:111], v[16:19]
    s_waitcnt lgkmcnt(1)
    v_mfma_f32_16x16x32_bf16 v[16:19], v[72:75], v[112:115], v[16:19]
    s_waitcnt lgkmcnt(0)
    v_mfma_f32_16x16x32_bf16 v[16:19], v[76:79], v[116:119], v[16:19]
    s_branch L_convjoin_7
L_roleB_6:
    ds_read_b128 v[104:107], v240 offset:496
    ds_read_b128 v[108:111], v240 offset:512
    ds_read2_b32 v[56:57], v237 offset0:0 offset1:1
    ds_read2_b32 v[58:59], v237 offset0:2 offset1:3
    ds_read2_b32 v[48:49], v237 offset0:32 offset1:33
    ds_read2_b32 v[50:51], v237 offset0:34 offset1:35
    ds_read_b128 v[112:115], v240 offset:128
    ds_read_b128 v[116:119], v240 offset:64
    ds_read_b128 v[120:123], v240 offset:16
    v_mov_b32 v32, v188
    v_mov_b32 v33, v188
    v_mov_b32 v34, v188
    v_mov_b32 v35, v188
    s_waitcnt lgkmcnt(8)
    v_mfma_f32_16x16x32_bf16 v[128:131], v[104:107], v[192:195], 0
    ds_read2_b32 v[52:53], v237 offset0:16 offset1:17
    ds_read_b128 v[124:127], v240 offset:1008
    s_waitcnt lgkmcnt(9)
    v_mfma_f32_16x16x32_bf16 v[132:135], v[108:111], v[196:199], 0
    buffer_load_dwordx4 a[148:151], v220, s[20:23], s77 offen offset:2048 sc1
    ds_read2_b32 v[54:55], v237 offset0:18 offset1:19
    v_mfma_f32_16x16x32_bf16 v[136:139], v[108:111], v[192:195], 0
    ds_read2_b32 v[60:61], v238 offset0:192 offset1:193
    v_mfma_f32_16x16x32_bf16 v[140:143], v[108:111], v[200:203], 0
    buffer_load_dwordx4 a[152:155], v220, s[20:23], s77 offen offset:3072 sc1
    ds_read2_b32 v[62:63], v238 offset0:194 offset1:195
    v_mfma_f32_16x16x32_bf16 v[144:147], v[104:107], v[204:207], 0
    ds_read2_b32 v[64:65], v239 offset0:32 offset1:33
    ds_read_b128 v[104:107], v240 offset:1024
    v_mfma_f32_16x16x32_bf16 v[148:151], v[108:111], v[208:211], 0
    buffer_load_dwordx4 a[156:159], v221, s[20:23], s77 offen offset:0 sc1
    ds_read2_b32 v[66:67], v239 offset0:56 offset1:57
    s_waitcnt lgkmcnt(13)
    v_mfma_f32_16x16x32_bf16 v[40:43], v[56:59], v[108:111], v[188:191]
    ds_read2_b32 v[76:77], v239 offset0:80 offset1:81
    ds_read_b128 v[108:111], v240 offset:640
    s_waitcnt lgkmcnt(12)
    v_mfma_f32_16x16x32_bf16 v[36:39], v[48:51], v[112:115], v[188:191]
    s_mul_i32 s76, s88, 5
    buffer_load_dwordx4 a[160:163], v220, s[20:23], s76 offen offset:0 sc1
    ds_read2_b32 v[78:79], v239 offset0:104 offset1:105
    ds_read_b128 v[112:115], v240 offset:576
    v_cvt_pk_bf16_f32 v152, v128, v129
    v_cvt_pk_bf16_f32 v153, v130, v131
    s_waitcnt lgkmcnt(9)
    v_mfma_f32_16x16x32_bf16 v[36:39], v[52:55], v[116:119], v[36:39]
    ds_read2_b32 v[88:89], v239 offset0:144 offset1:145
    ds_read_b128 v[116:119], v240 offset:528
    v_cvt_pk_bf16_f32 v154, v132, v133
    v_cvt_pk_bf16_f32 v155, v134, v135
    s_waitcnt lgkmcnt(9)
    v_mfma_f32_16x16x32_bf16 v[44:47], v[60:63], v[120:123], v[188:191]
    buffer_load_dwordx4 a[164:167], v220, s[20:23], s76 offen offset:1024 sc1
    ds_read2_b32 v[90:91], v239 offset0:184 offset1:185
    ds_read_b128 v[120:123], v240 offset:1520
    v_cvt_pk_bf16_f32 v156, v136, v137
    v_cvt_pk_bf16_f32 v157, v138, v139
    v_cvt_pk_bf16_f32 v158, v140, v141
    v_cvt_pk_bf16_f32 v159, v142, v143
    v_cvt_pk_bf16_f32 v160, v144, v145
    v_cvt_pk_bf16_f32 v161, v146, v147
    v_cvt_pk_bf16_f32 v162, v148, v149
    v_cvt_pk_bf16_f32 v163, v150, v151
    v_mfma_f32_16x16x32_bf16 v[128:131], v[124:127], v[192:195], 0
    ds_read2_b32 v[68:69], v239 offset0:24 offset1:25
    s_waitcnt lgkmcnt(10)
    v_mfma_f32_16x16x32_bf16 v[132:135], v[104:107], v[196:199], 0
    buffer_load_dwordx4 a[168:171], v220, s[20:23], s76 offen offset:2048 sc1
    ds_read2_b32 v[70:71], v239 offset0:48 offset1:49
    ds_read2_b32 v[80:81], v239 offset0:72 offset1:73
    v_mfma_f32_16x16x32_bf16 v[136:139], v[104:107], v[192:195], 0
    ds_read2_b32 v[82:83], v239 offset0:96 offset1:97
    ds_read2_b32 v[92:93], v239 offset0:136 offset1:137
    v_mfma_f32_16x16x32_bf16 v[140:143], v[104:107], v[200:203], 0
    buffer_load_dwordx4 a[172:175], v220, s[20:23], s76 offen offset:3072 sc1
    ds_read2_b32 v[94:95], v239 offset0:176 offset1:177
    ds_read2_b32 v[72:73], v239 offset0:16 offset1:17
    v_mfma_f32_16x16x32_bf16 v[144:147], v[124:127], v[204:207], 0
    ds_read2_b32 v[74:75], v239 offset0:40 offset1:41
    ds_read2_b32 v[84:85], v239 offset0:64 offset1:65
    ds_read_b128 v[124:127], v240 offset:1536
    v_mfma_f32_16x16x32_bf16 v[148:151], v[104:107], v[208:211], 0
    ds_read2_b32 v[86:87], v239 offset0:88 offset1:89
    ds_read2_b32 v[96:97], v239 offset0:128 offset1:129
    v_mfma_f32_16x16x32_bf16 v[44:47], v[56:59], v[104:107], v[44:47]
    buffer_load_dwordx4 a[176:179], v221, s[20:23], s76 offen offset:0 sc1
    s_add_u32 s16, s64, s46
    s_addc_u32 s17, s65, 0
    s_mov_b32 s18, 221184
    s_mov_b32 s19, 0x20000
    v_min_u32 v229, 6, v0
    v_lshl_add_u32 v229, v229, 2, s28
    v_lshlrev_b32 v229, 7, v229
    ds_read2_b32 v[98:99], v239 offset0:168 offset1:169
    ds_read2_b32 v[100:101], v239 offset0:120 offset1:121
    ds_read_b128 v[104:107], v240 offset:1152
    s_waitcnt lgkmcnt(15)
    v_mfma_f32_16x16x32_bf16 v[40:43], v[48:51], v[108:111], v[40:43]
    ds_read2_b32 v[102:103], v239 offset0:160 offset1:161
    ds_read_b128 v[108:111], v240 offset:1088
    ds_write_b128 v244, v[36:39] offset:1024
    v_cvt_pk_bf16_f32 v164, v128, v129
    v_cvt_pk_bf16_f32 v165, v130, v131
    v_mfma_f32_16x16x32_bf16 v[40:43], v[52:55], v[112:115], v[40:43]
    s_mul_i32 s77, s89, 5
    buffer_load_dwordx4 a[180:183], v220, s[20:23], s77 offen offset:0 sc1
    ds_read_b128 v[112:115], v240 offset:1040
    ds_write_b128 v244, v[32:35] offset:0
    v_cvt_pk_bf16_f32 v166, v132, v133
    v_cvt_pk_bf16_f32 v167, v134, v135
    v_mfma_f32_16x16x32_bf16 v[16:19], v[60:63], v[116:119], 0
    ds_read_b128 v[116:119], v240 offset:2032
    v_cvt_pk_bf16_f32 v168, v136, v137
    v_cvt_pk_bf16_f32 v169, v138, v139
    v_mfma_f32_16x16x32_bf16 v[40:43], v[152:155], v[64:67], v[40:43]
    buffer_load_dwordx4 a[184:187], v220, s[20:23], s77 offen offset:1024 sc1
    s_add_u32 s68, s28, 1
    s_and_b32 s68, s68, 3
    s_mul_i32 s68, s68, 55296
    v_add_u32 v222, s68, v1
    s_add_u32 s68, s28, 2
    s_and_b32 s68, s68, 3
    s_mul_i32 s68, s68, 55296
    v_add_u32 v223, s68, v1
    s_add_u32 s68, s28, 3
    s_and_b32 s68, s68, 3
    s_mul_i32 s68, s68, 55296
    v_add_u32 v224, s68, v1
    s_add_u32 s68, s28, 4
    s_and_b32 s68, s68, 3
    s_mul_i32 s68, s68, 55296
    v_add_u32 v225, s68, v1
    v_cvt_pk_bf16_f32 v170, v140, v141
    v_cvt_pk_bf16_f32 v171, v142, v143
    v_mfma_f32_16x16x32_bf16 v[40:43], v[156:159], v[76:79], v[40:43]
    v_cvt_pk_bf16_f32 v172, v144, v145
    v_cvt_pk_bf16_f32 v173, v146, v147
    v_mfma_f32_16x16x32_bf16 v[16:19], v[160:163], v[88:91], v[16:19]
    buffer_load_dwordx4 a[188:191], v220, s[20:23], s77 offen offset:2048 sc1
    v_cvt_pk_bf16_f32 v174, v148, v149
    v_cvt_pk_bf16_f32 v175, v150, v151
    s_waitcnt lgkmcnt(15)
    v_mfma_f32_16x16x32_bf16 v[44:47], v[152:155], v[68:71], v[44:47]
    ds_write_b128 v244, v[40:43] offset:2048
    v_mfma_f32_16x16x32_bf16 v[44:47], v[156:159], v[80:83], v[44:47]
    buffer_load_dwordx4 a[192:195], v220, s[20:23], s77 offen offset:3072 sc1
    buffer_load_dword v228, v229, s[12:15], s94 offen sc1
    v_mfma_f32_16x16x32_bf16 v[20:23], v[160:163], v[92:95], 0
    s_waitcnt lgkmcnt(14)
    v_mfma_f32_16x16x32_bf16 v[16:19], v[152:155], v[72:75], v[16:19]
    buffer_load_dwordx4 a[196:199], v221, s[20:23], s77 offen offset:0 sc1
    s_waitcnt lgkmcnt(11)
    v_mfma_f32_16x16x32_bf16 v[16:19], v[156:159], v[84:87], v[16:19]
    s_waitcnt lgkmcnt(9)
    v_mfma_f32_16x16x32_bf16 v[24:27], v[160:163], v[96:99], 0
    s_mul_i32 s76, s90, 5
    buffer_load_dwordx4 a[200:203], v220, s[20:23], s76 offen offset:0 sc1
    s_waitcnt lgkmcnt(6)
    v_mfma_f32_16x16x32_bf16 v[28:31], v[160:163], v[100:103], 0
    v_mfma_f32_16x16x32_bf16 v[128:131], v[120:123], v[192:195], 0
    v_mfma_f32_16x16x32_bf16 v[132:135], v[124:127], v[196:199], 0
    buffer_load_dwordx4 a[204:207], v220, s[20:23], s76 offen offset:1024 sc1
    v_mfma_f32_16x16x32_bf16 v[136:139], v[124:127], v[192:195], 0
    buffer_load_dwordx4 a[208:211], v220, s[20:23], s76 offen offset:2048 sc1
    v_mfma_f32_16x16x32_bf16 v[140:143], v[124:127], v[200:203], 0
    v_mfma_f32_16x16x32_bf16 v[144:147], v[120:123], v[204:207], 0
    buffer_load_dwordx4 a[212:215], v220, s[20:23], s76 offen offset:3072 sc1
    ds_read_b128 v[120:123], v240 offset:2048
    v_mfma_f32_16x16x32_bf16 v[148:151], v[124:127], v[208:211], 0
    v_mfma_f32_16x16x32_bf16 v[16:19], v[56:59], v[124:127], v[16:19]
    buffer_load_dwordx4 a[216:219], v221, s[20:23], s76 offen offset:0 sc1
    ds_read_b128 v[124:127], v240 offset:1664
    v_mfma_f32_16x16x32_bf16 v[44:47], v[48:51], v[104:107], v[44:47]
    ds_read_b128 v[104:107], v240 offset:1600
    v_cvt_pk_bf16_f32 v152, v128, v129
    v_cvt_pk_bf16_f32 v153, v130, v131
    s_waitcnt lgkmcnt(8)
    v_mfma_f32_16x16x32_bf16 v[44:47], v[52:55], v[108:111], v[44:47]
    s_mul_i32 s77, s91, 5
    buffer_load_dwordx4 a[220:223], v220, s[20:23], s77 offen offset:0 sc1
    ds_read_b128 v[108:111], v240 offset:1552
    v_cvt_pk_bf16_f32 v154, v132, v133
    v_cvt_pk_bf16_f32 v155, v134, v135
    s_waitcnt lgkmcnt(7)
    v_mfma_f32_16x16x32_bf16 v[20:23], v[60:63], v[112:115], v[20:23]
    ds_read_b128 v[112:115], v240 offset:2544
    v_cvt_pk_bf16_f32 v156, v136, v137
    v_cvt_pk_bf16_f32 v157, v138, v139
    v_mfma_f32_16x16x32_bf16 v[44:47], v[164:167], v[64:67], v[44:47]
    buffer_load_dwordx4 a[224:227], v220, s[20:23], s77 offen offset:1024 sc1
    v_cvt_pk_bf16_f32 v158, v140, v141
    v_cvt_pk_bf16_f32 v159, v142, v143
    v_mfma_f32_16x16x32_bf16 v[44:47], v[168:171], v[76:79], v[44:47]
    v_cvt_pk_bf16_f32 v160, v144, v145
    v_cvt_pk_bf16_f32 v161, v146, v147
    v_mfma_f32_16x16x32_bf16 v[20:23], v[172:175], v[88:91], v[20:23]
    buffer_load_dwordx4 a[228:231], v220, s[20:23], s77 offen offset:2048 sc1
    v_cvt_pk_bf16_f32 v162, v148, v149
    v_cvt_pk_bf16_f32 v163, v150, v151
    v_mfma_f32_16x16x32_bf16 v[16:19], v[164:167], v[68:71], v[16:19]
    s_nop 0
    ds_write_b128 v244, v[44:47] offset:3072
    v_mfma_f32_16x16x32_bf16 v[16:19], v[168:171], v[80:83], v[16:19]
    v_mfma_f32_16x16x32_bf16 v[24:27], v[172:175], v[92:95], v[24:27]
    buffer_load_dwordx4 a[232:235], v220, s[20:23], s77 offen offset:3072 sc1
    v_mfma_f32_16x16x32_bf16 v[20:23], v[164:167], v[72:75], v[20:23]
    v_mfma_f32_16x16x32_bf16 v[20:23], v[168:171], v[84:87], v[20:23]
    buffer_load_dwordx4 a[236:239], v221, s[20:23], s77 offen offset:0 sc1
    v_mfma_f32_16x16x32_bf16 v[28:31], v[172:175], v[96:99], v[28:31]
    s_waitcnt lgkmcnt(7)
    v_mfma_f32_16x16x32_bf16 v[128:131], v[116:119], v[192:195], 0
    s_mul_i32 s76, s92, 5
    buffer_load_dwordx4 a[240:243], v220, s[20:23], s76 offen offset:0 sc1
    s_waitcnt lgkmcnt(5)
    v_mfma_f32_16x16x32_bf16 v[132:135], v[120:123], v[196:199], 0
    v_mfma_f32_16x16x32_bf16 v[136:139], v[120:123], v[192:195], 0
    buffer_load_dwordx4 a[244:247], v220, s[20:23], s76 offen offset:1024 sc1
    v_mfma_f32_16x16x32_bf16 v[140:143], v[120:123], v[200:203], 0
    v_mfma_f32_16x16x32_bf16 v[144:147], v[116:119], v[204:207], 0
    buffer_load_dwordx4 a[248:251], v220, s[20:23], s76 offen offset:2048 sc1
    ds_read_b128 v[116:119], v240 offset:2560
    v_mfma_f32_16x16x32_bf16 v[148:151], v[120:123], v[208:211], 0
    v_mfma_f32_16x16x32_bf16 v[20:23], v[56:59], v[120:123], v[20:23]
    buffer_load_dwordx4 a[252:255], v220, s[20:23], s76 offen offset:3072 sc1
    ds_read_b128 v[120:123], v240 offset:2176
    s_waitcnt lgkmcnt(6)
    v_mfma_f32_16x16x32_bf16 v[16:19], v[48:51], v[124:127], v[16:19]
    ds_read_b128 v[124:127], v240 offset:2112
    v_cvt_pk_bf16_f32 v164, v128, v129
    v_cvt_pk_bf16_f32 v165, v130, v131
    s_waitcnt lgkmcnt(6)
    v_mfma_f32_16x16x32_bf16 v[16:19], v[52:55], v[104:107], v[16:19]
    ds_read_b128 v[104:107], v240 offset:2064
    v_cvt_pk_bf16_f32 v166, v132, v133
    v_cvt_pk_bf16_f32 v167, v134, v135
    s_waitcnt lgkmcnt(6)
    v_mfma_f32_16x16x32_bf16 v[24:27], v[60:63], v[108:111], v[24:27]
    ds_read_b128 v[108:111], v240 offset:3056
    v_cvt_pk_bf16_f32 v168, v136, v137
    v_cvt_pk_bf16_f32 v169, v138, v139
    v_mfma_f32_16x16x32_bf16 v[16:19], v[152:155], v[64:67], v[16:19]
    v_cvt_pk_bf16_f32 v170, v140, v141
    v_cvt_pk_bf16_f32 v171, v142, v143
    v_mfma_f32_16x16x32_bf16 v[16:19], v[156:159], v[76:79], v[16:19]
    v_cvt_pk_bf16_f32 v172, v144, v145
    v_cvt_pk_bf16_f32 v173, v146, v147
    v_mfma_f32_16x16x32_bf16 v[24:27], v[160:163], v[88:91], v[24:27]
    v_cvt_pk_bf16_f32 v174, v148, v149
    v_cvt_pk_bf16_f32 v175, v150, v151
    v_mfma_f32_16x16x32_bf16 v[20:23], v[152:155], v[68:71], v[20:23]
    v_mfma_f32_16x16x32_bf16 v[20:23], v[156:159], v[80:83], v[20:23]
    v_mfma_f32_16x16x32_bf16 v[28:31], v[160:163], v[92:95], v[28:31]
    v_mfma_f32_16x16x32_bf16 v[24:27], v[152:155], v[72:75], v[24:27]
    v_mfma_f32_16x16x32_bf16 v[24:27], v[156:159], v[84:87], v[24:27]
    s_waitcnt lgkmcnt(6)
    v_mfma_f32_16x16x32_bf16 v[128:131], v[112:115], v[192:195], 0
    s_waitcnt vmcnt(15)
    v_cmp_ne_u32 vcc, 1, v228
    s_cbranch_vccz L_fh0_ok_10
    s_mov_b32 s74, 20000
L_fh0_spin_11:
    s_mov_b64 exec, vcc
    s_sleep 1
    buffer_load_dword v228, v229, s[12:15], s94 offen sc1
    s_waitcnt vmcnt(0)
    v_cmp_ne_u32 vcc, 1, v228
    s_mov_b64 exec, -1
    s_cbranch_vccz L_fh0_ok_10
    s_sub_u32 s74, s74, 1
    s_cmp_lg_u32 s74, 0
    s_cbranch_scc1 L_fh0_spin_11
L_fh0_ok_10:
    ds_read_b128 v[112:115], v240 offset:3072
    s_waitcnt lgkmcnt(5)
    v_mfma_f32_16x16x32_bf16 v[132:135], v[116:119], v[196:199], 0
    buffer_load_dwordx4 v[176:179], v222, s[16:19], s80 offen sc1
    v_mfma_f32_16x16x32_bf16 v[136:139], v[116:119], v[192:195], 0
    v_mfma_f32_16x16x32_bf16 v[140:143], v[116:119], v[200:203], 0
    v_mfma_f32_16x16x32_bf16 v[24:27], v[56:59], v[116:119], v[24:27]
    ds_read_b128 v[116:119], v240 offset:2688
    s_waitcnt lgkmcnt(5)
    v_mfma_f32_16x16x32_bf16 v[20:23], v[48:51], v[120:123], v[20:23]
    buffer_load_dwordx4 v[180:183], v223, s[16:19], s80 offen sc1
    ds_read_b128 v[120:123], v240 offset:2624
    v_cvt_pk_bf16_f32 v152, v128, v129
    v_cvt_pk_bf16_f32 v153, v130, v131
    s_waitcnt lgkmcnt(5)
    v_mfma_f32_16x16x32_bf16 v[20:23], v[52:55], v[124:127], v[20:23]
    ds_read_b128 v[124:127], v240 offset:3200
    v_cvt_pk_bf16_f32 v154, v132, v133
    v_cvt_pk_bf16_f32 v155, v134, v135
    s_waitcnt lgkmcnt(5)
    v_mfma_f32_16x16x32_bf16 v[28:31], v[60:63], v[104:107], v[28:31]
    ds_read_b128 v[104:107], v240 offset:3136
    v_cvt_pk_bf16_f32 v156, v136, v137
    v_cvt_pk_bf16_f32 v157, v138, v139
    v_mfma_f32_16x16x32_bf16 v[20:23], v[164:167], v[64:67], v[20:23]
    v_cvt_pk_bf16_f32 v158, v140, v141
    v_cvt_pk_bf16_f32 v159, v142, v143
    v_mfma_f32_16x16x32_bf16 v[20:23], v[168:171], v[76:79], v[20:23]
    buffer_load_dwordx4 v[184:187], v224, s[16:19], s80 offen sc1
    v_mfma_f32_16x16x32_bf16 v[28:31], v[172:175], v[88:91], v[28:31]
    v_mfma_f32_16x16x32_bf16 v[24:27], v[164:167], v[68:71], v[24:27]
    v_mfma_f32_16x16x32_bf16 v[24:27], v[168:171], v[80:83], v[24:27]
    v_mfma_f32_16x16x32_bf16 v[28:31], v[164:167], v[72:75], v[28:31]
    buffer_load_dwordx4 v[188:191], v225, s[16:19], s80 offen sc1
    v_mfma_f32_16x16x32_bf16 v[28:31], v[168:171], v[84:87], v[28:31]
    s_waitcnt lgkmcnt(5)
    v_mfma_f32_16x16x32_bf16 v[128:131], v[108:111], v[192:195], 0
    s_waitcnt lgkmcnt(4)
    v_mfma_f32_16x16x32_bf16 v[132:135], v[112:115], v[196:199], 0
    v_mfma_f32_16x16x32_bf16 v[136:139], v[112:115], v[192:195], 0
    v_mfma_f32_16x16x32_bf16 v[140:143], v[112:115], v[200:203], 0
    v_mfma_f32_16x16x32_bf16 v[28:31], v[56:59], v[112:115], v[28:31]
    s_waitcnt lgkmcnt(3)
    v_mfma_f32_16x16x32_bf16 v[24:27], v[48:51], v[116:119], v[24:27]
    s_nop 0
    v_cvt_pk_bf16_f32 v164, v128, v129
    v_cvt_pk_bf16_f32 v165, v130, v131
    s_waitcnt lgkmcnt(2)
    v_mfma_f32_16x16x32_bf16 v[24:27], v[52:55], v[120:123], v[24:27]
    v_cvt_pk_bf16_f32 v166, v132, v133
    v_cvt_pk_bf16_f32 v167, v134, v135
    s_waitcnt lgkmcnt(1)
    v_mfma_f32_16x16x32_bf16 v[28:31], v[48:51], v[124:127], v[28:31]
    v_mov_b32 v11, 1
    s_mov_b64 exec, 1
    buffer_store_dword v11, off, s[12:15], s38 offset:0 sc1
    s_mov_b64 exec, -1
    v_cvt_pk_bf16_f32 v168, v136, v137
    v_cvt_pk_bf16_f32 v169, v138, v139
    s_waitcnt lgkmcnt(0)
    v_mfma_f32_16x16x32_bf16 v[28:31], v[52:55], v[104:107], v[28:31]
    v_cvt_pk_bf16_f32 v170, v140, v141
    v_cvt_pk_bf16_f32 v171, v142, v143
    v_mfma_f32_16x16x32_bf16 v[24:27], v[152:155], v[64:67], v[24:27]
    v_mfma_f32_16x16x32_bf16 v[24:27], v[156:159], v[76:79], v[24:27]
    v_mfma_f32_16x16x32_bf16 v[28:31], v[152:155], v[68:71], v[28:31]
    v_mfma_f32_16x16x32_bf16 v[28:31], v[156:159], v[80:83], v[28:31]
    v_mfma_f32_16x16x32_bf16 v[28:31], v[164:167], v[64:67], v[28:31]
    v_mfma_f32_16x16x32_bf16 v[28:31], v[168:171], v[76:79], v[28:31]
L_convjoin_7:
    s_barrier
    ds_read_b128 v[32:35], v245 offset:0
    ds_read_b128 v[36:39], v245 offset:1024
    ds_read_b128 v[40:43], v245 offset:2048
    ds_read_b128 v[44:47], v245 offset:3072
    buffer_load_dwordx4 v[112:115], v222, s[16:19], s81 offen sc1
    buffer_load_dwordx4 v[116:119], v223, s[16:19], s81 offen sc1
    buffer_load_dwordx4 v[120:123], v224, s[16:19], s81 offen sc1
    s_waitcnt lgkmcnt(3)
    v_pk_add_f32 v[16:17], v[16:17], v[32:33]
    v_pk_add_f32 v[18:19], v[18:19], v[34:35]
    buffer_load_dwordx4 v[124:127], v225, s[16:19], s81 offen sc1
    s_waitcnt lgkmcnt(2)
    v_pk_add_f32 v[20:21], v[20:21], v[36:37]
    v_pk_add_f32 v[22:23], v[22:23], v[38:39]
    v_cvt_pk_bf16_f32 v48, v16, v17
    buffer_load_dwordx4 v[128:131], v222, s[16:19], s82 offen sc1
    v_cvt_pk_bf16_f32 v49, v18, v19
    v_cvt_pk_bf16_f32 v50, v20, v21
    v_cvt_pk_bf16_f32 v51, v22, v23
    buffer_load_dwordx4 v[132:135], v223, s[16:19], s82 offen sc1
    v_permlane16_swap_b32 v48, v50
    v_permlane16_swap_b32 v49, v51
    s_waitcnt lgkmcnt(1)
    v_pk_add_f32 v[24:25], v[24:25], v[40:41]
    buffer_load_dwordx4 v[136:139], v224, s[16:19], s82 offen sc1
    v_pk_add_f32 v[26:27], v[26:27], v[42:43]
    s_waitcnt lgkmcnt(0)
    v_pk_add_f32 v[28:29], v[28:29], v[44:45]
    v_pk_add_f32 v[30:31], v[30:31], v[46:47]
    buffer_load_dwordx4 v[140:143], v225, s[16:19], s82 offen sc1
    v_cvt_pk_bf16_f32 v52, v24, v25
    v_cvt_pk_bf16_f32 v53, v26, v27
    v_cvt_pk_bf16_f32 v54, v28, v29
    v_cvt_pk_bf16_f32 v55, v30, v31
    s_nop 0
    v_permlane16_swap_b32 v52, v54
    v_permlane16_swap_b32 v53, v55
    buffer_store_dwordx4 v[48:51], v246, s[12:15], s42 offen offset:0 sc1
    buffer_store_dwordx4 v[52:55], v246, s[12:15], s42 offen offset:1024 sc1
L_gemm2:
    s_waitcnt vmcnt(10)
    v_mfma_f32_16x16x32_bf16 v[16:19], a[0:3], v[176:179], 0
    buffer_load_dword v228, v229, s[12:15], s94 offen sc1
    s_add_u32 s94, s94, 131072
    v_mfma_f32_16x16x32_bf16 v[32:35], a[4:7], v[176:179], 0
    v_min_u32 v13, 19, v0
    s_lshl_b32 s68, s28, 4
    v_mfma_f32_16x16x32_bf16 v[48:51], a[8:11], v[176:179], 0
    s_mul_i32 s69, s28, -12
    s_add_u32 s69, s69, 48
    v_mfma_f32_16x16x32_bf16 v[64:67], a[12:15], v[176:179], 0
    v_mov_b32 v14, s69
    v_mfma_f32_16x16x32_bf16 v[80:83], a[16:19], v[176:179], 0
    buffer_load_dwordx4 v[144:147], v222, s[16:19], s83 offen sc1
    v_mfma_f32_16x16x32_bf16 v[20:23], a[0:3], v[180:183], 0
    v_cmp_lt_u32 vcc, 15, v13
    v_add_u32 v13, s68, v13
    s_nop 0
    v_cndmask_b32 v14, 0, v14, vcc
    v_mfma_f32_16x16x32_bf16 v[36:39], a[4:7], v[180:183], 0
    v_add_lshl_u32 v226, v13, v14, 7
    v_add_u32 v13, 0, v0
    v_mfma_f32_16x16x32_bf16 v[52:55], a[8:11], v[180:183], 0
    v_mul_u32_u24 v14, 6554, v13
    v_lshrrev_b32 v14, 16, v14
    v_mfma_f32_16x16x32_bf16 v[68:71], a[12:15], v[180:183], 0
    buffer_load_dwordx4 v[148:151], v223, s[16:19], s83 offen sc1
    v_mul_u32_u24 v15, 10, v14
    v_mfma_f32_16x16x32_bf16 v[84:87], a[16:19], v[180:183], 0
    v_sub_u32 v15, v13, v15
    v_mul_u32_u24 v13, 1280, v14
    v_mfma_f32_16x16x32_bf16 v[24:27], a[0:3], v[184:187], 0
    v_lshl_add_u32 v8, v15, 4, v13
    v_add_u32 v13, 64, v0
    v_mfma_f32_16x16x32_bf16 v[40:43], a[4:7], v[184:187], 0
    v_mul_u32_u24 v14, 6554, v13
    v_lshrrev_b32 v14, 16, v14
    v_mfma_f32_16x16x32_bf16 v[56:59], a[8:11], v[184:187], 0
    buffer_load_dwordx4 v[152:155], v224, s[16:19], s83 offen sc1
    v_mul_u32_u24 v15, 10, v14
    v_mfma_f32_16x16x32_bf16 v[72:75], a[12:15], v[184:187], 0
    v_sub_u32 v15, v13, v15
    v_mul_u32_u24 v13, 1280, v14
    v_mfma_f32_16x16x32_bf16 v[88:91], a[16:19], v[184:187], 0
    v_lshl_add_u32 v9, v15, 4, v13
    v_add_u32 v13, 128, v0
    v_mfma_f32_16x16x32_bf16 v[28:31], a[0:3], v[188:191], 0
    v_mul_u32_u24 v14, 6554, v13
    v_lshrrev_b32 v14, 16, v14
    v_mfma_f32_16x16x32_bf16 v[44:47], a[4:7], v[188:191], 0
    buffer_load_dwordx4 v[156:159], v225, s[16:19], s83 offen sc1
    v_mul_u32_u24 v15, 10, v14
    v_mfma_f32_16x16x32_bf16 v[60:63], a[8:11], v[188:191], 0
    v_sub_u32 v15, v13, v15
    v_mul_u32_u24 v13, 1280, v14
    v_mfma_f32_16x16x32_bf16 v[76:79], a[12:15], v[188:191], 0
    v_lshl_add_u32 v10, v15, 4, v13
    s_mul_i32 s97, s28, 3072
    v_mfma_f32_16x16x32_bf16 v[92:95], a[16:19], v[188:191], 0
    s_add_u32 s69, s97, 114688
    v_add_u32 v192, s69, v1
    s_waitcnt vmcnt(14)
    v_mfma_f32_16x16x32_bf16 v[16:19], a[20:23], v[112:115], v[16:19]
    buffer_load_dwordx4 v[160:163], v222, s[16:19], s84 offen sc1
    v_and_b32 v13, 15, v0
    v_mfma_f32_16x16x32_bf16 v[32:35], a[24:27], v[112:115], v[32:35]
    v_lshrrev_b32 v14, 4, v0
    v_mul_u32_u24 v15, 160, v13
    v_mfma_f32_16x16x32_bf16 v[48:51], a[28:31], v[112:115], v[48:51]
    v_add_u32 v15, s69, v15
    v_lshl_add_u32 v6, v14, 4, v15
    v_mfma_f32_16x16x32_bf16 v[64:67], a[32:35], v[112:115], v[64:67]
    v_lshl_add_u32 v3, v14, 3, v15
    v_and_b32 v14, 1, v14
    v_mfma_f32_16x16x32_bf16 v[80:83], a[36:39], v[112:115], v[80:83]
    buffer_load_dwordx4 v[164:167], v223, s[16:19], s84 offen sc1
    v_lshl_add_u32 v199, v14, 4, v15
    s_waitcnt vmcnt(15)
    v_mfma_f32_16x16x32_bf16 v[20:23], a[20:23], v[116:119], v[20:23]
    v_lshlrev_b32 v15, 5, v13
    v_lshl_add_u32 v15, v14, 4, v15
    v_mfma_f32_16x16x32_bf16 v[36:39], a[24:27], v[116:119], v[36:39]
    s_add_u32 s68, s97, 98304
    v_add_u32 v5, s68, v15
    v_mfma_f32_16x16x32_bf16 v[52:55], a[28:31], v[116:119], v[52:55]
    v_lshrrev_b32 v13, 1, v0
    v_and_b32 v14, 1, v0
    v_mfma_f32_16x16x32_bf16 v[68:71], a[32:35], v[116:119], v[68:71]
    buffer_load_dwordx4 v[168:171], v224, s[16:19], s84 offen sc1
    v_lshlrev_b32 v15, 12, v13
    v_mfma_f32_16x16x32_bf16 v[84:87], a[36:39], v[116:119], v[84:87]
    v_lshl_add_u32 v227, v14, 4, v15
    s_mul_i32 s68, s28, 15360
    s_waitcnt vmcnt(15)
    v_mfma_f32_16x16x32_bf16 v[24:27], a[20:23], v[120:123], v[24:27]
    v_lshl_add_u32 v198, v0, 3, s68
    s_add_u32 s68, s28, 1
    v_mfma_f32_16x16x32_bf16 v[40:43], a[24:27], v[120:123], v[40:43]
    s_and_b32 s68, s68, 3
    s_mul_i32 s68, s68, 15360
    v_mfma_f32_16x16x32_bf16 v[56:59], a[28:31], v[120:123], v[56:59]
    buffer_load_dwordx4 v[172:175], v225, s[16:19], s84 offen sc1
    s_add_u32 s68, s68, 0
    v_mfma_f32_16x16x32_bf16 v[72:75], a[32:35], v[120:123], v[72:75]
    v_lshl_add_u32 v195, v0, 3, s68
    s_add_u32 s68, s28, 2
    v_mfma_f32_16x16x32_bf16 v[88:91], a[36:39], v[120:123], v[88:91]
    s_and_b32 s68, s68, 3
    s_mul_i32 s68, s68, 15360
    s_waitcnt vmcnt(15)
    v_mfma_f32_16x16x32_bf16 v[28:31], a[20:23], v[124:127], v[28:31]
    s_add_u32 s68, s68, 5120
    v_lshl_add_u32 v196, v0, 3, s68
    v_mfma_f32_16x16x32_bf16 v[44:47], a[24:27], v[124:127], v[44:47]
    s_mul_i32 s76, s92, 5
    buffer_load_dwordx4 v[232:235], v221, s[20:23], s76 offen offset:0 sc1
    v_mfma_f32_16x16x32_bf16 v[60:63], a[28:31], v[124:127], v[60:63]
    s_add_u32 s68, s28, 3
    s_and_b32 s68, s68, 3
    v_mfma_f32_16x16x32_bf16 v[76:79], a[32:35], v[124:127], v[76:79]
    s_mul_i32 s68, s68, 15360
    s_add_u32 s68, s68, 10240
    v_mfma_f32_16x16x32_bf16 v[92:95], a[36:39], v[124:127], v[92:95]
    v_lshl_add_u32 v197, v0, 3, s68
    v_and_b32 v13, 15, v0
    s_waitcnt vmcnt(15)
    v_mfma_f32_16x16x32_bf16 v[16:19], a[40:43], v[128:131], v[16:19]
    buffer_load_dwordx4 v[96:99], v222, s[16:19], s85 offen sc1
    v_lshrrev_b32 v14, 4, v0
    v_mfma_f32_16x16x32_bf16 v[32:35], a[44:47], v[128:131], v[32:35]
    v_lshlrev_b32 v14, 3, v14
    v_sub_u32 v13, v13, v14
    v_mfma_f32_16x16x32_bf16 v[48:51], a[48:51], v[128:131], v[48:51]
    v_and_b32 v14, 1, v13
    v_lshlrev_b32 v14, 4, v14
    v_mfma_f32_16x16x32_bf16 v[64:67], a[52:55], v[128:131], v[64:67]
    v_mov_b32 v15, 0x3f80
    v_lshlrev_b32 v14, v14, v15
    v_mfma_f32_16x16x32_bf16 v[80:83], a[56:59], v[128:131], v[80:83]
    buffer_load_dwordx4 v[100:103], v223, s[16:19], s85 offen sc1
    v_ashrrev_i32 v13, 1, v13
    s_waitcnt vmcnt(16)
    v_mfma_f32_16x16x32_bf16 v[20:23], a[40:43], v[132:135], v[20:23]
    v_cmp_eq_i32 vcc, 0, v13
    s_nop 1
    v_cndmask_b32 v212, 0, v14, vcc
    v_mfma_f32_16x16x32_bf16 v[36:39], a[44:47], v[132:135], v[36:39]
    v_cmp_eq_i32 vcc, 1, v13
    s_nop 1
    v_cndmask_b32 v213, 0, v14, vcc
    v_mfma_f32_16x16x32_bf16 v[52:55], a[48:51], v[132:135], v[52:55]
    v_cmp_eq_i32 vcc, 2, v13
    s_nop 1
    v_cndmask_b32 v214, 0, v14, vcc
    v_mfma_f32_16x16x32_bf16 v[68:71], a[52:55], v[132:135], v[68:71]
    buffer_load_dwordx4 v[104:107], v224, s[16:19], s85 offen sc1
    v_mfma_f32_16x16x32_bf16 v[84:87], a[56:59], v[132:135], v[84:87]
    v_cmp_eq_i32 vcc, 3, v13
    s_nop 1
    v_cndmask_b32 v215, 0, v14, vcc
    s_waitcnt vmcnt(16)
    v_mfma_f32_16x16x32_bf16 v[24:27], a[40:43], v[136:139], v[24:27]
    v_cmp_eq_i32 vcc, -8, v13
    s_nop 1
    v_cndmask_b32 v216, 0, v14, vcc
    v_mfma_f32_16x16x32_bf16 v[40:43], a[44:47], v[136:139], v[40:43]
    v_cmp_eq_i32 vcc, -7, v13
    s_nop 1
    v_cndmask_b32 v217, 0, v14, vcc
    v_mfma_f32_16x16x32_bf16 v[56:59], a[48:51], v[136:139], v[56:59]
    buffer_load_dwordx4 v[108:111], v225, s[16:19], s85 offen sc1
    v_mfma_f32_16x16x32_bf16 v[72:75], a[52:55], v[136:139], v[72:75]
    v_cmp_eq_i32 vcc, -6, v13
    s_nop 1
    v_cndmask_b32 v218, 0, v14, vcc
    v_mfma_f32_16x16x32_bf16 v[88:91], a[56:59], v[136:139], v[88:91]
    v_cmp_eq_i32 vcc, -5, v13
    s_nop 1
    v_cndmask_b32 v219, 0, v14, vcc
    s_waitcnt vmcnt(16)
    v_mfma_f32_16x16x32_bf16 v[28:31], a[40:43], v[140:143], v[28:31]
    v_bfe_u32 v13, v0, 2, 2
    v_lshrrev_b32 v14, 4, v0
    v_mfma_f32_16x16x32_bf16 v[44:47], a[44:47], v[140:143], v[44:47]
    s_mul_i32 s77, s93, 5
    buffer_load_dwordx4 v[236:239], v220, s[20:23], s77 offen offset:0 sc1
    v_mfma_f32_16x16x32_bf16 v[60:63], a[48:51], v[140:143], v[60:63]
    v_and_b32 v15, 1, v0
    v_lshlrev_b32 v15, 4, v15
    v_mfma_f32_16x16x32_bf16 v[76:79], a[52:55], v[140:143], v[76:79]
    v_mov_b32 v12, 0x3f80
    v_lshlrev_b32 v15, v15, v12
    v_mfma_f32_16x16x32_bf16 v[92:95], a[56:59], v[140:143], v[92:95]
    v_cmp_eq_u32 vcc, v13, v14
    v_bfe_u32 v13, v0, 1, 1
    s_nop 0
    v_cndmask_b32 v15, 0, v15, vcc
    s_waitcnt vmcnt(14)
    v_cmp_ne_u32 vcc, 1, v228
    s_cbranch_vccz L_fh1_ok_25
    s_mov_b32 s74, 20000
L_fh1_spin_26:
    s_mov_b64 exec, vcc
    s_sleep 1
    buffer_load_dword v228, v229, s[12:15], s94 offen sc1
    s_waitcnt vmcnt(0)
    v_cmp_ne_u32 vcc, 1, v228
    s_mov_b64 exec, -1
    s_cbranch_vccz L_fh1_ok_25
    s_sub_u32 s74, s74, 1
    s_cmp_lg_u32 s74, 0
    s_cbranch_scc1 L_fh1_spin_26
L_fh1_ok_25:
    s_waitcnt vmcnt(13)
    v_mfma_f32_16x16x32_bf16 v[16:19], a[60:63], v[144:147], v[16:19]
    v_mov_b32 v11, 1
    s_mov_b64 exec, 1
    buffer_store_dword v11, off, s[12:15], s43 offset:0 sc1
    s_mov_b64 exec, -1
    v_mfma_f32_16x16x32_bf16 v[32:35], a[64:67], v[144:147], v[32:35]
    v_cmp_eq_u32 vcc, 0, v13
    s_nop 1
    v_cndmask_b32 v4, 0, v15, vcc
    v_cndmask_b32 v7, v15, 0, vcc
    v_mfma_f32_16x16x32_bf16 v[48:51], a[68:71], v[144:147], v[48:51]
    buffer_load_dwordx4 v[112:115], v222, s[16:19], s86 offen sc1
    v_mfma_f32_16x16x32_bf16 v[64:67], a[72:75], v[144:147], v[64:67]
    v_mfma_f32_16x16x32_bf16 v[80:83], a[76:79], v[144:147], v[80:83]
    buffer_load_dwordx4 v[116:119], v223, s[16:19], s86 offen sc1
    s_waitcnt vmcnt(15)
    v_mfma_f32_16x16x32_bf16 v[20:23], a[60:63], v[148:151], v[20:23]
    v_mfma_f32_16x16x32_bf16 v[36:39], a[64:67], v[148:151], v[36:39]
    buffer_load_dwordx4 v[120:123], v224, s[16:19], s86 offen sc1
    v_mfma_f32_16x16x32_bf16 v[52:55], a[68:71], v[148:151], v[52:55]
    v_mfma_f32_16x16x32_bf16 v[68:71], a[72:75], v[148:151], v[68:71]
    buffer_load_dwordx4 v[124:127], v225, s[16:19], s86 offen sc1
    v_mfma_f32_16x16x32_bf16 v[84:87], a[76:79], v[148:151], v[84:87]
    s_waitcnt vmcnt(16)
    v_mfma_f32_16x16x32_bf16 v[24:27], a[60:63], v[152:155], v[24:27]
    buffer_load_dwordx4 v[128:131], v222, s[16:19], s87 offen sc1
    v_mfma_f32_16x16x32_bf16 v[40:43], a[64:67], v[152:155], v[40:43]
    v_mfma_f32_16x16x32_bf16 v[56:59], a[68:71], v[152:155], v[56:59]
    buffer_load_dwordx4 v[132:135], v223, s[16:19], s87 offen sc1
    v_mfma_f32_16x16x32_bf16 v[72:75], a[72:75], v[152:155], v[72:75]
    v_mfma_f32_16x16x32_bf16 v[88:91], a[76:79], v[152:155], v[88:91]
    buffer_load_dwordx4 v[136:139], v224, s[16:19], s87 offen sc1
    s_waitcnt vmcnt(18)
    v_mfma_f32_16x16x32_bf16 v[28:31], a[60:63], v[156:159], v[28:31]
    v_mfma_f32_16x16x32_bf16 v[44:47], a[64:67], v[156:159], v[44:47]
    buffer_load_dwordx4 v[140:143], v225, s[16:19], s87 offen sc1
    v_mfma_f32_16x16x32_bf16 v[60:63], a[68:71], v[156:159], v[60:63]
    v_mfma_f32_16x16x32_bf16 v[76:79], a[72:75], v[156:159], v[76:79]
    buffer_load_dwordx4 v[240:243], v220, s[20:23], s77 offen offset:1024 sc1
    v_mfma_f32_16x16x32_bf16 v[92:95], a[76:79], v[156:159], v[92:95]
    s_waitcnt vmcnt(19)
    v_mfma_f32_16x16x32_bf16 v[16:19], a[80:83], v[160:163], v[16:19]
    buffer_load_dwordx4 v[144:147], v222, s[16:19], s88 offen sc1
    v_mfma_f32_16x16x32_bf16 v[32:35], a[84:87], v[160:163], v[32:35]
    v_mfma_f32_16x16x32_bf16 v[48:51], a[88:91], v[160:163], v[48:51]
    v_mfma_f32_16x16x32_bf16 v[64:67], a[92:95], v[160:163], v[64:67]
    v_mfma_f32_16x16x32_bf16 v[80:83], a[96:99], v[160:163], v[80:83]
    buffer_load_dwordx4 v[148:151], v223, s[16:19], s88 offen sc1
    s_waitcnt vmcnt(20)
    v_mfma_f32_16x16x32_bf16 v[20:23], a[80:83], v[164:167], v[20:23]
    v_mfma_f32_16x16x32_bf16 v[36:39], a[84:87], v[164:167], v[36:39]
    v_mfma_f32_16x16x32_bf16 v[52:55], a[88:91], v[164:167], v[52:55]
    v_mfma_f32_16x16x32_bf16 v[68:71], a[92:95], v[164:167], v[68:71]
    buffer_load_dwordx4 v[152:155], v224, s[16:19], s88 offen sc1
    v_mfma_f32_16x16x32_bf16 v[84:87], a[96:99], v[164:167], v[84:87]
    s_waitcnt vmcnt(20)
    v_mfma_f32_16x16x32_bf16 v[24:27], a[80:83], v[168:171], v[24:27]
    v_mfma_f32_16x16x32_bf16 v[40:43], a[84:87], v[168:171], v[40:43]
    v_mfma_f32_16x16x32_bf16 v[56:59], a[88:91], v[168:171], v[56:59]
    buffer_load_dwordx4 v[156:159], v225, s[16:19], s88 offen sc1
    v_mfma_f32_16x16x32_bf16 v[72:75], a[92:95], v[168:171], v[72:75]
    v_mfma_f32_16x16x32_bf16 v[88:91], a[96:99], v[168:171], v[88:91]
    s_waitcnt vmcnt(20)
    v_mfma_f32_16x16x32_bf16 v[28:31], a[80:83], v[172:175], v[28:31]
    v_mfma_f32_16x16x32_bf16 v[44:47], a[84:87], v[172:175], v[44:47]
    buffer_load_dwordx4 v[244:247], v220, s[20:23], s77 offen offset:2048 sc1
    v_mfma_f32_16x16x32_bf16 v[60:63], a[88:91], v[172:175], v[60:63]
    v_mfma_f32_16x16x32_bf16 v[76:79], a[92:95], v[172:175], v[76:79]
    v_mfma_f32_16x16x32_bf16 v[92:95], a[96:99], v[172:175], v[92:95]
    s_waitcnt vmcnt(19)
    v_mfma_f32_16x16x32_bf16 v[16:19], a[100:103], v[96:99], v[16:19]
    buffer_load_dwordx4 v[160:163], v222, s[16:19], s89 offen sc1
    v_mfma_f32_16x16x32_bf16 v[32:35], a[104:107], v[96:99], v[32:35]
    v_mfma_f32_16x16x32_bf16 v[48:51], a[108:111], v[96:99], v[48:51]
    v_mfma_f32_16x16x32_bf16 v[64:67], a[112:115], v[96:99], v[64:67]
    v_mfma_f32_16x16x32_bf16 v[80:83], a[116:119], v[96:99], v[80:83]
    buffer_load_dwordx4 v[164:167], v223, s[16:19], s89 offen sc1
    s_waitcnt vmcnt(20)
    v_mfma_f32_16x16x32_bf16 v[20:23], a[100:103], v[100:103], v[20:23]
    v_mfma_f32_16x16x32_bf16 v[36:39], a[104:107], v[100:103], v[36:39]
    v_mfma_f32_16x16x32_bf16 v[52:55], a[108:111], v[100:103], v[52:55]
    v_mfma_f32_16x16x32_bf16 v[68:71], a[112:115], v[100:103], v[68:71]
    buffer_load_dwordx4 v[168:171], v224, s[16:19], s89 offen sc1
    v_mfma_f32_16x16x32_bf16 v[84:87], a[116:119], v[100:103], v[84:87]
    s_waitcnt vmcnt(20)
    v_mfma_f32_16x16x32_bf16 v[24:27], a[100:103], v[104:107], v[24:27]
    v_mfma_f32_16x16x32_bf16 v[40:43], a[104:107], v[104:107], v[40:43]
    v_mfma_f32_16x16x32_bf16 v[56:59], a[108:111], v[104:107], v[56:59]
    buffer_load_dwordx4 v[172:175], v225, s[16:19], s89 offen sc1
    v_mfma_f32_16x16x32_bf16 v[72:75], a[112:115], v[104:107], v[72:75]
    v_mfma_f32_16x16x32_bf16 v[88:91], a[116:119], v[104:107], v[88:91]
    s_waitcnt vmcnt(20)
    v_mfma_f32_16x16x32_bf16 v[28:31], a[100:103], v[108:111], v[28:31]
    v_mfma_f32_16x16x32_bf16 v[44:47], a[104:107], v[108:111], v[44:47]
    buffer_load_dwordx4 v[248:251], v220, s[20:23], s77 offen offset:3072 sc1
    v_mfma_f32_16x16x32_bf16 v[60:63], a[108:111], v[108:111], v[60:63]
    v_mfma_f32_16x16x32_bf16 v[76:79], a[112:115], v[108:111], v[76:79]
    v_mfma_f32_16x16x32_bf16 v[92:95], a[116:119], v[108:111], v[92:95]
    s_waitcnt vmcnt(18)
    v_mfma_f32_16x16x32_bf16 v[16:19], a[120:123], v[112:115], v[16:19]
    buffer_load_dwordx4 v[96:99], v222, s[16:19], s90 offen sc1
    v_mfma_f32_16x16x32_bf16 v[32:35], a[124:127], v[112:115], v[32:35]
    v_mfma_f32_16x16x32_bf16 v[48:51], a[128:131], v[112:115], v[48:51]
    v_mfma_f32_16x16x32_bf16 v[64:67], a[132:135], v[112:115], v[64:67]
    v_mfma_f32_16x16x32_bf16 v[80:83], a[136:139], v[112:115], v[80:83]
    buffer_load_dwordx4 v[100:103], v223, s[16:19], s90 offen sc1
    s_waitcnt vmcnt(19)
    v_mfma_f32_16x16x32_bf16 v[20:23], a[120:123], v[116:119], v[20:23]
    v_mfma_f32_16x16x32_bf16 v[36:39], a[124:127], v[116:119], v[36:39]
    v_mfma_f32_16x16x32_bf16 v[52:55], a[128:131], v[116:119], v[52:55]
    v_mfma_f32_16x16x32_bf16 v[68:71], a[132:135], v[116:119], v[68:71]
    buffer_load_dwordx4 v[104:107], v224, s[16:19], s90 offen sc1
    v_mfma_f32_16x16x32_bf16 v[84:87], a[136:139], v[116:119], v[84:87]
    s_waitcnt vmcnt(19)
    v_mfma_f32_16x16x32_bf16 v[24:27], a[120:123], v[120:123], v[24:27]
    v_mfma_f32_16x16x32_bf16 v[40:43], a[124:127], v[120:123], v[40:43]
    v_mfma_f32_16x16x32_bf16 v[56:59], a[128:131], v[120:123], v[56:59]
    buffer_load_dwordx4 v[108:111], v225, s[16:19], s90 offen sc1
    v_mfma_f32_16x16x32_bf16 v[72:75], a[132:135], v[120:123], v[72:75]
    v_mfma_f32_16x16x32_bf16 v[88:91], a[136:139], v[120:123], v[88:91]
    s_waitcnt vmcnt(19)
    v_mfma_f32_16x16x32_bf16 v[28:31], a[120:123], v[124:127], v[28:31]
    v_mfma_f32_16x16x32_bf16 v[44:47], a[124:127], v[124:127], v[44:47]
    buffer_load_dwordx4 v[252:255], v221, s[20:23], s77 offen offset:0 sc1
    v_mfma_f32_16x16x32_bf16 v[60:63], a[128:131], v[124:127], v[60:63]
    v_mfma_f32_16x16x32_bf16 v[76:79], a[132:135], v[124:127], v[76:79]
    v_mfma_f32_16x16x32_bf16 v[92:95], a[136:139], v[124:127], v[92:95]
    s_waitcnt vmcnt(19)
    v_mfma_f32_16x16x32_bf16 v[16:19], a[140:143], v[128:131], v[16:19]
    buffer_load_dwordx4 v[112:115], v222, s[16:19], s91 offen sc1
    v_mfma_f32_16x16x32_bf16 v[32:35], a[144:147], v[128:131], v[32:35]
    v_mfma_f32_16x16x32_bf16 v[48:51], a[148:151], v[128:131], v[48:51]
    v_mfma_f32_16x16x32_bf16 v[64:67], a[152:155], v[128:131], v[64:67]
    v_mfma_f32_16x16x32_bf16 v[80:83], a[156:159], v[128:131], v[80:83]
    s_waitcnt vmcnt(19)
    v_mfma_f32_16x16x32_bf16 v[20:23], a[140:143], v[132:135], v[20:23]
    buffer_load_dwordx4 v[116:119], v223, s[16:19], s91 offen sc1
    v_mfma_f32_16x16x32_bf16 v[36:39], a[144:147], v[132:135], v[36:39]
    v_mfma_f32_16x16x32_bf16 v[52:55], a[148:151], v[132:135], v[52:55]
    v_mfma_f32_16x16x32_bf16 v[68:71], a[152:155], v[132:135], v[68:71]
    v_mfma_f32_16x16x32_bf16 v[84:87], a[156:159], v[132:135], v[84:87]
    s_waitcnt vmcnt(19)
    v_mfma_f32_16x16x32_bf16 v[24:27], a[140:143], v[136:139], v[24:27]
    buffer_load_dwordx4 v[120:123], v224, s[16:19], s91 offen sc1
    v_mfma_f32_16x16x32_bf16 v[40:43], a[144:147], v[136:139], v[40:43]
    v_mfma_f32_16x16x32_bf16 v[56:59], a[148:151], v[136:139], v[56:59]
    v_mfma_f32_16x16x32_bf16 v[72:75], a[152:155], v[136:139], v[72:75]
    v_mfma_f32_16x16x32_bf16 v[88:91], a[156:159], v[136:139], v[88:91]
    s_waitcnt vmcnt(19)
    v_mfma_f32_16x16x32_bf16 v[28:31], a[140:143], v[140:143], v[28:31]
    buffer_load_dwordx4 v[124:127], v225, s[16:19], s91 offen sc1
    v_mfma_f32_16x16x32_bf16 v[44:47], a[144:147], v[140:143], v[44:47]
    v_mfma_f32_16x16x32_bf16 v[60:63], a[148:151], v[140:143], v[60:63]
    v_mfma_f32_16x16x32_bf16 v[76:79], a[152:155], v[140:143], v[76:79]
    v_mfma_f32_16x16x32_bf16 v[92:95], a[156:159], v[140:143], v[92:95]
    s_waitcnt vmcnt(18)
    v_mfma_f32_16x16x32_bf16 v[16:19], a[160:163], v[144:147], v[16:19]
    buffer_load_dwordx4 v[128:131], v222, s[16:19], s92 offen sc1
    v_mfma_f32_16x16x32_bf16 v[32:35], a[164:167], v[144:147], v[32:35]
    v_mfma_f32_16x16x32_bf16 v[48:51], a[168:171], v[144:147], v[48:51]
    v_mfma_f32_16x16x32_bf16 v[64:67], a[172:175], v[144:147], v[64:67]
    v_mfma_f32_16x16x32_bf16 v[80:83], a[176:179], v[144:147], v[80:83]
    buffer_load_dwordx4 v[132:135], v223, s[16:19], s92 offen sc1
    s_waitcnt vmcnt(19)
    v_mfma_f32_16x16x32_bf16 v[20:23], a[160:163], v[148:151], v[20:23]
    v_mfma_f32_16x16x32_bf16 v[36:39], a[164:167], v[148:151], v[36:39]
    v_mfma_f32_16x16x32_bf16 v[52:55], a[168:171], v[148:151], v[52:55]
    v_mfma_f32_16x16x32_bf16 v[68:71], a[172:175], v[148:151], v[68:71]
    buffer_load_dwordx4 v[136:139], v224, s[16:19], s92 offen sc1
    v_mfma_f32_16x16x32_bf16 v[84:87], a[176:179], v[148:151], v[84:87]
    s_waitcnt vmcnt(19)
    v_mfma_f32_16x16x32_bf16 v[24:27], a[160:163], v[152:155], v[24:27]
    v_mfma_f32_16x16x32_bf16 v[40:43], a[164:167], v[152:155], v[40:43]
    v_mfma_f32_16x16x32_bf16 v[56:59], a[168:171], v[152:155], v[56:59]
    buffer_load_dwordx4 v[140:143], v225, s[16:19], s92 offen sc1
    v_mfma_f32_16x16x32_bf16 v[72:75], a[172:175], v[152:155], v[72:75]
    v_mfma_f32_16x16x32_bf16 v[88:91], a[176:179], v[152:155], v[88:91]
    s_waitcnt vmcnt(19)
    v_mfma_f32_16x16x32_bf16 v[28:31], a[160:163], v[156:159], v[28:31]
    v_mfma_f32_16x16x32_bf16 v[44:47], a[164:167], v[156:159], v[44:47]
    buffer_load_dword v2, v226, s[12:15], s48 offen sc1
    v_mfma_f32_16x16x32_bf16 v[60:63], a[168:171], v[156:159], v[60:63]
    v_mfma_f32_16x16x32_bf16 v[76:79], a[172:175], v[156:159], v[76:79]
    v_mfma_f32_16x16x32_bf16 v[92:95], a[176:179], v[156:159], v[92:95]
    s_waitcnt vmcnt(18)
    v_mfma_f32_16x16x32_bf16 v[16:19], a[180:183], v[160:163], v[16:19]
    buffer_load_dwordx4 v[144:147], v222, s[16:19], s93 offen sc1
    v_mfma_f32_16x16x32_bf16 v[32:35], a[184:187], v[160:163], v[32:35]
    v_mfma_f32_16x16x32_bf16 v[48:51], a[188:191], v[160:163], v[48:51]
    v_mfma_f32_16x16x32_bf16 v[64:67], a[192:195], v[160:163], v[64:67]
    v_mfma_f32_16x16x32_bf16 v[80:83], a[196:199], v[160:163], v[80:83]
    s_waitcnt vmcnt(18)
    v_mfma_f32_16x16x32_bf16 v[20:23], a[180:183], v[164:167], v[20:23]
    buffer_load_dwordx4 v[148:151], v223, s[16:19], s93 offen sc1
    v_mfma_f32_16x16x32_bf16 v[36:39], a[184:187], v[164:167], v[36:39]
    v_mfma_f32_16x16x32_bf16 v[52:55], a[188:191], v[164:167], v[52:55]
    v_mfma_f32_16x16x32_bf16 v[68:71], a[192:195], v[164:167], v[68:71]
    v_mfma_f32_16x16x32_bf16 v[84:87], a[196:199], v[164:167], v[84:87]
    s_waitcnt vmcnt(18)
    v_mfma_f32_16x16x32_bf16 v[24:27], a[180:183], v[168:171], v[24:27]
    buffer_load_dwordx4 v[152:155], v224, s[16:19], s93 offen sc1
    v_mfma_f32_16x16x32_bf16 v[40:43], a[184:187], v[168:171], v[40:43]
    v_mfma_f32_16x16x32_bf16 v[56:59], a[188:191], v[168:171], v[56:59]
    v_mfma_f32_16x16x32_bf16 v[72:75], a[192:195], v[168:171], v[72:75]
    v_mfma_f32_16x16x32_bf16 v[88:91], a[196:199], v[168:171], v[88:91]
    s_waitcnt vmcnt(18)
    v_mfma_f32_16x16x32_bf16 v[28:31], a[180:183], v[172:175], v[28:31]
    buffer_load_dwordx4 v[156:159], v225, s[16:19], s93 offen sc1
    v_mfma_f32_16x16x32_bf16 v[44:47], a[184:187], v[172:175], v[44:47]
    v_mfma_f32_16x16x32_bf16 v[60:63], a[188:191], v[172:175], v[60:63]
    v_mfma_f32_16x16x32_bf16 v[76:79], a[192:195], v[172:175], v[76:79]
    v_mfma_f32_16x16x32_bf16 v[92:95], a[196:199], v[172:175], v[92:95]
    s_waitcnt vmcnt(17)
    v_mfma_f32_16x16x32_bf16 v[16:19], a[200:203], v[96:99], v[16:19]
    s_add_u32 m0, s97, 114688
    s_nop 0
    buffer_load_dwordx4 v8, s[4:7], s49 offen  lds
    v_mfma_f32_16x16x32_bf16 v[32:35], a[204:207], v[96:99], v[32:35]
    v_mfma_f32_16x16x32_bf16 v[48:51], a[208:211], v[96:99], v[48:51]
    v_mfma_f32_16x16x32_bf16 v[64:67], a[212:215], v[96:99], v[64:67]
    v_mfma_f32_16x16x32_bf16 v[80:83], a[216:219], v[96:99], v[80:83]
    s_waitcnt vmcnt(17)
    v_mfma_f32_16x16x32_bf16 v[20:23], a[200:203], v[100:103], v[20:23]
    v_mfma_f32_16x16x32_bf16 v[36:39], a[204:207], v[100:103], v[36:39]
    s_add_u32 m0, s97, 115712
    s_nop 0
    buffer_load_dwordx4 v9, s[4:7], s49 offen  lds
    v_mfma_f32_16x16x32_bf16 v[52:55], a[208:211], v[100:103], v[52:55]
    v_mfma_f32_16x16x32_bf16 v[68:71], a[212:215], v[100:103], v[68:71]
    v_mfma_f32_16x16x32_bf16 v[84:87], a[216:219], v[100:103], v[84:87]
    s_waitcnt vmcnt(17)
    v_mfma_f32_16x16x32_bf16 v[24:27], a[200:203], v[104:107], v[24:27]
    v_mfma_f32_16x16x32_bf16 v[40:43], a[204:207], v[104:107], v[40:43]
    v_mfma_f32_16x16x32_bf16 v[56:59], a[208:211], v[104:107], v[56:59]
    v_mfma_f32_16x16x32_bf16 v[72:75], a[212:215], v[104:107], v[72:75]
    s_add_u32 m0, s97, 116736
    s_mov_b32 exec_hi, 0
    buffer_load_dwordx4 v10, s[4:7], s49 offen  lds
    s_mov_b32 exec_hi, -1
    v_mfma_f32_16x16x32_bf16 v[88:91], a[216:219], v[104:107], v[88:91]
    s_waitcnt vmcnt(17)
    v_mfma_f32_16x16x32_bf16 v[28:31], a[200:203], v[108:111], v[28:31]
    v_mfma_f32_16x16x32_bf16 v[44:47], a[204:207], v[108:111], v[44:47]
    v_mfma_f32_16x16x32_bf16 v[60:63], a[208:211], v[108:111], v[60:63]
    v_mfma_f32_16x16x32_bf16 v[76:79], a[212:215], v[108:111], v[76:79]
    v_mfma_f32_16x16x32_bf16 v[92:95], a[216:219], v[108:111], v[92:95]
    s_waitcnt vmcnt(7)
    v_cmp_ne_u32 vcc, 1, v2
    s_cbranch_vccz L_fy_ok_27
    s_mov_b32 s74, 20000
L_fy_spin_28:
    s_mov_b64 exec, vcc
    s_sleep 1
    buffer_load_dword v2, v226, s[12:15], s48 offen sc1
    s_waitcnt vmcnt(0)
    v_cmp_ne_u32 vcc, 1, v2
    s_mov_b64 exec, -1
    s_cbranch_vccz L_fy_ok_27
    s_sub_u32 s74, s74, 1
    s_cmp_lg_u32 s74, 0
    s_cbranch_scc1 L_fy_spin_28
L_fy_ok_27:
    s_barrier
    v_mfma_f32_16x16x32_bf16 v[16:19], a[220:223], v[112:115], v[16:19]
    s_add_u32 m0, s97, 98304
    s_nop 0
    buffer_load_dwordx4 v227, s[12:15], s47 offen sc1 lds
    s_add_u32 s47, s47, 131072
    v_mfma_f32_16x16x32_bf16 v[32:35], a[224:227], v[112:115], v[32:35]
    v_mfma_f32_16x16x32_bf16 v[48:51], a[228:231], v[112:115], v[48:51]
    v_mfma_f32_16x16x32_bf16 v[64:67], a[232:235], v[112:115], v[64:67]
    v_mfma_f32_16x16x32_bf16 v[80:83], a[236:239], v[112:115], v[80:83]
    s_add_u32 m0, s97, 99328
    s_nop 0
    buffer_load_dwordx4 v227, s[12:15], s47 offen sc1 lds
    s_add_u32 s47, s47, 131072
    v_mfma_f32_16x16x32_bf16 v[16:19], a[240:243], v[128:131], v[16:19]
    v_mfma_f32_16x16x32_bf16 v[32:35], a[244:247], v[128:131], v[32:35]
    v_mfma_f32_16x16x32_bf16 v[48:51], a[248:251], v[128:131], v[48:51]
    v_mfma_f32_16x16x32_bf16 v[64:67], a[252:255], v[128:131], v[64:67]
    s_add_u32 m0, s97, 100352
    s_mov_b32 exec_hi, 0
    buffer_load_dwordx4 v227, s[12:15], s47 offen sc1 lds
    s_mov_b32 exec_hi, -1
    v_mfma_f32_16x16x32_bf16 v[80:83], v[232:235], v[128:131], v[80:83]
    s_waitcnt vmcnt(9)
    v_mfma_f32_16x16x32_bf16 v[16:19], v[236:239], v[144:147], v[16:19]
    v_mfma_f32_16x16x32_bf16 v[32:35], v[240:243], v[144:147], v[32:35]
    v_mfma_f32_16x16x32_bf16 v[48:51], v[244:247], v[144:147], v[48:51]
    v_mfma_f32_16x16x32_bf16 v[64:67], v[248:251], v[144:147], v[64:67]
    v_mfma_f32_16x16x32_bf16 v[80:83], v[252:255], v[144:147], v[80:83]
    v_mfma_f32_16x16x32_bf16 v[20:23], a[220:223], v[116:119], v[20:23]
    v_mfma_f32_16x16x32_bf16 v[36:39], a[224:227], v[116:119], v[36:39]
    v_mfma_f32_16x16x32_bf16 v[52:55], a[228:231], v[116:119], v[52:55]
    s_nop 0
    v_cvt_pk_bf16_f32 v160, v16, v17
    v_cvt_pk_bf16_f32 v161, v18, v19
    v_mfma_f32_16x16x32_bf16 v[68:71], a[232:235], v[116:119], v[68:71]
    ds_write_b64 v195, v[160:161] offset:0
    v_mfma_f32_16x16x32_bf16 v[84:87], a[236:239], v[116:119], v[84:87]
    v_cvt_pk_bf16_f32 v162, v32, v33
    v_cvt_pk_bf16_f32 v163, v34, v35
    v_mfma_f32_16x16x32_bf16 v[20:23], a[240:243], v[132:135], v[20:23]
    ds_write_b64 v195, v[162:163] offset:512
    v_mfma_f32_16x16x32_bf16 v[36:39], a[244:247], v[132:135], v[36:39]
    v_cvt_pk_bf16_f32 v164, v48, v49
    v_cvt_pk_bf16_f32 v165, v50, v51
    v_mfma_f32_16x16x32_bf16 v[52:55], a[248:251], v[132:135], v[52:55]
    v_mfma_f32_16x16x32_bf16 v[68:71], a[252:255], v[132:135], v[68:71]
    ds_write_b64 v195, v[164:165] offset:1024
    v_mfma_f32_16x16x32_bf16 v[84:87], v[232:235], v[132:135], v[84:87]
    v_cvt_pk_bf16_f32 v166, v64, v65
    v_cvt_pk_bf16_f32 v167, v66, v67
    s_waitcnt vmcnt(8)
    v_mfma_f32_16x16x32_bf16 v[20:23], v[236:239], v[148:151], v[20:23]
    ds_write_b64 v195, v[166:167] offset:1536
    v_mfma_f32_16x16x32_bf16 v[36:39], v[240:243], v[148:151], v[36:39]
    v_cvt_pk_bf16_f32 v168, v80, v81
    v_cvt_pk_bf16_f32 v169, v82, v83
    v_mfma_f32_16x16x32_bf16 v[52:55], v[244:247], v[148:151], v[52:55]
    ds_write_b64 v195, v[168:169] offset:2048
    v_mfma_f32_16x16x32_bf16 v[68:71], v[248:251], v[148:151], v[68:71]
    v_mfma_f32_16x16x32_bf16 v[84:87], v[252:255], v[148:151], v[84:87]
    v_mfma_f32_16x16x32_bf16 v[24:27], a[220:223], v[120:123], v[24:27]
    v_mfma_f32_16x16x32_bf16 v[40:43], a[224:227], v[120:123], v[40:43]
    v_mfma_f32_16x16x32_bf16 v[56:59], a[228:231], v[120:123], v[56:59]
    v_cvt_pk_bf16_f32 v160, v20, v21
    v_cvt_pk_bf16_f32 v161, v22, v23
    v_mfma_f32_16x16x32_bf16 v[72:75], a[232:235], v[120:123], v[72:75]
    ds_write_b64 v196, v[160:161] offset:0
    v_mfma_f32_16x16x32_bf16 v[88:91], a[236:239], v[120:123], v[88:91]
    v_cvt_pk_bf16_f32 v162, v36, v37
    v_cvt_pk_bf16_f32 v163, v38, v39
    v_mfma_f32_16x16x32_bf16 v[24:27], a[240:243], v[136:139], v[24:27]
    ds_write_b64 v196, v[162:163] offset:512
    v_mfma_f32_16x16x32_bf16 v[40:43], a[244:247], v[136:139], v[40:43]
    v_cvt_pk_bf16_f32 v164, v52, v53
    v_cvt_pk_bf16_f32 v165, v54, v55
    v_mfma_f32_16x16x32_bf16 v[56:59], a[248:251], v[136:139], v[56:59]
    v_mfma_f32_16x16x32_bf16 v[72:75], a[252:255], v[136:139], v[72:75]
    ds_write_b64 v196, v[164:165] offset:1024
    v_mfma_f32_16x16x32_bf16 v[88:91], v[232:235], v[136:139], v[88:91]
    v_cvt_pk_bf16_f32 v166, v68, v69
    v_cvt_pk_bf16_f32 v167, v70, v71
    s_waitcnt vmcnt(7)
    v_mfma_f32_16x16x32_bf16 v[24:27], v[236:239], v[152:155], v[24:27]
    ds_write_b64 v196, v[166:167] offset:1536
    v_mfma_f32_16x16x32_bf16 v[40:43], v[240:243], v[152:155], v[40:43]
    v_cvt_pk_bf16_f32 v168, v84, v85
    v_cvt_pk_bf16_f32 v169, v86, v87
    v_mfma_f32_16x16x32_bf16 v[56:59], v[244:247], v[152:155], v[56:59]
    ds_write_b64 v196, v[168:169] offset:2048
    v_mfma_f32_16x16x32_bf16 v[72:75], v[248:251], v[152:155], v[72:75]
    v_mfma_f32_16x16x32_bf16 v[88:91], v[252:255], v[152:155], v[88:91]
    v_mfma_f32_16x16x32_bf16 v[28:31], a[220:223], v[124:127], v[28:31]
    v_mfma_f32_16x16x32_bf16 v[44:47], a[224:227], v[124:127], v[44:47]
    v_mfma_f32_16x16x32_bf16 v[60:63], a[228:231], v[124:127], v[60:63]
    v_cvt_pk_bf16_f32 v160, v24, v25
    v_cvt_pk_bf16_f32 v161, v26, v27
    ds_write_b64 v197, v[160:161] offset:0
    v_mfma_f32_16x16x32_bf16 v[76:79], a[232:235], v[124:127], v[76:79]
    v_cvt_pk_bf16_f32 v162, v40, v41
    v_cvt_pk_bf16_f32 v163, v42, v43
    v_mfma_f32_16x16x32_bf16 v[92:95], a[236:239], v[124:127], v[92:95]
    ds_write_b64 v197, v[162:163] offset:512
    v_mfma_f32_16x16x32_bf16 v[28:31], a[240:243], v[140:143], v[28:31]
    v_cvt_pk_bf16_f32 v164, v56, v57
    v_cvt_pk_bf16_f32 v165, v58, v59
    v_mfma_f32_16x16x32_bf16 v[44:47], a[244:247], v[140:143], v[44:47]
    ds_write_b64 v197, v[164:165] offset:1024
    v_mfma_f32_16x16x32_bf16 v[60:63], a[248:251], v[140:143], v[60:63]
    v_cvt_pk_bf16_f32 v166, v72, v73
    v_cvt_pk_bf16_f32 v167, v74, v75
    v_mfma_f32_16x16x32_bf16 v[76:79], a[252:255], v[140:143], v[76:79]
    ds_write_b64 v197, v[166:167] offset:1536
    v_mfma_f32_16x16x32_bf16 v[92:95], v[232:235], v[140:143], v[92:95]
    v_cvt_pk_bf16_f32 v168, v88, v89
    v_cvt_pk_bf16_f32 v169, v90, v91
    s_waitcnt vmcnt(6)
    v_mfma_f32_16x16x32_bf16 v[28:31], v[236:239], v[156:159], v[28:31]
    ds_write_b64 v197, v[168:169] offset:2048
    s_waitcnt vmcnt(0)
    v_mfma_f32_16x16x32_bf16 v[44:47], v[240:243], v[156:159], v[44:47]
    ds_read_b128 v[200:203], v6
    ds_read_b128 v[204:207], v6 offset:64
    v_mfma_f32_16x16x32_bf16 v[60:63], v[244:247], v[156:159], v[60:63]
    ds_read_b128 v[208:211], v199 offset:128
    ds_read_b128 v[172:175], v5 offset:0
    v_mfma_f32_16x16x32_bf16 v[76:79], v[248:251], v[156:159], v[76:79]
    ds_read_b128 v[176:179], v5 offset:512
    ds_read_b128 v[180:183], v5 offset:1024
    v_mfma_f32_16x16x32_bf16 v[92:95], v[252:255], v[156:159], v[92:95]
    ds_read_b128 v[184:187], v5 offset:1536
    ds_read_b128 v[188:191], v5 offset:2048
    s_waitcnt lgkmcnt(7)
    v_mfma_f32_16x16x32_bf16 v[28:31], v[212:215], v[200:203], v[28:31]
    v_mfma_f32_16x16x32_bf16 v[44:47], v[216:219], v[200:203], v[44:47]
    s_waitcnt lgkmcnt(6)
    v_mfma_f32_16x16x32_bf16 v[60:63], v[212:215], v[204:207], v[60:63]
    v_mfma_f32_16x16x32_bf16 v[76:79], v[216:219], v[204:207], v[76:79]
    s_waitcnt lgkmcnt(5)
    v_mfma_f32_16x16x32_bf16 v[92:95], v[212:215], v[208:211], v[92:95]
    s_waitcnt lgkmcnt(4)
    v_mfma_f32_16x16x32_bf16 v[28:31], v[172:175], v[212:215], v[28:31]
    s_waitcnt lgkmcnt(3)
    v_mfma_f32_16x16x32_bf16 v[44:47], v[176:179], v[212:215], v[44:47]
    s_waitcnt lgkmcnt(2)
    v_mfma_f32_16x16x32_bf16 v[60:63], v[180:183], v[212:215], v[60:63]
    s_waitcnt lgkmcnt(1)
    v_mfma_f32_16x16x32_bf16 v[76:79], v[184:187], v[212:215], v[76:79]
    s_waitcnt lgkmcnt(0)
    v_mfma_f32_16x16x32_bf16 v[92:95], v[188:191], v[212:215], v[92:95]
    v_mov_b32 v96, v4
    v_mov_b32 v97, v7
    v_mov_b32 v98, v4
    v_mov_b32 v99, v7
    v_mov_b32 v100, v4
    v_mov_b32 v101, v7
    v_mov_b32 v102, 0
    v_mov_b32 v103, 0
    v_mov_b32 v110, 0
    v_mov_b32 v111, 0
    v_mov_b32 v118, 0
    v_mov_b32 v119, 0
    v_mov_b32 v126, 0
    v_mov_b32 v127, 0
    v_mov_b32 v134, 0
    v_mov_b32 v135, 0
    v_mov_b32 v142, 0
    v_mov_b32 v143, 0
    s_barrier
    ds_read_b64 v[104:105], v198 offset:0
    ds_read_b64 v[106:107], v198 offset:5120
    ds_read_b64 v[108:109], v198 offset:10240
    ds_read_b64 v[112:113], v198 offset:512
    ds_read_b64 v[114:115], v198 offset:5632
    ds_read_b64 v[116:117], v198 offset:10752
    ds_read_b64 v[120:121], v198 offset:1024
    ds_read_b64 v[122:123], v198 offset:6144
    ds_read_b64 v[124:125], v198 offset:11264
    ds_read_b64 v[128:129], v198 offset:1536
    ds_read_b64 v[130:131], v198 offset:6656
    ds_read_b64 v[132:133], v198 offset:11776
    ds_read_b64 v[136:137], v198 offset:2048
    ds_read_b64 v[138:139], v198 offset:7168
    ds_read_b64 v[140:141], v198 offset:12288
    s_waitcnt lgkmcnt(13)
    v_mfma_f32_16x16x32_bf16 v[28:31], v[96:99], v[104:107], v[28:31]
    s_waitcnt lgkmcnt(12)
    v_mfma_f32_16x16x32_bf16 v[28:31], v[100:103], v[108:111], v[28:31]
    s_waitcnt lgkmcnt(10)
    v_mfma_f32_16x16x32_bf16 v[44:47], v[96:99], v[112:115], v[44:47]
    s_waitcnt lgkmcnt(9)
    v_mfma_f32_16x16x32_bf16 v[44:47], v[100:103], v[116:119], v[44:47]
    s_waitcnt lgkmcnt(7)
    v_mfma_f32_16x16x32_bf16 v[60:63], v[96:99], v[120:123], v[60:63]
    s_waitcnt lgkmcnt(6)
    v_mfma_f32_16x16x32_bf16 v[60:63], v[100:103], v[124:127], v[60:63]
    s_waitcnt lgkmcnt(4)
    v_mfma_f32_16x16x32_bf16 v[76:79], v[96:99], v[128:131], v[76:79]
    s_waitcnt lgkmcnt(3)
    v_mfma_f32_16x16x32_bf16 v[76:79], v[100:103], v[132:135], v[76:79]
    s_waitcnt lgkmcnt(1)
    v_mfma_f32_16x16x32_bf16 v[92:95], v[96:99], v[136:139], v[92:95]
    s_waitcnt lgkmcnt(0)
    v_mfma_f32_16x16x32_bf16 v[92:95], v[100:103], v[140:143], v[92:95]
    v_cvt_pk_bf16_f32 v160, v28, v29
    v_cvt_pk_bf16_f32 v161, v30, v31
    ds_write_b64 v3, v[160:161] offset:0
    v_cvt_pk_bf16_f32 v162, v44, v45
    v_cvt_pk_bf16_f32 v163, v46, v47
    ds_write_b64 v3, v[162:163] offset:32
    v_cvt_pk_bf16_f32 v164, v60, v61
    v_cvt_pk_bf16_f32 v165, v62, v63
    ds_write_b64 v3, v[164:165] offset:64
    v_cvt_pk_bf16_f32 v166, v76, v77
    v_cvt_pk_bf16_f32 v167, v78, v79
    ds_write_b64 v3, v[166:167] offset:96
    v_cvt_pk_bf16_f32 v168, v92, v93
    v_cvt_pk_bf16_f32 v169, v94, v95
    ds_write_b64 v3, v[168:169] offset:128
    ds_read_b128 v[172:175], v192 offset:0
    ds_read_b128 v[176:179], v192 offset:1024
    ds_read_b128 v[180:183], v192 offset:2048
    s_waitcnt lgkmcnt(2)
    buffer_store_dwordx4 v[172:175], v8, s[24:27], s49 offen nt
    s_waitcnt lgkmcnt(1)
    buffer_store_dwordx4 v[176:179], v9, s[24:27], s49 offen nt
    s_mov_b32 exec_hi, 0
    s_waitcnt lgkmcnt(0)
    buffer_store_dwordx4 v[180:183], v10, s[24:27], s49 offen nt
    s_mov_b32 exec_hi, -1
L_end:
    s_endpgm
L_spare:
    s_lshl_b32 s96, s29, 5
    s_add_u32 s96, s96, s30
    s_and_b32 s68, s30, 3
    s_lshr_b32 s34, s30, 2
    s_lshr_b32 s69, s29, 1
    s_lshl_b32 s69, s69, 2
    s_add_u32 s31, s69, s68
    s_and_b32 s69, s29, 1
    s_mul_i32 s69, s69, 7
    s_add_u32 s32, s69, s34
    s_mul_i32 s35, s29, 40
    v_lshrrev_b32 v13, 5, v0
    v_and_b32 v14, 31, v0
    v_mul_u32_u24 v15, 1280, v13
    v_lshl_add_u32 v76, v14, 4, v15
    v_lshl_add_u32 v77, v14, 3, v15
    s_mul_i32 s3, s96, 10240
    s_mul_i32 s69, s28, 2560
    s_add_u32 s3, s3, s69
    s_waitcnt lgkmcnt(0)
    s_mov_b32 s4, s36
    s_mov_b32 s5, s37
    s_mov_b32 s6, 2621440
    s_mov_b32 s7, 0x20000
    buffer_load_dwordx4 v[40:43], v76, s[4:7], s3 offen
    buffer_load_dwordx4 v[44:47], v76, s[4:7], s3 offen offset:512
    buffer_load_dwordx2 v[48:49], v77, s[4:7], s3 offen offset:1024
    s_mov_b32 s8, s52
    s_mov_b32 s9, s53
    s_mov_b32 s10, 2211840
    s_mov_b32 s11, 0x20000
    s_and_b32 s52, s28, 1
    s_lshr_b32 s53, s28, 1
    s_sub_u32 s68, s30, 28
    s_mul_i32 s69, s68, 3
    s_add_u32 s35, s35, s69
    s_add_u32 s35, s35, 28
    s_lshl_b32 s68, s2, 2
    s_add_u32 s68, s68, s28
    s_lshl_b32 s68, s68, 7
    s_add_u32 s98, s68, L_sc-L_pc
    s_load_dwordx16 s[80:95], s[66:67], s98
    s_add_u32 s98, s98, 64
    s_mov_b32 s12, s64
    s_mov_b32 s13, s65
    s_mov_b32 s14, 33554432
    s_mov_b32 s15, 0x20000
    s_mov_b32 s24, s60
    s_mov_b32 s25, s61
    s_mov_b32 s26, 2621440
    s_mov_b32 s27, 0x20000
    s_cmp_lg_u32 s2, 248
    s_cbranch_scc1 L_noclear_12
    v_mov_b32 v16, 0
    v_lshlrev_b32 v18, 7, v0
    s_lshl_b32 s70, s28, 13
    s_add_u32 s70, s70, 131072
    buffer_store_dword v16, v18, s[12:15], s70 offen sc1
L_noclear_12:
    v_lshrrev_b32 v14, 4, v0
    v_mul_u32_u24 v13, 1280, v14
    v_bfe_u32 v15, v0, 1, 3
    v_xor_b32 v15, v15, v14
    v_lshl_add_u32 v13, v15, 5, v13
    v_and_b32 v15, 1, v0
    v_lshl_add_u32 v13, v15, 4, v13
    s_mul_i32 s68, s28, 10240
    v_add_u32 v254, s68, v13
    v_xor_b32 v13, 128, v254
    v_add_u32 v255, 5120, v13
    s_mov_b32 s16, s56
    s_mov_b32 s17, s57
    s_mov_b32 s18, 2211840
    s_mov_b32 s19, 0x20000
    s_lshl_b32 s99, s28, 11
    s_mul_i32 s69, s2, 52429
    s_lshr_b32 s69, s69, 18
    s_mul_i32 s68, s69, 5
    s_sub_u32 s68, s2, s68
    s_mul_i32 s69, s69, 40960
    s_lshl_b32 s68, s68, 8
    s_add_u32 s71, s69, s68
    s_add_u32 m0, s99, 141824
    s_nop 0
    buffer_load_dwordx4 v254, s[16:19], s71 offen lds
    s_add_u32 m0, s99, 142848
    s_nop 0
    buffer_load_dwordx4 v255, s[16:19], s71 offen lds
    s_add_u32 s70, s2, 32
    s_mul_i32 s69, s70, 52429
    s_lshr_b32 s69, s69, 18
    s_mul_i32 s68, s69, 5
    s_sub_u32 s68, s70, s68
    s_mul_i32 s69, s69, 40960
    s_lshl_b32 s68, s68, 8
    s_add_u32 s71, s69, s68
    s_add_u32 m0, s99, 150016
    s_nop 0
    buffer_load_dwordx4 v254, s[16:19], s71 offen lds
    s_add_u32 m0, s99, 151040
    s_nop 0
    buffer_load_dwordx4 v255, s[16:19], s71 offen lds
    s_lshl_b32 s68, s35, 2
    s_load_dwordx2 s[54:55], s[58:59], s68
    s_add_u32 s68, s68, 8
    s_load_dword s61, s[58:59], s68
    s_lshl_b32 s68, s35, 1
    s_add_u32 s68, s68, s53
    s_lshl_b32 s74, s68, 1
    s_lshl_b32 s68, s68, 8
    s_lshl_b32 s69, s52, 7
    s_add_u32 s68, s68, s69
    v_lshl_add_u32 v100, v0, 1, s68
    v_mov_b32 v101, s74
    global_load_ushort v176, v100, s[38:39]
    global_load_ushort v177, v100, s[40:41]
    global_load_ushort v178, v100, s[42:43]
    global_load_ushort v179, v100, s[44:45]
    global_load_ushort v180, v101, s[46:47]
    global_load_ushort v181, v101, s[48:49]
    s_add_u32 s35, s35, 1
    s_mul_i32 s68, s28, 2688
    s_add_u32 s68, s68, 131072
    v_lshrrev_b32 v13, 5, v0
    v_lshlrev_b32 v15, 6, v13
    v_add3_u32 v78, v76, v15, s68
    v_add3_u32 v79, v77, v15, s68
    v_lshlrev_b32 v82, 3, v13
    v_bfe_u32 v14, v0, 2, 2
    v_mul_u32_u24 v14, 1344, v14
    v_and_b32 v15, 3, v0
    v_lshl_add_u32 v14, v15, 3, v14
    v_lshrrev_b32 v15, 4, v0
    s_lshl_b32 s68, s28, 7
    s_add_u32 s68, s68, 131072
    v_lshl_add_u32 v13, v15, 5, v14
    v_add_u32 v80, s68, v13
    v_and_b32 v15, 1, v15
    s_lshl_b32 s68, s28, 6
    s_add_u32 s68, s68, 132096
    v_lshl_add_u32 v13, v15, 5, v14
    v_add_u32 v81, s68, v13
    s_lshl_b32 s68, s96, 6
    s_lshl_b32 s69, s28, 4
    s_add_u32 s68, s68, s69
    s_add_u32 s76, s68, 65536
    s_mul_i32 s68, s96, 10240
    s_add_u32 s68, s68, 1048576
    s_lshl_b32 s69, s28, 10
    s_add_u32 s77, s69, s68
    s_lshl_b32 s69, s28, 9
    s_add_u32 s69, s69, s68
    s_add_u32 s60, s69, 8192
    v_mov_b32 v229, 0
    v_add_u32 v83, 4096, v1
    v_bfe_u32 v13, v0, 2, 3
    s_lshl_b32 s68, s28, 1
    v_xor_b32 v15, s68, v13
    v_lshrrev_b32 v14, 5, v0
    v_lshl_add_u32 v13, v14, 4, v13
    v_lshlrev_b32 v13, 8, v13
    v_lshl_add_u32 v13, v15, 5, v13
    v_and_b32 v15, 3, v0
    v_lshl_add_u32 v13, v15, 3, v13
    v_add_u32 v253, 141824, v13
    v_xor_b32 v230, 32, v253
    s_lshl_b32 s68, s35, 1
    s_add_u32 s68, s68, s53
    s_lshl_b32 s74, s68, 1
    s_lshl_b32 s68, s68, 8
    s_lshl_b32 s69, s52, 7
    s_add_u32 s68, s68, s69
    v_lshl_add_u32 v102, v0, 1, s68
    v_mov_b32 v103, s74
    global_load_ushort v88, v102, s[38:39]
    global_load_ushort v89, v102, s[40:41]
    global_load_ushort v90, v102, s[42:43]
    global_load_ushort v91, v102, s[44:45]
    global_load_ushort v92, v103, s[46:47]
    global_load_ushort v93, v103, s[48:49]
    s_add_u32 s35, s35, 1
    s_lshl_b32 s68, s35, 1
    s_add_u32 s68, s68, s53
    s_lshl_b32 s74, s68, 1
    s_lshl_b32 s68, s68, 8
    s_lshl_b32 s69, s52, 7
    s_add_u32 s68, s68, s69
    v_lshl_add_u32 v104, v0, 1, s68
    v_mov_b32 v105, s74
    global_load_ushort v94, v104, s[38:39]
    global_load_ushort v95, v104, s[40:41]
    global_load_ushort v96, v104, s[42:43]
    global_load_ushort v97, v104, s[44:45]
    global_load_ushort v98, v105, s[46:47]
    global_load_ushort v99, v105, s[48:49]
    s_load_dwordx16 s[36:51], s[66:67], s98
    v_and_b32 v13, 15, v0
    v_lshrrev_b32 v14, 4, v0
    s_mul_i32 s68, s53, 31008
    s_add_u32 s68, s68, 0
    s_lshl_b32 s70, s52, 8
    s_add_u32 s70, s70, s68
    v_lshl_add_u32 v222, v0, 2, s70
    v_mul_u32_u24 v15, 544, v13
    v_lshl_add_u32 v15, v14, 4, v15
    s_mul_i32 s70, s52, 8704
    s_add_u32 s70, s70, s68
    v_add_u32 v223, s70, v15
    s_add_u32 s68, s68, 17408
    v_add_u32 v224, s68, v15
    s_mul_i32 s68, s53, 1536
    s_add_u32 s68, s68, 148800
    v_mov_b32 v227, s68
    v_lshlrev_b32 v15, 4, v13
    v_lshl_add_u32 v225, v14, 3, v15
    v_lshlrev_b32 v15, 3, v13
    v_lshl_add_u32 v226, v14, 7, v15
    v_cmp_gt_u32 vcc, 2, v14
    v_lshlrev_b32 v15, 5, v13
    v_lshl_add_u32 v15, v14, 3, v15
    v_cndmask_b32 v225, v226, v225, vcc
    v_add_u32 v225, 512, v225
    s_cmp_eq_u32 s52, 0
    s_cselect_b64 s[70:71], -1, 0
    v_cndmask_b32 v225, v225, v15, s[70:71]
    v_add_u32 v225, s68, v225
    v_lshlrev_b32 v15, 2, v13
    v_lshl_add_u32 v15, v14, 7, v15
    v_add_u32 v15, 1024, v15
    v_mov_b32 v226, 1296
    v_cmp_gt_u32 vcc, 2, v14
    s_nop 1
    v_cndmask_b32 v226, v226, v15, vcc
    v_cmp_eq_u32 vcc, 32, v0
    v_mov_b32 v15, 1280
    s_nop 0
    v_cndmask_b32 v226, v226, v15, vcc
    v_add_u32 v226, s68, v226
    s_mul_i32 s68, s53, 4224
    s_add_u32 s68, s68, 131072
    s_lshl_b32 s69, s52, 10
    s_add_u32 s69, s69, s68
    v_add_u32 v236, s69, v1
    v_sub_u32 v15, 15, v13
    v_and_b32 v239, 1, v15
    v_mul_u32_u24 v239, 2110, v239
    v_lshl_add_u32 v15, v15, 1, v239
    v_add_u32 v15, s68, v15
    v_lshl_add_u32 v237, v14, 4, v15
    v_add_u32 v238, 1024, v237
    v_lshl_add_u32 v239, v14, 3, v15
    v_add_u32 v239, 1024, v239
    s_mul_i32 s68, s53, 4640
    s_add_u32 s68, s68, 139520
    v_min_u32 v15, 33, v0
    v_lshl_add_u32 v243, v15, 4, s68
    s_add_u32 s68, s68, 0
    v_lshlrev_b32 v15, 5, v13
    v_lshl_add_u32 v240, v14, 4, v15
    v_add_u32 v240, s68, v240
    v_and_b32 v246, 1, v14
    v_lshl_add_u32 v246, v246, 9, v15
    v_lshrrev_b32 v15, 1, v14
    v_lshl_add_u32 v246, v15, 4, v246
    v_lshrrev_b32 v13, 1, v0
    v_and_b32 v14, 1, v0
    v_mul_u32_u24 v15, 10240, v13
    v_lshl_add_u32 v241, v14, 4, v15
    v_mul_u32_u24 v14, 4640, v14
    v_lshl_add_u32 v13, v13, 4, v14
    s_lshl_b32 s68, s28, 10
    s_add_u32 s68, s68, 140064
    v_add_u32 v242, s68, v13
    s_lshl_b32 s68, s53, 13
    s_lshl_b32 s69, s52, 12
    s_add_u32 s68, s68, s69
    v_add_u32 v244, s68, v1
    v_xor_b32 v245, 4096, v244
    s_lshl_b32 s69, s52, 10
    s_add_u32 s69, s69, L_tab-L_pc
    v_add_u32 v13, s69, v1
    global_load_dwordx4 v[2:5], v13, s[66:67]
    s_lshl_b32 s69, s52, 8
    s_add_u32 s69, s69, L_tab-L_pc+2048
    v_lshl_add_u32 v13, v0, 2, s69
    global_load_dword v6, v13, s[66:67]
    s_waitcnt vmcnt(26)
    v_lshlrev_b32 v52, 16, v40
    v_and_b32 v53, 0xffff0000, v40
    v_lshlrev_b32 v54, 16, v41
    v_and_b32 v55, 0xffff0000, v41
    v_lshlrev_b32 v56, 16, v42
    v_and_b32 v57, 0xffff0000, v42
    v_lshlrev_b32 v58, 16, v43
    v_and_b32 v59, 0xffff0000, v43
    s_waitcnt vmcnt(25)
    v_lshlrev_b32 v60, 16, v44
    v_and_b32 v61, 0xffff0000, v44
    v_lshlrev_b32 v62, 16, v45
    v_and_b32 v63, 0xffff0000, v45
    v_lshlrev_b32 v64, 16, v46
    v_and_b32 v65, 0xffff0000, v46
    v_lshlrev_b32 v66, 16, v47
    v_and_b32 v67, 0xffff0000, v47
    s_waitcnt vmcnt(24)
    v_lshlrev_b32 v68, 16, v48
    v_and_b32 v69, 0xffff0000, v48
    v_lshlrev_b32 v70, 16, v49
    v_and_b32 v71, 0xffff0000, v49
    v_pk_add_f32 v[72:73], v[52:53], v[54:55]
    v_pk_add_f32 v[74:75], v[56:57], v[58:59]
    v_pk_add_f32 v[72:73], v[72:73], v[60:61]
    v_pk_add_f32 v[74:75], v[74:75], v[62:63]
    v_pk_add_f32 v[72:73], v[72:73], v[64:65]
    v_pk_add_f32 v[74:75], v[74:75], v[66:67]
    v_pk_add_f32 v[72:73], v[72:73], v[68:69]
    v_pk_add_f32 v[74:75], v[74:75], v[70:71]
    v_pk_add_f32 v[72:73], v[72:73], v[74:75]
    v_add_f32 v72, v72, v73
    s_nop 1
    v_add_f32_dpp v72, v72, v72 quad_perm:[1,0,3,2] row_mask:0xf bank_mask:0xf
    s_nop 1
    v_add_f32_dpp v72, v72, v72 quad_perm:[2,3,0,1] row_mask:0xf bank_mask:0xf
    s_nop 1
    v_add_f32_dpp v72, v72, v72 row_half_mirror row_mask:0xf bank_mask:0xf
    s_nop 1
    v_add_f32_dpp v72, v72, v72 row_mirror row_mask:0xf bank_mask:0xf
    v_mov_b32 v73, v72
    s_nop 1
    v_permlane16_swap_b32 v72, v73
    v_add_f32 v72, v72, v73
    v_mul_f32 v72, 0x3acccccd, v72
    v_pk_add_f32 v[52:53], v[52:53], v[72:73] op_sel_hi:[1,0] neg_lo:[0,1] neg_hi:[0,1]
    v_pk_add_f32 v[54:55], v[54:55], v[72:73] op_sel_hi:[1,0] neg_lo:[0,1] neg_hi:[0,1]
    v_pk_add_f32 v[56:57], v[56:57], v[72:73] op_sel_hi:[1,0] neg_lo:[0,1] neg_hi:[0,1]
    v_pk_add_f32 v[58:59], v[58:59], v[72:73] op_sel_hi:[1,0] neg_lo:[0,1] neg_hi:[0,1]
    v_pk_add_f32 v[60:61], v[60:61], v[72:73] op_sel_hi:[1,0] neg_lo:[0,1] neg_hi:[0,1]
    v_pk_add_f32 v[62:63], v[62:63], v[72:73] op_sel_hi:[1,0] neg_lo:[0,1] neg_hi:[0,1]
    v_pk_add_f32 v[64:65], v[64:65], v[72:73] op_sel_hi:[1,0] neg_lo:[0,1] neg_hi:[0,1]
    v_pk_add_f32 v[66:67], v[66:67], v[72:73] op_sel_hi:[1,0] neg_lo:[0,1] neg_hi:[0,1]
    v_pk_add_f32 v[68:69], v[68:69], v[72:73] op_sel_hi:[1,0] neg_lo:[0,1] neg_hi:[0,1]
    v_pk_add_f32 v[70:71], v[70:71], v[72:73] op_sel_hi:[1,0] neg_lo:[0,1] neg_hi:[0,1]
    v_pk_mul_f32 v[74:75], v[52:53], v[52:53]
    v_pk_mul_f32 v[50:51], v[54:55], v[54:55]
    v_pk_fma_f32 v[74:75], v[56:57], v[56:57], v[74:75]
    v_pk_fma_f32 v[50:51], v[58:59], v[58:59], v[50:51]
    v_pk_fma_f32 v[74:75], v[60:61], v[60:61], v[74:75]
    v_pk_fma_f32 v[50:51], v[62:63], v[62:63], v[50:51]
    v_pk_fma_f32 v[74:75], v[64:65], v[64:65], v[74:75]
    v_pk_fma_f32 v[50:51], v[66:67], v[66:67], v[50:51]
    v_pk_fma_f32 v[74:75], v[68:69], v[68:69], v[74:75]
    v_pk_fma_f32 v[50:51], v[70:71], v[70:71], v[50:51]
    v_pk_add_f32 v[74:75], v[74:75], v[50:51]
    v_add_f32 v74, v74, v75
    s_nop 1
    v_add_f32_dpp v74, v74, v74 quad_perm:[1,0,3,2] row_mask:0xf bank_mask:0xf
    s_nop 1
    v_add_f32_dpp v74, v74, v74 quad_perm:[2,3,0,1] row_mask:0xf bank_mask:0xf
    s_nop 1
    v_add_f32_dpp v74, v74, v74 row_half_mirror row_mask:0xf bank_mask:0xf
    s_nop 1
    v_add_f32_dpp v74, v74, v74 row_mirror row_mask:0xf bank_mask:0xf
    v_mov_b32 v75, v74
    s_nop 1
    v_permlane16_swap_b32 v74, v75
    v_add_f32 v74, v74, v75
    v_mul_f32 v74, 0x3acccccd, v74
    v_add_f32 v75, 0x3727c5ac, v74
    v_rsq_f32 v50, v75
    s_nop 0
    v_pk_mul_f32 v[52:53], v[52:53], v[50:51] op_sel_hi:[1,0]
    v_pk_mul_f32 v[54:55], v[54:55], v[50:51] op_sel_hi:[1,0]
    v_pk_mul_f32 v[56:57], v[56:57], v[50:51] op_sel_hi:[1,0]
    v_pk_mul_f32 v[58:59], v[58:59], v[50:51] op_sel_hi:[1,0]
    v_pk_mul_f32 v[60:61], v[60:61], v[50:51] op_sel_hi:[1,0]
    v_pk_mul_f32 v[62:63], v[62:63], v[50:51] op_sel_hi:[1,0]
    v_pk_mul_f32 v[64:65], v[64:65], v[50:51] op_sel_hi:[1,0]
    v_pk_mul_f32 v[66:67], v[66:67], v[50:51] op_sel_hi:[1,0]
    v_pk_mul_f32 v[68:69], v[68:69], v[50:51] op_sel_hi:[1,0]
    v_pk_mul_f32 v[70:71], v[70:71], v[50:51] op_sel_hi:[1,0]
    v_cvt_pk_bf16_f32 v40, v52, v53
    v_cvt_pk_bf16_f32 v41, v54, v55
    v_cvt_pk_bf16_f32 v42, v56, v57
    v_cvt_pk_bf16_f32 v43, v58, v59
    v_cvt_pk_bf16_f32 v44, v60, v61
    v_cvt_pk_bf16_f32 v45, v62, v63
    v_cvt_pk_bf16_f32 v46, v64, v65
    v_cvt_pk_bf16_f32 v47, v66, v67
    v_cvt_pk_bf16_f32 v48, v68, v69
    v_cvt_pk_bf16_f32 v49, v70, v71
    ds_write_b128 v78, v[40:43]
    ds_write_b128 v78, v[44:47] offset:512
    ds_write_b64 v79, v[48:49] offset:1024
    v_mul_f32 v74, v74, v50
    v_mul_f32 v74, v74, v50
    v_add_f32 v74, 0x3727c5ac, v74
    v_rsq_f32 v74, v74
    s_nop 0
    v_mul_f32 v50, v74, v50
    v_mul_f32 v51, v50, v72
    s_waitcnt vmcnt(20) lgkmcnt(0)
    s_barrier
    s_cmp_lg_u32 s2, 248
    s_cbranch_scc1 L_nogate_13
    v_mov_b32 v16, 0
    v_mov_b32 v17, 1
    s_mov_b64 exec, 1
    global_store_dword v16, v17, s[62:63] sc1
    s_mov_b64 exec, -1
L_nogate_13:
    ds_read_b64_tr_b16 v[52:53], v80 offset:0
    ds_read_b64_tr_b16 v[54:55], v80 offset:5376
    ds_read_b64_tr_b16 v[56:57], v80 offset:512
    ds_read_b64_tr_b16 v[58:59], v80 offset:5888
    ds_read_b64_tr_b16 v[60:61], v81 offset:0
    ds_read_b64_tr_b16 v[62:63], v81 offset:5376
    ds_read_b64_tr_b16 v[108:109], v253 offset:0
    ds_read_b64_tr_b16 v[110:111], v253 offset:2048
    ds_read_b64_tr_b16 v[112:113], v230 offset:0
    ds_read_b64_tr_b16 v[114:115], v230 offset:2048
    ds_read_b64_tr_b16 v[116:117], v253 offset:8192
    ds_read_b64_tr_b16 v[118:119], v253 offset:10240
    ds_read_b64_tr_b16 v[120:121], v230 offset:8192
    ds_read_b64_tr_b16 v[122:123], v230 offset:10240
    s_mov_b32 exec_lo, 1
    s_mov_b32 exec_hi, 1
    buffer_store_dwordx2 v[50:51], v82, s[12:15], s76 offen sc1
    s_mov_b64 exec, -1
    s_waitcnt lgkmcnt(12)
    buffer_store_dwordx4 v[52:55], v1, s[12:15], s77 offen sc1
    s_waitcnt lgkmcnt(10)
    buffer_store_dwordx4 v[56:59], v83, s[12:15], s77 offen sc1
    s_mov_b32 exec_hi, 0
    s_waitcnt lgkmcnt(8)
    buffer_store_dwordx4 v[60:63], v1, s[12:15], s60 offen sc1
    s_mov_b32 exec_hi, -1
    s_waitcnt lgkmcnt(6)
    buffer_store_dwordx4 v[108:111], v1, s[12:15], s50 offen sc1
    s_waitcnt lgkmcnt(4)
    buffer_store_dwordx4 v[112:115], v1, s[12:15], s95 offen sc1
    s_waitcnt lgkmcnt(2)
    buffer_store_dwordx4 v[116:119], v1, s[12:15], s36 offen sc1
    s_waitcnt lgkmcnt(0)
    buffer_store_dwordx4 v[120:123], v1, s[12:15], s37 offen sc1
    global_load_dword v228, v229, s[62:63] sc1
    v_lshl_add_u32 v124, v0, 8, s43
    v_mov_b32 v125, 0
    s_add_u32 s74, s38, 131072
    v_writelane_b32 v124, s38, 3
    v_writelane_b32 v124, s74, 4
    s_mov_b64 exec, 31
    buffer_store_dword v125, v124, s[12:15], 0 offen sc1
    s_mov_b64 exec, -1
    s_waitcnt vmcnt(17)
    v_lshl_or_b32 v29, v94, 16, v88
    s_waitcnt vmcnt(16)
    v_lshl_or_b32 v30, v95, 16, v89
    s_waitcnt vmcnt(15)
    v_lshl_or_b32 v31, v96, 16, v90
    s_waitcnt vmcnt(14)
    v_lshl_or_b32 v32, v97, 16, v91
    s_waitcnt vmcnt(13)
    v_lshl_or_b32 v33, v98, 16, v92
    s_waitcnt vmcnt(12)
    v_lshl_or_b32 v34, v99, 16, v93
    s_mul_i32 s68, s53, 31008
    s_lshl_b32 s69, s52, 8
    s_add_u32 s97, s68, s69
    s_add_u32 m0, s97, 0
    v_lshlrev_b32 v176, 16, v176
    v_lshlrev_b32 v177, 16, v177
    v_lshlrev_b32 v178, 16, v178
    v_lshlrev_b32 v179, 16, v179
    v_lshlrev_b32 v180, 16, v180
    v_lshlrev_b32 v181, 16, v181
    v_mul_f32 v189, 0x3fb8aa3b, v180
    v_mul_f32 v190, 0x3fb8aa3b, v176
    v_exp_f32 v189, v189
    v_exp_f32 v190, v190
    s_cmp_eq_u32 s52, 0
    s_cselect_b64 vcc, 1, 0
    v_cndmask_b32 v35, 0, v181, vcc
    v_cvt_pk_bf16_f32 v189, v189, v190
    v_lshlrev_b32 v186, 16, v189
    v_and_b32 v190, 0xffff0000, v189
    v_mul_f32 v190, v190, v186
    v_mul_f32 v185, v177, v186
    v_mul_f32 v184, 0xbfb8aa3b, v190
    v_mul_f32 v185, 0x3e22f983, v185
    v_add_f32 v186, v186, v186
    v_mul_f32 v166, v178, v186
    v_mul_f32 v167, v179, v186
    v_fract_f32 v190, v185
    v_exp_f32 v189, v184
    v_cos_f32 v168, v190
    v_sin_f32 v169, v190
    v_mul_f32 v168, v168, v189
    v_mul_f32 v169, v169, v189
    v_mul_f32 v190, 0x41800000, v185
    v_mul_f32 v189, 0x41800000, v184
    v_fract_f32 v190, v190
    v_exp_f32 v189, v189
    v_cos_f32 v170, v190
    v_sin_f32 v171, v190
    v_mul_f32 v170, v170, v189
    v_mul_f32_e64 v171, -v171, v189
    v_mul_f32 v190, 0x43800000, v185
    v_mul_f32 v189, 0x43800000, v184
    v_fract_f32 v190, v190
    v_exp_f32 v189, v189
    v_cos_f32 v172, v190
    v_sin_f32 v173, v190
    v_mul_f32 v172, v172, v189
    v_mul_f32 v173, v173, v189
    v_mov_b32 v137, 0x3f80
    v_cvt_pk_bf16_f32 v140, v166, v167
    ds_write_addtid_b32 v137 offset:22304
    ds_write_addtid_b32 v140 offset:0
    v_cvt_pk_bf16_f32 v138, v170, v171
    v_pk_mul_f32 v[178:179], v[166:167], v[168:169] op_sel:[0,0] op_sel_hi:[0,1]
    ds_write_addtid_b32 v138 offset:22848
    v_pk_fma_f32 v[178:179], v[166:167], v[168:169], v[178:179] op_sel:[1,1,0] op_sel_hi:[1,0,1] neg_lo:[1,0,0]
    v_pk_mul_f32 v[190:191], v[170:171], v[170:171] op_sel:[0,0] op_sel_hi:[0,1]
    v_cvt_pk_bf16_f32 v141, v178, v179
    v_pk_fma_f32 v[190:191], v[170:171], v[170:171], v[190:191] op_sel:[1,1,0] op_sel_hi:[1,0,1] neg_lo:[1,0,0]
    ds_write_addtid_b32 v141 offset:544
    v_cvt_pk_bf16_f32 v139, v190, v191
    v_pk_mul_f32 v[176:177], v[178:179], v[168:169] op_sel:[0,0] op_sel_hi:[0,1]
    ds_write_addtid_b32 v139 offset:23392
    v_pk_fma_f32 v[176:177], v[178:179], v[168:169], v[176:177] op_sel:[1,1,0] op_sel_hi:[1,0,1] neg_lo:[1,0,0]
    v_pk_mul_f32 v[188:189], v[190:191], v[170:171] op_sel:[0,0] op_sel_hi:[0,1]
    v_cvt_pk_bf16_f32 v142, v176, v177
    v_pk_fma_f32 v[188:189], v[190:191], v[170:171], v[188:189] op_sel:[1,1,0] op_sel_hi:[1,0,1] neg_lo:[1,0,0]
    ds_write_addtid_b32 v142 offset:1088
    v_cvt_pk_bf16_f32 v136, v188, v189
    v_pk_mul_f32 v[178:179], v[176:177], v[168:169] op_sel:[0,0] op_sel_hi:[0,1]
    ds_write_addtid_b32 v136 offset:23936
    v_pk_fma_f32 v[178:179], v[176:177], v[168:169], v[178:179] op_sel:[1,1,0] op_sel_hi:[1,0,1] neg_lo:[1,0,0]
    v_pk_mul_f32 v[190:191], v[188:189], v[170:171] op_sel:[0,0] op_sel_hi:[0,1]
    v_cvt_pk_bf16_f32 v143, v178, v179
    v_pk_fma_f32 v[190:191], v[188:189], v[170:171], v[190:191] op_sel:[1,1,0] op_sel_hi:[1,0,1] neg_lo:[1,0,0]
    ds_write_addtid_b32 v143 offset:1632
    v_cvt_pk_bf16_f32 v137, v190, v191
    v_pk_mul_f32 v[176:177], v[178:179], v[168:169] op_sel:[0,0] op_sel_hi:[0,1]
    ds_write_addtid_b32 v137 offset:24480
    v_pk_fma_f32 v[176:177], v[178:179], v[168:169], v[176:177] op_sel:[1,1,0] op_sel_hi:[1,0,1] neg_lo:[1,0,0]
    v_pk_mul_f32 v[188:189], v[190:191], v[170:171] op_sel:[0,0] op_sel_hi:[0,1]
    v_cvt_pk_bf16_f32 v140, v176, v177
    v_pk_fma_f32 v[188:189], v[190:191], v[170:171], v[188:189] op_sel:[1,1,0] op_sel_hi:[1,0,1] neg_lo:[1,0,0]
    ds_write_addtid_b32 v140 offset:2176
    v_cvt_pk_bf16_f32 v138, v188, v189
    v_pk_mul_f32 v[178:179], v[176:177], v[168:169] op_sel:[0,0] op_sel_hi:[0,1]
    ds_write_addtid_b32 v138 offset:25024
    v_pk_fma_f32 v[178:179], v[176:177], v[168:169], v[178:179] op_sel:[1,1,0] op_sel_hi:[1,0,1] neg_lo:[1,0,0]
    v_pk_mul_f32 v[190:191], v[188:189], v[170:171] op_sel:[0,0] op_sel_hi:[0,1]
    v_cvt_pk_bf16_f32 v141, v178, v179
    v_pk_fma_f32 v[190:191], v[188:189], v[170:171], v[190:191] op_sel:[1,1,0] op_sel_hi:[1,0,1] neg_lo:[1,0,0]
    ds_write_addtid_b32 v141 offset:2720
    v_cvt_pk_bf16_f32 v139, v190, v191
    v_pk_mul_f32 v[176:177], v[178:179], v[168:169] op_sel:[0,0] op_sel_hi:[0,1]
    ds_write_addtid_b32 v139 offset:25568
    v_pk_fma_f32 v[176:177], v[178:179], v[168:169], v[176:177] op_sel:[1,1,0] op_sel_hi:[1,0,1] neg_lo:[1,0,0]
    v_pk_mul_f32 v[188:189], v[190:191], v[170:171] op_sel:[0,0] op_sel_hi:[0,1]
    v_cvt_pk_bf16_f32 v142, v176, v177
    v_pk_fma_f32 v[188:189], v[190:191], v[170:171], v[188:189] op_sel:[1,1,0] op_sel_hi:[1,0,1] neg_lo:[1,0,0]
    ds_write_addtid_b32 v142 offset:3264
    v_cvt_pk_bf16_f32 v136, v188, v189
    v_pk_mul_f32 v[178:179], v[176:177], v[168:169] op_sel:[0,0] op_sel_hi:[0,1]
    ds_write_addtid_b32 v136 offset:26112
    v_pk_fma_f32 v[178:179], v[176:177], v[168:169], v[178:179] op_sel:[1,1,0] op_sel_hi:[1,0,1] neg_lo:[1,0,0]
    v_pk_mul_f32 v[190:191], v[188:189], v[170:171] op_sel:[0,0] op_sel_hi:[0,1]
    v_cvt_pk_bf16_f32 v143, v178, v179
    v_pk_fma_f32 v[190:191], v[188:189], v[170:171], v[190:191] op_sel:[1,1,0] op_sel_hi:[1,0,1] neg_lo:[1,0,0]
    ds_write_addtid_b32 v143 offset:3808
    v_cvt_pk_bf16_f32 v137, v190, v191
    v_pk_mul_f32 v[176:177], v[178:179], v[168:169] op_sel:[0,0] op_sel_hi:[0,1]
    ds_write_addtid_b32 v137 offset:26656
    v_pk_fma_f32 v[176:177], v[178:179], v[168:169], v[176:177] op_sel:[1,1,0] op_sel_hi:[1,0,1] neg_lo:[1,0,0]
    v_pk_mul_f32 v[188:189], v[190:191], v[170:171] op_sel:[0,0] op_sel_hi:[0,1]
    v_cvt_pk_bf16_f32 v140, v176, v177
    v_pk_fma_f32 v[188:189], v[190:191], v[170:171], v[188:189] op_sel:[1,1,0] op_sel_hi:[1,0,1] neg_lo:[1,0,0]
    ds_write_addtid_b32 v140 offset:4352
    v_cvt_pk_bf16_f32 v138, v188, v189
    v_pk_mul_f32 v[178:179], v[176:177], v[168:169] op_sel:[0,0] op_sel_hi:[0,1]
    ds_write_addtid_b32 v138 offset:27200
    v_pk_fma_f32 v[178:179], v[176:177], v[168:169], v[178:179] op_sel:[1,1,0] op_sel_hi:[1,0,1] neg_lo:[1,0,0]
    v_pk_mul_f32 v[190:191], v[188:189], v[170:171] op_sel:[0,0] op_sel_hi:[0,1]
    v_cvt_pk_bf16_f32 v141, v178, v179
    v_pk_fma_f32 v[190:191], v[188:189], v[170:171], v[190:191] op_sel:[1,1,0] op_sel_hi:[1,0,1] neg_lo:[1,0,0]
    ds_write_addtid_b32 v141 offset:4896
    v_cvt_pk_bf16_f32 v139, v190, v191
    v_pk_mul_f32 v[176:177], v[178:179], v[168:169] op_sel:[0,0] op_sel_hi:[0,1]
    ds_write_addtid_b32 v139 offset:27744
    v_pk_fma_f32 v[176:177], v[178:179], v[168:169], v[176:177] op_sel:[1,1,0] op_sel_hi:[1,0,1] neg_lo:[1,0,0]
    v_pk_mul_f32 v[188:189], v[190:191], v[170:171] op_sel:[0,0] op_sel_hi:[0,1]
    v_cvt_pk_bf16_f32 v142, v176, v177
    v_pk_fma_f32 v[188:189], v[190:191], v[170:171], v[188:189] op_sel:[1,1,0] op_sel_hi:[1,0,1] neg_lo:[1,0,0]
    ds_write_addtid_b32 v142 offset:5440
    v_cvt_pk_bf16_f32 v136, v188, v189
    v_pk_mul_f32 v[178:179], v[176:177], v[168:169] op_sel:[0,0] op_sel_hi:[0,1]
    ds_write_addtid_b32 v136 offset:28288
    v_pk_fma_f32 v[178:179], v[176:177], v[168:169], v[178:179] op_sel:[1,1,0] op_sel_hi:[1,0,1] neg_lo:[1,0,0]
    v_pk_mul_f32 v[190:191], v[188:189], v[170:171] op_sel:[0,0] op_sel_hi:[0,1]
    v_cvt_pk_bf16_f32 v143, v178, v179
    v_pk_fma_f32 v[190:191], v[188:189], v[170:171], v[190:191] op_sel:[1,1,0] op_sel_hi:[1,0,1] neg_lo:[1,0,0]
    ds_write_addtid_b32 v143 offset:5984
    v_cvt_pk_bf16_f32 v137, v190, v191
    v_pk_mul_f32 v[176:177], v[178:179], v[168:169] op_sel:[0,0] op_sel_hi:[0,1]
    ds_write_addtid_b32 v137 offset:28832
    v_pk_fma_f32 v[176:177], v[178:179], v[168:169], v[176:177] op_sel:[1,1,0] op_sel_hi:[1,0,1] neg_lo:[1,0,0]
    v_pk_mul_f32 v[188:189], v[190:191], v[170:171] op_sel:[0,0] op_sel_hi:[0,1]
    v_cvt_pk_bf16_f32 v140, v176, v177
    v_pk_fma_f32 v[188:189], v[190:191], v[170:171], v[188:189] op_sel:[1,1,0] op_sel_hi:[1,0,1] neg_lo:[1,0,0]
    ds_write_addtid_b32 v140 offset:6528
    v_cvt_pk_bf16_f32 v138, v188, v189
    v_pk_mul_f32 v[178:179], v[176:177], v[168:169] op_sel:[0,0] op_sel_hi:[0,1]
    ds_write_addtid_b32 v138 offset:29376
    v_pk_fma_f32 v[178:179], v[176:177], v[168:169], v[178:179] op_sel:[1,1,0] op_sel_hi:[1,0,1] neg_lo:[1,0,0]
    v_pk_mul_f32 v[190:191], v[188:189], v[170:171] op_sel:[0,0] op_sel_hi:[0,1]
    v_cvt_pk_bf16_f32 v141, v178, v179
    v_pk_fma_f32 v[190:191], v[188:189], v[170:171], v[190:191] op_sel:[1,1,0] op_sel_hi:[1,0,1] neg_lo:[1,0,0]
    ds_write_addtid_b32 v141 offset:7072
    v_cvt_pk_bf16_f32 v139, v190, v191
    v_pk_mul_f32 v[176:177], v[178:179], v[168:169] op_sel:[0,0] op_sel_hi:[0,1]
    ds_write_addtid_b32 v139 offset:29920
    v_pk_fma_f32 v[176:177], v[178:179], v[168:169], v[176:177] op_sel:[1,1,0] op_sel_hi:[1,0,1] neg_lo:[1,0,0]
    v_pk_mul_f32 v[188:189], v[190:191], v[170:171] op_sel:[0,0] op_sel_hi:[0,1]
    v_cvt_pk_bf16_f32 v142, v176, v177
    v_pk_fma_f32 v[188:189], v[190:191], v[170:171], v[188:189] op_sel:[1,1,0] op_sel_hi:[1,0,1] neg_lo:[1,0,0]
    ds_write_addtid_b32 v142 offset:7616
    v_cvt_pk_bf16_f32 v136, v188, v189
    v_pk_mul_f32 v[178:179], v[176:177], v[168:169] op_sel:[0,0] op_sel_hi:[0,1]
    ds_write_addtid_b32 v136 offset:30464
    v_pk_fma_f32 v[178:179], v[176:177], v[168:169], v[178:179] op_sel:[1,1,0] op_sel_hi:[1,0,1] neg_lo:[1,0,0]
    v_cvt_pk_bf16_f32 v143, v178, v179
    ds_write_addtid_b32 v143 offset:8160
    v_pk_mul_f32 v[174:175], v[168:169], v[168:169] op_sel:[0,0] op_sel_hi:[0,1]
    v_pk_mul_f32 v[184:185], v[166:167], v[172:173] op_sel:[0,0] op_sel_hi:[0,1]
    v_pk_fma_f32 v[174:175], v[168:169], v[168:169], v[174:175] op_sel:[1,1,0] op_sel_hi:[1,0,1] neg_lo:[1,0,0]
    v_pk_fma_f32 v[184:185], v[166:167], v[172:173], v[184:185] op_sel:[1,1,0] op_sel_hi:[1,0,1] neg_lo:[1,0,0]
    v_pk_mul_f32 v[182:183], v[174:175], v[174:175] op_sel:[0,0] op_sel_hi:[0,1]
    v_pk_mul_f32 v[186:187], v[184:185], v[172:173] op_sel:[0,0] op_sel_hi:[0,1]
    v_pk_fma_f32 v[182:183], v[174:175], v[174:175], v[182:183] op_sel:[1,1,0] op_sel_hi:[1,0,1] neg_lo:[1,0,0]
    v_pk_fma_f32 v[186:187], v[184:185], v[172:173], v[186:187] op_sel:[1,1,0] op_sel_hi:[1,0,1] neg_lo:[1,0,0]
    v_pk_mul_f32 v[180:181], v[182:183], v[182:183] op_sel:[0,0] op_sel_hi:[0,1]
    v_pk_mul_f32 v[166:167], v[186:187], v[172:173] op_sel:[0,0] op_sel_hi:[0,1]
    v_pk_fma_f32 v[180:181], v[182:183], v[182:183], v[180:181] op_sel:[1,1,0] op_sel_hi:[1,0,1] neg_lo:[1,0,0]
    v_pk_fma_f32 v[166:167], v[186:187], v[172:173], v[166:167] op_sel:[1,1,0] op_sel_hi:[1,0,1] neg_lo:[1,0,0]
    v_cvt_pk_bf16_f32 v136, v184, v185
    v_cvt_pk_bf16_f32 v140, v186, v187
    ds_write_addtid_b32 v136 offset:8704
    ds_write_addtid_b32 v140 offset:13056
    v_pk_mul_f32 v[190:191], v[184:185], v[174:175] op_sel:[0,0] op_sel_hi:[0,1]
    v_pk_mul_f32 v[178:179], v[186:187], v[182:183] op_sel:[0,0] op_sel_hi:[0,1]
    v_pk_fma_f32 v[190:191], v[184:185], v[174:175], v[190:191] op_sel:[1,1,0] op_sel_hi:[1,0,1] neg_lo:[1,0,0]
    v_pk_fma_f32 v[178:179], v[186:187], v[182:183], v[178:179] op_sel:[1,1,0] op_sel_hi:[1,0,1] neg_lo:[1,0,0]
    v_cvt_pk_bf16_f32 v137, v190, v191
    v_cvt_pk_bf16_f32 v141, v178, v179
    ds_write_addtid_b32 v137 offset:9248
    ds_write_addtid_b32 v141 offset:13600
    v_pk_mul_f32 v[188:189], v[190:191], v[174:175] op_sel:[0,0] op_sel_hi:[0,1]
    v_pk_mul_f32 v[176:177], v[178:179], v[182:183] op_sel:[0,0] op_sel_hi:[0,1]
    v_pk_fma_f32 v[188:189], v[190:191], v[174:175], v[188:189] op_sel:[1,1,0] op_sel_hi:[1,0,1] neg_lo:[1,0,0]
    v_pk_fma_f32 v[176:177], v[178:179], v[182:183], v[176:177] op_sel:[1,1,0] op_sel_hi:[1,0,1] neg_lo:[1,0,0]
    v_cvt_pk_bf16_f32 v138, v188, v189
    v_cvt_pk_bf16_f32 v142, v176, v177
    ds_write_addtid_b32 v138 offset:9792
    ds_write_addtid_b32 v142 offset:14144
    v_pk_mul_f32 v[190:191], v[188:189], v[174:175] op_sel:[0,0] op_sel_hi:[0,1]
    v_pk_mul_f32 v[178:179], v[176:177], v[182:183] op_sel:[0,0] op_sel_hi:[0,1]
    v_pk_fma_f32 v[190:191], v[188:189], v[174:175], v[190:191] op_sel:[1,1,0] op_sel_hi:[1,0,1] neg_lo:[1,0,0]
    v_pk_fma_f32 v[178:179], v[176:177], v[182:183], v[178:179] op_sel:[1,1,0] op_sel_hi:[1,0,1] neg_lo:[1,0,0]
    v_cvt_pk_bf16_f32 v139, v190, v191
    v_cvt_pk_bf16_f32 v143, v178, v179
    ds_write_addtid_b32 v139 offset:10336
    ds_write_addtid_b32 v143 offset:14688
    v_pk_mul_f32 v[188:189], v[190:191], v[174:175] op_sel:[0,0] op_sel_hi:[0,1]
    v_cvt_pk_bf16_f32 v140, v166, v167
    v_pk_fma_f32 v[188:189], v[190:191], v[174:175], v[188:189] op_sel:[1,1,0] op_sel_hi:[1,0,1] neg_lo:[1,0,0]
    ds_write_addtid_b32 v140 offset:15232
    v_cvt_pk_bf16_f32 v136, v188, v189
    v_pk_mul_f32 v[178:179], v[166:167], v[182:183] op_sel:[0,0] op_sel_hi:[0,1]
    ds_write_addtid_b32 v136 offset:10880
    v_pk_fma_f32 v[178:179], v[166:167], v[182:183], v[178:179] op_sel:[1,1,0] op_sel_hi:[1,0,1] neg_lo:[1,0,0]
    v_pk_mul_f32 v[190:191], v[188:189], v[174:175] op_sel:[0,0] op_sel_hi:[0,1]
    v_cvt_pk_bf16_f32 v141, v178, v179
    v_pk_fma_f32 v[190:191], v[188:189], v[174:175], v[190:191] op_sel:[1,1,0] op_sel_hi:[1,0,1] neg_lo:[1,0,0]
    ds_write_addtid_b32 v141 offset:15776
    v_cvt_pk_bf16_f32 v137, v190, v191
    v_pk_mul_f32 v[176:177], v[178:179], v[182:183] op_sel:[0,0] op_sel_hi:[0,1]
    ds_write_addtid_b32 v137 offset:11424
    v_pk_fma_f32 v[176:177], v[178:179], v[182:183], v[176:177] op_sel:[1,1,0] op_sel_hi:[1,0,1] neg_lo:[1,0,0]
    v_pk_mul_f32 v[188:189], v[190:191], v[174:175] op_sel:[0,0] op_sel_hi:[0,1]
    v_cvt_pk_bf16_f32 v142, v176, v177
    v_pk_fma_f32 v[188:189], v[190:191], v[174:175], v[188:189] op_sel:[1,1,0] op_sel_hi:[1,0,1] neg_lo:[1,0,0]
    ds_write_addtid_b32 v142 offset:16320
    v_cvt_pk_bf16_f32 v138, v188, v189
    v_pk_mul_f32 v[178:179], v[176:177], v[182:183] op_sel:[0,0] op_sel_hi:[0,1]
    ds_write_addtid_b32 v138 offset:11968
    v_pk_fma_f32 v[178:179], v[176:177], v[182:183], v[178:179] op_sel:[1,1,0] op_sel_hi:[1,0,1] neg_lo:[1,0,0]
    v_pk_mul_f32 v[190:191], v[188:189], v[174:175] op_sel:[0,0] op_sel_hi:[0,1]
    v_cvt_pk_bf16_f32 v143, v178, v179
    v_pk_fma_f32 v[190:191], v[188:189], v[174:175], v[190:191] op_sel:[1,1,0] op_sel_hi:[1,0,1] neg_lo:[1,0,0]
    ds_write_addtid_b32 v143 offset:16864
    v_cvt_pk_bf16_f32 v139, v190, v191
    ds_write_addtid_b32 v139 offset:12512
    v_pk_mul_f32 v[168:169], v[166:167], v[172:173] op_sel:[0,0] op_sel_hi:[0,1]
    v_pk_fma_f32 v[168:169], v[166:167], v[172:173], v[168:169] op_sel:[1,1,0] op_sel_hi:[1,0,1] neg_lo:[1,0,0]
    v_cvt_pk_bf16_f32 v136, v168, v169
    ds_write_addtid_b32 v136 offset:17408
    v_pk_mul_f32 v[170:171], v[168:169], v[172:173] op_sel:[0,0] op_sel_hi:[0,1]
    v_pk_mul_f32 v[176:177], v[168:169], v[180:181] op_sel:[0,0] op_sel_hi:[0,1]
    v_pk_fma_f32 v[170:171], v[168:169], v[172:173], v[170:171] op_sel:[1,1,0] op_sel_hi:[1,0,1] neg_lo:[1,0,0]
    v_pk_fma_f32 v[176:177], v[168:169], v[180:181], v[176:177] op_sel:[1,1,0] op_sel_hi:[1,0,1] neg_lo:[1,0,0]
    v_cvt_pk_bf16_f32 v138, v170, v171
    v_cvt_pk_bf16_f32 v141, v176, v177
    ds_write_addtid_b32 v138 offset:18496
    ds_write_addtid_b32 v141 offset:17952
    v_pk_mul_f32 v[174:175], v[170:171], v[172:173] op_sel:[0,0] op_sel_hi:[0,1]
    v_pk_mul_f32 v[178:179], v[170:171], v[180:181] op_sel:[0,0] op_sel_hi:[0,1]
    v_pk_fma_f32 v[174:175], v[170:171], v[172:173], v[174:175] op_sel:[1,1,0] op_sel_hi:[1,0,1] neg_lo:[1,0,0]
    v_pk_fma_f32 v[178:179], v[170:171], v[180:181], v[178:179] op_sel:[1,1,0] op_sel_hi:[1,0,1] neg_lo:[1,0,0]
    v_cvt_pk_bf16_f32 v136, v174, v175
    v_cvt_pk_bf16_f32 v143, v178, v179
    ds_write_addtid_b32 v136 offset:19584
    ds_write_addtid_b32 v143 offset:19040
    v_pk_mul_f32 v[182:183], v[174:175], v[172:173] op_sel:[0,0] op_sel_hi:[0,1]
    v_pk_mul_f32 v[176:177], v[174:175], v[180:181] op_sel:[0,0] op_sel_hi:[0,1]
    v_pk_fma_f32 v[182:183], v[174:175], v[172:173], v[182:183] op_sel:[1,1,0] op_sel_hi:[1,0,1] neg_lo:[1,0,0]
    v_pk_fma_f32 v[176:177], v[174:175], v[180:181], v[176:177] op_sel:[1,1,0] op_sel_hi:[1,0,1] neg_lo:[1,0,0]
    v_cvt_pk_bf16_f32 v138, v182, v183
    v_cvt_pk_bf16_f32 v141, v176, v177
    ds_write_addtid_b32 v138 offset:20672
    ds_write_addtid_b32 v141 offset:20128
    v_pk_mul_f32 v[184:185], v[182:183], v[172:173] op_sel:[0,0] op_sel_hi:[0,1]
    v_pk_mul_f32 v[178:179], v[182:183], v[180:181] op_sel:[0,0] op_sel_hi:[0,1]
    v_pk_fma_f32 v[184:185], v[182:183], v[172:173], v[184:185] op_sel:[1,1,0] op_sel_hi:[1,0,1] neg_lo:[1,0,0]
    v_pk_fma_f32 v[178:179], v[182:183], v[180:181], v[178:179] op_sel:[1,1,0] op_sel_hi:[1,0,1] neg_lo:[1,0,0]
    v_cvt_pk_bf16_f32 v136, v184, v185
    v_cvt_pk_bf16_f32 v143, v178, v179
    ds_write_addtid_b32 v136 offset:21760
    ds_write_addtid_b32 v143 offset:21216
    s_waitcnt vmcnt(0)
    s_waitcnt lgkmcnt(0)
    s_barrier
    s_cmp_lg_u32 s28, 0
    s_cbranch_scc1 L_pub_skip_14
    v_cmp_ne_u32 vcc, 1, v228
    s_cbranch_vccz L_rdy_ok_15
    s_mov_b32 s74, 20000
L_rdy_spin_16:
    s_mov_b64 exec, vcc
    s_sleep 1
    global_load_dword v228, v229, s[62:63] sc1
    s_waitcnt vmcnt(0)
    v_cmp_ne_u32 vcc, 1, v228
    s_mov_b64 exec, -1
    s_cbranch_vccz L_rdy_ok_15
    s_sub_u32 s74, s74, 1
    s_cmp_lg_u32 s74, 0
    s_cbranch_scc1 L_rdy_spin_16
L_rdy_ok_15:
    s_lshl_b32 s96, s96, 7
    s_add_u32 s96, s96, 131072
    s_getreg_b32 s74, hwreg(HW_REG_XCC_ID, 0, 4)
    s_lshl_b32 s74, s74, 1
    s_or_b32 s74, s74, 1
    v_mov_b32 v11, s74
    s_mov_b64 exec, 1
    buffer_store_dword v11, off, s[12:15], s96 offset:0 sc1
    s_mov_b64 exec, -1
L_pub_skip_14:
    v_and_b32 v176, 0xffff, v29
    v_and_b32 v177, 0xffff, v30
    v_and_b32 v178, 0xffff, v31
    v_and_b32 v179, 0xffff, v32
    v_and_b32 v180, 0xffff, v33
    v_and_b32 v181, 0xffff, v34
    s_add_u32 m0, s97, 29248
    v_lshlrev_b32 v176, 16, v176
    ds_read_b128 v[104:107], v224 offset:4896
    v_lshlrev_b32 v177, 16, v177
    v_lshlrev_b32 v178, 16, v178
    ds_read_b128 v[40:43], v223 offset:0
    v_lshlrev_b32 v179, 16, v179
    v_lshlrev_b32 v180, 16, v180
    ds_read_b128 v[72:75], v224 offset:0
    v_lshlrev_b32 v181, 16, v181
    v_mul_f32 v189, 0x3fb8aa3b, v180
    ds_read_b128 v[108:111], v224 offset:4960
    v_mul_f32 v190, 0x3fb8aa3b, v176
    v_exp_f32 v189, v189
    ds_read_b128 v[44:47], v223 offset:64
    v_exp_f32 v190, v190
    s_cmp_eq_u32 s52, 0
    s_cselect_b64 vcc, 1, 0
    v_cndmask_b32 v36, 0, v181, vcc
    ds_read_b128 v[76:79], v224 offset:64
    v_cvt_pk_bf16_f32 v189, v189, v190
    v_lshlrev_b32 v186, 16, v189
    ds_read_b128 v[112:115], v224 offset:5024
    v_and_b32 v190, 0xffff0000, v189
    v_mul_f32 v190, v190, v186
    ds_read_b128 v[48:51], v223 offset:128
    v_mul_f32 v185, v177, v186
    v_mul_f32 v184, 0xbfb8aa3b, v190
    ds_read_b128 v[80:83], v224 offset:128
    v_mul_f32 v185, 0x3e22f983, v185
    v_add_f32 v186, v186, v186
    ds_read_b128 v[116:119], v224 offset:5088
    v_mul_f32 v166, v178, v186
    v_mul_f32 v167, v179, v186
    ds_read_b128 v[52:55], v223 offset:192
    v_fract_f32 v190, v185
    v_exp_f32 v189, v184
    ds_read_b128 v[84:87], v224 offset:192
    v_cos_f32 v168, v190
    v_sin_f32 v169, v190
    ds_read_b128 v[120:123], v224 offset:5152
    v_mul_f32 v168, v168, v189
    v_mul_f32 v169, v169, v189
    ds_read_b128 v[56:59], v223 offset:256
    v_mul_f32 v190, 0x41800000, v185
    v_mul_f32 v189, 0x41800000, v184
    ds_read_b128 v[88:91], v224 offset:256
    v_fract_f32 v190, v190
    v_exp_f32 v189, v189
    ds_read_b128 v[124:127], v224 offset:5216
    v_cos_f32 v170, v190
    v_sin_f32 v171, v190
    ds_read_b128 v[60:63], v223 offset:320
    v_mul_f32 v170, v170, v189
    v_mul_f32_e64 v171, -v171, v189
    ds_read_b128 v[92:95], v224 offset:320
    v_mul_f32 v190, 0x43800000, v185
    v_mul_f32 v189, 0x43800000, v184
    ds_read_b128 v[128:131], v224 offset:5280
    v_fract_f32 v190, v190
    v_exp_f32 v189, v189
    ds_read_b128 v[64:67], v223 offset:384
    v_cos_f32 v172, v190
    v_sin_f32 v173, v190
    ds_read_b128 v[96:99], v224 offset:384
    v_mul_f32 v172, v172, v189
    v_mul_f32 v173, v173, v189
    ds_read_b128 v[132:135], v224 offset:5344
    ds_read_b128 v[68:71], v223 offset:448
    ds_read_b128 v[100:103], v224 offset:448
    s_waitcnt lgkmcnt(15)
    v_mfma_f32_16x16x32_bf16 v[16:19], v[40:43], v[104:107], 0
    v_and_b32 v13, 15, v0
    v_lshrrev_b32 v14, 4, v0
    v_mfma_f32_16x16x32_bf16 v[20:23], v[72:75], v[104:107], 0
    v_lshlrev_b32 v14, 3, v14
    v_sub_u32 v15, v14, v13
    v_mfma_f32_16x16x32_bf16 v[16:19], v[44:47], v[108:111], v[16:19]
    v_add_u32 v15, 15, v15
    v_min_u32 v15, 31, v15
    v_mfma_f32_16x16x32_bf16 v[20:23], v[76:79], v[108:111], v[20:23]
    s_mov_b32 s68, 65011712
    v_lshrrev_b32 v14, v15, s68
    v_mfma_f32_16x16x32_bf16 v[16:19], v[48:51], v[112:115], v[16:19]
    v_bfe_u32 v192, v14, 0, 2
    v_lshl_or_b32 v192, v192, 15, v192
    v_mfma_f32_16x16x32_bf16 v[20:23], v[80:83], v[112:115], v[20:23]
    v_and_b32 v192, 0x10001, v192
    v_mul_u32_u24 v192, 0x3f80, v192
    s_waitcnt lgkmcnt(13)
    v_mfma_f32_16x16x32_bf16 v[16:19], v[52:55], v[116:119], v[16:19]
    v_bfe_u32 v193, v14, 2, 2
    v_lshl_or_b32 v193, v193, 15, v193
    s_waitcnt lgkmcnt(12)
    v_mfma_f32_16x16x32_bf16 v[20:23], v[84:87], v[116:119], v[20:23]
    v_and_b32 v193, 0x10001, v193
    v_mul_u32_u24 v193, 0x3f80, v193
    s_waitcnt lgkmcnt(10)
    v_mfma_f32_16x16x32_bf16 v[16:19], v[56:59], v[120:123], v[16:19]
    v_bfe_u32 v194, v14, 4, 2
    v_lshl_or_b32 v194, v194, 15, v194
    s_waitcnt lgkmcnt(9)
    v_mfma_f32_16x16x32_bf16 v[20:23], v[88:91], v[120:123], v[20:23]
    v_and_b32 v194, 0x10001, v194
    v_mul_u32_u24 v194, 0x3f80, v194
    s_waitcnt lgkmcnt(7)
    v_mfma_f32_16x16x32_bf16 v[16:19], v[60:63], v[124:127], v[16:19]
    v_bfe_u32 v195, v14, 6, 2
    v_lshl_or_b32 v195, v195, 15, v195
    s_waitcnt lgkmcnt(6)
    v_mfma_f32_16x16x32_bf16 v[20:23], v[92:95], v[124:127], v[20:23]
    v_and_b32 v195, 0x10001, v195
    v_mul_u32_u24 v195, 0x3f80, v195
    s_waitcnt lgkmcnt(4)
    v_mfma_f32_16x16x32_bf16 v[16:19], v[64:67], v[128:131], v[16:19]
    s_mov_b32 s68, 469762048
    v_lshrrev_b32 v14, v15, s68
    s_waitcnt lgkmcnt(3)
    v_mfma_f32_16x16x32_bf16 v[20:23], v[96:99], v[128:131], v[20:23]
    v_bfe_u32 v196, v14, 0, 2
    v_lshl_or_b32 v196, v196, 15, v196
    s_waitcnt lgkmcnt(1)
    v_mfma_f32_16x16x32_bf16 v[16:19], v[68:71], v[132:135], v[16:19]
    v_and_b32 v196, 0x10001, v196
    v_mul_u32_u24 v196, 0x3f80, v196
    s_waitcnt lgkmcnt(0)
    v_mfma_f32_16x16x32_bf16 v[20:23], v[100:103], v[132:135], v[20:23]
    v_bfe_u32 v197, v14, 2, 2
    v_lshl_or_b32 v197, v197, 15, v197
    v_mov_b32 v28, 0
    ds_write_b32 v227, v28 offset:1288
    v_mov_b32 v137, 0x3f80
    v_cvt_pk_bf16_f32 v140, v166, v167
    ds_write_addtid_b32 v137 offset:55072
    ds_write_addtid_b32 v140 offset:32768
    v_cvt_pk_bf16_f32 v138, v170, v171
    v_pk_mul_f32 v[178:179], v[166:167], v[168:169] op_sel:[0,0] op_sel_hi:[0,1]
    ds_write_addtid_b32 v138 offset:55616
    v_pk_fma_f32 v[178:179], v[166:167], v[168:169], v[178:179] op_sel:[1,1,0] op_sel_hi:[1,0,1] neg_lo:[1,0,0]
    v_add_f32 v16, v16, v35
    v_cvt_pk_bf16_f32 v25, v18, v19
    v_cvt_pk_bf16_f32 v24, v16, v17
    ds_write_b64 v225, v[24:25] offset:0
    v_cvt_pk_bf16_f32 v26, v20, v21
    v_cvt_pk_bf16_f32 v27, v22, v23
    ds_write_b32 v226, v26 offset:0
    ds_write_b32 v226, v27 offset:64
    v_add_u32 v223, 62016, v223
    v_add_u32 v224, 62016, v224
    v_pk_mul_f32 v[190:191], v[170:171], v[170:171] op_sel:[0,0] op_sel_hi:[0,1]
    v_cvt_pk_bf16_f32 v141, v178, v179
    v_pk_fma_f32 v[190:191], v[170:171], v[170:171], v[190:191] op_sel:[1,1,0] op_sel_hi:[1,0,1] neg_lo:[1,0,0]
    ds_write_addtid_b32 v141 offset:33312
    v_cvt_pk_bf16_f32 v139, v190, v191
    v_pk_mul_f32 v[176:177], v[178:179], v[168:169] op_sel:[0,0] op_sel_hi:[0,1]
    ds_write_addtid_b32 v139 offset:56160
    v_pk_fma_f32 v[176:177], v[178:179], v[168:169], v[176:177] op_sel:[1,1,0] op_sel_hi:[1,0,1] neg_lo:[1,0,0]
    v_pk_mul_f32 v[188:189], v[190:191], v[170:171] op_sel:[0,0] op_sel_hi:[0,1]
    v_cvt_pk_bf16_f32 v142, v176, v177
    v_pk_fma_f32 v[188:189], v[190:191], v[170:171], v[188:189] op_sel:[1,1,0] op_sel_hi:[1,0,1] neg_lo:[1,0,0]
    ds_write_addtid_b32 v142 offset:33856
    v_cvt_pk_bf16_f32 v136, v188, v189
    v_pk_mul_f32 v[178:179], v[176:177], v[168:169] op_sel:[0,0] op_sel_hi:[0,1]
    ds_write_addtid_b32 v136 offset:56704
    v_pk_fma_f32 v[178:179], v[176:177], v[168:169], v[178:179] op_sel:[1,1,0] op_sel_hi:[1,0,1] neg_lo:[1,0,0]
    v_pk_mul_f32 v[190:191], v[188:189], v[170:171] op_sel:[0,0] op_sel_hi:[0,1]
    v_cvt_pk_bf16_f32 v143, v178, v179
    v_pk_fma_f32 v[190:191], v[188:189], v[170:171], v[190:191] op_sel:[1,1,0] op_sel_hi:[1,0,1] neg_lo:[1,0,0]
    ds_write_addtid_b32 v143 offset:34400
    v_cvt_pk_bf16_f32 v137, v190, v191
    v_pk_mul_f32 v[176:177], v[178:179], v[168:169] op_sel:[0,0] op_sel_hi:[0,1]
    ds_write_addtid_b32 v137 offset:57248
    v_pk_fma_f32 v[176:177], v[178:179], v[168:169], v[176:177] op_sel:[1,1,0] op_sel_hi:[1,0,1] neg_lo:[1,0,0]
    v_pk_mul_f32 v[188:189], v[190:191], v[170:171] op_sel:[0,0] op_sel_hi:[0,1]
    v_cvt_pk_bf16_f32 v140, v176, v177
    v_pk_fma_f32 v[188:189], v[190:191], v[170:171], v[188:189] op_sel:[1,1,0] op_sel_hi:[1,0,1] neg_lo:[1,0,0]
    ds_write_addtid_b32 v140 offset:34944
    v_cvt_pk_bf16_f32 v138, v188, v189
    v_pk_mul_f32 v[178:179], v[176:177], v[168:169] op_sel:[0,0] op_sel_hi:[0,1]
    ds_write_addtid_b32 v138 offset:57792
    v_pk_fma_f32 v[178:179], v[176:177], v[168:169], v[178:179] op_sel:[1,1,0] op_sel_hi:[1,0,1] neg_lo:[1,0,0]
    v_pk_mul_f32 v[190:191], v[188:189], v[170:171] op_sel:[0,0] op_sel_hi:[0,1]
    v_cvt_pk_bf16_f32 v141, v178, v179
    v_pk_fma_f32 v[190:191], v[188:189], v[170:171], v[190:191] op_sel:[1,1,0] op_sel_hi:[1,0,1] neg_lo:[1,0,0]
    ds_write_addtid_b32 v141 offset:35488
    v_cvt_pk_bf16_f32 v139, v190, v191
    v_pk_mul_f32 v[176:177], v[178:179], v[168:169] op_sel:[0,0] op_sel_hi:[0,1]
    ds_write_addtid_b32 v139 offset:58336
    v_pk_fma_f32 v[176:177], v[178:179], v[168:169], v[176:177] op_sel:[1,1,0] op_sel_hi:[1,0,1] neg_lo:[1,0,0]
    v_pk_mul_f32 v[188:189], v[190:191], v[170:171] op_sel:[0,0] op_sel_hi:[0,1]
    v_cvt_pk_bf16_f32 v142, v176, v177
    v_pk_fma_f32 v[188:189], v[190:191], v[170:171], v[188:189] op_sel:[1,1,0] op_sel_hi:[1,0,1] neg_lo:[1,0,0]
    ds_write_addtid_b32 v142 offset:36032
    v_cvt_pk_bf16_f32 v136, v188, v189
    v_pk_mul_f32 v[178:179], v[176:177], v[168:169] op_sel:[0,0] op_sel_hi:[0,1]
    ds_write_addtid_b32 v136 offset:58880
    v_pk_fma_f32 v[178:179], v[176:177], v[168:169], v[178:179] op_sel:[1,1,0] op_sel_hi:[1,0,1] neg_lo:[1,0,0]
    v_pk_mul_f32 v[190:191], v[188:189], v[170:171] op_sel:[0,0] op_sel_hi:[0,1]
    v_cvt_pk_bf16_f32 v143, v178, v179
    v_pk_fma_f32 v[190:191], v[188:189], v[170:171], v[190:191] op_sel:[1,1,0] op_sel_hi:[1,0,1] neg_lo:[1,0,0]
    ds_write_addtid_b32 v143 offset:36576
    v_cvt_pk_bf16_f32 v137, v190, v191
    v_pk_mul_f32 v[176:177], v[178:179], v[168:169] op_sel:[0,0] op_sel_hi:[0,1]
    ds_write_addtid_b32 v137 offset:59424
    v_pk_fma_f32 v[176:177], v[178:179], v[168:169], v[176:177] op_sel:[1,1,0] op_sel_hi:[1,0,1] neg_lo:[1,0,0]
    v_pk_mul_f32 v[188:189], v[190:191], v[170:171] op_sel:[0,0] op_sel_hi:[0,1]
    v_cvt_pk_bf16_f32 v140, v176, v177
    v_pk_fma_f32 v[188:189], v[190:191], v[170:171], v[188:189] op_sel:[1,1,0] op_sel_hi:[1,0,1] neg_lo:[1,0,0]
    ds_write_addtid_b32 v140 offset:37120
    v_cvt_pk_bf16_f32 v138, v188, v189
    v_pk_mul_f32 v[178:179], v[176:177], v[168:169] op_sel:[0,0] op_sel_hi:[0,1]
    ds_write_addtid_b32 v138 offset:59968
    v_pk_fma_f32 v[178:179], v[176:177], v[168:169], v[178:179] op_sel:[1,1,0] op_sel_hi:[1,0,1] neg_lo:[1,0,0]
    v_pk_mul_f32 v[190:191], v[188:189], v[170:171] op_sel:[0,0] op_sel_hi:[0,1]
    v_cvt_pk_bf16_f32 v141, v178, v179
    v_pk_fma_f32 v[190:191], v[188:189], v[170:171], v[190:191] op_sel:[1,1,0] op_sel_hi:[1,0,1] neg_lo:[1,0,0]
    ds_write_addtid_b32 v141 offset:37664
    v_cvt_pk_bf16_f32 v139, v190, v191
    v_pk_mul_f32 v[176:177], v[178:179], v[168:169] op_sel:[0,0] op_sel_hi:[0,1]
    ds_write_addtid_b32 v139 offset:60512
    v_pk_fma_f32 v[176:177], v[178:179], v[168:169], v[176:177] op_sel:[1,1,0] op_sel_hi:[1,0,1] neg_lo:[1,0,0]
    v_pk_mul_f32 v[188:189], v[190:191], v[170:171] op_sel:[0,0] op_sel_hi:[0,1]
    v_cvt_pk_bf16_f32 v142, v176, v177
    v_pk_fma_f32 v[188:189], v[190:191], v[170:171], v[188:189] op_sel:[1,1,0] op_sel_hi:[1,0,1] neg_lo:[1,0,0]
    ds_write_addtid_b32 v142 offset:38208
    v_cvt_pk_bf16_f32 v136, v188, v189
    v_pk_mul_f32 v[178:179], v[176:177], v[168:169] op_sel:[0,0] op_sel_hi:[0,1]
    ds_write_addtid_b32 v136 offset:61056
    v_pk_fma_f32 v[178:179], v[176:177], v[168:169], v[178:179] op_sel:[1,1,0] op_sel_hi:[1,0,1] neg_lo:[1,0,0]
    v_pk_mul_f32 v[190:191], v[188:189], v[170:171] op_sel:[0,0] op_sel_hi:[0,1]
    v_cvt_pk_bf16_f32 v143, v178, v179
    v_pk_fma_f32 v[190:191], v[188:189], v[170:171], v[190:191] op_sel:[1,1,0] op_sel_hi:[1,0,1] neg_lo:[1,0,0]
    ds_write_addtid_b32 v143 offset:38752
    v_cvt_pk_bf16_f32 v137, v190, v191
    v_pk_mul_f32 v[176:177], v[178:179], v[168:169] op_sel:[0,0] op_sel_hi:[0,1]
    ds_write_addtid_b32 v137 offset:61600
    v_pk_fma_f32 v[176:177], v[178:179], v[168:169], v[176:177] op_sel:[1,1,0] op_sel_hi:[1,0,1] neg_lo:[1,0,0]
    v_pk_mul_f32 v[188:189], v[190:191], v[170:171] op_sel:[0,0] op_sel_hi:[0,1]
    v_cvt_pk_bf16_f32 v140, v176, v177
    v_pk_fma_f32 v[188:189], v[190:191], v[170:171], v[188:189] op_sel:[1,1,0] op_sel_hi:[1,0,1] neg_lo:[1,0,0]
    ds_write_addtid_b32 v140 offset:39296
    v_cvt_pk_bf16_f32 v138, v188, v189
    v_pk_mul_f32 v[178:179], v[176:177], v[168:169] op_sel:[0,0] op_sel_hi:[0,1]
    ds_write_addtid_b32 v138 offset:62144
    v_pk_fma_f32 v[178:179], v[176:177], v[168:169], v[178:179] op_sel:[1,1,0] op_sel_hi:[1,0,1] neg_lo:[1,0,0]
    v_pk_mul_f32 v[190:191], v[188:189], v[170:171] op_sel:[0,0] op_sel_hi:[0,1]
    v_cvt_pk_bf16_f32 v141, v178, v179
    v_pk_fma_f32 v[190:191], v[188:189], v[170:171], v[190:191] op_sel:[1,1,0] op_sel_hi:[1,0,1] neg_lo:[1,0,0]
    ds_write_addtid_b32 v141 offset:39840
    v_cvt_pk_bf16_f32 v139, v190, v191
    v_pk_mul_f32 v[176:177], v[178:179], v[168:169] op_sel:[0,0] op_sel_hi:[0,1]
    ds_write_addtid_b32 v139 offset:62688
    v_pk_fma_f32 v[176:177], v[178:179], v[168:169], v[176:177] op_sel:[1,1,0] op_sel_hi:[1,0,1] neg_lo:[1,0,0]
    v_pk_mul_f32 v[188:189], v[190:191], v[170:171] op_sel:[0,0] op_sel_hi:[0,1]
    v_cvt_pk_bf16_f32 v142, v176, v177
    v_pk_fma_f32 v[188:189], v[190:191], v[170:171], v[188:189] op_sel:[1,1,0] op_sel_hi:[1,0,1] neg_lo:[1,0,0]
    ds_write_addtid_b32 v142 offset:40384
    v_cvt_pk_bf16_f32 v136, v188, v189
    v_pk_mul_f32 v[178:179], v[176:177], v[168:169] op_sel:[0,0] op_sel_hi:[0,1]
    ds_write_addtid_b32 v136 offset:63232
    v_pk_fma_f32 v[178:179], v[176:177], v[168:169], v[178:179] op_sel:[1,1,0] op_sel_hi:[1,0,1] neg_lo:[1,0,0]
    v_cvt_pk_bf16_f32 v143, v178, v179
    ds_write_addtid_b32 v143 offset:40928
    v_pk_mul_f32 v[174:175], v[168:169], v[168:169] op_sel:[0,0] op_sel_hi:[0,1]
    v_pk_mul_f32 v[184:185], v[166:167], v[172:173] op_sel:[0,0] op_sel_hi:[0,1]
    v_pk_fma_f32 v[174:175], v[168:169], v[168:169], v[174:175] op_sel:[1,1,0] op_sel_hi:[1,0,1] neg_lo:[1,0,0]
    v_pk_fma_f32 v[184:185], v[166:167], v[172:173], v[184:185] op_sel:[1,1,0] op_sel_hi:[1,0,1] neg_lo:[1,0,0]
    v_pk_mul_f32 v[182:183], v[174:175], v[174:175] op_sel:[0,0] op_sel_hi:[0,1]
    v_pk_mul_f32 v[186:187], v[184:185], v[172:173] op_sel:[0,0] op_sel_hi:[0,1]
    v_pk_fma_f32 v[182:183], v[174:175], v[174:175], v[182:183] op_sel:[1,1,0] op_sel_hi:[1,0,1] neg_lo:[1,0,0]
    v_pk_fma_f32 v[186:187], v[184:185], v[172:173], v[186:187] op_sel:[1,1,0] op_sel_hi:[1,0,1] neg_lo:[1,0,0]
    v_pk_mul_f32 v[180:181], v[182:183], v[182:183] op_sel:[0,0] op_sel_hi:[0,1]
    v_pk_mul_f32 v[166:167], v[186:187], v[172:173] op_sel:[0,0] op_sel_hi:[0,1]
    v_pk_fma_f32 v[180:181], v[182:183], v[182:183], v[180:181] op_sel:[1,1,0] op_sel_hi:[1,0,1] neg_lo:[1,0,0]
    v_pk_fma_f32 v[166:167], v[186:187], v[172:173], v[166:167] op_sel:[1,1,0] op_sel_hi:[1,0,1] neg_lo:[1,0,0]
    v_cvt_pk_bf16_f32 v136, v184, v185
    v_cvt_pk_bf16_f32 v140, v186, v187
    ds_write_addtid_b32 v136 offset:41472
    ds_write_addtid_b32 v140 offset:45824
    v_pk_mul_f32 v[190:191], v[184:185], v[174:175] op_sel:[0,0] op_sel_hi:[0,1]
    v_pk_mul_f32 v[178:179], v[186:187], v[182:183] op_sel:[0,0] op_sel_hi:[0,1]
    v_pk_fma_f32 v[190:191], v[184:185], v[174:175], v[190:191] op_sel:[1,1,0] op_sel_hi:[1,0,1] neg_lo:[1,0,0]
    v_pk_fma_f32 v[178:179], v[186:187], v[182:183], v[178:179] op_sel:[1,1,0] op_sel_hi:[1,0,1] neg_lo:[1,0,0]
    v_cvt_pk_bf16_f32 v137, v190, v191
    v_cvt_pk_bf16_f32 v141, v178, v179
    ds_write_addtid_b32 v137 offset:42016
    ds_write_addtid_b32 v141 offset:46368
    v_pk_mul_f32 v[188:189], v[190:191], v[174:175] op_sel:[0,0] op_sel_hi:[0,1]
    v_pk_mul_f32 v[176:177], v[178:179], v[182:183] op_sel:[0,0] op_sel_hi:[0,1]
    v_pk_fma_f32 v[188:189], v[190:191], v[174:175], v[188:189] op_sel:[1,1,0] op_sel_hi:[1,0,1] neg_lo:[1,0,0]
    v_pk_fma_f32 v[176:177], v[178:179], v[182:183], v[176:177] op_sel:[1,1,0] op_sel_hi:[1,0,1] neg_lo:[1,0,0]
    v_cvt_pk_bf16_f32 v138, v188, v189
    v_cvt_pk_bf16_f32 v142, v176, v177
    ds_write_addtid_b32 v138 offset:42560
    ds_write_addtid_b32 v142 offset:46912
    v_pk_mul_f32 v[190:191], v[188:189], v[174:175] op_sel:[0,0] op_sel_hi:[0,1]
    v_pk_mul_f32 v[178:179], v[176:177], v[182:183] op_sel:[0,0] op_sel_hi:[0,1]
    v_pk_fma_f32 v[190:191], v[188:189], v[174:175], v[190:191] op_sel:[1,1,0] op_sel_hi:[1,0,1] neg_lo:[1,0,0]
    v_pk_fma_f32 v[178:179], v[176:177], v[182:183], v[178:179] op_sel:[1,1,0] op_sel_hi:[1,0,1] neg_lo:[1,0,0]
    v_cvt_pk_bf16_f32 v139, v190, v191
    v_cvt_pk_bf16_f32 v143, v178, v179
    ds_write_addtid_b32 v139 offset:43104
    ds_write_addtid_b32 v143 offset:47456
    v_pk_mul_f32 v[188:189], v[190:191], v[174:175] op_sel:[0,0] op_sel_hi:[0,1]
    v_cvt_pk_bf16_f32 v140, v166, v167
    v_pk_fma_f32 v[188:189], v[190:191], v[174:175], v[188:189] op_sel:[1,1,0] op_sel_hi:[1,0,1] neg_lo:[1,0,0]
    ds_write_addtid_b32 v140 offset:48000
    v_cvt_pk_bf16_f32 v136, v188, v189
    v_pk_mul_f32 v[178:179], v[166:167], v[182:183] op_sel:[0,0] op_sel_hi:[0,1]
    ds_write_addtid_b32 v136 offset:43648
    v_pk_fma_f32 v[178:179], v[166:167], v[182:183], v[178:179] op_sel:[1,1,0] op_sel_hi:[1,0,1] neg_lo:[1,0,0]
    v_pk_mul_f32 v[190:191], v[188:189], v[174:175] op_sel:[0,0] op_sel_hi:[0,1]
    v_cvt_pk_bf16_f32 v141, v178, v179
    v_pk_fma_f32 v[190:191], v[188:189], v[174:175], v[190:191] op_sel:[1,1,0] op_sel_hi:[1,0,1] neg_lo:[1,0,0]
    ds_write_addtid_b32 v141 offset:48544
    v_cvt_pk_bf16_f32 v137, v190, v191
    v_pk_mul_f32 v[176:177], v[178:179], v[182:183] op_sel:[0,0] op_sel_hi:[0,1]
    ds_write_addtid_b32 v137 offset:44192
    v_pk_fma_f32 v[176:177], v[178:179], v[182:183], v[176:177] op_sel:[1,1,0] op_sel_hi:[1,0,1] neg_lo:[1,0,0]
    v_pk_mul_f32 v[188:189], v[190:191], v[174:175] op_sel:[0,0] op_sel_hi:[0,1]
    v_cvt_pk_bf16_f32 v142, v176, v177
    v_pk_fma_f32 v[188:189], v[190:191], v[174:175], v[188:189] op_sel:[1,1,0] op_sel_hi:[1,0,1] neg_lo:[1,0,0]
    ds_write_addtid_b32 v142 offset:49088
    v_cvt_pk_bf16_f32 v138, v188, v189
    v_pk_mul_f32 v[178:179], v[176:177], v[182:183] op_sel:[0,0] op_sel_hi:[0,1]
    ds_write_addtid_b32 v138 offset:44736
    v_pk_fma_f32 v[178:179], v[176:177], v[182:183], v[178:179] op_sel:[1,1,0] op_sel_hi:[1,0,1] neg_lo:[1,0,0]
    v_pk_mul_f32 v[190:191], v[188:189], v[174:175] op_sel:[0,0] op_sel_hi:[0,1]
    v_cvt_pk_bf16_f32 v143, v178, v179
    v_pk_fma_f32 v[190:191], v[188:189], v[174:175], v[190:191] op_sel:[1,1,0] op_sel_hi:[1,0,1] neg_lo:[1,0,0]
    ds_write_addtid_b32 v143 offset:49632
    v_cvt_pk_bf16_f32 v139, v190, v191
    ds_write_addtid_b32 v139 offset:45280
    v_pk_mul_f32 v[168:169], v[166:167], v[172:173] op_sel:[0,0] op_sel_hi:[0,1]
    v_pk_fma_f32 v[168:169], v[166:167], v[172:173], v[168:169] op_sel:[1,1,0] op_sel_hi:[1,0,1] neg_lo:[1,0,0]
    v_cvt_pk_bf16_f32 v136, v168, v169
    ds_write_addtid_b32 v136 offset:50176
    v_pk_mul_f32 v[170:171], v[168:169], v[172:173] op_sel:[0,0] op_sel_hi:[0,1]
    v_pk_mul_f32 v[176:177], v[168:169], v[180:181] op_sel:[0,0] op_sel_hi:[0,1]
    v_pk_fma_f32 v[170:171], v[168:169], v[172:173], v[170:171] op_sel:[1,1,0] op_sel_hi:[1,0,1] neg_lo:[1,0,0]
    v_pk_fma_f32 v[176:177], v[168:169], v[180:181], v[176:177] op_sel:[1,1,0] op_sel_hi:[1,0,1] neg_lo:[1,0,0]
    v_cvt_pk_bf16_f32 v138, v170, v171
    v_cvt_pk_bf16_f32 v141, v176, v177
    ds_write_addtid_b32 v138 offset:51264
    ds_write_addtid_b32 v141 offset:50720
    v_pk_mul_f32 v[174:175], v[170:171], v[172:173] op_sel:[0,0] op_sel_hi:[0,1]
    v_pk_mul_f32 v[178:179], v[170:171], v[180:181] op_sel:[0,0] op_sel_hi:[0,1]
    v_pk_fma_f32 v[174:175], v[170:171], v[172:173], v[174:175] op_sel:[1,1,0] op_sel_hi:[1,0,1] neg_lo:[1,0,0]
    v_pk_fma_f32 v[178:179], v[170:171], v[180:181], v[178:179] op_sel:[1,1,0] op_sel_hi:[1,0,1] neg_lo:[1,0,0]
    v_cvt_pk_bf16_f32 v136, v174, v175
    v_cvt_pk_bf16_f32 v143, v178, v179
    ds_write_addtid_b32 v136 offset:52352
    ds_write_addtid_b32 v143 offset:51808
    v_pk_mul_f32 v[182:183], v[174:175], v[172:173] op_sel:[0,0] op_sel_hi:[0,1]
    v_pk_mul_f32 v[176:177], v[174:175], v[180:181] op_sel:[0,0] op_sel_hi:[0,1]
    v_pk_fma_f32 v[182:183], v[174:175], v[172:173], v[182:183] op_sel:[1,1,0] op_sel_hi:[1,0,1] neg_lo:[1,0,0]
    v_pk_fma_f32 v[176:177], v[174:175], v[180:181], v[176:177] op_sel:[1,1,0] op_sel_hi:[1,0,1] neg_lo:[1,0,0]
    v_cvt_pk_bf16_f32 v138, v182, v183
    v_cvt_pk_bf16_f32 v141, v176, v177
    ds_write_addtid_b32 v138 offset:53440
    ds_write_addtid_b32 v141 offset:52896
    v_pk_mul_f32 v[184:185], v[182:183], v[172:173] op_sel:[0,0] op_sel_hi:[0,1]
    v_pk_mul_f32 v[178:179], v[182:183], v[180:181] op_sel:[0,0] op_sel_hi:[0,1]
    v_pk_fma_f32 v[184:185], v[182:183], v[172:173], v[184:185] op_sel:[1,1,0] op_sel_hi:[1,0,1] neg_lo:[1,0,0]
    v_pk_fma_f32 v[178:179], v[182:183], v[180:181], v[178:179] op_sel:[1,1,0] op_sel_hi:[1,0,1] neg_lo:[1,0,0]
    v_cvt_pk_bf16_f32 v136, v184, v185
    v_cvt_pk_bf16_f32 v143, v178, v179
    ds_write_addtid_b32 v136 offset:54528
    ds_write_addtid_b32 v143 offset:53984
    s_waitcnt lgkmcnt(0)
    s_barrier
    v_lshrrev_b32 v176, 16, v29
    v_lshrrev_b32 v177, 16, v30
    v_lshrrev_b32 v178, 16, v31
    v_lshrrev_b32 v179, 16, v32
    v_lshrrev_b32 v180, 16, v33
    v_lshrrev_b32 v181, 16, v34
    s_add_u32 m0, s97, 0
    v_lshlrev_b32 v176, 16, v176
    ds_read_b128 v[104:107], v224 offset:4896
    v_lshlrev_b32 v177, 16, v177
    v_lshlrev_b32 v178, 16, v178
    ds_read_b128 v[40:43], v223 offset:0
    v_lshlrev_b32 v179, 16, v179
    v_lshlrev_b32 v180, 16, v180
    ds_read_b128 v[72:75], v224 offset:0
    v_lshlrev_b32 v181, 16, v181
    v_mul_f32 v189, 0x3fb8aa3b, v180
    ds_read_b128 v[108:111], v224 offset:4960
    v_mul_f32 v190, 0x3fb8aa3b, v176
    v_exp_f32 v189, v189
    ds_read_b128 v[44:47], v223 offset:64
    v_exp_f32 v190, v190
    s_cmp_eq_u32 s52, 0
    s_cselect_b64 vcc, 1, 0
    v_cndmask_b32 v35, 0, v181, vcc
    ds_read_b128 v[76:79], v224 offset:64
    v_cvt_pk_bf16_f32 v189, v189, v190
    v_lshlrev_b32 v186, 16, v189
    ds_read_b128 v[112:115], v224 offset:5024
    v_and_b32 v190, 0xffff0000, v189
    v_mul_f32 v190, v190, v186
    ds_read_b128 v[48:51], v223 offset:128
    v_mul_f32 v185, v177, v186
    v_mul_f32 v184, 0xbfb8aa3b, v190
    ds_read_b128 v[80:83], v224 offset:128
    v_mul_f32 v185, 0x3e22f983, v185
    v_add_f32 v186, v186, v186
    ds_read_b128 v[116:119], v224 offset:5088
    v_mul_f32 v166, v178, v186
    v_mul_f32 v167, v179, v186
    ds_read_b128 v[52:55], v223 offset:192
    v_fract_f32 v190, v185
    v_exp_f32 v189, v184
    ds_read_b128 v[84:87], v224 offset:192
    v_cos_f32 v168, v190
    v_sin_f32 v169, v190
    ds_read_b128 v[120:123], v224 offset:5152
    v_mul_f32 v168, v168, v189
    v_mul_f32 v169, v169, v189
    ds_read_b128 v[56:59], v223 offset:256
    v_mul_f32 v190, 0x41800000, v185
    v_mul_f32 v189, 0x41800000, v184
    ds_read_b128 v[88:91], v224 offset:256
    v_fract_f32 v190, v190
    v_exp_f32 v189, v189
    ds_read_b128 v[124:127], v224 offset:5216
    v_cos_f32 v170, v190
    v_sin_f32 v171, v190
    ds_read_b128 v[60:63], v223 offset:320
    v_mul_f32 v170, v170, v189
    v_mul_f32_e64 v171, -v171, v189
    ds_read_b128 v[92:95], v224 offset:320
    v_mul_f32 v190, 0x43800000, v185
    v_mul_f32 v189, 0x43800000, v184
    ds_read_b128 v[128:131], v224 offset:5280
    v_fract_f32 v190, v190
    v_exp_f32 v189, v189
    ds_read_b128 v[64:67], v223 offset:384
    v_cos_f32 v172, v190
    v_sin_f32 v173, v190
    ds_read_b128 v[96:99], v224 offset:384
    v_mul_f32 v172, v172, v189
    v_mul_f32 v173, v173, v189
    ds_read_b128 v[132:135], v224 offset:5344
    ds_read_b128 v[68:71], v223 offset:448
    ds_read_b128 v[100:103], v224 offset:448
    s_waitcnt lgkmcnt(15)
    v_mfma_f32_16x16x32_bf16 v[16:19], v[40:43], v[104:107], 0
    v_and_b32 v197, 0x10001, v197
    v_mul_u32_u24 v197, 0x3f80, v197
    v_mfma_f32_16x16x32_bf16 v[20:23], v[72:75], v[104:107], 0
    v_bfe_u32 v198, v14, 4, 2
    v_lshl_or_b32 v198, v198, 15, v198
    v_mfma_f32_16x16x32_bf16 v[16:19], v[44:47], v[108:111], v[16:19]
    v_and_b32 v198, 0x10001, v198
    v_mul_u32_u24 v198, 0x3f80, v198
    v_mfma_f32_16x16x32_bf16 v[20:23], v[76:79], v[108:111], v[20:23]
    v_bfe_u32 v199, v14, 6, 2
    v_lshl_or_b32 v199, v199, 15, v199
    v_mfma_f32_16x16x32_bf16 v[16:19], v[48:51], v[112:115], v[16:19]
    v_and_b32 v199, 0x10001, v199
    v_mul_u32_u24 v199, 0x3f80, v199
    v_mfma_f32_16x16x32_bf16 v[20:23], v[80:83], v[112:115], v[20:23]
    s_mov_b32 s68, 1835008
    v_lshrrev_b32 v14, v15, s68
    s_waitcnt lgkmcnt(13)
    v_mfma_f32_16x16x32_bf16 v[16:19], v[52:55], v[116:119], v[16:19]
    v_bfe_u32 v200, v14, 0, 2
    v_lshl_or_b32 v200, v200, 15, v200
    s_waitcnt lgkmcnt(12)
    v_mfma_f32_16x16x32_bf16 v[20:23], v[84:87], v[116:119], v[20:23]
    v_and_b32 v200, 0x10001, v200
    v_mul_u32_u24 v200, 0x3f80, v200
    s_waitcnt lgkmcnt(10)
    v_mfma_f32_16x16x32_bf16 v[16:19], v[56:59], v[120:123], v[16:19]
    v_bfe_u32 v201, v14, 2, 2
    v_lshl_or_b32 v201, v201, 15, v201
    s_waitcnt lgkmcnt(9)
    v_mfma_f32_16x16x32_bf16 v[20:23], v[88:91], v[120:123], v[20:23]
    v_and_b32 v201, 0x10001, v201
    v_mul_u32_u24 v201, 0x3f80, v201
    s_waitcnt lgkmcnt(7)
    v_mfma_f32_16x16x32_bf16 v[16:19], v[60:63], v[124:127], v[16:19]
    v_bfe_u32 v202, v14, 4, 2
    v_lshl_or_b32 v202, v202, 15, v202
    s_waitcnt lgkmcnt(6)
    v_mfma_f32_16x16x32_bf16 v[20:23], v[92:95], v[124:127], v[20:23]
    v_and_b32 v202, 0x10001, v202
    v_mul_u32_u24 v202, 0x3f80, v202
    s_waitcnt lgkmcnt(4)
    v_mfma_f32_16x16x32_bf16 v[16:19], v[64:67], v[128:131], v[16:19]
    v_bfe_u32 v203, v14, 6, 2
    v_lshl_or_b32 v203, v203, 15, v203
    s_waitcnt lgkmcnt(3)
    v_mfma_f32_16x16x32_bf16 v[20:23], v[96:99], v[128:131], v[20:23]
    v_and_b32 v203, 0x10001, v203
    v_mul_u32_u24 v203, 0x3f80, v203
    s_waitcnt lgkmcnt(1)
    v_mfma_f32_16x16x32_bf16 v[16:19], v[68:71], v[132:135], v[16:19]
    s_mov_b32 s68, 267911168
    v_lshrrev_b32 v14, v15, s68
    s_waitcnt lgkmcnt(0)
    v_mfma_f32_16x16x32_bf16 v[20:23], v[100:103], v[132:135], v[20:23]
    v_bfe_u32 v204, v14, 0, 2
    v_lshl_or_b32 v204, v204, 15, v204
    v_and_b32 v204, 0x10001, v204
    v_mul_u32_u24 v204, 0x3f80, v204
    v_bfe_u32 v205, v14, 2, 2
    v_lshl_or_b32 v205, v205, 15, v205
    v_and_b32 v205, 0x10001, v205
    v_mul_u32_u24 v205, 0x3f80, v205
    v_bfe_u32 v206, v14, 4, 2
    v_lshl_or_b32 v206, v206, 15, v206
    v_and_b32 v206, 0x10001, v206
    v_mul_u32_u24 v206, 0x3f80, v206
    v_bfe_u32 v207, v14, 6, 2
    v_lshl_or_b32 v207, v207, 15, v207
    v_and_b32 v207, 0x10001, v207
    v_mul_u32_u24 v207, 0x3f80, v207
    s_mov_b32 s68, 133169152
    v_lshrrev_b32 v14, v15, s68
    v_bfe_u32 v208, v14, 0, 2
    v_lshl_or_b32 v208, v208, 15, v208
    v_and_b32 v208, 0x10001, v208
    v_mul_u32_u24 v208, 0x3f80, v208
    v_bfe_u32 v209, v14, 2, 2
    v_lshl_or_b32 v209, v209, 15, v209
    v_and_b32 v209, 0x10001, v209
    v_mul_u32_u24 v209, 0x3f80, v209
    v_bfe_u32 v210, v14, 4, 2
    v_lshl_or_b32 v210, v210, 15, v210
    v_and_b32 v210, 0x10001, v210
    v_mul_u32_u24 v210, 0x3f80, v210
    v_bfe_u32 v211, v14, 6, 2
    v_lshl_or_b32 v211, v211, 15, v211
    v_and_b32 v211, 0x10001, v211
    v_mul_u32_u24 v211, 0x3f80, v211
    s_mul_i32 s68, s53, 1536
    s_add_u32 s68, s68, 148800
    v_add_u32_sdwa v10, s68, v6 dst_sel:DWORD dst_unused:UNUSED_PAD src0_sel:DWORD src1_sel:WORD_0
    v_add_u32_sdwa v9, s68, v5 dst_sel:DWORD dst_unused:UNUSED_PAD src0_sel:DWORD src1_sel:WORD_1
    v_add_u32_sdwa v8, s68, v5 dst_sel:DWORD dst_unused:UNUSED_PAD src0_sel:DWORD src1_sel:WORD_0
    v_add_u32_sdwa v7, s68, v4 dst_sel:DWORD dst_unused:UNUSED_PAD src0_sel:DWORD src1_sel:WORD_1
    v_add_u32_sdwa v6, s68, v4 dst_sel:DWORD dst_unused:UNUSED_PAD src0_sel:DWORD src1_sel:WORD_0
    v_add_u32_sdwa v5, s68, v3 dst_sel:DWORD dst_unused:UNUSED_PAD src0_sel:DWORD src1_sel:WORD_1
    v_add_u32_sdwa v4, s68, v3 dst_sel:DWORD dst_unused:UNUSED_PAD src0_sel:DWORD src1_sel:WORD_0
    v_add_u32_sdwa v3, s68, v2 dst_sel:DWORD dst_unused:UNUSED_PAD src0_sel:DWORD src1_sel:WORD_1
    v_add_u32_sdwa v2, s68, v2 dst_sel:DWORD dst_unused:UNUSED_PAD src0_sel:DWORD src1_sel:WORD_0
    s_add_u32 s20, s64, s44
    s_addc_u32 s21, s65, 0
    s_mov_b32 s22, 276480
    s_mov_b32 s23, 0x20000
    v_mov_b32 v220, v1
    v_add_u32 v221, 4096, v1
    v_mov_b32 v28, 0
    ds_write_b32 v227, v28 offset:4360
    v_mov_b32 v137, 0x3f80
    v_cvt_pk_bf16_f32 v140, v166, v167
    ds_write_addtid_b32 v137 offset:22304
    ds_write_addtid_b32 v140 offset:0
    v_cvt_pk_bf16_f32 v138, v170, v171
    v_pk_mul_f32 v[178:179], v[166:167], v[168:169] op_sel:[0,0] op_sel_hi:[0,1]
    ds_write_addtid_b32 v138 offset:22848
    v_pk_fma_f32 v[178:179], v[166:167], v[168:169], v[178:179] op_sel:[1,1,0] op_sel_hi:[1,0,1] neg_lo:[1,0,0]
    v_add_f32 v16, v16, v36
    v_cvt_pk_bf16_f32 v25, v18, v19
    v_cvt_pk_bf16_f32 v24, v16, v17
    ds_write_b64 v225, v[24:25] offset:3072
    v_cvt_pk_bf16_f32 v26, v20, v21
    v_cvt_pk_bf16_f32 v27, v22, v23
    ds_write_b32 v226, v26 offset:3072
    ds_write_b32 v226, v27 offset:3136
    v_add_u32 v223, -62016, v223
    v_add_u32 v224, -62016, v224
    v_pk_mul_f32 v[190:191], v[170:171], v[170:171] op_sel:[0,0] op_sel_hi:[0,1]
    v_cvt_pk_bf16_f32 v141, v178, v179
    v_pk_fma_f32 v[190:191], v[170:171], v[170:171], v[190:191] op_sel:[1,1,0] op_sel_hi:[1,0,1] neg_lo:[1,0,0]
    ds_write_addtid_b32 v141 offset:544
    v_cvt_pk_bf16_f32 v139, v190, v191
    v_pk_mul_f32 v[176:177], v[178:179], v[168:169] op_sel:[0,0] op_sel_hi:[0,1]
    ds_write_addtid_b32 v139 offset:23392
    v_pk_fma_f32 v[176:177], v[178:179], v[168:169], v[176:177] op_sel:[1,1,0] op_sel_hi:[1,0,1] neg_lo:[1,0,0]
    v_pk_mul_f32 v[188:189], v[190:191], v[170:171] op_sel:[0,0] op_sel_hi:[0,1]
    v_cvt_pk_bf16_f32 v142, v176, v177
    v_pk_fma_f32 v[188:189], v[190:191], v[170:171], v[188:189] op_sel:[1,1,0] op_sel_hi:[1,0,1] neg_lo:[1,0,0]
    ds_write_addtid_b32 v142 offset:1088
    v_cvt_pk_bf16_f32 v136, v188, v189
    v_pk_mul_f32 v[178:179], v[176:177], v[168:169] op_sel:[0,0] op_sel_hi:[0,1]
    ds_write_addtid_b32 v136 offset:23936
    v_pk_fma_f32 v[178:179], v[176:177], v[168:169], v[178:179] op_sel:[1,1,0] op_sel_hi:[1,0,1] neg_lo:[1,0,0]
    v_pk_mul_f32 v[190:191], v[188:189], v[170:171] op_sel:[0,0] op_sel_hi:[0,1]
    v_cvt_pk_bf16_f32 v143, v178, v179
    v_pk_fma_f32 v[190:191], v[188:189], v[170:171], v[190:191] op_sel:[1,1,0] op_sel_hi:[1,0,1] neg_lo:[1,0,0]
    ds_write_addtid_b32 v143 offset:1632
    v_cvt_pk_bf16_f32 v137, v190, v191
    v_pk_mul_f32 v[176:177], v[178:179], v[168:169] op_sel:[0,0] op_sel_hi:[0,1]
    ds_write_addtid_b32 v137 offset:24480
    v_pk_fma_f32 v[176:177], v[178:179], v[168:169], v[176:177] op_sel:[1,1,0] op_sel_hi:[1,0,1] neg_lo:[1,0,0]
    v_pk_mul_f32 v[188:189], v[190:191], v[170:171] op_sel:[0,0] op_sel_hi:[0,1]
    v_cvt_pk_bf16_f32 v140, v176, v177
    v_pk_fma_f32 v[188:189], v[190:191], v[170:171], v[188:189] op_sel:[1,1,0] op_sel_hi:[1,0,1] neg_lo:[1,0,0]
    ds_write_addtid_b32 v140 offset:2176
    v_cvt_pk_bf16_f32 v138, v188, v189
    v_pk_mul_f32 v[178:179], v[176:177], v[168:169] op_sel:[0,0] op_sel_hi:[0,1]
    ds_write_addtid_b32 v138 offset:25024
    v_pk_fma_f32 v[178:179], v[176:177], v[168:169], v[178:179] op_sel:[1,1,0] op_sel_hi:[1,0,1] neg_lo:[1,0,0]
    v_pk_mul_f32 v[190:191], v[188:189], v[170:171] op_sel:[0,0] op_sel_hi:[0,1]
    v_cvt_pk_bf16_f32 v141, v178, v179
    v_pk_fma_f32 v[190:191], v[188:189], v[170:171], v[190:191] op_sel:[1,1,0] op_sel_hi:[1,0,1] neg_lo:[1,0,0]
    ds_write_addtid_b32 v141 offset:2720
    v_cvt_pk_bf16_f32 v139, v190, v191
    v_pk_mul_f32 v[176:177], v[178:179], v[168:169] op_sel:[0,0] op_sel_hi:[0,1]
    ds_write_addtid_b32 v139 offset:25568
    v_pk_fma_f32 v[176:177], v[178:179], v[168:169], v[176:177] op_sel:[1,1,0] op_sel_hi:[1,0,1] neg_lo:[1,0,0]
    v_pk_mul_f32 v[188:189], v[190:191], v[170:171] op_sel:[0,0] op_sel_hi:[0,1]
    v_cvt_pk_bf16_f32 v142, v176, v177
    v_pk_fma_f32 v[188:189], v[190:191], v[170:171], v[188:189] op_sel:[1,1,0] op_sel_hi:[1,0,1] neg_lo:[1,0,0]
    ds_write_addtid_b32 v142 offset:3264
    v_cvt_pk_bf16_f32 v136, v188, v189
    v_pk_mul_f32 v[178:179], v[176:177], v[168:169] op_sel:[0,0] op_sel_hi:[0,1]
    ds_write_addtid_b32 v136 offset:26112
    v_pk_fma_f32 v[178:179], v[176:177], v[168:169], v[178:179] op_sel:[1,1,0] op_sel_hi:[1,0,1] neg_lo:[1,0,0]
    v_pk_mul_f32 v[190:191], v[188:189], v[170:171] op_sel:[0,0] op_sel_hi:[0,1]
    v_cvt_pk_bf16_f32 v143, v178, v179
    v_pk_fma_f32 v[190:191], v[188:189], v[170:171], v[190:191] op_sel:[1,1,0] op_sel_hi:[1,0,1] neg_lo:[1,0,0]
    ds_write_addtid_b32 v143 offset:3808
    v_cvt_pk_bf16_f32 v137, v190, v191
    v_pk_mul_f32 v[176:177], v[178:179], v[168:169] op_sel:[0,0] op_sel_hi:[0,1]
    ds_write_addtid_b32 v137 offset:26656
    v_pk_fma_f32 v[176:177], v[178:179], v[168:169], v[176:177] op_sel:[1,1,0] op_sel_hi:[1,0,1] neg_lo:[1,0,0]
    v_pk_mul_f32 v[188:189], v[190:191], v[170:171] op_sel:[0,0] op_sel_hi:[0,1]
    v_cvt_pk_bf16_f32 v140, v176, v177
    v_pk_fma_f32 v[188:189], v[190:191], v[170:171], v[188:189] op_sel:[1,1,0] op_sel_hi:[1,0,1] neg_lo:[1,0,0]
    ds_write_addtid_b32 v140 offset:4352
    v_cvt_pk_bf16_f32 v138, v188, v189
    v_pk_mul_f32 v[178:179], v[176:177], v[168:169] op_sel:[0,0] op_sel_hi:[0,1]
    ds_write_addtid_b32 v138 offset:27200
    v_pk_fma_f32 v[178:179], v[176:177], v[168:169], v[178:179] op_sel:[1,1,0] op_sel_hi:[1,0,1] neg_lo:[1,0,0]
    v_pk_mul_f32 v[190:191], v[188:189], v[170:171] op_sel:[0,0] op_sel_hi:[0,1]
    v_cvt_pk_bf16_f32 v141, v178, v179
    v_pk_fma_f32 v[190:191], v[188:189], v[170:171], v[190:191] op_sel:[1,1,0] op_sel_hi:[1,0,1] neg_lo:[1,0,0]
    ds_write_addtid_b32 v141 offset:4896
    v_cvt_pk_bf16_f32 v139, v190, v191
    v_pk_mul_f32 v[176:177], v[178:179], v[168:169] op_sel:[0,0] op_sel_hi:[0,1]
    s_lshl_b32 s74, s28, 13
    s_add_u32 s74, s74, 131072
    v_lshl_add_u32 v213, v0, 7, s74
    buffer_load_dword v212, v213, s[12:15], 0 offen sc1
    ds_write_addtid_b32 v139 offset:27744
    v_pk_fma_f32 v[176:177], v[178:179], v[168:169], v[176:177] op_sel:[1,1,0] op_sel_hi:[1,0,1] neg_lo:[1,0,0]
    v_pk_mul_f32 v[188:189], v[190:191], v[170:171] op_sel:[0,0] op_sel_hi:[0,1]
    v_cvt_pk_bf16_f32 v142, v176, v177
    v_pk_fma_f32 v[188:189], v[190:191], v[170:171], v[188:189] op_sel:[1,1,0] op_sel_hi:[1,0,1] neg_lo:[1,0,0]
    ds_write_addtid_b32 v142 offset:5440
    v_cvt_pk_bf16_f32 v136, v188, v189
    v_pk_mul_f32 v[178:179], v[176:177], v[168:169] op_sel:[0,0] op_sel_hi:[0,1]
    ds_write_addtid_b32 v136 offset:28288
    v_pk_fma_f32 v[178:179], v[176:177], v[168:169], v[178:179] op_sel:[1,1,0] op_sel_hi:[1,0,1] neg_lo:[1,0,0]
    v_pk_mul_f32 v[190:191], v[188:189], v[170:171] op_sel:[0,0] op_sel_hi:[0,1]
    v_cvt_pk_bf16_f32 v143, v178, v179
    v_pk_fma_f32 v[190:191], v[188:189], v[170:171], v[190:191] op_sel:[1,1,0] op_sel_hi:[1,0,1] neg_lo:[1,0,0]
    ds_write_addtid_b32 v143 offset:5984
    v_cvt_pk_bf16_f32 v137, v190, v191
    v_pk_mul_f32 v[176:177], v[178:179], v[168:169] op_sel:[0,0] op_sel_hi:[0,1]
    ds_write_addtid_b32 v137 offset:28832
    v_pk_fma_f32 v[176:177], v[178:179], v[168:169], v[176:177] op_sel:[1,1,0] op_sel_hi:[1,0,1] neg_lo:[1,0,0]
    v_pk_mul_f32 v[188:189], v[190:191], v[170:171] op_sel:[0,0] op_sel_hi:[0,1]
    v_cvt_pk_bf16_f32 v140, v176, v177
    v_pk_fma_f32 v[188:189], v[190:191], v[170:171], v[188:189] op_sel:[1,1,0] op_sel_hi:[1,0,1] neg_lo:[1,0,0]
    ds_write_addtid_b32 v140 offset:6528
    v_cvt_pk_bf16_f32 v138, v188, v189
    v_pk_mul_f32 v[178:179], v[176:177], v[168:169] op_sel:[0,0] op_sel_hi:[0,1]
    ds_write_addtid_b32 v138 offset:29376
    v_pk_fma_f32 v[178:179], v[176:177], v[168:169], v[178:179] op_sel:[1,1,0] op_sel_hi:[1,0,1] neg_lo:[1,0,0]
    v_pk_mul_f32 v[190:191], v[188:189], v[170:171] op_sel:[0,0] op_sel_hi:[0,1]
    v_cvt_pk_bf16_f32 v141, v178, v179
    v_pk_fma_f32 v[190:191], v[188:189], v[170:171], v[190:191] op_sel:[1,1,0] op_sel_hi:[1,0,1] neg_lo:[1,0,0]
    ds_write_addtid_b32 v141 offset:7072
    v_cvt_pk_bf16_f32 v139, v190, v191
    v_pk_mul_f32 v[176:177], v[178:179], v[168:169] op_sel:[0,0] op_sel_hi:[0,1]
    ds_write_addtid_b32 v139 offset:29920
    v_pk_fma_f32 v[176:177], v[178:179], v[168:169], v[176:177] op_sel:[1,1,0] op_sel_hi:[1,0,1] neg_lo:[1,0,0]
    v_pk_mul_f32 v[188:189], v[190:191], v[170:171] op_sel:[0,0] op_sel_hi:[0,1]
    v_cvt_pk_bf16_f32 v142, v176, v177
    v_pk_fma_f32 v[188:189], v[190:191], v[170:171], v[188:189] op_sel:[1,1,0] op_sel_hi:[1,0,1] neg_lo:[1,0,0]
    ds_write_addtid_b32 v142 offset:7616
    v_cvt_pk_bf16_f32 v136, v188, v189
    v_pk_mul_f32 v[178:179], v[176:177], v[168:169] op_sel:[0,0] op_sel_hi:[0,1]
    ds_write_addtid_b32 v136 offset:30464
    v_pk_fma_f32 v[178:179], v[176:177], v[168:169], v[178:179] op_sel:[1,1,0] op_sel_hi:[1,0,1] neg_lo:[1,0,0]
    v_cvt_pk_bf16_f32 v143, v178, v179
    ds_write_addtid_b32 v143 offset:8160
    v_pk_mul_f32 v[174:175], v[168:169], v[168:169] op_sel:[0,0] op_sel_hi:[0,1]
    v_pk_mul_f32 v[184:185], v[166:167], v[172:173] op_sel:[0,0] op_sel_hi:[0,1]
    v_pk_fma_f32 v[174:175], v[168:169], v[168:169], v[174:175] op_sel:[1,1,0] op_sel_hi:[1,0,1] neg_lo:[1,0,0]
    v_pk_fma_f32 v[184:185], v[166:167], v[172:173], v[184:185] op_sel:[1,1,0] op_sel_hi:[1,0,1] neg_lo:[1,0,0]
    v_pk_mul_f32 v[182:183], v[174:175], v[174:175] op_sel:[0,0] op_sel_hi:[0,1]
    v_pk_mul_f32 v[186:187], v[184:185], v[172:173] op_sel:[0,0] op_sel_hi:[0,1]
    v_pk_fma_f32 v[182:183], v[174:175], v[174:175], v[182:183] op_sel:[1,1,0] op_sel_hi:[1,0,1] neg_lo:[1,0,0]
    v_pk_fma_f32 v[186:187], v[184:185], v[172:173], v[186:187] op_sel:[1,1,0] op_sel_hi:[1,0,1] neg_lo:[1,0,0]
    v_pk_mul_f32 v[180:181], v[182:183], v[182:183] op_sel:[0,0] op_sel_hi:[0,1]
    v_pk_mul_f32 v[166:167], v[186:187], v[172:173] op_sel:[0,0] op_sel_hi:[0,1]
    v_pk_fma_f32 v[180:181], v[182:183], v[182:183], v[180:181] op_sel:[1,1,0] op_sel_hi:[1,0,1] neg_lo:[1,0,0]
    v_pk_fma_f32 v[166:167], v[186:187], v[172:173], v[166:167] op_sel:[1,1,0] op_sel_hi:[1,0,1] neg_lo:[1,0,0]
    v_cvt_pk_bf16_f32 v136, v184, v185
    v_cvt_pk_bf16_f32 v140, v186, v187
    ds_write_addtid_b32 v136 offset:8704
    ds_write_addtid_b32 v140 offset:13056
    v_pk_mul_f32 v[190:191], v[184:185], v[174:175] op_sel:[0,0] op_sel_hi:[0,1]
    v_pk_mul_f32 v[178:179], v[186:187], v[182:183] op_sel:[0,0] op_sel_hi:[0,1]
    v_pk_fma_f32 v[190:191], v[184:185], v[174:175], v[190:191] op_sel:[1,1,0] op_sel_hi:[1,0,1] neg_lo:[1,0,0]
    v_pk_fma_f32 v[178:179], v[186:187], v[182:183], v[178:179] op_sel:[1,1,0] op_sel_hi:[1,0,1] neg_lo:[1,0,0]
    v_cvt_pk_bf16_f32 v137, v190, v191
    v_cvt_pk_bf16_f32 v141, v178, v179
    ds_write_addtid_b32 v137 offset:9248
    ds_write_addtid_b32 v141 offset:13600
    v_pk_mul_f32 v[188:189], v[190:191], v[174:175] op_sel:[0,0] op_sel_hi:[0,1]
    v_pk_mul_f32 v[176:177], v[178:179], v[182:183] op_sel:[0,0] op_sel_hi:[0,1]
    v_pk_fma_f32 v[188:189], v[190:191], v[174:175], v[188:189] op_sel:[1,1,0] op_sel_hi:[1,0,1] neg_lo:[1,0,0]
    v_pk_fma_f32 v[176:177], v[178:179], v[182:183], v[176:177] op_sel:[1,1,0] op_sel_hi:[1,0,1] neg_lo:[1,0,0]
    v_cvt_pk_bf16_f32 v138, v188, v189
    v_cvt_pk_bf16_f32 v142, v176, v177
    ds_write_addtid_b32 v138 offset:9792
    ds_write_addtid_b32 v142 offset:14144
    v_pk_mul_f32 v[190:191], v[188:189], v[174:175] op_sel:[0,0] op_sel_hi:[0,1]
    v_pk_mul_f32 v[178:179], v[176:177], v[182:183] op_sel:[0,0] op_sel_hi:[0,1]
    v_pk_fma_f32 v[190:191], v[188:189], v[174:175], v[190:191] op_sel:[1,1,0] op_sel_hi:[1,0,1] neg_lo:[1,0,0]
    v_pk_fma_f32 v[178:179], v[176:177], v[182:183], v[178:179] op_sel:[1,1,0] op_sel_hi:[1,0,1] neg_lo:[1,0,0]
    v_cvt_pk_bf16_f32 v139, v190, v191
    v_cvt_pk_bf16_f32 v143, v178, v179
    ds_write_addtid_b32 v139 offset:10336
    ds_write_addtid_b32 v143 offset:14688
    v_pk_mul_f32 v[188:189], v[190:191], v[174:175] op_sel:[0,0] op_sel_hi:[0,1]
    v_cvt_pk_bf16_f32 v140, v166, v167
    v_pk_fma_f32 v[188:189], v[190:191], v[174:175], v[188:189] op_sel:[1,1,0] op_sel_hi:[1,0,1] neg_lo:[1,0,0]
    ds_write_addtid_b32 v140 offset:15232
    v_cvt_pk_bf16_f32 v136, v188, v189
    v_pk_mul_f32 v[178:179], v[166:167], v[182:183] op_sel:[0,0] op_sel_hi:[0,1]
    ds_write_addtid_b32 v136 offset:10880
    v_pk_fma_f32 v[178:179], v[166:167], v[182:183], v[178:179] op_sel:[1,1,0] op_sel_hi:[1,0,1] neg_lo:[1,0,0]
    v_pk_mul_f32 v[190:191], v[188:189], v[174:175] op_sel:[0,0] op_sel_hi:[0,1]
    v_cvt_pk_bf16_f32 v141, v178, v179
    v_pk_fma_f32 v[190:191], v[188:189], v[174:175], v[190:191] op_sel:[1,1,0] op_sel_hi:[1,0,1] neg_lo:[1,0,0]
    ds_write_addtid_b32 v141 offset:15776
    v_cvt_pk_bf16_f32 v137, v190, v191
    v_pk_mul_f32 v[176:177], v[178:179], v[182:183] op_sel:[0,0] op_sel_hi:[0,1]
    ds_write_addtid_b32 v137 offset:11424
    v_pk_fma_f32 v[176:177], v[178:179], v[182:183], v[176:177] op_sel:[1,1,0] op_sel_hi:[1,0,1] neg_lo:[1,0,0]
    v_pk_mul_f32 v[188:189], v[190:191], v[174:175] op_sel:[0,0] op_sel_hi:[0,1]
    v_cvt_pk_bf16_f32 v142, v176, v177
    v_pk_fma_f32 v[188:189], v[190:191], v[174:175], v[188:189] op_sel:[1,1,0] op_sel_hi:[1,0,1] neg_lo:[1,0,0]
    ds_write_addtid_b32 v142 offset:16320
    v_cvt_pk_bf16_f32 v138, v188, v189
    v_pk_mul_f32 v[178:179], v[176:177], v[182:183] op_sel:[0,0] op_sel_hi:[0,1]
    ds_write_addtid_b32 v138 offset:11968
    v_pk_fma_f32 v[178:179], v[176:177], v[182:183], v[178:179] op_sel:[1,1,0] op_sel_hi:[1,0,1] neg_lo:[1,0,0]
    v_pk_mul_f32 v[190:191], v[188:189], v[174:175] op_sel:[0,0] op_sel_hi:[0,1]
    v_cvt_pk_bf16_f32 v143, v178, v179
    v_pk_fma_f32 v[190:191], v[188:189], v[174:175], v[190:191] op_sel:[1,1,0] op_sel_hi:[1,0,1] neg_lo:[1,0,0]
    ds_write_addtid_b32 v143 offset:16864
    v_cvt_pk_bf16_f32 v139, v190, v191
    ds_write_addtid_b32 v139 offset:12512
    v_pk_mul_f32 v[168:169], v[166:167], v[172:173] op_sel:[0,0] op_sel_hi:[0,1]
    v_pk_fma_f32 v[168:169], v[166:167], v[172:173], v[168:169] op_sel:[1,1,0] op_sel_hi:[1,0,1] neg_lo:[1,0,0]
    v_cvt_pk_bf16_f32 v136, v168, v169
    ds_write_addtid_b32 v136 offset:17408
    v_pk_mul_f32 v[170:171], v[168:169], v[172:173] op_sel:[0,0] op_sel_hi:[0,1]
    v_pk_mul_f32 v[176:177], v[168:169], v[180:181] op_sel:[0,0] op_sel_hi:[0,1]
    v_pk_fma_f32 v[170:171], v[168:169], v[172:173], v[170:171] op_sel:[1,1,0] op_sel_hi:[1,0,1] neg_lo:[1,0,0]
    v_pk_fma_f32 v[176:177], v[168:169], v[180:181], v[176:177] op_sel:[1,1,0] op_sel_hi:[1,0,1] neg_lo:[1,0,0]
    v_cvt_pk_bf16_f32 v138, v170, v171
    v_cvt_pk_bf16_f32 v141, v176, v177
    ds_write_addtid_b32 v138 offset:18496
    ds_write_addtid_b32 v141 offset:17952
    v_pk_mul_f32 v[174:175], v[170:171], v[172:173] op_sel:[0,0] op_sel_hi:[0,1]
    v_pk_mul_f32 v[178:179], v[170:171], v[180:181] op_sel:[0,0] op_sel_hi:[0,1]
    v_pk_fma_f32 v[174:175], v[170:171], v[172:173], v[174:175] op_sel:[1,1,0] op_sel_hi:[1,0,1] neg_lo:[1,0,0]
    v_pk_fma_f32 v[178:179], v[170:171], v[180:181], v[178:179] op_sel:[1,1,0] op_sel_hi:[1,0,1] neg_lo:[1,0,0]
    v_cvt_pk_bf16_f32 v136, v174, v175
    v_cvt_pk_bf16_f32 v143, v178, v179
    ds_write_addtid_b32 v136 offset:19584
    ds_write_addtid_b32 v143 offset:19040
    v_pk_mul_f32 v[182:183], v[174:175], v[172:173] op_sel:[0,0] op_sel_hi:[0,1]
    v_pk_mul_f32 v[176:177], v[174:175], v[180:181] op_sel:[0,0] op_sel_hi:[0,1]
    v_pk_fma_f32 v[182:183], v[174:175], v[172:173], v[182:183] op_sel:[1,1,0] op_sel_hi:[1,0,1] neg_lo:[1,0,0]
    v_pk_fma_f32 v[176:177], v[174:175], v[180:181], v[176:177] op_sel:[1,1,0] op_sel_hi:[1,0,1] neg_lo:[1,0,0]
    v_cvt_pk_bf16_f32 v138, v182, v183
    v_cvt_pk_bf16_f32 v141, v176, v177
    ds_write_addtid_b32 v138 offset:20672
    ds_write_addtid_b32 v141 offset:20128
    v_pk_mul_f32 v[184:185], v[182:183], v[172:173] op_sel:[0,0] op_sel_hi:[0,1]
    v_pk_mul_f32 v[178:179], v[182:183], v[180:181] op_sel:[0,0] op_sel_hi:[0,1]
    v_pk_fma_f32 v[184:185], v[182:183], v[172:173], v[184:185] op_sel:[1,1,0] op_sel_hi:[1,0,1] neg_lo:[1,0,0]
    v_pk_fma_f32 v[178:179], v[182:183], v[180:181], v[178:179] op_sel:[1,1,0] op_sel_hi:[1,0,1] neg_lo:[1,0,0]
    v_cvt_pk_bf16_f32 v136, v184, v185
    v_cvt_pk_bf16_f32 v143, v178, v179
    ds_write_addtid_b32 v136 offset:21760
    ds_write_addtid_b32 v143 offset:21216
    s_waitcnt vmcnt(0)
    v_and_b32 v212, 1, v212
    v_cmp_ne_u32 vcc, 1, v212
    s_cbranch_vccz L_faall_ok_17
    s_mov_b32 s74, 20000
L_faall_spin_18:
    s_mov_b64 exec, vcc
    s_sleep 2
    buffer_load_dword v212, v213, s[12:15], 0 offen sc1
    s_waitcnt vmcnt(0)
    v_and_b32 v212, 1, v212
    v_cmp_ne_u32 vcc, 1, v212
    s_mov_b64 exec, -1
    s_cbranch_vccz L_faall_ok_17
    s_sub_u32 s74, s74, 1
    s_cmp_lg_u32 s74, 0
    s_cbranch_scc1 L_faall_spin_18
L_faall_ok_17:
    buffer_load_dwordx4 v[212:215], v241, s[12:15], s40 offen sc1
    buffer_load_dwordx4 v[216:219], v241, s[12:15], s41 offen sc1
    s_waitcnt lgkmcnt(0)
    s_barrier
    ds_read_b128 v[104:107], v224 offset:4896
    ds_read_b128 v[40:43], v223 offset:0
    ds_read_b128 v[72:75], v224 offset:0
    ds_read_b128 v[108:111], v224 offset:4960
    ds_read_b128 v[44:47], v223 offset:64
    ds_read_b128 v[76:79], v224 offset:64
    ds_read_b128 v[112:115], v224 offset:5024
    ds_read_b128 v[48:51], v223 offset:128
    ds_read_b128 v[80:83], v224 offset:128
    ds_read_b128 v[116:119], v224 offset:5088
    ds_read_b128 v[52:55], v223 offset:192
    ds_read_b128 v[84:87], v224 offset:192
    s_add_u32 s40, s40, 32
    s_add_u32 s41, s41, 32
    buffer_load_dwordx4 v[136:139], v241, s[12:15], s40 offen sc1
    buffer_load_dwordx4 v[140:143], v241, s[12:15], s41 offen sc1
    ds_read_u16 v144, v2 offset:0
    ds_read_u16 v145, v3 offset:0
    ds_read_u16 v146, v4 offset:0
    ds_read_u16 v147, v5 offset:0
    ds_read_u16 v148, v6 offset:0
    ds_read_u16 v149, v7 offset:0
    ds_read_u16 v150, v8 offset:0
    ds_read_u16 v151, v9 offset:0
    ds_read_u16 v152, v10 offset:0
    ds_read_u16 v166, v2 offset:3072
    ds_read_u16 v167, v3 offset:3072
    ds_read_u16 v168, v4 offset:3072
    ds_read_u16 v169, v5 offset:3072
    ds_read_u16 v170, v6 offset:3072
    ds_read_u16 v171, v7 offset:3072
    ds_read_u16 v172, v8 offset:3072
    ds_read_u16 v173, v9 offset:3072
    ds_read_u16 v174, v10 offset:3072
    s_mul_i32 s76, s80, 5
    buffer_load_dwordx4 a[0:3], v220, s[20:23], s76 offen offset:0 sc1
    buffer_load_dwordx4 a[4:7], v220, s[20:23], s76 offen offset:1024 sc1
    s_waitcnt lgkmcnt(15)
    v_mfma_f32_16x16x32_bf16 v[16:19], v[40:43], v[104:107], 0
    ds_read_b128 v[120:123], v224 offset:5152
    ds_read_b128 v[56:59], v223 offset:256
    v_mfma_f32_16x16x32_bf16 v[20:23], v[72:75], v[104:107], 0
    ds_read_b128 v[88:91], v224 offset:256
    v_mfma_f32_16x16x32_bf16 v[16:19], v[44:47], v[108:111], v[16:19]
    ds_read_b128 v[124:127], v224 offset:5216
    ds_read_b128 v[60:63], v223 offset:320
    v_mfma_f32_16x16x32_bf16 v[20:23], v[76:79], v[108:111], v[20:23]
    ds_read_b128 v[92:95], v224 offset:320
    v_mfma_f32_16x16x32_bf16 v[16:19], v[48:51], v[112:115], v[16:19]
    ds_read_b128 v[128:131], v224 offset:5280
    ds_read_b128 v[64:67], v223 offset:384
    v_mfma_f32_16x16x32_bf16 v[20:23], v[80:83], v[112:115], v[20:23]
    ds_read_b128 v[96:99], v224 offset:384
    v_mfma_f32_16x16x32_bf16 v[16:19], v[52:55], v[116:119], v[16:19]
    ds_read_b128 v[132:135], v224 offset:5344
    ds_read_b128 v[68:71], v223 offset:448
    v_mfma_f32_16x16x32_bf16 v[20:23], v[84:87], v[116:119], v[20:23]
    ds_read_b128 v[100:103], v224 offset:448
    s_waitcnt lgkmcnt(10)
    v_mfma_f32_16x16x32_bf16 v[16:19], v[56:59], v[120:123], v[16:19]
    s_waitcnt lgkmcnt(9)
    v_mfma_f32_16x16x32_bf16 v[20:23], v[88:91], v[120:123], v[20:23]
    s_waitcnt lgkmcnt(7)
    v_mfma_f32_16x16x32_bf16 v[16:19], v[60:63], v[124:127], v[16:19]
    s_waitcnt lgkmcnt(6)
    v_mfma_f32_16x16x32_bf16 v[20:23], v[92:95], v[124:127], v[20:23]
    s_waitcnt lgkmcnt(4)
    v_mfma_f32_16x16x32_bf16 v[16:19], v[64:67], v[128:131], v[16:19]
    s_waitcnt lgkmcnt(3)
    v_mfma_f32_16x16x32_bf16 v[20:23], v[96:99], v[128:131], v[20:23]
    s_waitcnt lgkmcnt(1)
    v_mfma_f32_16x16x32_bf16 v[16:19], v[68:71], v[132:135], v[16:19]
    s_waitcnt lgkmcnt(0)
    v_mfma_f32_16x16x32_bf16 v[20:23], v[100:103], v[132:135], v[20:23]
    v_mov_b32 v28, 0
    ds_write_b32 v227, v28 offset:7432
    v_mov_b32 v184, 0
    v_mov_b32 v185, 0
    v_mov_b32 v186, 0
    v_mov_b32 v187, 0
    ds_write_b128 v243, v[184:187]
    v_lshl_or_b32 v156, v145, 16, v144
    v_lshl_or_b32 v157, v147, 16, v146
    v_lshl_or_b32 v158, v149, 16, v148
    v_lshl_or_b32 v159, v151, 16, v150
    ds_write_b128 v236, v[156:159]
    v_lshl_or_b32 v160, v146, 16, v145
    v_lshl_or_b32 v161, v148, 16, v147
    v_lshl_or_b32 v162, v150, 16, v149
    v_lshl_or_b32 v163, v152, 16, v151
    ds_write_b128 v236, v[160:163] offset:2112
    s_waitcnt vmcnt(5)
    ds_write_b128 v242, v[212:215]
    s_waitcnt vmcnt(4)
    ds_write_b128 v242, v[216:219] offset:512
    v_add_u32 v236, -65536, v236
    v_add_u32 v242, -65536, v242
    v_add_u32 v243, -65536, v243
    ds_write_b128 v243, v[184:187]
    v_lshl_or_b32 v176, v167, 16, v166
    v_lshl_or_b32 v177, v169, 16, v168
    v_lshl_or_b32 v178, v171, 16, v170
    v_lshl_or_b32 v179, v173, 16, v172
    ds_write_b128 v236, v[176:179]
    v_lshl_or_b32 v180, v168, 16, v167
    v_lshl_or_b32 v181, v170, 16, v169
    v_lshl_or_b32 v182, v172, 16, v171
    v_lshl_or_b32 v183, v174, 16, v173
    ds_write_b128 v236, v[180:183] offset:2112
    s_waitcnt vmcnt(3)
    ds_write_b128 v242, v[136:139]
    s_waitcnt vmcnt(2)
    ds_write_b128 v242, v[140:143] offset:512
    v_add_u32 v236, 20480, v236
    v_add_u32 v242, 20480, v242
    v_add_u32 v243, 20480, v243
    ds_write_b128 v243, v[184:187]
    s_cmp_eq_u32 s52, 0
    s_cselect_b32 s36, s54, s55
    s_lshl_b32 s68, s53, 4
    s_lshr_b32 s68, s36, s68
    s_lshl_b32 s68, s68, 16
    v_mov_b32 v188, s68
    v_mov_b32 v189, s68
    v_mov_b32 v190, s68
    v_mov_b32 v191, s68
    v_add_f32 v16, v16, v35
    v_cvt_pk_bf16_f32 v25, v18, v19
    v_cvt_pk_bf16_f32 v24, v16, v17
    ds_write_b64 v225, v[24:25] offset:6144
    v_cvt_pk_bf16_f32 v26, v20, v21
    v_cvt_pk_bf16_f32 v27, v22, v23
    ds_write_b32 v226, v26 offset:6144
    ds_write_b32 v226, v27 offset:6208
    s_mul_i32 s68, s52, -65536
    v_add_u32 v237, s68, v237
    v_add_u32 v238, s68, v238
    v_add_u32 v239, s68, v239
    v_add_u32 v240, s68, v240
    s_mul_i32 s68, s52, 6144
    s_add_u32 s37, s42, s68
    s_mul_i32 s68, s52, -81664
    s_add_u32 s39, s43, s68
    s_add_u32 s42, s42, 16384
    s_add_u32 s43, s43, 512
    s_waitcnt lgkmcnt(0)
    s_barrier
    ds_read2_b32 v[48:49], v238 offset0:0 offset1:1
    ds_read2_b32 v[50:51], v238 offset0:2 offset1:3
    ds_read_b128 v[116:119], v240 offset:4096
    ds_read2_b32 v[52:53], v237 offset0:240 offset1:241
    ds_read2_b32 v[54:55], v237 offset0:242 offset1:243
    ds_read_b128 v[120:123], v240 offset:4032
    ds_read2_b32 v[56:57], v237 offset0:224 offset1:225
    ds_read2_b32 v[58:59], v237 offset0:226 offset1:227
    ds_read_b128 v[124:127], v240 offset:3968
    ds_read2_b32 v[60:61], v237 offset0:208 offset1:209
    ds_read2_b32 v[62:63], v237 offset0:210 offset1:211
    ds_read_b128 v[128:131], v240 offset:3904
    ds_read2_b32 v[64:65], v237 offset0:192 offset1:193
    ds_read2_b32 v[66:67], v237 offset0:194 offset1:195
    ds_read_b128 v[132:135], v240 offset:3840
    ds_read2_b32 v[68:69], v237 offset0:176 offset1:177
    ds_read2_b32 v[70:71], v237 offset0:178 offset1:179
    ds_read_b128 v[136:139], v240 offset:3776
    s_waitcnt lgkmcnt(15)
    v_mfma_f32_16x16x32_bf16 v[44:47], v[48:51], v[116:119], v[188:191]
    ds_read2_b32 v[72:73], v237 offset0:160 offset1:161
    ds_read2_b32 v[74:75], v237 offset0:162 offset1:163
    ds_read_b128 v[140:143], v240 offset:3712
    s_waitcnt lgkmcnt(15)
    v_mfma_f32_16x16x32_bf16 v[44:47], v[52:55], v[120:123], v[44:47]
    ds_read2_b32 v[76:77], v237 offset0:144 offset1:145
    ds_read2_b32 v[78:79], v237 offset0:146 offset1:147
    ds_read_b128 v[144:147], v240 offset:3648
    s_waitcnt lgkmcnt(15)
    v_mfma_f32_16x16x32_bf16 v[44:47], v[56:59], v[124:127], v[44:47]
    s_add_u32 s40, s40, 32
    s_add_u32 s41, s41, 32
    ds_read2_b32 v[80:81], v237 offset0:128 offset1:129
    ds_read2_b32 v[82:83], v237 offset0:130 offset1:131
    ds_read_b128 v[116:119], v240 offset:3584
    s_waitcnt lgkmcnt(15)
    v_mfma_f32_16x16x32_bf16 v[44:47], v[60:63], v[128:131], v[44:47]
    ds_read2_b32 v[84:85], v237 offset0:112 offset1:113
    ds_read2_b32 v[86:87], v237 offset0:114 offset1:115
    ds_read_b128 v[120:123], v240 offset:3520
    s_waitcnt lgkmcnt(15)
    v_mfma_f32_16x16x32_bf16 v[44:47], v[64:67], v[132:135], v[44:47]
    ds_read2_b32 v[88:89], v237 offset0:96 offset1:97
    ds_read2_b32 v[90:91], v237 offset0:98 offset1:99
    ds_read_b128 v[124:127], v240 offset:3456
    s_waitcnt lgkmcnt(15)
    v_mfma_f32_16x16x32_bf16 v[44:47], v[68:71], v[136:139], v[44:47]
    buffer_load_dwordx4 v[212:215], v241, s[12:15], s40 offen sc1
    ds_read2_b32 v[92:93], v237 offset0:80 offset1:81
    ds_read2_b32 v[94:95], v237 offset0:82 offset1:83
    ds_read_b128 v[128:131], v240 offset:3392
    s_waitcnt lgkmcnt(15)
    v_mfma_f32_16x16x32_bf16 v[44:47], v[72:75], v[140:143], v[44:47]
    ds_read2_b32 v[96:97], v237 offset0:64 offset1:65
    ds_read2_b32 v[98:99], v237 offset0:66 offset1:67
    ds_read_b128 v[132:135], v240 offset:3328
    s_waitcnt lgkmcnt(15)
    v_mfma_f32_16x16x32_bf16 v[44:47], v[76:79], v[144:147], v[44:47]
    ds_read2_b32 v[100:101], v237 offset0:48 offset1:49
    ds_read2_b32 v[102:103], v237 offset0:50 offset1:51
    ds_read_b128 v[136:139], v240 offset:3264
    s_waitcnt lgkmcnt(15)
    v_mfma_f32_16x16x32_bf16 v[44:47], v[80:83], v[116:119], v[44:47]
    buffer_load_dwordx4 v[216:219], v241, s[12:15], s41 offen sc1
    ds_read2_b32 v[104:105], v237 offset0:32 offset1:33
    ds_read2_b32 v[106:107], v237 offset0:34 offset1:35
    ds_read_b128 v[140:143], v240 offset:3200
    v_mfma_f32_16x16x32_bf16 v[40:43], v[48:51], v[116:119], v[188:191]
    s_waitcnt lgkmcnt(15)
    v_mfma_f32_16x16x32_bf16 v[44:47], v[84:87], v[120:123], v[44:47]
    ds_read2_b32 v[108:109], v237 offset0:16 offset1:17
    ds_read2_b32 v[110:111], v237 offset0:18 offset1:19
    ds_read_b128 v[144:147], v240 offset:3136
    v_mfma_f32_16x16x32_bf16 v[40:43], v[52:55], v[120:123], v[40:43]
    s_waitcnt lgkmcnt(15)
    v_mfma_f32_16x16x32_bf16 v[44:47], v[88:91], v[124:127], v[44:47]
    buffer_load_dwordx4 a[8:11], v220, s[20:23], s76 offen offset:2048 sc1
    ds_read2_b32 v[112:113], v237 offset0:0 offset1:1
    ds_read2_b32 v[114:115], v237 offset0:2 offset1:3
    ds_read_b128 v[116:119], v240 offset:3072
    v_mfma_f32_16x16x32_bf16 v[40:43], v[56:59], v[124:127], v[40:43]
    s_waitcnt lgkmcnt(15)
    v_mfma_f32_16x16x32_bf16 v[44:47], v[92:95], v[128:131], v[44:47]
    ds_read_b128 v[120:123], v240 offset:3008
    v_mfma_f32_16x16x32_bf16 v[40:43], v[60:63], v[128:131], v[40:43]
    s_waitcnt lgkmcnt(13)
    v_mfma_f32_16x16x32_bf16 v[44:47], v[96:99], v[132:135], v[44:47]
    buffer_load_dwordx4 a[12:15], v220, s[20:23], s76 offen offset:3072 sc1
    ds_read_b128 v[124:127], v240 offset:2944
    v_mfma_f32_16x16x32_bf16 v[40:43], v[64:67], v[132:135], v[40:43]
    s_waitcnt lgkmcnt(11)
    v_mfma_f32_16x16x32_bf16 v[44:47], v[100:103], v[136:139], v[44:47]
    ds_read_b128 v[128:131], v240 offset:2880
    v_mfma_f32_16x16x32_bf16 v[40:43], v[68:71], v[136:139], v[40:43]
    s_waitcnt lgkmcnt(9)
    v_mfma_f32_16x16x32_bf16 v[44:47], v[104:107], v[140:143], v[44:47]
    buffer_load_dwordx4 a[16:19], v221, s[20:23], s76 offen offset:0 sc1
    ds_read_b128 v[132:135], v240 offset:2816
    v_mfma_f32_16x16x32_bf16 v[40:43], v[72:75], v[140:143], v[40:43]
    s_waitcnt lgkmcnt(7)
    v_mfma_f32_16x16x32_bf16 v[44:47], v[108:111], v[144:147], v[44:47]
    ds_read_b128 v[136:139], v240 offset:2752
    v_mfma_f32_16x16x32_bf16 v[40:43], v[76:79], v[144:147], v[40:43]
    s_mul_i32 s77, s81, 5
    buffer_load_dwordx4 a[20:23], v220, s[20:23], s77 offen offset:0 sc1
    s_waitcnt lgkmcnt(5)
    v_mfma_f32_16x16x32_bf16 v[44:47], v[112:115], v[116:119], v[44:47]
    ds_read_b128 v[140:143], v240 offset:2688
    v_mfma_f32_16x16x32_bf16 v[40:43], v[80:83], v[116:119], v[40:43]
    v_mfma_f32_16x16x32_bf16 v[36:39], v[48:51], v[116:119], v[188:191]
    buffer_load_dwordx4 a[24:27], v220, s[20:23], s77 offen offset:1024 sc1
    s_waitcnt lgkmcnt(5)
    v_mfma_f32_16x16x32_bf16 v[40:43], v[84:87], v[120:123], v[40:43]
    ds_read_b128 v[144:147], v240 offset:2624
    v_mfma_f32_16x16x32_bf16 v[36:39], v[52:55], v[120:123], v[36:39]
    s_waitcnt lgkmcnt(5)
    v_mfma_f32_16x16x32_bf16 v[40:43], v[88:91], v[124:127], v[40:43]
    ds_read_b128 v[116:119], v240 offset:2560
    v_mfma_f32_16x16x32_bf16 v[36:39], v[56:59], v[124:127], v[36:39]
    buffer_load_dwordx4 a[28:31], v220, s[20:23], s77 offen offset:2048 sc1
    s_waitcnt lgkmcnt(5)
    v_mfma_f32_16x16x32_bf16 v[40:43], v[92:95], v[128:131], v[40:43]
    ds_read_b128 v[120:123], v240 offset:2496
    v_mfma_f32_16x16x32_bf16 v[36:39], v[60:63], v[128:131], v[36:39]
    s_waitcnt lgkmcnt(5)
    v_mfma_f32_16x16x32_bf16 v[40:43], v[96:99], v[132:135], v[40:43]
    ds_read_b128 v[124:127], v240 offset:2432
    v_mfma_f32_16x16x32_bf16 v[36:39], v[64:67], v[132:135], v[36:39]
    buffer_load_dwordx4 a[32:35], v220, s[20:23], s77 offen offset:3072 sc1
    s_waitcnt lgkmcnt(5)
    v_mfma_f32_16x16x32_bf16 v[40:43], v[100:103], v[136:139], v[40:43]
    ds_read_b128 v[128:131], v240 offset:2368
    v_mfma_f32_16x16x32_bf16 v[36:39], v[68:71], v[136:139], v[36:39]
    s_waitcnt lgkmcnt(5)
    v_mfma_f32_16x16x32_bf16 v[40:43], v[104:107], v[140:143], v[40:43]
    buffer_load_dwordx4 a[36:39], v221, s[20:23], s77 offen offset:0 sc1
    ds_read_b128 v[132:135], v240 offset:2304
    v_mfma_f32_16x16x32_bf16 v[36:39], v[72:75], v[140:143], v[36:39]
    s_waitcnt lgkmcnt(5)
    v_mfma_f32_16x16x32_bf16 v[40:43], v[108:111], v[144:147], v[40:43]
    ds_read_b128 v[136:139], v240 offset:2240
    v_mfma_f32_16x16x32_bf16 v[36:39], v[76:79], v[144:147], v[36:39]
    s_waitcnt lgkmcnt(5)
    v_mfma_f32_16x16x32_bf16 v[40:43], v[112:115], v[116:119], v[40:43]
    s_mul_i32 s76, s82, 5
    buffer_load_dwordx4 a[40:43], v220, s[20:23], s76 offen offset:0 sc1
    ds_read_b128 v[140:143], v240 offset:2176
    v_mfma_f32_16x16x32_bf16 v[36:39], v[80:83], v[116:119], v[36:39]
    v_mfma_f32_16x16x32_bf16 v[32:35], v[48:51], v[116:119], v[188:191]
    s_waitcnt lgkmcnt(5)
    v_mfma_f32_16x16x32_bf16 v[36:39], v[84:87], v[120:123], v[36:39]
    ds_read_b128 v[144:147], v240 offset:2112
    v_mfma_f32_16x16x32_bf16 v[32:35], v[52:55], v[120:123], v[32:35]
    buffer_load_dwordx4 a[44:47], v220, s[20:23], s76 offen offset:1024 sc1
    ds_read2_b32 v[148:149], v239 offset0:32 offset1:33
    s_waitcnt lgkmcnt(6)
    v_mfma_f32_16x16x32_bf16 v[36:39], v[88:91], v[124:127], v[36:39]
    ds_read_b128 v[116:119], v240 offset:2048
    v_mfma_f32_16x16x32_bf16 v[32:35], v[56:59], v[124:127], v[32:35]
    ds_read2_b32 v[150:151], v239 offset0:56 offset1:57
    s_waitcnt lgkmcnt(7)
    v_mfma_f32_16x16x32_bf16 v[36:39], v[92:95], v[128:131], v[36:39]
    ds_read_b128 v[120:123], v240 offset:1984
    v_mfma_f32_16x16x32_bf16 v[32:35], v[60:63], v[128:131], v[32:35]
    buffer_load_dwordx4 a[48:51], v220, s[20:23], s76 offen offset:2048 sc1
    ds_read2_b32 v[160:161], v239 offset0:80 offset1:81
    s_waitcnt lgkmcnt(8)
    v_mfma_f32_16x16x32_bf16 v[36:39], v[96:99], v[132:135], v[36:39]
    ds_read_b128 v[124:127], v240 offset:1920
    v_mfma_f32_16x16x32_bf16 v[32:35], v[64:67], v[132:135], v[32:35]
    buffer_load_dwordx4 a[52:55], v220, s[20:23], s76 offen offset:3072 sc1
    ds_read2_b32 v[162:163], v239 offset0:104 offset1:105
    s_waitcnt lgkmcnt(9)
    v_mfma_f32_16x16x32_bf16 v[36:39], v[100:103], v[136:139], v[36:39]
    ds_read_b128 v[128:131], v240 offset:1856
    v_mfma_f32_16x16x32_bf16 v[32:35], v[68:71], v[136:139], v[32:35]
    ds_read2_b32 v[172:173], v239 offset0:144 offset1:145
    s_waitcnt lgkmcnt(10)
    v_mfma_f32_16x16x32_bf16 v[36:39], v[104:107], v[140:143], v[36:39]
    ds_read_b128 v[132:135], v240 offset:1792
    v_mfma_f32_16x16x32_bf16 v[32:35], v[72:75], v[140:143], v[32:35]
    buffer_load_dwordx4 a[56:59], v221, s[20:23], s76 offen offset:0 sc1
    ds_read2_b32 v[174:175], v239 offset0:184 offset1:185
    s_waitcnt lgkmcnt(11)
    v_mfma_f32_16x16x32_bf16 v[36:39], v[108:111], v[144:147], v[36:39]
    ds_read_b128 v[136:139], v240 offset:1728
    v_mfma_f32_16x16x32_bf16 v[32:35], v[76:79], v[144:147], v[32:35]
    ds_read2_b32 v[152:153], v239 offset0:24 offset1:25
    s_waitcnt lgkmcnt(11)
    v_mfma_f32_16x16x32_bf16 v[36:39], v[112:115], v[116:119], v[36:39]
    ds_read_b128 v[140:143], v240 offset:1664
    v_mfma_f32_16x16x32_bf16 v[32:35], v[80:83], v[116:119], v[32:35]
    s_mul_i32 s77, s83, 5
    buffer_load_dwordx4 a[60:63], v220, s[20:23], s77 offen offset:0 sc1
    ds_read2_b32 v[154:155], v239 offset0:48 offset1:49
    v_mfma_f32_16x16x32_bf16 v[28:31], v[48:51], v[116:119], v[188:191]
    s_waitcnt lgkmcnt(11)
    v_mfma_f32_16x16x32_bf16 v[32:35], v[84:87], v[120:123], v[32:35]
    ds_read_b128 v[144:147], v240 offset:1600
    v_mfma_f32_16x16x32_bf16 v[28:31], v[52:55], v[120:123], v[28:31]
    s_waitcnt vmcnt(15)
    ds_write_b128 v242, v[212:215]
    ds_read2_b32 v[164:165], v239 offset0:72 offset1:73
    s_waitcnt lgkmcnt(12)
    v_mfma_f32_16x16x32_bf16 v[32:35], v[88:91], v[124:127], v[32:35]
    ds_read_b128 v[116:119], v240 offset:1536
    v_mfma_f32_16x16x32_bf16 v[28:31], v[56:59], v[124:127], v[28:31]
    ds_read2_b32 v[166:167], v239 offset0:96 offset1:97
    s_waitcnt lgkmcnt(12)
    v_mfma_f32_16x16x32_bf16 v[32:35], v[92:95], v[128:131], v[32:35]
    ds_read_b128 v[120:123], v240 offset:1472
    v_mfma_f32_16x16x32_bf16 v[28:31], v[60:63], v[128:131], v[28:31]
    s_waitcnt vmcnt(14)
    ds_write_b128 v242, v[216:219] offset:512
    ds_read2_b32 v[176:177], v239 offset0:136 offset1:137
    s_waitcnt lgkmcnt(13)
    v_mfma_f32_16x16x32_bf16 v[32:35], v[96:99], v[132:135], v[32:35]
    ds_read_b128 v[124:127], v240 offset:1408
    v_mfma_f32_16x16x32_bf16 v[28:31], v[64:67], v[132:135], v[28:31]
    ds_read2_b32 v[178:179], v239 offset0:176 offset1:177
    s_waitcnt lgkmcnt(13)
    v_mfma_f32_16x16x32_bf16 v[32:35], v[100:103], v[136:139], v[32:35]
    ds_read_b128 v[128:131], v240 offset:1344
    v_mfma_f32_16x16x32_bf16 v[28:31], v[68:71], v[136:139], v[28:31]
    buffer_load_dwordx4 a[64:67], v220, s[20:23], s77 offen offset:1024 sc1
    ds_read2_b32 v[156:157], v239 offset0:16 offset1:17
    s_waitcnt lgkmcnt(13)
    v_mfma_f32_16x16x32_bf16 v[32:35], v[104:107], v[140:143], v[32:35]
    ds_read_b128 v[132:135], v240 offset:1280
    v_mfma_f32_16x16x32_bf16 v[28:31], v[72:75], v[140:143], v[28:31]
    ds_read2_b32 v[158:159], v239 offset0:40 offset1:41
    s_waitcnt lgkmcnt(13)
    v_mfma_f32_16x16x32_bf16 v[32:35], v[108:111], v[144:147], v[32:35]
    buffer_load_dwordx4 a[68:71], v220, s[20:23], s77 offen offset:2048 sc1
    ds_read_b128 v[136:139], v240 offset:1216
    v_mfma_f32_16x16x32_bf16 v[28:31], v[76:79], v[144:147], v[28:31]
    ds_read2_b32 v[168:169], v239 offset0:64 offset1:65
    s_waitcnt lgkmcnt(12)
    v_mfma_f32_16x16x32_bf16 v[32:35], v[112:115], v[116:119], v[32:35]
    ds_read_b128 v[140:143], v240 offset:1152
    v_mfma_f32_16x16x32_bf16 v[28:31], v[80:83], v[116:119], v[28:31]
    buffer_load_dwordx4 a[72:75], v220, s[20:23], s77 offen offset:3072 sc1
    ds_read2_b32 v[170:171], v239 offset0:88 offset1:89
    v_mfma_f32_16x16x32_bf16 v[24:27], v[48:51], v[116:119], v[188:191]
    s_waitcnt lgkmcnt(12)
    v_mfma_f32_16x16x32_bf16 v[28:31], v[84:87], v[120:123], v[28:31]
    ds_read_b128 v[144:147], v240 offset:1088
    v_mfma_f32_16x16x32_bf16 v[24:27], v[52:55], v[120:123], v[24:27]
    ds_read2_b32 v[180:181], v239 offset0:128 offset1:129
    s_waitcnt lgkmcnt(11)
    v_mfma_f32_16x16x32_bf16 v[28:31], v[88:91], v[124:127], v[28:31]
    buffer_load_dwordx4 a[76:79], v221, s[20:23], s77 offen offset:0 sc1
    ds_read_b128 v[116:119], v240 offset:1024
    v_mfma_f32_16x16x32_bf16 v[24:27], v[56:59], v[124:127], v[24:27]
    ds_read2_b32 v[182:183], v239 offset0:168 offset1:169
    s_waitcnt lgkmcnt(11)
    v_mfma_f32_16x16x32_bf16 v[28:31], v[92:95], v[128:131], v[28:31]
    ds_read_b128 v[120:123], v240 offset:960
    v_mfma_f32_16x16x32_bf16 v[24:27], v[60:63], v[128:131], v[24:27]
    ds_read2_b32 v[184:185], v239 offset0:120 offset1:121
    s_waitcnt lgkmcnt(11)
    v_mfma_f32_16x16x32_bf16 v[28:31], v[96:99], v[132:135], v[28:31]
    s_mul_i32 s76, s84, 5
    buffer_load_dwordx4 a[80:83], v220, s[20:23], s76 offen offset:0 sc1
    ds_read_b128 v[124:127], v240 offset:896
    v_mfma_f32_16x16x32_bf16 v[24:27], v[64:67], v[132:135], v[24:27]
    ds_read2_b32 v[186:187], v239 offset0:160 offset1:161
    s_waitcnt lgkmcnt(11)
    v_mfma_f32_16x16x32_bf16 v[28:31], v[100:103], v[136:139], v[28:31]
    ds_read_b128 v[128:131], v240 offset:832
    v_mfma_f32_16x16x32_bf16 v[24:27], v[68:71], v[136:139], v[24:27]
    s_waitcnt lgkmcnt(10)
    v_mfma_f32_16x16x32_bf16 v[28:31], v[104:107], v[140:143], v[28:31]
    buffer_load_dwordx4 a[84:87], v220, s[20:23], s76 offen offset:1024 sc1
    ds_read_b128 v[132:135], v240 offset:768
    v_mfma_f32_16x16x32_bf16 v[24:27], v[72:75], v[140:143], v[24:27]
    s_waitcnt lgkmcnt(9)
    v_mfma_f32_16x16x32_bf16 v[28:31], v[108:111], v[144:147], v[28:31]
    ds_read_b128 v[136:139], v240 offset:704
    v_mfma_f32_16x16x32_bf16 v[24:27], v[76:79], v[144:147], v[24:27]
    buffer_load_dwordx4 a[88:91], v220, s[20:23], s76 offen offset:2048 sc1
    s_waitcnt lgkmcnt(8)
    v_mfma_f32_16x16x32_bf16 v[28:31], v[112:115], v[116:119], v[28:31]
    ds_read_b128 v[140:143], v240 offset:640
    v_mfma_f32_16x16x32_bf16 v[24:27], v[80:83], v[116:119], v[24:27]
    v_mfma_f32_16x16x32_bf16 v[20:23], v[48:51], v[116:119], v[188:191]
    s_waitcnt lgkmcnt(7)
    v_mfma_f32_16x16x32_bf16 v[24:27], v[84:87], v[120:123], v[24:27]
    buffer_load_dwordx4 a[92:95], v220, s[20:23], s76 offen offset:3072 sc1
    ds_read_b128 v[144:147], v240 offset:576
    v_mfma_f32_16x16x32_bf16 v[20:23], v[52:55], v[120:123], v[20:23]
    s_waitcnt lgkmcnt(6)
    v_mfma_f32_16x16x32_bf16 v[24:27], v[88:91], v[124:127], v[24:27]
    ds_read_b128 v[116:119], v240 offset:512
    v_mfma_f32_16x16x32_bf16 v[20:23], v[56:59], v[124:127], v[20:23]
    buffer_load_dwordx4 a[96:99], v221, s[20:23], s76 offen offset:0 sc1
    s_waitcnt lgkmcnt(5)
    v_mfma_f32_16x16x32_bf16 v[24:27], v[92:95], v[128:131], v[24:27]
    ds_read_b128 v[120:123], v240 offset:448
    v_mfma_f32_16x16x32_bf16 v[20:23], v[60:63], v[128:131], v[20:23]
    s_waitcnt lgkmcnt(5)
    v_mfma_f32_16x16x32_bf16 v[24:27], v[96:99], v[132:135], v[24:27]
    ds_read_b128 v[124:127], v240 offset:384
    v_mfma_f32_16x16x32_bf16 v[20:23], v[64:67], v[132:135], v[20:23]
    s_mul_i32 s77, s85, 5
    buffer_load_dwordx4 a[100:103], v220, s[20:23], s77 offen offset:0 sc1
    s_waitcnt lgkmcnt(5)
    v_mfma_f32_16x16x32_bf16 v[24:27], v[100:103], v[136:139], v[24:27]
    ds_read_b128 v[128:131], v240 offset:320
    v_mfma_f32_16x16x32_bf16 v[20:23], v[68:71], v[136:139], v[20:23]
    s_waitcnt lgkmcnt(5)
    v_mfma_f32_16x16x32_bf16 v[24:27], v[104:107], v[140:143], v[24:27]
    buffer_load_dwordx4 a[104:107], v220, s[20:23], s77 offen offset:1024 sc1
    ds_read_b128 v[132:135], v240 offset:256
    v_mfma_f32_16x16x32_bf16 v[20:23], v[72:75], v[140:143], v[20:23]
    s_waitcnt lgkmcnt(5)
    v_mfma_f32_16x16x32_bf16 v[24:27], v[108:111], v[144:147], v[24:27]
    ds_read_b128 v[136:139], v240 offset:192
    v_mfma_f32_16x16x32_bf16 v[20:23], v[76:79], v[144:147], v[20:23]
    s_waitcnt lgkmcnt(5)
    v_mfma_f32_16x16x32_bf16 v[24:27], v[112:115], v[116:119], v[24:27]
    buffer_load_dwordx4 a[108:111], v220, s[20:23], s77 offen offset:2048 sc1
    ds_read_b128 v[140:143], v240 offset:128
    v_mfma_f32_16x16x32_bf16 v[20:23], v[80:83], v[116:119], v[20:23]
    v_mfma_f32_16x16x32_bf16 v[16:19], v[48:51], v[116:119], v[188:191]
    s_waitcnt lgkmcnt(5)
    v_mfma_f32_16x16x32_bf16 v[20:23], v[84:87], v[120:123], v[20:23]
    ds_read_b128 v[144:147], v240 offset:64
    v_mfma_f32_16x16x32_bf16 v[16:19], v[52:55], v[120:123], v[16:19]
    buffer_load_dwordx4 a[112:115], v220, s[20:23], s77 offen offset:3072 sc1
    ds_read2_b32 v[112:113], v238 offset0:192 offset1:193
    ds_read2_b32 v[114:115], v238 offset0:194 offset1:195
    s_waitcnt lgkmcnt(7)
    v_mfma_f32_16x16x32_bf16 v[20:23], v[88:91], v[124:127], v[20:23]
    ds_read_b128 v[116:119], v240 offset:496
    v_mfma_f32_16x16x32_bf16 v[16:19], v[56:59], v[124:127], v[16:19]
    s_waitcnt lgkmcnt(7)
    v_mfma_f32_16x16x32_bf16 v[20:23], v[92:95], v[128:131], v[20:23]
    ds_read_b128 v[120:123], v240 offset:512
    v_mfma_f32_16x16x32_bf16 v[16:19], v[60:63], v[128:131], v[16:19]
    buffer_load_dwordx4 a[116:119], v221, s[20:23], s77 offen offset:0 sc1
    s_waitcnt lgkmcnt(7)
    v_mfma_f32_16x16x32_bf16 v[20:23], v[96:99], v[132:135], v[20:23]
    ds_read_b128 v[124:127], v240 offset:16
    v_mfma_f32_16x16x32_bf16 v[16:19], v[64:67], v[132:135], v[16:19]
    s_waitcnt lgkmcnt(7)
    v_mfma_f32_16x16x32_bf16 v[20:23], v[100:103], v[136:139], v[20:23]
    ds_read_b128 v[128:131], v240 offset:1008
    v_mfma_f32_16x16x32_bf16 v[16:19], v[68:71], v[136:139], v[16:19]
    s_waitcnt lgkmcnt(7)
    v_mfma_f32_16x16x32_bf16 v[20:23], v[104:107], v[140:143], v[20:23]
    ds_read_b128 v[132:135], v240 offset:1024
    v_mfma_f32_16x16x32_bf16 v[16:19], v[72:75], v[140:143], v[16:19]
    s_waitcnt lgkmcnt(7)
    v_mfma_f32_16x16x32_bf16 v[20:23], v[108:111], v[144:147], v[20:23]
    ds_read_b128 v[136:139], v240 offset:528
    v_mfma_f32_16x16x32_bf16 v[16:19], v[76:79], v[144:147], v[16:19]
    s_waitcnt lgkmcnt(5)
    v_mfma_f32_16x16x32_bf16 v[48:51], v[116:119], v[192:195], 0
    ds_read_b128 v[140:143], v240 offset:1520
    s_waitcnt lgkmcnt(5)
    v_mfma_f32_16x16x32_bf16 v[52:55], v[120:123], v[196:199], 0
    ds_read_b128 v[144:147], v240 offset:1536
    v_mfma_f32_16x16x32_bf16 v[56:59], v[120:123], v[192:195], 0
    v_mfma_f32_16x16x32_bf16 v[60:63], v[120:123], v[200:203], 0
    v_mfma_f32_16x16x32_bf16 v[64:67], v[116:119], v[204:207], 0
    ds_read_u16 v96, v2 offset:6144
    ds_read_u16 v97, v3 offset:6144
    ds_read_u16 v98, v4 offset:6144
    ds_read_b128 v[116:119], v240 offset:1040
    v_mfma_f32_16x16x32_bf16 v[68:71], v[120:123], v[208:211], 0
    ds_read_b128 v[120:123], v240 offset:2032
    s_waitcnt lgkmcnt(10)
    v_mfma_f32_16x16x32_bf16 v[28:31], v[112:115], v[124:127], v[28:31]
    ds_read_u16 v99, v5 offset:6144
    ds_read_u16 v100, v6 offset:6144
    ds_read_u16 v101, v7 offset:6144
    ds_read_b128 v[124:127], v240 offset:2048
    v_cvt_pk_bf16_f32 v72, v48, v49
    v_cvt_pk_bf16_f32 v73, v50, v51
    v_cvt_pk_bf16_f32 v74, v52, v53
    v_cvt_pk_bf16_f32 v75, v54, v55
    v_cvt_pk_bf16_f32 v76, v56, v57
    v_cvt_pk_bf16_f32 v77, v58, v59
    v_cvt_pk_bf16_f32 v78, v60, v61
    v_cvt_pk_bf16_f32 v79, v62, v63
    v_cvt_pk_bf16_f32 v80, v64, v65
    v_cvt_pk_bf16_f32 v81, v66, v67
    v_cvt_pk_bf16_f32 v82, v68, v69
    v_cvt_pk_bf16_f32 v83, v70, v71
    s_waitcnt lgkmcnt(13)
    v_mfma_f32_16x16x32_bf16 v[48:51], v[128:131], v[192:195], 0
    s_waitcnt lgkmcnt(12)
    v_mfma_f32_16x16x32_bf16 v[52:55], v[132:135], v[196:199], 0
    v_mfma_f32_16x16x32_bf16 v[56:59], v[132:135], v[192:195], 0
    v_mfma_f32_16x16x32_bf16 v[60:63], v[132:135], v[200:203], 0
    ds_read_u16 v102, v8 offset:6144
    ds_read_u16 v103, v9 offset:6144
    ds_read_u16 v104, v10 offset:6144
    v_mfma_f32_16x16x32_bf16 v[64:67], v[128:131], v[204:207], 0
    ds_read_b128 v[128:131], v240 offset:1552
    v_mfma_f32_16x16x32_bf16 v[68:71], v[132:135], v[208:211], 0
    ds_read_b128 v[132:135], v240 offset:2544
    s_waitcnt lgkmcnt(15)
    v_mfma_f32_16x16x32_bf16 v[32:35], v[112:115], v[136:139], v[32:35]
    s_mul_i32 s76, s86, 5
    buffer_load_dwordx4 a[120:123], v220, s[20:23], s76 offen offset:0 sc1
    ds_read_b128 v[136:139], v240 offset:2560
    v_mfma_f32_16x16x32_bf16 v[24:27], v[72:75], v[148:151], v[24:27]
    v_cvt_pk_bf16_f32 v84, v48, v49
    v_cvt_pk_bf16_f32 v85, v50, v51
    v_mfma_f32_16x16x32_bf16 v[24:27], v[76:79], v[160:163], v[24:27]
    v_cvt_pk_bf16_f32 v86, v52, v53
    v_cvt_pk_bf16_f32 v87, v54, v55
    v_mfma_f32_16x16x32_bf16 v[32:35], v[80:83], v[172:175], v[32:35]
    buffer_load_dwordx4 a[124:127], v220, s[20:23], s76 offen offset:1024 sc1
    v_cvt_pk_bf16_f32 v88, v56, v57
    v_cvt_pk_bf16_f32 v89, v58, v59
    v_mfma_f32_16x16x32_bf16 v[28:31], v[72:75], v[152:155], v[28:31]
    v_cvt_pk_bf16_f32 v90, v60, v61
    v_cvt_pk_bf16_f32 v91, v62, v63
    v_mfma_f32_16x16x32_bf16 v[28:31], v[76:79], v[164:167], v[28:31]
    v_cvt_pk_bf16_f32 v92, v64, v65
    v_cvt_pk_bf16_f32 v93, v66, v67
    v_mfma_f32_16x16x32_bf16 v[36:39], v[80:83], v[176:179], v[36:39]
    buffer_load_dwordx4 a[128:131], v220, s[20:23], s76 offen offset:2048 sc1
    v_cvt_pk_bf16_f32 v94, v68, v69
    v_cvt_pk_bf16_f32 v95, v70, v71
    v_mfma_f32_16x16x32_bf16 v[32:35], v[72:75], v[156:159], v[32:35]
    v_mfma_f32_16x16x32_bf16 v[32:35], v[76:79], v[168:171], v[32:35]
    buffer_load_dwordx4 a[132:135], v220, s[20:23], s76 offen offset:3072 sc1
    v_mfma_f32_16x16x32_bf16 v[40:43], v[80:83], v[180:183], v[40:43]
    v_mfma_f32_16x16x32_bf16 v[44:47], v[80:83], v[184:187], v[44:47]
    v_mfma_f32_16x16x32_bf16 v[48:51], v[140:143], v[192:195], 0
    buffer_load_dwordx4 a[136:139], v221, s[20:23], s76 offen offset:0 sc1
    s_waitcnt lgkmcnt(15)
    v_mfma_f32_16x16x32_bf16 v[52:55], v[144:147], v[196:199], 0
    v_mfma_f32_16x16x32_bf16 v[56:59], v[144:147], v[192:195], 0
    v_mfma_f32_16x16x32_bf16 v[60:63], v[144:147], v[200:203], 0
    s_mul_i32 s77, s87, 5
    buffer_load_dwordx4 a[140:143], v220, s[20:23], s77 offen offset:0 sc1
    v_mfma_f32_16x16x32_bf16 v[64:67], v[140:143], v[204:207], 0
    ds_read_b128 v[140:143], v240 offset:2064
    v_mfma_f32_16x16x32_bf16 v[68:71], v[144:147], v[208:211], 0
    ds_read_b128 v[144:147], v240 offset:3056
    s_waitcnt lgkmcnt(13)
    v_mfma_f32_16x16x32_bf16 v[36:39], v[112:115], v[116:119], v[36:39]
    buffer_load_dwordx4 a[144:147], v220, s[20:23], s77 offen offset:1024 sc1
    ds_read_b128 v[116:119], v240 offset:3072
    v_mfma_f32_16x16x32_bf16 v[28:31], v[84:87], v[148:151], v[28:31]
    v_cvt_pk_bf16_f32 v72, v48, v49
    v_cvt_pk_bf16_f32 v73, v50, v51
    v_mfma_f32_16x16x32_bf16 v[28:31], v[88:91], v[160:163], v[28:31]
    v_cvt_pk_bf16_f32 v74, v52, v53
    v_cvt_pk_bf16_f32 v75, v54, v55
    v_mfma_f32_16x16x32_bf16 v[36:39], v[92:95], v[172:175], v[36:39]
    buffer_load_dwordx4 a[148:151], v220, s[20:23], s77 offen offset:2048 sc1
    v_cvt_pk_bf16_f32 v76, v56, v57
    v_cvt_pk_bf16_f32 v77, v58, v59
    v_mfma_f32_16x16x32_bf16 v[32:35], v[84:87], v[152:155], v[32:35]
    v_cvt_pk_bf16_f32 v78, v60, v61
    v_cvt_pk_bf16_f32 v79, v62, v63
    v_mfma_f32_16x16x32_bf16 v[32:35], v[88:91], v[164:167], v[32:35]
    v_cvt_pk_bf16_f32 v80, v64, v65
    v_cvt_pk_bf16_f32 v81, v66, v67
    v_mfma_f32_16x16x32_bf16 v[40:43], v[92:95], v[176:179], v[40:43]
    v_lshl_or_b32 v212, v97, 16, v96
    s_waitcnt lgkmcnt(12)
    v_lshl_or_b32 v213, v99, 16, v98
    s_waitcnt lgkmcnt(10)
    v_lshl_or_b32 v214, v101, 16, v100
    s_waitcnt lgkmcnt(7)
    v_lshl_or_b32 v215, v103, 16, v102
    v_cvt_pk_bf16_f32 v82, v68, v69
    v_cvt_pk_bf16_f32 v83, v70, v71
    v_mfma_f32_16x16x32_bf16 v[36:39], v[84:87], v[156:159], v[36:39]
    v_mfma_f32_16x16x32_bf16 v[36:39], v[88:91], v[168:171], v[36:39]
    v_mfma_f32_16x16x32_bf16 v[44:47], v[92:95], v[180:183], v[44:47]
    ds_write_b128 v236, v[212:215]
    v_mfma_f32_16x16x32_bf16 v[48:51], v[120:123], v[192:195], 0
    v_mfma_f32_16x16x32_bf16 v[52:55], v[124:127], v[196:199], 0
    v_mfma_f32_16x16x32_bf16 v[56:59], v[124:127], v[192:195], 0
    v_lshl_or_b32 v216, v98, 16, v97
    v_lshl_or_b32 v217, v100, 16, v99
    v_lshl_or_b32 v218, v102, 16, v101
    s_waitcnt lgkmcnt(7)
    v_lshl_or_b32 v219, v104, 16, v103
    v_mfma_f32_16x16x32_bf16 v[60:63], v[124:127], v[200:203], 0
    v_mfma_f32_16x16x32_bf16 v[64:67], v[120:123], v[204:207], 0
    v_mfma_f32_16x16x32_bf16 v[68:71], v[124:127], v[208:211], 0
    ds_write_b128 v236, v[216:219] offset:2112
    s_waitcnt lgkmcnt(7)
    v_mfma_f32_16x16x32_bf16 v[40:43], v[112:115], v[128:131], v[40:43]
    v_mfma_f32_16x16x32_bf16 v[32:35], v[72:75], v[148:151], v[32:35]
    v_cvt_pk_bf16_f32 v84, v48, v49
    v_cvt_pk_bf16_f32 v85, v50, v51
    v_mfma_f32_16x16x32_bf16 v[32:35], v[76:79], v[160:163], v[32:35]
    buffer_load_dwordx4 a[152:155], v220, s[20:23], s77 offen offset:3072 sc1
    v_cvt_pk_bf16_f32 v86, v52, v53
    v_cvt_pk_bf16_f32 v87, v54, v55
    v_mfma_f32_16x16x32_bf16 v[40:43], v[80:83], v[172:175], v[40:43]
    v_cvt_pk_bf16_f32 v88, v56, v57
    v_cvt_pk_bf16_f32 v89, v58, v59
    v_mfma_f32_16x16x32_bf16 v[36:39], v[72:75], v[152:155], v[36:39]
    v_cvt_pk_bf16_f32 v90, v60, v61
    v_cvt_pk_bf16_f32 v91, v62, v63
    v_mfma_f32_16x16x32_bf16 v[36:39], v[76:79], v[164:167], v[36:39]
    buffer_load_dwordx4 a[156:159], v221, s[20:23], s77 offen offset:0 sc1
    v_cvt_pk_bf16_f32 v92, v64, v65
    v_cvt_pk_bf16_f32 v93, v66, v67
    v_mfma_f32_16x16x32_bf16 v[44:47], v[80:83], v[176:179], v[44:47]
    v_cvt_pk_bf16_f32 v94, v68, v69
    v_cvt_pk_bf16_f32 v95, v70, v71
    v_mfma_f32_16x16x32_bf16 v[40:43], v[72:75], v[156:159], v[40:43]
    v_mfma_f32_16x16x32_bf16 v[40:43], v[76:79], v[168:171], v[40:43]
    s_mul_i32 s76, s88, 5
    buffer_load_dwordx4 a[160:163], v220, s[20:23], s76 offen offset:0 sc1
    s_waitcnt lgkmcnt(6)
    v_mfma_f32_16x16x32_bf16 v[48:51], v[132:135], v[192:195], 0
    s_waitcnt lgkmcnt(5)
    v_mfma_f32_16x16x32_bf16 v[52:55], v[136:139], v[196:199], 0
    buffer_load_dwordx4 a[164:167], v220, s[20:23], s76 offen offset:1024 sc1
    v_mfma_f32_16x16x32_bf16 v[56:59], v[136:139], v[192:195], 0
    v_mfma_f32_16x16x32_bf16 v[60:63], v[136:139], v[200:203], 0
    s_waitcnt lgkmcnt(4)
    v_mfma_f32_16x16x32_bf16 v[44:47], v[112:115], v[140:143], v[44:47]
    v_mfma_f32_16x16x32_bf16 v[36:39], v[84:87], v[148:151], v[36:39]
    buffer_load_dwordx4 a[168:171], v220, s[20:23], s76 offen offset:2048 sc1
    v_cvt_pk_bf16_f32 v72, v48, v49
    v_cvt_pk_bf16_f32 v73, v50, v51
    v_mfma_f32_16x16x32_bf16 v[36:39], v[88:91], v[160:163], v[36:39]
    v_cvt_pk_bf16_f32 v74, v52, v53
    v_cvt_pk_bf16_f32 v75, v54, v55
    v_mfma_f32_16x16x32_bf16 v[44:47], v[92:95], v[172:175], v[44:47]
    v_cvt_pk_bf16_f32 v76, v56, v57
    v_cvt_pk_bf16_f32 v77, v58, v59
    v_mfma_f32_16x16x32_bf16 v[40:43], v[84:87], v[152:155], v[40:43]
    buffer_load_dwordx4 a[172:175], v220, s[20:23], s76 offen offset:3072 sc1
    v_cvt_pk_bf16_f32 v78, v60, v61
    v_cvt_pk_bf16_f32 v79, v62, v63
    v_mfma_f32_16x16x32_bf16 v[40:43], v[88:91], v[164:167], v[40:43]
    v_mfma_f32_16x16x32_bf16 v[44:47], v[84:87], v[156:159], v[44:47]
    v_mfma_f32_16x16x32_bf16 v[44:47], v[88:91], v[168:171], v[44:47]
    buffer_load_dwordx4 a[176:179], v221, s[20:23], s76 offen offset:0 sc1
    s_waitcnt lgkmcnt(3)
    v_mfma_f32_16x16x32_bf16 v[48:51], v[144:147], v[192:195], 0
    s_waitcnt lgkmcnt(2)
    v_mfma_f32_16x16x32_bf16 v[52:55], v[116:119], v[196:199], 0
    v_mfma_f32_16x16x32_bf16 v[56:59], v[116:119], v[192:195], 0
    s_mul_i32 s77, s89, 5
    buffer_load_dwordx4 a[180:183], v220, s[20:23], s77 offen offset:0 sc1
    v_mfma_f32_16x16x32_bf16 v[60:63], v[116:119], v[200:203], 0
    v_mfma_f32_16x16x32_bf16 v[40:43], v[72:75], v[148:151], v[40:43]
    v_mfma_f32_16x16x32_bf16 v[40:43], v[76:79], v[160:163], v[40:43]
    v_cvt_pk_bf16_f32 v84, v48, v49
    v_cvt_pk_bf16_f32 v85, v50, v51
    v_mfma_f32_16x16x32_bf16 v[44:47], v[72:75], v[152:155], v[44:47]
    v_cvt_pk_bf16_f32 v86, v52, v53
    v_cvt_pk_bf16_f32 v87, v54, v55
    v_mfma_f32_16x16x32_bf16 v[44:47], v[76:79], v[164:167], v[44:47]
    v_cvt_pk_bf16_f32 v88, v56, v57
    v_cvt_pk_bf16_f32 v89, v58, v59
    v_cvt_pk_bf16_f32 v90, v60, v61
    v_cvt_pk_bf16_f32 v91, v62, v63
    v_mfma_f32_16x16x32_bf16 v[44:47], v[84:87], v[148:151], v[44:47]
    s_nop 0
    v_mfma_f32_16x16x32_bf16 v[44:47], v[88:91], v[160:163], v[44:47]
    s_mul_i32 s68, s52, 65536
    s_add_u32 s68, s68, -45056
    v_add_u32 v237, s68, v237
    v_add_u32 v238, s68, v238
    v_add_u32 v239, s68, v239
    v_add_u32 v240, s68, v240
    s_lshl_b32 s68, s53, 4
    s_lshr_b32 s68, s61, s68
    s_lshl_b32 s68, s68, 16
    v_mov_b32 v188, s68
    v_mov_b32 v189, s68
    v_mov_b32 v190, s68
    v_mov_b32 v191, s68
    v_cvt_pk_bf16_f32 v48, v16, v17
    v_cvt_pk_bf16_f32 v49, v18, v19
    v_cvt_pk_bf16_f32 v50, v20, v21
    v_cvt_pk_bf16_f32 v51, v22, v23
    s_nop 0
    v_permlane16_swap_b32 v48, v50
    v_permlane16_swap_b32 v49, v51
    buffer_store_dwordx4 v[48:51], v246, s[12:15], s37 offen offset:0 sc1
    v_cvt_pk_bf16_f32 v52, v24, v25
    v_cvt_pk_bf16_f32 v53, v26, v27
    v_cvt_pk_bf16_f32 v54, v28, v29
    v_cvt_pk_bf16_f32 v55, v30, v31
    s_nop 0
    v_permlane16_swap_b32 v52, v54
    v_permlane16_swap_b32 v53, v55
    buffer_store_dwordx4 v[52:55], v246, s[12:15], s37 offen offset:1024 sc1
    v_cvt_pk_bf16_f32 v56, v32, v33
    v_cvt_pk_bf16_f32 v57, v34, v35
    v_cvt_pk_bf16_f32 v58, v36, v37
    v_cvt_pk_bf16_f32 v59, v38, v39
    s_nop 0
    v_permlane16_swap_b32 v56, v58
    v_permlane16_swap_b32 v57, v59
    buffer_store_dwordx4 v[56:59], v246, s[12:15], s37 offen offset:2048 sc1
    v_cvt_pk_bf16_f32 v60, v40, v41
    v_cvt_pk_bf16_f32 v61, v42, v43
    v_cvt_pk_bf16_f32 v62, v44, v45
    v_cvt_pk_bf16_f32 v63, v46, v47
    s_nop 0
    v_permlane16_swap_b32 v60, v62
    v_permlane16_swap_b32 v61, v63
    buffer_store_dwordx4 v[60:63], v246, s[12:15], s37 offen offset:3072 sc1
    s_waitcnt lgkmcnt(0)
    s_barrier
    s_cmp_eq_u32 s52, 1
    s_cbranch_scc1 L_roleB_19
    ds_read2_b32 v[48:49], v238 offset0:0 offset1:1
    ds_read2_b32 v[50:51], v238 offset0:2 offset1:3
    ds_read_b128 v[104:107], v240 offset:4096
    ds_read2_b32 v[52:53], v237 offset0:240 offset1:241
    ds_read2_b32 v[54:55], v237 offset0:242 offset1:243
    ds_read_b128 v[108:111], v240 offset:4032
    ds_read2_b32 v[56:57], v237 offset0:224 offset1:225
    ds_read2_b32 v[58:59], v237 offset0:226 offset1:227
    ds_read_b128 v[112:115], v240 offset:3968
    ds_read2_b32 v[60:61], v237 offset0:208 offset1:209
    ds_read2_b32 v[62:63], v237 offset0:210 offset1:211
    ds_read_b128 v[116:119], v240 offset:3904
    s_waitcnt lgkmcnt(9)
    v_mfma_f32_16x16x32_bf16 v[44:47], v[48:51], v[104:107], v[188:191]
    ds_read2_b32 v[64:65], v237 offset0:192 offset1:193
    ds_read2_b32 v[66:67], v237 offset0:194 offset1:195
    ds_read_b128 v[120:123], v240 offset:3840
    s_waitcnt lgkmcnt(9)
    v_mfma_f32_16x16x32_bf16 v[44:47], v[52:55], v[108:111], v[44:47]
    ds_read2_b32 v[68:69], v237 offset0:176 offset1:177
    ds_read2_b32 v[70:71], v237 offset0:178 offset1:179
    ds_read_b128 v[124:127], v240 offset:3776
    s_waitcnt lgkmcnt(9)
    v_mfma_f32_16x16x32_bf16 v[44:47], v[56:59], v[112:115], v[44:47]
    buffer_load_dwordx4 a[184:187], v220, s[20:23], s77 offen offset:1024 sc1
    ds_read2_b32 v[72:73], v237 offset0:160 offset1:161
    ds_read2_b32 v[74:75], v237 offset0:162 offset1:163
    ds_read_b128 v[128:131], v240 offset:3712
    s_waitcnt lgkmcnt(9)
    v_mfma_f32_16x16x32_bf16 v[44:47], v[60:63], v[116:119], v[44:47]
    ds_read2_b32 v[76:77], v237 offset0:144 offset1:145
    ds_read2_b32 v[78:79], v237 offset0:146 offset1:147
    ds_read_b128 v[132:135], v240 offset:3648
    s_waitcnt lgkmcnt(9)
    v_mfma_f32_16x16x32_bf16 v[44:47], v[64:67], v[120:123], v[44:47]
    ds_read2_b32 v[80:81], v237 offset0:128 offset1:129
    ds_read2_b32 v[82:83], v237 offset0:130 offset1:131
    ds_read_b128 v[136:139], v240 offset:3584
    s_waitcnt lgkmcnt(9)
    v_mfma_f32_16x16x32_bf16 v[44:47], v[68:71], v[124:127], v[44:47]
    buffer_load_dwordx4 a[188:191], v220, s[20:23], s77 offen offset:2048 sc1
    ds_read2_b32 v[84:85], v237 offset0:112 offset1:113
    ds_read2_b32 v[86:87], v237 offset0:114 offset1:115
    ds_read_b128 v[140:143], v240 offset:3520
    s_waitcnt lgkmcnt(9)
    v_mfma_f32_16x16x32_bf16 v[44:47], v[72:75], v[128:131], v[44:47]
    ds_read2_b32 v[88:89], v237 offset0:96 offset1:97
    ds_read2_b32 v[90:91], v237 offset0:98 offset1:99
    ds_read_b128 v[104:107], v240 offset:3456
    s_waitcnt lgkmcnt(9)
    v_mfma_f32_16x16x32_bf16 v[44:47], v[76:79], v[132:135], v[44:47]
    ds_read2_b32 v[92:93], v237 offset0:80 offset1:81
    ds_read2_b32 v[94:95], v237 offset0:82 offset1:83
    ds_read_b128 v[108:111], v240 offset:3392
    s_waitcnt lgkmcnt(9)
    v_mfma_f32_16x16x32_bf16 v[44:47], v[80:83], v[136:139], v[44:47]
    buffer_load_dwordx4 a[192:195], v220, s[20:23], s77 offen offset:3072 sc1
    ds_read2_b32 v[96:97], v237 offset0:64 offset1:65
    ds_read2_b32 v[98:99], v237 offset0:66 offset1:67
    ds_read_b128 v[112:115], v240 offset:3328
    v_mfma_f32_16x16x32_bf16 v[40:43], v[48:51], v[136:139], v[188:191]
    s_waitcnt lgkmcnt(9)
    v_mfma_f32_16x16x32_bf16 v[44:47], v[84:87], v[140:143], v[44:47]
    ds_read2_b32 v[100:101], v237 offset0:48 offset1:49
    ds_read2_b32 v[102:103], v237 offset0:50 offset1:51
    ds_read_b128 v[116:119], v240 offset:3264
    v_mfma_f32_16x16x32_bf16 v[40:43], v[52:55], v[140:143], v[40:43]
    buffer_load_dwordx4 a[196:199], v221, s[20:23], s77 offen offset:0 sc1
    s_waitcnt lgkmcnt(9)
    v_mfma_f32_16x16x32_bf16 v[44:47], v[88:91], v[104:107], v[44:47]
    ds_read_b128 v[120:123], v240 offset:3200
    v_mfma_f32_16x16x32_bf16 v[40:43], v[56:59], v[104:107], v[40:43]
    s_waitcnt lgkmcnt(7)
    v_mfma_f32_16x16x32_bf16 v[44:47], v[92:95], v[108:111], v[44:47]
    s_mul_i32 s76, s90, 5
    buffer_load_dwordx4 a[200:203], v220, s[20:23], s76 offen offset:0 sc1
    ds_read_b128 v[124:127], v240 offset:3136
    v_mfma_f32_16x16x32_bf16 v[40:43], v[60:63], v[108:111], v[40:43]
    s_waitcnt lgkmcnt(5)
    v_mfma_f32_16x16x32_bf16 v[44:47], v[96:99], v[112:115], v[44:47]
    ds_read_b128 v[128:131], v240 offset:3072
    v_mfma_f32_16x16x32_bf16 v[40:43], v[64:67], v[112:115], v[40:43]
    s_waitcnt lgkmcnt(3)
    v_mfma_f32_16x16x32_bf16 v[44:47], v[100:103], v[116:119], v[44:47]
    s_add_u32 s16, s64, s46
    s_addc_u32 s17, s65, 0
    s_mov_b32 s18, 221184
    s_mov_b32 s19, 0x20000
    v_min_u32 v229, 6, v0
    v_lshl_add_u32 v229, v229, 2, s28
    v_lshlrev_b32 v229, 7, v229
    ds_read_b128 v[132:135], v240 offset:3008
    v_mfma_f32_16x16x32_bf16 v[40:43], v[68:71], v[116:119], v[40:43]
    buffer_load_dwordx4 a[204:207], v220, s[20:23], s76 offen offset:1024 sc1
    s_waitcnt lgkmcnt(3)
    v_mfma_f32_16x16x32_bf16 v[40:43], v[72:75], v[120:123], v[40:43]
    ds_read_b128 v[136:139], v240 offset:2944
    s_waitcnt lgkmcnt(3)
    v_mfma_f32_16x16x32_bf16 v[40:43], v[76:79], v[124:127], v[40:43]
    ds_read_b128 v[140:143], v240 offset:2880
    s_waitcnt lgkmcnt(3)
    v_mfma_f32_16x16x32_bf16 v[40:43], v[80:83], v[128:131], v[40:43]
    buffer_load_dwordx4 a[208:211], v220, s[20:23], s76 offen offset:2048 sc1
    s_add_u32 s68, s28, 1
    s_and_b32 s68, s68, 3
    s_mul_i32 s68, s68, 55296
    v_add_u32 v222, s68, v1
    s_add_u32 s68, s28, 2
    s_and_b32 s68, s68, 3
    s_mul_i32 s68, s68, 55296
    v_add_u32 v223, s68, v1
    s_add_u32 s68, s28, 3
    s_and_b32 s68, s68, 3
    s_mul_i32 s68, s68, 55296
    v_add_u32 v224, s68, v1
    s_add_u32 s68, s28, 4
    s_and_b32 s68, s68, 3
    s_mul_i32 s68, s68, 55296
    v_add_u32 v225, s68, v1
    ds_read_b128 v[104:107], v240 offset:2816
    v_mfma_f32_16x16x32_bf16 v[36:39], v[48:51], v[128:131], v[188:191]
    s_waitcnt lgkmcnt(3)
    v_mfma_f32_16x16x32_bf16 v[40:43], v[84:87], v[132:135], v[40:43]
    ds_read_b128 v[108:111], v240 offset:2752
    v_mfma_f32_16x16x32_bf16 v[36:39], v[52:55], v[132:135], v[36:39]
    buffer_load_dwordx4 a[212:215], v220, s[20:23], s76 offen offset:3072 sc1
    ds_write_b128 v244, v[44:47] offset:3072
    s_waitcnt lgkmcnt(4)
    v_mfma_f32_16x16x32_bf16 v[40:43], v[88:91], v[136:139], v[40:43]
    buffer_load_dword v228, v229, s[12:15], s94 offen sc1
    ds_read_b128 v[112:115], v240 offset:2688
    v_mfma_f32_16x16x32_bf16 v[36:39], v[56:59], v[136:139], v[36:39]
    s_waitcnt lgkmcnt(4)
    v_mfma_f32_16x16x32_bf16 v[40:43], v[92:95], v[140:143], v[40:43]
    buffer_load_dwordx4 a[216:219], v221, s[20:23], s76 offen offset:0 sc1
    ds_read_b128 v[116:119], v240 offset:2624
    v_mfma_f32_16x16x32_bf16 v[36:39], v[60:63], v[140:143], v[36:39]
    s_waitcnt lgkmcnt(4)
    v_mfma_f32_16x16x32_bf16 v[40:43], v[96:99], v[104:107], v[40:43]
    ds_read_b128 v[120:123], v240 offset:2560
    v_mfma_f32_16x16x32_bf16 v[36:39], v[64:67], v[104:107], v[36:39]
    s_waitcnt vmcnt(10)
    v_mov_b32 v11, 1
    s_mov_b64 exec, 1
    buffer_store_dword v11, off, s[12:15], s39 offset:0 sc1
    s_mov_b64 exec, -1
    s_add_u32 s39, s39, 81920
    v_mov_b32 v11, 1
    s_mov_b64 exec, 1
    buffer_store_dword v11, off, s[12:15], s39 offset:0 sc1
    s_mov_b64 exec, -1
    s_waitcnt lgkmcnt(4)
    v_mfma_f32_16x16x32_bf16 v[40:43], v[100:103], v[108:111], v[40:43]
    s_mul_i32 s77, s91, 5
    buffer_load_dwordx4 a[220:223], v220, s[20:23], s77 offen offset:0 sc1
    ds_read_b128 v[124:127], v240 offset:2496
    v_mfma_f32_16x16x32_bf16 v[36:39], v[68:71], v[108:111], v[36:39]
    s_waitcnt lgkmcnt(3)
    v_mfma_f32_16x16x32_bf16 v[36:39], v[72:75], v[112:115], v[36:39]
    ds_read_b128 v[128:131], v240 offset:2432
    s_waitcnt lgkmcnt(3)
    v_mfma_f32_16x16x32_bf16 v[36:39], v[76:79], v[116:119], v[36:39]
    ds_read_b128 v[132:135], v240 offset:2368
    s_waitcnt lgkmcnt(3)
    v_mfma_f32_16x16x32_bf16 v[36:39], v[80:83], v[120:123], v[36:39]
    buffer_load_dwordx4 a[224:227], v220, s[20:23], s77 offen offset:1024 sc1
    ds_read_b128 v[136:139], v240 offset:2304
    v_mfma_f32_16x16x32_bf16 v[32:35], v[48:51], v[120:123], v[188:191]
    s_waitcnt lgkmcnt(3)
    v_mfma_f32_16x16x32_bf16 v[36:39], v[84:87], v[124:127], v[36:39]
    ds_read_b128 v[140:143], v240 offset:2240
    v_mfma_f32_16x16x32_bf16 v[32:35], v[52:55], v[124:127], v[32:35]
    buffer_load_dwordx4 a[228:231], v220, s[20:23], s77 offen offset:2048 sc1
    ds_write_b128 v244, v[40:43] offset:2048
    s_waitcnt lgkmcnt(4)
    v_mfma_f32_16x16x32_bf16 v[36:39], v[88:91], v[128:131], v[36:39]
    ds_read_b128 v[104:107], v240 offset:2176
    v_mfma_f32_16x16x32_bf16 v[32:35], v[56:59], v[128:131], v[32:35]
    s_waitcnt lgkmcnt(4)
    v_mfma_f32_16x16x32_bf16 v[36:39], v[92:95], v[132:135], v[36:39]
    buffer_load_dwordx4 a[232:235], v220, s[20:23], s77 offen offset:3072 sc1
    ds_read_b128 v[108:111], v240 offset:2112
    v_mfma_f32_16x16x32_bf16 v[32:35], v[60:63], v[132:135], v[32:35]
    s_waitcnt lgkmcnt(4)
    v_mfma_f32_16x16x32_bf16 v[36:39], v[96:99], v[136:139], v[36:39]
    ds_read_b128 v[112:115], v240 offset:2048
    v_mfma_f32_16x16x32_bf16 v[32:35], v[64:67], v[136:139], v[32:35]
    buffer_load_dwordx4 a[236:239], v221, s[20:23], s77 offen offset:0 sc1
    s_waitcnt lgkmcnt(4)
    v_mfma_f32_16x16x32_bf16 v[36:39], v[100:103], v[140:143], v[36:39]
    ds_read_b128 v[116:119], v240 offset:1984
    v_mfma_f32_16x16x32_bf16 v[32:35], v[68:71], v[140:143], v[32:35]
    s_waitcnt lgkmcnt(3)
    v_mfma_f32_16x16x32_bf16 v[32:35], v[72:75], v[104:107], v[32:35]
    ds_read_b128 v[120:123], v240 offset:1920
    s_waitcnt lgkmcnt(3)
    v_mfma_f32_16x16x32_bf16 v[32:35], v[76:79], v[108:111], v[32:35]
    s_mul_i32 s76, s92, 5
    buffer_load_dwordx4 a[240:243], v220, s[20:23], s76 offen offset:0 sc1
    ds_read_b128 v[124:127], v240 offset:1856
    s_waitcnt lgkmcnt(3)
    v_mfma_f32_16x16x32_bf16 v[32:35], v[80:83], v[112:115], v[32:35]
    ds_read_b128 v[128:131], v240 offset:1792
    v_mfma_f32_16x16x32_bf16 v[28:31], v[48:51], v[112:115], 0
    s_waitcnt lgkmcnt(3)
    v_mfma_f32_16x16x32_bf16 v[32:35], v[84:87], v[116:119], v[32:35]
    buffer_load_dwordx4 a[244:247], v220, s[20:23], s76 offen offset:1024 sc1
    ds_read_b128 v[132:135], v240 offset:1728
    v_mfma_f32_16x16x32_bf16 v[28:31], v[52:55], v[116:119], v[28:31]
    ds_write_b128 v244, v[36:39] offset:1024
    s_waitcnt lgkmcnt(4)
    v_mfma_f32_16x16x32_bf16 v[32:35], v[88:91], v[120:123], v[32:35]
    ds_read_b128 v[136:139], v240 offset:1664
    v_mfma_f32_16x16x32_bf16 v[28:31], v[56:59], v[120:123], v[28:31]
    s_waitcnt lgkmcnt(4)
    v_mfma_f32_16x16x32_bf16 v[32:35], v[92:95], v[124:127], v[32:35]
    buffer_load_dwordx4 a[248:251], v220, s[20:23], s76 offen offset:2048 sc1
    ds_read_b128 v[140:143], v240 offset:1600
    v_mfma_f32_16x16x32_bf16 v[28:31], v[60:63], v[124:127], v[28:31]
    s_waitcnt lgkmcnt(4)
    v_mfma_f32_16x16x32_bf16 v[32:35], v[96:99], v[128:131], v[32:35]
    ds_read_b128 v[104:107], v240 offset:1536
    v_mfma_f32_16x16x32_bf16 v[28:31], v[64:67], v[128:131], v[28:31]
    buffer_load_dwordx4 a[252:255], v220, s[20:23], s76 offen offset:3072 sc1
    s_waitcnt lgkmcnt(4)
    v_mfma_f32_16x16x32_bf16 v[32:35], v[100:103], v[132:135], v[32:35]
    ds_read_b128 v[108:111], v240 offset:1472
    v_mfma_f32_16x16x32_bf16 v[28:31], v[68:71], v[132:135], v[28:31]
    s_waitcnt lgkmcnt(3)
    v_mfma_f32_16x16x32_bf16 v[28:31], v[72:75], v[136:139], v[28:31]
    ds_read_b128 v[112:115], v240 offset:1408
    s_waitcnt lgkmcnt(3)
    v_mfma_f32_16x16x32_bf16 v[28:31], v[76:79], v[140:143], v[28:31]
    ds_read_b128 v[116:119], v240 offset:1344
    s_waitcnt lgkmcnt(3)
    v_mfma_f32_16x16x32_bf16 v[28:31], v[80:83], v[104:107], v[28:31]
    ds_read_b128 v[120:123], v240 offset:1280
    v_mfma_f32_16x16x32_bf16 v[24:27], v[48:51], v[104:107], 0
    s_waitcnt lgkmcnt(3)
    v_mfma_f32_16x16x32_bf16 v[28:31], v[84:87], v[108:111], v[28:31]
    ds_read_b128 v[124:127], v240 offset:1216
    v_mfma_f32_16x16x32_bf16 v[24:27], v[52:55], v[108:111], v[24:27]
    ds_write_b128 v244, v[32:35] offset:0
    s_waitcnt lgkmcnt(4)
    v_mfma_f32_16x16x32_bf16 v[28:31], v[88:91], v[112:115], v[28:31]
    ds_read_b128 v[128:131], v240 offset:1152
    v_mfma_f32_16x16x32_bf16 v[24:27], v[56:59], v[112:115], v[24:27]
    s_waitcnt lgkmcnt(4)
    v_mfma_f32_16x16x32_bf16 v[28:31], v[92:95], v[116:119], v[28:31]
    ds_read_b128 v[132:135], v240 offset:1088
    v_mfma_f32_16x16x32_bf16 v[24:27], v[60:63], v[116:119], v[24:27]
    s_waitcnt lgkmcnt(4)
    v_mfma_f32_16x16x32_bf16 v[28:31], v[96:99], v[120:123], v[28:31]
    ds_read_b128 v[136:139], v240 offset:1024
    v_mfma_f32_16x16x32_bf16 v[24:27], v[64:67], v[120:123], v[24:27]
    s_waitcnt lgkmcnt(4)
    v_mfma_f32_16x16x32_bf16 v[28:31], v[100:103], v[124:127], v[28:31]
    s_waitcnt vmcnt(12)
    v_cmp_ne_u32 vcc, 1, v228
    s_cbranch_vccz L_fh0_ok_21
    s_mov_b32 s74, 20000
L_fh0_spin_22:
    s_mov_b64 exec, vcc
    s_sleep 1
    buffer_load_dword v228, v229, s[12:15], s94 offen sc1
    s_waitcnt vmcnt(0)
    v_cmp_ne_u32 vcc, 1, v228
    s_mov_b64 exec, -1
    s_cbranch_vccz L_fh0_ok_21
    s_sub_u32 s74, s74, 1
    s_cmp_lg_u32 s74, 0
    s_cbranch_scc1 L_fh0_spin_22
L_fh0_ok_21:
    ds_read_b128 v[140:143], v240 offset:960
    v_mfma_f32_16x16x32_bf16 v[24:27], v[68:71], v[124:127], v[24:27]
    buffer_load_dwordx4 v[176:179], v222, s[16:19], s80 offen sc1
    s_waitcnt lgkmcnt(3)
    v_mfma_f32_16x16x32_bf16 v[24:27], v[72:75], v[128:131], v[24:27]
    ds_read_b128 v[104:107], v240 offset:896
    s_waitcnt lgkmcnt(3)
    v_mfma_f32_16x16x32_bf16 v[24:27], v[76:79], v[132:135], v[24:27]
    ds_read_b128 v[108:111], v240 offset:832
    s_waitcnt lgkmcnt(3)
    v_mfma_f32_16x16x32_bf16 v[24:27], v[80:83], v[136:139], v[24:27]
    ds_read_b128 v[112:115], v240 offset:768
    v_mfma_f32_16x16x32_bf16 v[20:23], v[48:51], v[136:139], 0
    buffer_load_dwordx4 v[180:183], v223, s[16:19], s80 offen sc1
    s_waitcnt lgkmcnt(3)
    v_mfma_f32_16x16x32_bf16 v[24:27], v[84:87], v[140:143], v[24:27]
    ds_read_b128 v[116:119], v240 offset:704
    v_mfma_f32_16x16x32_bf16 v[20:23], v[52:55], v[140:143], v[20:23]
    s_waitcnt lgkmcnt(3)
    v_mfma_f32_16x16x32_bf16 v[24:27], v[88:91], v[104:107], v[24:27]
    ds_read_b128 v[120:123], v240 offset:640
    v_mfma_f32_16x16x32_bf16 v[20:23], v[56:59], v[104:107], v[20:23]
    buffer_load_dwordx4 v[184:187], v224, s[16:19], s80 offen sc1
    s_waitcnt lgkmcnt(3)
    v_mfma_f32_16x16x32_bf16 v[24:27], v[92:95], v[108:111], v[24:27]
    ds_read_b128 v[124:127], v240 offset:576
    v_mfma_f32_16x16x32_bf16 v[20:23], v[60:63], v[108:111], v[20:23]
    s_waitcnt lgkmcnt(3)
    v_mfma_f32_16x16x32_bf16 v[24:27], v[96:99], v[112:115], v[24:27]
    ds_read_b128 v[128:131], v240 offset:512
    v_mfma_f32_16x16x32_bf16 v[20:23], v[64:67], v[112:115], v[20:23]
    buffer_load_dwordx4 v[188:191], v225, s[16:19], s80 offen sc1
    s_waitcnt lgkmcnt(3)
    v_mfma_f32_16x16x32_bf16 v[24:27], v[100:103], v[116:119], v[24:27]
    ds_read_b128 v[132:135], v240 offset:448
    v_mfma_f32_16x16x32_bf16 v[20:23], v[68:71], v[116:119], v[20:23]
    s_waitcnt lgkmcnt(3)
    v_mfma_f32_16x16x32_bf16 v[20:23], v[72:75], v[120:123], v[20:23]
    ds_read_b128 v[136:139], v240 offset:384
    s_waitcnt lgkmcnt(3)
    v_mfma_f32_16x16x32_bf16 v[20:23], v[76:79], v[124:127], v[20:23]
    ds_read_b128 v[140:143], v240 offset:320
    s_waitcnt lgkmcnt(3)
    v_mfma_f32_16x16x32_bf16 v[20:23], v[80:83], v[128:131], v[20:23]
    ds_read_b128 v[104:107], v240 offset:256
    v_mfma_f32_16x16x32_bf16 v[16:19], v[48:51], v[128:131], 0
    s_waitcnt lgkmcnt(3)
    v_mfma_f32_16x16x32_bf16 v[20:23], v[84:87], v[132:135], v[20:23]
    ds_read_b128 v[108:111], v240 offset:192
    v_mfma_f32_16x16x32_bf16 v[16:19], v[52:55], v[132:135], v[16:19]
    s_waitcnt lgkmcnt(3)
    v_mfma_f32_16x16x32_bf16 v[20:23], v[88:91], v[136:139], v[20:23]
    ds_read_b128 v[112:115], v240 offset:128
    v_mfma_f32_16x16x32_bf16 v[16:19], v[56:59], v[136:139], v[16:19]
    s_waitcnt lgkmcnt(3)
    v_mfma_f32_16x16x32_bf16 v[20:23], v[92:95], v[140:143], v[20:23]
    ds_read_b128 v[116:119], v240 offset:64
    v_mfma_f32_16x16x32_bf16 v[16:19], v[60:63], v[140:143], v[16:19]
    s_waitcnt lgkmcnt(3)
    v_mfma_f32_16x16x32_bf16 v[20:23], v[96:99], v[104:107], v[20:23]
    v_mfma_f32_16x16x32_bf16 v[16:19], v[64:67], v[104:107], v[16:19]
    s_waitcnt lgkmcnt(2)
    v_mfma_f32_16x16x32_bf16 v[20:23], v[100:103], v[108:111], v[20:23]
    v_mfma_f32_16x16x32_bf16 v[16:19], v[68:71], v[108:111], v[16:19]
    s_waitcnt lgkmcnt(1)
    v_mfma_f32_16x16x32_bf16 v[16:19], v[72:75], v[112:115], v[16:19]
    s_waitcnt lgkmcnt(0)
    v_mfma_f32_16x16x32_bf16 v[16:19], v[76:79], v[116:119], v[16:19]
    s_branch L_convjoin_20
L_roleB_19:
    ds_read_b128 v[104:107], v240 offset:496
    ds_read_b128 v[108:111], v240 offset:512
    ds_read2_b32 v[56:57], v237 offset0:0 offset1:1
    ds_read2_b32 v[58:59], v237 offset0:2 offset1:3
    ds_read2_b32 v[48:49], v237 offset0:32 offset1:33
    ds_read2_b32 v[50:51], v237 offset0:34 offset1:35
    ds_read_b128 v[112:115], v240 offset:128
    ds_read_b128 v[116:119], v240 offset:64
    ds_read_b128 v[120:123], v240 offset:16
    v_mov_b32 v32, v188
    v_mov_b32 v33, v188
    v_mov_b32 v34, v188
    v_mov_b32 v35, v188
    s_waitcnt lgkmcnt(8)
    v_mfma_f32_16x16x32_bf16 v[128:131], v[104:107], v[192:195], 0
    ds_read2_b32 v[52:53], v237 offset0:16 offset1:17
    ds_read_b128 v[124:127], v240 offset:1008
    s_waitcnt lgkmcnt(9)
    v_mfma_f32_16x16x32_bf16 v[132:135], v[108:111], v[196:199], 0
    buffer_load_dwordx4 a[184:187], v220, s[20:23], s77 offen offset:1024 sc1
    ds_read2_b32 v[54:55], v237 offset0:18 offset1:19
    v_mfma_f32_16x16x32_bf16 v[136:139], v[108:111], v[192:195], 0
    ds_read2_b32 v[60:61], v238 offset0:192 offset1:193
    v_mfma_f32_16x16x32_bf16 v[140:143], v[108:111], v[200:203], 0
    ds_read2_b32 v[62:63], v238 offset0:194 offset1:195
    v_mfma_f32_16x16x32_bf16 v[144:147], v[104:107], v[204:207], 0
    buffer_load_dwordx4 a[188:191], v220, s[20:23], s77 offen offset:2048 sc1
    ds_read2_b32 v[64:65], v239 offset0:32 offset1:33
    ds_read_b128 v[104:107], v240 offset:1024
    v_mfma_f32_16x16x32_bf16 v[148:151], v[108:111], v[208:211], 0
    ds_read2_b32 v[66:67], v239 offset0:56 offset1:57
    s_waitcnt lgkmcnt(13)
    v_mfma_f32_16x16x32_bf16 v[40:43], v[56:59], v[108:111], v[188:191]
    ds_read2_b32 v[76:77], v239 offset0:80 offset1:81
    ds_read_b128 v[108:111], v240 offset:640
    s_waitcnt lgkmcnt(12)
    v_mfma_f32_16x16x32_bf16 v[36:39], v[48:51], v[112:115], v[188:191]
    buffer_load_dwordx4 a[192:195], v220, s[20:23], s77 offen offset:3072 sc1
    ds_read2_b32 v[78:79], v239 offset0:104 offset1:105
    ds_read_b128 v[112:115], v240 offset:576
    v_cvt_pk_bf16_f32 v152, v128, v129
    v_cvt_pk_bf16_f32 v153, v130, v131
    s_waitcnt lgkmcnt(9)
    v_mfma_f32_16x16x32_bf16 v[36:39], v[52:55], v[116:119], v[36:39]
    ds_read2_b32 v[88:89], v239 offset0:144 offset1:145
    ds_read_b128 v[116:119], v240 offset:528
    v_cvt_pk_bf16_f32 v154, v132, v133
    v_cvt_pk_bf16_f32 v155, v134, v135
    s_waitcnt lgkmcnt(9)
    v_mfma_f32_16x16x32_bf16 v[44:47], v[60:63], v[120:123], v[188:191]
    ds_read2_b32 v[90:91], v239 offset0:184 offset1:185
    ds_read_b128 v[120:123], v240 offset:1520
    v_cvt_pk_bf16_f32 v156, v136, v137
    v_cvt_pk_bf16_f32 v157, v138, v139
    v_cvt_pk_bf16_f32 v158, v140, v141
    v_cvt_pk_bf16_f32 v159, v142, v143
    v_cvt_pk_bf16_f32 v160, v144, v145
    v_cvt_pk_bf16_f32 v161, v146, v147
    v_cvt_pk_bf16_f32 v162, v148, v149
    v_cvt_pk_bf16_f32 v163, v150, v151
    v_mfma_f32_16x16x32_bf16 v[128:131], v[124:127], v[192:195], 0
    buffer_load_dwordx4 a[196:199], v221, s[20:23], s77 offen offset:0 sc1
    ds_read2_b32 v[68:69], v239 offset0:24 offset1:25
    s_waitcnt lgkmcnt(10)
    v_mfma_f32_16x16x32_bf16 v[132:135], v[104:107], v[196:199], 0
    ds_read2_b32 v[70:71], v239 offset0:48 offset1:49
    ds_read2_b32 v[80:81], v239 offset0:72 offset1:73
    v_mfma_f32_16x16x32_bf16 v[136:139], v[104:107], v[192:195], 0
    ds_read2_b32 v[82:83], v239 offset0:96 offset1:97
    ds_read2_b32 v[92:93], v239 offset0:136 offset1:137
    v_mfma_f32_16x16x32_bf16 v[140:143], v[104:107], v[200:203], 0
    s_mul_i32 s76, s90, 5
    buffer_load_dwordx4 a[200:203], v220, s[20:23], s76 offen offset:0 sc1
    ds_read2_b32 v[94:95], v239 offset0:176 offset1:177
    ds_read2_b32 v[72:73], v239 offset0:16 offset1:17
    v_mfma_f32_16x16x32_bf16 v[144:147], v[124:127], v[204:207], 0
    ds_read2_b32 v[74:75], v239 offset0:40 offset1:41
    ds_read2_b32 v[84:85], v239 offset0:64 offset1:65
    ds_read_b128 v[124:127], v240 offset:1536
    v_mfma_f32_16x16x32_bf16 v[148:151], v[104:107], v[208:211], 0
    ds_read2_b32 v[86:87], v239 offset0:88 offset1:89
    ds_read2_b32 v[96:97], v239 offset0:128 offset1:129
    v_mfma_f32_16x16x32_bf16 v[44:47], v[56:59], v[104:107], v[44:47]
    s_add_u32 s16, s64, s46
    s_addc_u32 s17, s65, 0
    s_mov_b32 s18, 221184
    s_mov_b32 s19, 0x20000
    v_min_u32 v229, 6, v0
    v_lshl_add_u32 v229, v229, 2, s28
    v_lshlrev_b32 v229, 7, v229
    ds_read2_b32 v[98:99], v239 offset0:168 offset1:169
    ds_read2_b32 v[100:101], v239 offset0:120 offset1:121
    ds_read_b128 v[104:107], v240 offset:1152
    s_waitcnt lgkmcnt(15)
    v_mfma_f32_16x16x32_bf16 v[40:43], v[48:51], v[108:111], v[40:43]
    buffer_load_dwordx4 a[204:207], v220, s[20:23], s76 offen offset:1024 sc1
    ds_read2_b32 v[102:103], v239 offset0:160 offset1:161
    ds_read_b128 v[108:111], v240 offset:1088
    ds_write_b128 v244, v[36:39] offset:1024
    v_cvt_pk_bf16_f32 v164, v128, v129
    v_cvt_pk_bf16_f32 v165, v130, v131
    v_mfma_f32_16x16x32_bf16 v[40:43], v[52:55], v[112:115], v[40:43]
    ds_read_b128 v[112:115], v240 offset:1040
    ds_write_b128 v244, v[32:35] offset:0
    v_cvt_pk_bf16_f32 v166, v132, v133
    v_cvt_pk_bf16_f32 v167, v134, v135
    v_mfma_f32_16x16x32_bf16 v[16:19], v[60:63], v[116:119], 0
    ds_read_b128 v[116:119], v240 offset:2032
    v_cvt_pk_bf16_f32 v168, v136, v137
    v_cvt_pk_bf16_f32 v169, v138, v139
    v_mfma_f32_16x16x32_bf16 v[40:43], v[152:155], v[64:67], v[40:43]
    buffer_load_dwordx4 a[208:211], v220, s[20:23], s76 offen offset:2048 sc1
    s_add_u32 s68, s28, 1
    s_and_b32 s68, s68, 3
    s_mul_i32 s68, s68, 55296
    v_add_u32 v222, s68, v1
    s_add_u32 s68, s28, 2
    s_and_b32 s68, s68, 3
    s_mul_i32 s68, s68, 55296
    v_add_u32 v223, s68, v1
    s_add_u32 s68, s28, 3
    s_and_b32 s68, s68, 3
    s_mul_i32 s68, s68, 55296
    v_add_u32 v224, s68, v1
    s_add_u32 s68, s28, 4
    s_and_b32 s68, s68, 3
    s_mul_i32 s68, s68, 55296
    v_add_u32 v225, s68, v1
    v_cvt_pk_bf16_f32 v170, v140, v141
    v_cvt_pk_bf16_f32 v171, v142, v143
    v_mfma_f32_16x16x32_bf16 v[40:43], v[156:159], v[76:79], v[40:43]
    v_cvt_pk_bf16_f32 v172, v144, v145
    v_cvt_pk_bf16_f32 v173, v146, v147
    v_mfma_f32_16x16x32_bf16 v[16:19], v[160:163], v[88:91], v[16:19]
    v_cvt_pk_bf16_f32 v174, v148, v149
    v_cvt_pk_bf16_f32 v175, v150, v151
    s_waitcnt lgkmcnt(15)
    v_mfma_f32_16x16x32_bf16 v[44:47], v[152:155], v[68:71], v[44:47]
    buffer_load_dwordx4 a[212:215], v220, s[20:23], s76 offen offset:3072 sc1
    ds_write_b128 v244, v[40:43] offset:2048
    v_mfma_f32_16x16x32_bf16 v[44:47], v[156:159], v[80:83], v[44:47]
    buffer_load_dword v228, v229, s[12:15], s94 offen sc1
    v_mfma_f32_16x16x32_bf16 v[20:23], v[160:163], v[92:95], 0
    s_waitcnt lgkmcnt(14)
    v_mfma_f32_16x16x32_bf16 v[16:19], v[152:155], v[72:75], v[16:19]
    buffer_load_dwordx4 a[216:219], v221, s[20:23], s76 offen offset:0 sc1
    s_waitcnt lgkmcnt(11)
    v_mfma_f32_16x16x32_bf16 v[16:19], v[156:159], v[84:87], v[16:19]
    s_waitcnt lgkmcnt(9)
    v_mfma_f32_16x16x32_bf16 v[24:27], v[160:163], v[96:99], 0
    s_waitcnt lgkmcnt(6)
    v_mfma_f32_16x16x32_bf16 v[28:31], v[160:163], v[100:103], 0
    s_waitcnt vmcnt(10)
    v_mov_b32 v11, 1
    s_mov_b64 exec, 1
    buffer_store_dword v11, off, s[12:15], s39 offset:0 sc1
    s_mov_b64 exec, -1
    s_add_u32 s39, s39, 81920
    v_mov_b32 v11, 1
    s_mov_b64 exec, 1
    buffer_store_dword v11, off, s[12:15], s39 offset:0 sc1
    s_mov_b64 exec, -1
    v_mfma_f32_16x16x32_bf16 v[128:131], v[120:123], v[192:195], 0
    s_mul_i32 s77, s91, 5
    buffer_load_dwordx4 a[220:223], v220, s[20:23], s77 offen offset:0 sc1
    v_mfma_f32_16x16x32_bf16 v[132:135], v[124:127], v[196:199], 0
    v_mfma_f32_16x16x32_bf16 v[136:139], v[124:127], v[192:195], 0
    buffer_load_dwordx4 a[224:227], v220, s[20:23], s77 offen offset:1024 sc1
    v_mfma_f32_16x16x32_bf16 v[140:143], v[124:127], v[200:203], 0
    v_mfma_f32_16x16x32_bf16 v[144:147], v[120:123], v[204:207], 0
    ds_read_b128 v[120:123], v240 offset:2048
    v_mfma_f32_16x16x32_bf16 v[148:151], v[124:127], v[208:211], 0
    buffer_load_dwordx4 a[228:231], v220, s[20:23], s77 offen offset:2048 sc1
    v_mfma_f32_16x16x32_bf16 v[16:19], v[56:59], v[124:127], v[16:19]
    ds_read_b128 v[124:127], v240 offset:1664
    v_mfma_f32_16x16x32_bf16 v[44:47], v[48:51], v[104:107], v[44:47]
    ds_read_b128 v[104:107], v240 offset:1600
    v_cvt_pk_bf16_f32 v152, v128, v129
    v_cvt_pk_bf16_f32 v153, v130, v131
    s_waitcnt lgkmcnt(8)
    v_mfma_f32_16x16x32_bf16 v[44:47], v[52:55], v[108:111], v[44:47]
    buffer_load_dwordx4 a[232:235], v220, s[20:23], s77 offen offset:3072 sc1
    ds_read_b128 v[108:111], v240 offset:1552
    v_cvt_pk_bf16_f32 v154, v132, v133
    v_cvt_pk_bf16_f32 v155, v134, v135
    s_waitcnt lgkmcnt(7)
    v_mfma_f32_16x16x32_bf16 v[20:23], v[60:63], v[112:115], v[20:23]
    ds_read_b128 v[112:115], v240 offset:2544
    v_cvt_pk_bf16_f32 v156, v136, v137
    v_cvt_pk_bf16_f32 v157, v138, v139
    v_mfma_f32_16x16x32_bf16 v[44:47], v[164:167], v[64:67], v[44:47]
    v_cvt_pk_bf16_f32 v158, v140, v141
    v_cvt_pk_bf16_f32 v159, v142, v143
    v_mfma_f32_16x16x32_bf16 v[44:47], v[168:171], v[76:79], v[44:47]
    buffer_load_dwordx4 a[236:239], v221, s[20:23], s77 offen offset:0 sc1
    v_cvt_pk_bf16_f32 v160, v144, v145
    v_cvt_pk_bf16_f32 v161, v146, v147
    v_mfma_f32_16x16x32_bf16 v[20:23], v[172:175], v[88:91], v[20:23]
    v_cvt_pk_bf16_f32 v162, v148, v149
    v_cvt_pk_bf16_f32 v163, v150, v151
    v_mfma_f32_16x16x32_bf16 v[16:19], v[164:167], v[68:71], v[16:19]
    s_nop 0
    ds_write_b128 v244, v[44:47] offset:3072
    v_mfma_f32_16x16x32_bf16 v[16:19], v[168:171], v[80:83], v[16:19]
    v_mfma_f32_16x16x32_bf16 v[24:27], v[172:175], v[92:95], v[24:27]
    s_mul_i32 s76, s92, 5
    buffer_load_dwordx4 a[240:243], v220, s[20:23], s76 offen offset:0 sc1
    v_mfma_f32_16x16x32_bf16 v[20:23], v[164:167], v[72:75], v[20:23]
    v_mfma_f32_16x16x32_bf16 v[20:23], v[168:171], v[84:87], v[20:23]
    v_mfma_f32_16x16x32_bf16 v[28:31], v[172:175], v[96:99], v[28:31]
    buffer_load_dwordx4 a[244:247], v220, s[20:23], s76 offen offset:1024 sc1
    s_waitcnt lgkmcnt(7)
    v_mfma_f32_16x16x32_bf16 v[128:131], v[116:119], v[192:195], 0
    s_waitcnt lgkmcnt(5)
    v_mfma_f32_16x16x32_bf16 v[132:135], v[120:123], v[196:199], 0
    v_mfma_f32_16x16x32_bf16 v[136:139], v[120:123], v[192:195], 0
    buffer_load_dwordx4 a[248:251], v220, s[20:23], s76 offen offset:2048 sc1
    v_mfma_f32_16x16x32_bf16 v[140:143], v[120:123], v[200:203], 0
    v_mfma_f32_16x16x32_bf16 v[144:147], v[116:119], v[204:207], 0
    ds_read_b128 v[116:119], v240 offset:2560
    v_mfma_f32_16x16x32_bf16 v[148:151], v[120:123], v[208:211], 0
    buffer_load_dwordx4 a[252:255], v220, s[20:23], s76 offen offset:3072 sc1
    v_mfma_f32_16x16x32_bf16 v[20:23], v[56:59], v[120:123], v[20:23]
    ds_read_b128 v[120:123], v240 offset:2176
    s_waitcnt lgkmcnt(6)
    v_mfma_f32_16x16x32_bf16 v[16:19], v[48:51], v[124:127], v[16:19]
    ds_read_b128 v[124:127], v240 offset:2112
    v_cvt_pk_bf16_f32 v164, v128, v129
    v_cvt_pk_bf16_f32 v165, v130, v131
    s_waitcnt lgkmcnt(6)
    v_mfma_f32_16x16x32_bf16 v[16:19], v[52:55], v[104:107], v[16:19]
    ds_read_b128 v[104:107], v240 offset:2064
    v_cvt_pk_bf16_f32 v166, v132, v133
    v_cvt_pk_bf16_f32 v167, v134, v135
    s_waitcnt lgkmcnt(6)
    v_mfma_f32_16x16x32_bf16 v[24:27], v[60:63], v[108:111], v[24:27]
    ds_read_b128 v[108:111], v240 offset:3056
    v_cvt_pk_bf16_f32 v168, v136, v137
    v_cvt_pk_bf16_f32 v169, v138, v139
    v_mfma_f32_16x16x32_bf16 v[16:19], v[152:155], v[64:67], v[16:19]
    v_cvt_pk_bf16_f32 v170, v140, v141
    v_cvt_pk_bf16_f32 v171, v142, v143
    v_mfma_f32_16x16x32_bf16 v[16:19], v[156:159], v[76:79], v[16:19]
    v_cvt_pk_bf16_f32 v172, v144, v145
    v_cvt_pk_bf16_f32 v173, v146, v147
    v_mfma_f32_16x16x32_bf16 v[24:27], v[160:163], v[88:91], v[24:27]
    v_cvt_pk_bf16_f32 v174, v148, v149
    v_cvt_pk_bf16_f32 v175, v150, v151
    v_mfma_f32_16x16x32_bf16 v[20:23], v[152:155], v[68:71], v[20:23]
    v_mfma_f32_16x16x32_bf16 v[20:23], v[156:159], v[80:83], v[20:23]
    v_mfma_f32_16x16x32_bf16 v[28:31], v[160:163], v[92:95], v[28:31]
    v_mfma_f32_16x16x32_bf16 v[24:27], v[152:155], v[72:75], v[24:27]
    v_mfma_f32_16x16x32_bf16 v[24:27], v[156:159], v[84:87], v[24:27]
    s_waitcnt lgkmcnt(6)
    v_mfma_f32_16x16x32_bf16 v[128:131], v[112:115], v[192:195], 0
    s_waitcnt vmcnt(12)
    v_cmp_ne_u32 vcc, 1, v228
    s_cbranch_vccz L_fh0_ok_23
    s_mov_b32 s74, 20000
L_fh0_spin_24:
    s_mov_b64 exec, vcc
    s_sleep 1
    buffer_load_dword v228, v229, s[12:15], s94 offen sc1
    s_waitcnt vmcnt(0)
    v_cmp_ne_u32 vcc, 1, v228
    s_mov_b64 exec, -1
    s_cbranch_vccz L_fh0_ok_23
    s_sub_u32 s74, s74, 1
    s_cmp_lg_u32 s74, 0
    s_cbranch_scc1 L_fh0_spin_24
L_fh0_ok_23:
    ds_read_b128 v[112:115], v240 offset:3072
    s_waitcnt lgkmcnt(5)
    v_mfma_f32_16x16x32_bf16 v[132:135], v[116:119], v[196:199], 0
    buffer_load_dwordx4 v[176:179], v222, s[16:19], s80 offen sc1
    v_mfma_f32_16x16x32_bf16 v[136:139], v[116:119], v[192:195], 0
    v_mfma_f32_16x16x32_bf16 v[140:143], v[116:119], v[200:203], 0
    v_mfma_f32_16x16x32_bf16 v[24:27], v[56:59], v[116:119], v[24:27]
    ds_read_b128 v[116:119], v240 offset:2688
    s_waitcnt lgkmcnt(5)
    v_mfma_f32_16x16x32_bf16 v[20:23], v[48:51], v[120:123], v[20:23]
    buffer_load_dwordx4 v[180:183], v223, s[16:19], s80 offen sc1
    ds_read_b128 v[120:123], v240 offset:2624
    v_cvt_pk_bf16_f32 v152, v128, v129
    v_cvt_pk_bf16_f32 v153, v130, v131
    s_waitcnt lgkmcnt(5)
    v_mfma_f32_16x16x32_bf16 v[20:23], v[52:55], v[124:127], v[20:23]
    ds_read_b128 v[124:127], v240 offset:3200
    v_cvt_pk_bf16_f32 v154, v132, v133
    v_cvt_pk_bf16_f32 v155, v134, v135
    s_waitcnt lgkmcnt(5)
    v_mfma_f32_16x16x32_bf16 v[28:31], v[60:63], v[104:107], v[28:31]
    ds_read_b128 v[104:107], v240 offset:3136
    v_cvt_pk_bf16_f32 v156, v136, v137
    v_cvt_pk_bf16_f32 v157, v138, v139
    v_mfma_f32_16x16x32_bf16 v[20:23], v[164:167], v[64:67], v[20:23]
    v_cvt_pk_bf16_f32 v158, v140, v141
    v_cvt_pk_bf16_f32 v159, v142, v143
    v_mfma_f32_16x16x32_bf16 v[20:23], v[168:171], v[76:79], v[20:23]
    buffer_load_dwordx4 v[184:187], v224, s[16:19], s80 offen sc1
    v_mfma_f32_16x16x32_bf16 v[28:31], v[172:175], v[88:91], v[28:31]
    v_mfma_f32_16x16x32_bf16 v[24:27], v[164:167], v[68:71], v[24:27]
    v_mfma_f32_16x16x32_bf16 v[24:27], v[168:171], v[80:83], v[24:27]
    v_mfma_f32_16x16x32_bf16 v[28:31], v[164:167], v[72:75], v[28:31]
    buffer_load_dwordx4 v[188:191], v225, s[16:19], s80 offen sc1
    v_mfma_f32_16x16x32_bf16 v[28:31], v[168:171], v[84:87], v[28:31]
    s_waitcnt lgkmcnt(5)
    v_mfma_f32_16x16x32_bf16 v[128:131], v[108:111], v[192:195], 0
    s_waitcnt lgkmcnt(4)
    v_mfma_f32_16x16x32_bf16 v[132:135], v[112:115], v[196:199], 0
    v_mfma_f32_16x16x32_bf16 v[136:139], v[112:115], v[192:195], 0
    v_mfma_f32_16x16x32_bf16 v[140:143], v[112:115], v[200:203], 0
    v_mfma_f32_16x16x32_bf16 v[28:31], v[56:59], v[112:115], v[28:31]
    s_waitcnt lgkmcnt(3)
    v_mfma_f32_16x16x32_bf16 v[24:27], v[48:51], v[116:119], v[24:27]
    s_nop 0
    v_cvt_pk_bf16_f32 v164, v128, v129
    v_cvt_pk_bf16_f32 v165, v130, v131
    s_waitcnt lgkmcnt(2)
    v_mfma_f32_16x16x32_bf16 v[24:27], v[52:55], v[120:123], v[24:27]
    v_cvt_pk_bf16_f32 v166, v132, v133
    v_cvt_pk_bf16_f32 v167, v134, v135
    s_waitcnt lgkmcnt(1)
    v_mfma_f32_16x16x32_bf16 v[28:31], v[48:51], v[124:127], v[28:31]
    v_cvt_pk_bf16_f32 v168, v136, v137
    v_cvt_pk_bf16_f32 v169, v138, v139
    s_waitcnt lgkmcnt(0)
    v_mfma_f32_16x16x32_bf16 v[28:31], v[52:55], v[104:107], v[28:31]
    v_cvt_pk_bf16_f32 v170, v140, v141
    v_cvt_pk_bf16_f32 v171, v142, v143
    v_mfma_f32_16x16x32_bf16 v[24:27], v[152:155], v[64:67], v[24:27]
    v_mfma_f32_16x16x32_bf16 v[24:27], v[156:159], v[76:79], v[24:27]
    v_mfma_f32_16x16x32_bf16 v[28:31], v[152:155], v[68:71], v[28:31]
    v_mfma_f32_16x16x32_bf16 v[28:31], v[156:159], v[80:83], v[28:31]
    v_mfma_f32_16x16x32_bf16 v[28:31], v[164:167], v[64:67], v[28:31]
    v_mfma_f32_16x16x32_bf16 v[28:31], v[168:171], v[76:79], v[28:31]
L_convjoin_20:
    s_barrier
    ds_read_b128 v[32:35], v245 offset:0
    ds_read_b128 v[36:39], v245 offset:1024
    ds_read_b128 v[40:43], v245 offset:2048
    ds_read_b128 v[44:47], v245 offset:3072
    buffer_load_dwordx4 v[112:115], v222, s[16:19], s81 offen sc1
    buffer_load_dwordx4 v[116:119], v223, s[16:19], s81 offen sc1
    buffer_load_dwordx4 v[120:123], v224, s[16:19], s81 offen sc1
    s_waitcnt lgkmcnt(3)
    v_pk_add_f32 v[16:17], v[16:17], v[32:33]
    v_pk_add_f32 v[18:19], v[18:19], v[34:35]
    buffer_load_dwordx4 v[124:127], v225, s[16:19], s81 offen sc1
    s_waitcnt lgkmcnt(2)
    v_pk_add_f32 v[20:21], v[20:21], v[36:37]
    v_pk_add_f32 v[22:23], v[22:23], v[38:39]
    v_cvt_pk_bf16_f32 v48, v16, v17
    buffer_load_dwordx4 v[128:131], v222, s[16:19], s82 offen sc1
    v_cvt_pk_bf16_f32 v49, v18, v19
    v_cvt_pk_bf16_f32 v50, v20, v21
    v_cvt_pk_bf16_f32 v51, v22, v23
    buffer_load_dwordx4 v[132:135], v223, s[16:19], s82 offen sc1
    v_permlane16_swap_b32 v48, v50
    v_permlane16_swap_b32 v49, v51
    s_waitcnt lgkmcnt(1)
    v_pk_add_f32 v[24:25], v[24:25], v[40:41]
    buffer_load_dwordx4 v[136:139], v224, s[16:19], s82 offen sc1
    v_pk_add_f32 v[26:27], v[26:27], v[42:43]
    s_waitcnt lgkmcnt(0)
    v_pk_add_f32 v[28:29], v[28:29], v[44:45]
    v_pk_add_f32 v[30:31], v[30:31], v[46:47]
    buffer_load_dwordx4 v[140:143], v225, s[16:19], s82 offen sc1
    v_cvt_pk_bf16_f32 v52, v24, v25
    v_cvt_pk_bf16_f32 v53, v26, v27
    v_cvt_pk_bf16_f32 v54, v28, v29
    v_cvt_pk_bf16_f32 v55, v30, v31
    s_nop 0
    v_permlane16_swap_b32 v52, v54
    v_permlane16_swap_b32 v53, v55
    buffer_store_dwordx4 v[48:51], v246, s[12:15], s42 offen offset:0 sc1
    buffer_store_dwordx4 v[52:55], v246, s[12:15], s42 offen offset:1024 sc1
    s_branch L_gemm2
L_mk_send:
.p2align 7
.type L_tab,@object
L_tab:
.long 0x05080508, 0x05080508, 0x05080508, 0x05080508, 0x05080508, 0x05080508, 0x05080508, 0x05080508
.long 0x05080508, 0x05080508, 0x05080508, 0x05080508, 0x05080508, 0x05080508, 0x03000508, 0x03000300
.long 0x02fe0300, 0x02fc02fc, 0x02fa02fc, 0x02f802f8, 0x02f602f8, 0x02f402f4, 0x02f202f4, 0x02f002f0
.long 0x02ee02f0, 0x02ec02ec, 0x02ea02ec, 0x02e802e8, 0x02e602e8, 0x02e402e4, 0x02e202e4, 0x02e002e0
.long 0x02de02e0, 0x02dc02dc, 0x02da02dc, 0x02d802d8, 0x02d602d8, 0x02d402d4, 0x02d202d4, 0x02d002d0
.long 0x02ce02d0, 0x02cc02cc, 0x02ca02cc, 0x02c802c8, 0x02c602c8, 0x02c402c4, 0x02c202c4, 0x02c002c0
.long 0x02be02c0, 0x02bc02bc, 0x02ba02bc, 0x02b802b8, 0x02b602b8, 0x02b402b4, 0x02b202b4, 0x02b002b0
.long 0x02ae02b0, 0x02ac02ac, 0x02aa02ac, 0x02a802a8, 0x02a602a8, 0x02a402a4, 0x02a202a4, 0x02a002a0
.long 0x029e02a0, 0x029c029c, 0x029a029c, 0x02980298, 0x02960298, 0x02940294, 0x02920294, 0x02900290
.long 0x028e0290, 0x028c028c, 0x028a028c, 0x02880288, 0x02860288, 0x02840284, 0x02820284, 0x02800280
.long 0x027e0280, 0x027c027c, 0x027a027c, 0x02780278, 0x02760278, 0x02740274, 0x02720274, 0x02700270
.long 0x026e0270, 0x026c026c, 0x026a026c, 0x02680268, 0x02660268, 0x02640264, 0x02620264, 0x02600260
.long 0x025e0260, 0x025c025c, 0x025a025c, 0x02580258, 0x02560258, 0x02540254, 0x02520254, 0x02500250
.long 0x024e0250, 0x024c024c, 0x024a024c, 0x02480248, 0x02460248, 0x02440244, 0x02420244, 0x02400240
.long 0x023e0240, 0x023c023c, 0x023a023c, 0x02380238, 0x02360238, 0x02340234, 0x02320234, 0x02300230
.long 0x022e0230, 0x022c022c, 0x022a022c, 0x02280228, 0x02260228, 0x02240224, 0x02220224, 0x02200220
.long 0x021e0220, 0x021c021c, 0x021a021c, 0x02180218, 0x02160218, 0x02140214, 0x02120214, 0x02100210
.long 0x020e0210, 0x020c020c, 0x020a020c, 0x02080208, 0x02060208, 0x02040204, 0x02020204, 0x02000200
.long 0x01fc01fe, 0x01f801fa, 0x01f401f6, 0x01f001f2, 0x01ec01ee, 0x01e801ea, 0x01e401e6, 0x01e001e2
.long 0x01dc01de, 0x01d801da, 0x01d401d6, 0x01d001d2, 0x01cc01ce, 0x01c801ca, 0x01c401c6, 0x01c001c2
.long 0x01bc01be, 0x01b801ba, 0x01b401b6, 0x01b001b2, 0x01ac01ae, 0x01a801aa, 0x01a401a6, 0x01a001a2
.long 0x019c019e, 0x0198019a, 0x01940196, 0x01900192, 0x018c018e, 0x0188018a, 0x01840186, 0x01800182
.long 0x017c017e, 0x0178017a, 0x01740176, 0x01700172, 0x016c016e, 0x0168016a, 0x01640166, 0x01600162
.long 0x015c015e, 0x0158015a, 0x01540156, 0x01500152, 0x014c014e, 0x0148014a, 0x01440146, 0x01400142
.long 0x013c013e, 0x0138013a, 0x01340136, 0x01300132, 0x012c012e, 0x0128012a, 0x01240126, 0x01200122
.long 0x011c011e, 0x0118011a, 0x01140116, 0x01100112, 0x010c010e, 0x0108010a, 0x01040106, 0x01000102
.long 0x00fc00fe, 0x00f800fa, 0x00f400f6, 0x00f000f2, 0x00ec00ee, 0x00e800ea, 0x00e400e6, 0x00e000e2
.long 0x00dc00de, 0x00d800da, 0x00d400d6, 0x00d000d2, 0x00cc00ce, 0x00c800ca, 0x00c400c6, 0x00c000c2
.long 0x00bc00be, 0x00b800ba, 0x00b400b6, 0x00b000b2, 0x00ac00ae, 0x00a800aa, 0x00a400a6, 0x00a000a2
.long 0x009c009e, 0x0098009a, 0x00940096, 0x00900092, 0x008c008e, 0x0088008a, 0x00840086, 0x00800082
.long 0x007c007e, 0x0078007a, 0x00740076, 0x00700072, 0x006c006e, 0x0068006a, 0x00640066, 0x00600062
.long 0x005c005e, 0x0058005a, 0x00540056, 0x00500052, 0x004c004e, 0x0048004a, 0x00440046, 0x00400042
.long 0x003c003e, 0x0038003a, 0x00340036, 0x00300032, 0x002c002e, 0x0028002a, 0x00240026, 0x00200022
.long 0x001c001e, 0x0018001a, 0x00140016, 0x00100012, 0x000c000e, 0x0008000a, 0x00040006, 0x00000002
.long 0x05080508, 0x05080508, 0x05080508, 0x05080508, 0x05080508, 0x05080508, 0x05080508, 0x05080508
.long 0x03f80508, 0x03e803f0, 0x03d803e0, 0x03c803d0, 0x03b803c0, 0x03a803b0, 0x039803a0, 0x03880390
.long 0x03780380, 0x03680370, 0x03580360, 0x03480350, 0x03380340, 0x03280330, 0x03180320, 0x03080310
.long 0x05080508, 0x05080508, 0x05080508, 0x05080508, 0x05080508, 0x05080508, 0x05080508, 0x05080508
.long 0x03f203fa, 0x03e203ea, 0x03d203da, 0x03c203ca, 0x03b203ba, 0x03a203aa, 0x0392039a, 0x0382038a
.long 0x0372037a, 0x0362036a, 0x0352035a, 0x0342034a, 0x0332033a, 0x0322032a, 0x0312031a, 0x0302030a
.long 0x05080508, 0x05080508, 0x05080508, 0x05080508, 0x05080508, 0x05080508, 0x05080508, 0x05080508
.long 0x03f403fc, 0x03e403ec, 0x03d403dc, 0x03c403cc, 0x03b403bc, 0x03a403ac, 0x0394039c, 0x0384038c
.long 0x0374037c, 0x0364036c, 0x0354035c, 0x0344034c, 0x0334033c, 0x0324032c, 0x0314031c, 0x0304030c
.long 0x05080508, 0x05080508, 0x05080508, 0x05080508, 0x05080508, 0x05080508, 0x05080508, 0x05080508
.long 0x03f603fe, 0x03e603ee, 0x03d603de, 0x03c603ce, 0x03b603be, 0x03a603ae, 0x0396039e, 0x0386038e
.long 0x0376037e, 0x0366036e, 0x0356035e, 0x0346034e, 0x0336033e, 0x0326032e, 0x0316031e, 0x0306030e
.long 0x05080508, 0x05080508, 0x05080508, 0x05080508, 0x05080508, 0x05080508, 0x05080508, 0x05080508
.long 0x04fc0500, 0x04f404f8, 0x04ec04f0, 0x04e404e8, 0x04dc04e0, 0x04d404d8, 0x04cc04d0, 0x04c404c8
.long 0x04bc04c0, 0x04b404b8, 0x04ac04b0, 0x04a404a8, 0x049c04a0, 0x04940498, 0x048c0490, 0x04840488
.long 0x047c0480, 0x04740478, 0x046c0470, 0x04640468, 0x045c0460, 0x04540458, 0x044c0450, 0x04440448
.long 0x043c0440, 0x04340438, 0x042c0430, 0x04240428, 0x041c0420, 0x04140418, 0x040c0410, 0x04040408
.long 0x05080508, 0x05080508, 0x05080508, 0x05080508, 0x05080508, 0x05080508, 0x05080508, 0x05080508
.long 0x04fa04fe, 0x04f204f6, 0x04ea04ee, 0x04e204e6, 0x04da04de, 0x04d204d6, 0x04ca04ce, 0x04c204c6
.long 0x04ba04be, 0x04b204b6, 0x04aa04ae, 0x04a204a6, 0x049a049e, 0x04920496, 0x048a048e, 0x04820486
.long 0x047a047e, 0x04720476, 0x046a046e, 0x04620466, 0x045a045e, 0x04520456, 0x044a044e, 0x04420446
.long 0x043a043e, 0x04320436, 0x042a042e, 0x04220426, 0x041a041e, 0x04120416, 0x040a040e, 0x04020406
.long 0x05080508, 0x05080508, 0x05080508, 0x05080508, 0x05080508, 0x05080508, 0x05080508, 0x05080508
.long 0x05080508, 0x04000508, 0x04000400, 0x04000400, 0x04000400, 0x05080508, 0x05080508, 0x05080508
.long 0x05080508, 0x05080508, 0x05080508, 0x05080508, 0x05080508, 0x05080508, 0x05080508, 0x05080508
.long 0x05080508, 0x05080508, 0x05080508, 0x05080508, 0x05080508, 0x05080508, 0x05080508, 0x05080508
.long 0x05080508, 0x05080508, 0x05080508, 0x05080508, 0x05080508, 0x05080508, 0x05080508, 0x05080508
.long 0x05080508, 0x05080508, 0x05080508, 0x05080508, 0x05080508, 0x05080508, 0x05080508, 0x05080508
.long 0x05080508, 0x05080508, 0x05080508, 0x05080508, 0x05080508, 0x05080508, 0x05080508, 0x05080508
.long 0x05080508, 0x05080508, 0x05080508, 0x05080508, 0x05080508, 0x05080508, 0x05080508, 0x05080508
.long 0x05080508, 0x05080508, 0x05080508, 0x02fe0300, 0x02f602f8, 0x02ee02f0, 0x02e602e8, 0x02de02e0
.long 0x02d602d8, 0x02ce02d0, 0x02c602c8, 0x02be02c0, 0x02b602b8, 0x02ae02b0, 0x02a602a8, 0x029e02a0
.long 0x02960298, 0x028e0290, 0x02860288, 0x027e0280, 0x02760278, 0x026e0270, 0x02660268, 0x025e0260
.long 0x02560258, 0x024e0250, 0x02460248, 0x023e0240, 0x02360238, 0x022e0230, 0x02260228, 0x021e0220
.long 0x02160218, 0x020e0210, 0x02060208, 0x01fc01fe, 0x01ec01ee, 0x01dc01de, 0x01cc01ce, 0x01bc01be
.long 0x01ac01ae, 0x019c019e, 0x018c018e, 0x017c017e, 0x016c016e, 0x015c015e, 0x014c014e, 0x013c013e
.long 0x012c012e, 0x011c011e, 0x010c010e, 0x00fc00fe, 0x00ec00ee, 0x00dc00de, 0x00cc00ce, 0x00bc00be
.long 0x00ac00ae, 0x009c009e, 0x008c008e, 0x007c007e, 0x006c006e, 0x005c005e, 0x004c004e, 0x003c003e
.long 0x002c002e, 0x001c001e, 0x000c000e, 0x05080508, 0x05080508, 0x03f80508, 0x03b803c0, 0x03780380
.long 0x03380340, 0x05080508, 0x05080508, 0x03f203fa, 0x03b203ba, 0x0372037a, 0x0332033a, 0x05080508
.long 0x05080508, 0x03f403fc, 0x03b403bc, 0x0374037c, 0x0334033c, 0x05080508, 0x05080508, 0x03f603fe
.long 0x03b603be, 0x0376037e, 0x0336033e, 0x05080508, 0x05080508, 0x04fc0500, 0x04dc04e0, 0x04bc04c0
.long 0x049c04a0, 0x047c0480, 0x045c0460, 0x043c0440, 0x041c0420, 0x05080508, 0x05080508, 0x04fa04fe
.long 0x04da04de, 0x04ba04be, 0x049a049e, 0x047a047e, 0x045a045e, 0x043a043e, 0x041a041e, 0x05080508
.long 0x05080508, 0x05080508, 0x04000400, 0x05080508, 0x05080508, 0x05080508, 0x05080508, 0x05080508
.long 0x05080508, 0x05080508, 0x05080508, 0x05080508, 0x05080508, 0x05080508, 0x05080508, 0x05080508
L_tab_end:
.size L_tab, L_tab_end-L_tab
.p2align 7
.type L_sc,@object
L_sc:
.long 0,8192,16384,24576,32768,40960,49152,1024,9216,17408,25600,33792,41984,50176,262144,7341056
.long 0,1024,262144,65536,1048576,1376256,4194304,524288,7340032,10485760,10485760,4194304,524288,0,7340032,0
.long 2048,10240,18432,26624,34816,43008,51200,3072,11264,19456,27648,35840,44032,52224,262144,7343104
.long 2048,3072,262272,65536,1703936,2031616,4196352,606208,7340032,10485760,10485760,4194336,524288,20480,7342080,128
.long 4096,12288,20480,28672,36864,45056,53248,5120,13312,21504,29696,37888,46080,54272,262144,7616512
.long 222208,221184,266240,66048,2359296,2686976,4198400,524416,7340032,10485760,10485760,4194368,524288,40960,7344128,0
.long 6144,14336,22528,30720,38912,47104,268435456,7168,15360,23552,31744,39936,48128,268436480,262144,7618560
.long 224256,223232,266368,66048,3014656,3342336,4200448,606336,7340032,10485760,10485760,4194400,524288,61440,7617536,128
.long 0,8192,16384,24576,32768,40960,49152,1024,9216,17408,25600,33792,41984,50176,262144,7620608
.long 28672,29696,263936,65536,1049856,1377536,4521984,534528,8445952,10485760,10485760,5505024,565248,640,7619584,1792
.long 2048,10240,18432,26624,34816,43008,51200,3072,11264,19456,27648,35840,44032,52224,262144,7894016
.long 30720,31744,264064,65536,1705216,2032896,4524032,616448,8445952,10485760,10485760,5505056,565248,21120,7892992,1920
.long 4096,12288,20480,28672,36864,45056,53248,5120,13312,21504,29696,37888,46080,54272,262144,7896064
.long 250880,249856,268032,66048,2360576,2688256,4526080,534656,8445952,10485760,10485760,5505088,565248,41600,7895040,1792
.long 6144,14336,22528,30720,38912,47104,268435456,7168,15360,23552,31744,39936,48128,268436480,262144,8169472
.long 252928,251904,268160,66048,3015936,3343616,4528128,616576,8445952,10485760,10485760,5505120,565248,62080,7897088,1920
.long 0,8192,16384,24576,32768,40960,49152,1024,9216,17408,25600,33792,41984,50176,294912,8171520
.long 0,1024,294912,69632,1051136,1378816,4849664,544768,7340032,12255232,12255232,4195328,524288,655360,8170496,0
.long 2048,10240,18432,26624,34816,43008,51200,3072,11264,19456,27648,35840,44032,52224,294912,8173568
.long 2048,3072,295040,69632,1706496,2034176,4851712,626688,7340032,12255232,12255232,4195360,524288,675840,8172544,128
.long 4096,12288,20480,28672,36864,45056,53248,5120,13312,21504,29696,37888,46080,54272,294912,8446976
.long 222208,221184,299008,70144,2361856,2689536,4853760,544896,7340032,12255232,12255232,4195392,524288,696320,8445952,0
.long 6144,14336,22528,30720,38912,47104,268435456,7168,15360,23552,31744,39936,48128,268436480,294912,8449024
.long 224256,223232,299136,70144,3017216,3344896,4855808,626816,7340032,12255232,12255232,4195424,524288,716800,8448000,128
.long 0,8192,16384,24576,32768,40960,49152,1024,9216,17408,25600,33792,41984,50176,294912,8722432
.long 28672,29696,296704,69632,1052416,1380096,5177344,555008,8445952,12255232,12255232,5506048,565248,656000,8450048,1792
.long 2048,10240,18432,26624,34816,43008,51200,3072,11264,19456,27648,35840,44032,52224,294912,8724480
.long 30720,31744,296832,69632,1707776,2035456,5179392,636928,8445952,12255232,12255232,5506080,565248,676480,8723456,1920
.long 4096,12288,20480,28672,36864,45056,53248,5120,13312,21504,29696,37888,46080,54272,294912,8726528
.long 250880,249856,300800,70144,2363136,2690816,5181440,555136,8445952,12255232,12255232,5506112,565248,696960,8725504,1792
.long 6144,14336,22528,30720,38912,47104,268435456,7168,15360,23552,31744,39936,48128,268436480,294912,8999936
.long 252928,251904,300928,70144,3018496,3346176,5183488,637056,8445952,12255232,12255232,5506144,565248,717440,8998912,1920
.long 0,8192,16384,24576,32768,40960,49152,1024,9216,17408,25600,33792,41984,50176,327680,9001984
.long 0,1024,327680,73728,1053696,1381376,5505024,565248,7340032,14024704,14024704,4196352,606208,1310720,9000960,0
.long 2048,10240,18432,26624,34816,43008,51200,3072,11264,19456,27648,35840,44032,52224,327680,9275392
.long 2048,3072,327808,73728,1709056,2036736,5507072,647168,7340032,14024704,14024704,4196384,606208,1331200,9003008,128
.long 4096,12288,20480,28672,36864,45056,53248,5120,13312,21504,29696,37888,46080,54272,327680,9277440
.long 222208,221184,331776,74240,2364416,2692096,5509120,565376,7340032,14024704,14024704,4196416,606208,1351680,9276416,0
.long 6144,14336,22528,30720,38912,47104,268435456,7168,15360,23552,31744,39936,48128,268436480,327680,9279488
.long 224256,223232,331904,74240,3019776,3347456,5511168,647296,7340032,14024704,14024704,4196448,606208,1372160,9278464,128
.long 0,8192,16384,24576,32768,40960,49152,1024,9216,17408,25600,33792,41984,50176,327680,7346176
.long 28672,29696,329472,73728,1054976,1382656,5832704,575488,8445952,14024704,14024704,5507072,647168,1311360,7345152,1792
.long 2048,10240,18432,26624,34816,43008,51200,3072,11264,19456,27648,35840,44032,52224,327680,7348224
.long 30720,31744,329600,73728,1710336,2038016,5834752,657408,8445952,14024704,14024704,5507104,647168,1331840,7347200,1920
.long 4096,12288,20480,28672,36864,45056,53248,5120,13312,21504,29696,37888,46080,54272,327680,7621632
.long 250880,249856,333568,74240,2365696,2693376,5836800,575616,8445952,14024704,14024704,5507136,647168,1352320,7349248,1792
.long 6144,14336,22528,30720,38912,47104,268435456,7168,15360,23552,31744,39936,48128,268436480,327680,7623680
.long 252928,251904,333696,74240,3021056,3348736,5838848,657536,8445952,14024704,14024704,5507168,647168,1372800,7622656,1920
.long 0,8192,16384,24576,32768,40960,49152,1024,9216,17408,25600,33792,41984,50176,360448,7625728
.long 0,1024,360448,77824,1056256,1383936,6160384,585728,7340032,15794176,15794176,4197376,606208,1966080,7624704,0
.long 2048,10240,18432,26624,34816,43008,51200,3072,11264,19456,27648,35840,44032,52224,360448,7899136
.long 2048,3072,360576,77824,1711616,2039296,6162432,667648,7340032,15794176,15794176,4197408,606208,1986560,7898112,128
.long 4096,12288,20480,28672,36864,45056,53248,5120,13312,21504,29696,37888,46080,54272,360448,7901184
.long 222208,221184,364544,78336,2366976,2694656,6164480,585856,7340032,15794176,15794176,4197440,606208,2007040,7900160,0
.long 6144,14336,22528,30720,38912,47104,268435456,7168,15360,23552,31744,39936,48128,268436480,360448,8174592
.long 224256,223232,364672,78336,3022336,3350016,6166528,667776,7340032,15794176,15794176,4197472,606208,2027520,7902208,128
.long 0,8192,16384,24576,32768,40960,49152,1024,9216,17408,25600,33792,41984,50176,360448,8176640
.long 28672,29696,362240,77824,1057536,1385216,6488064,595968,8445952,15794176,15794176,5508096,647168,1966720,8175616,1792
.long 2048,10240,18432,26624,34816,43008,51200,3072,11264,19456,27648,35840,44032,52224,360448,8178688
.long 30720,31744,362368,77824,1712896,2040576,6490112,677888,8445952,15794176,15794176,5508128,647168,1987200,8177664,1920
.long 4096,12288,20480,28672,36864,45056,53248,5120,13312,21504,29696,37888,46080,54272,360448,8452096
.long 250880,249856,366336,78336,2368256,2695936,6492160,596096,8445952,15794176,15794176,5508160,647168,2007680,8451072,1792
.long 6144,14336,22528,30720,38912,47104,268435456,7168,15360,23552,31744,39936,48128,268436480,360448,8454144
.long 252928,251904,366464,78336,3023616,3351296,6494208,678016,8445952,15794176,15794176,5508192,647168,2028160,8453120,1920
.long 1024,9216,17408,25600,33792,41984,50176,0,8192,16384,24576,32768,40960,49152,266240,8727552
.long 0,1024,270336,66560,1048608,1376288,4202496,524544,7340032,10928128,10706944,4194432,524288,81920,8455168,0
.long 3072,11264,19456,27648,35840,44032,52224,2048,10240,18432,26624,34816,43008,51200,266240,8729600
.long 2048,3072,270464,66560,1703968,2031648,4204544,606464,7340032,10928128,10706944,4194464,524288,102400,8728576,128
.long 5120,13312,21504,29696,37888,46080,54272,4096,12288,20480,28672,36864,45056,53248,266240,8731648
.long 222208,221184,274432,67072,2359328,2687008,4206592,524672,7340032,10928128,10706944,4194496,524288,122880,8730624,0
.long 7168,15360,23552,31744,39936,48128,268435456,6144,14336,22528,30720,38912,47104,268436480,266240,9005056
.long 224256,223232,274560,67072,3014688,3342368,4208640,606592,7340032,10928128,10706944,4194528,524288,143360,9004032,128
.long 1024,9216,17408,25600,33792,41984,50176,0,8192,16384,24576,32768,40960,49152,266240,9007104
.long 28672,29696,272128,66560,1049888,1377568,4530176,534784,8445952,10928128,10706944,5505152,565248,82560,9006080,1792
.long 3072,11264,19456,27648,35840,44032,52224,2048,10240,18432,26624,34816,43008,51200,266240,9280512
.long 30720,31744,272256,66560,1705248,2032928,4532224,616704,8445952,10928128,10706944,5505184,565248,103040,9008128,1920
.long 5120,13312,21504,29696,37888,46080,54272,4096,12288,20480,28672,36864,45056,53248,266240,9282560
.long 250880,249856,276224,67072,2360608,2688288,4534272,534912,8445952,10928128,10706944,5505216,565248,123520,9281536,1792
.long 7168,15360,23552,31744,39936,48128,268435456,6144,14336,22528,30720,38912,47104,268436480,266240,9284608
.long 252928,251904,276352,67072,3015968,3343648,4536320,616832,8445952,10928128,10706944,5505248,565248,144000,9283584,1920
.long 1024,9216,17408,25600,33792,41984,50176,0,8192,16384,24576,32768,40960,49152,299008,7351296
.long 0,1024,303104,70656,1051168,1378848,4857856,545024,7340032,12697600,12476416,4195456,524288,737280,7350272,0
.long 3072,11264,19456,27648,35840,44032,52224,2048,10240,18432,26624,34816,43008,51200,299008,7353344
.long 2048,3072,303232,70656,1706528,2034208,4859904,626944,7340032,12697600,12476416,4195488,524288,757760,7352320,128
.long 5120,13312,21504,29696,37888,46080,54272,4096,12288,20480,28672,36864,45056,53248,299008,7626752
.long 222208,221184,307200,71168,2361888,2689568,4861952,545152,7340032,12697600,12476416,4195520,524288,778240,7354368,0
.long 7168,15360,23552,31744,39936,48128,268435456,6144,14336,22528,30720,38912,47104,268436480,299008,7628800
.long 224256,223232,307328,71168,3017248,3344928,4864000,627072,7340032,12697600,12476416,4195552,524288,798720,7627776,128
.long 1024,9216,17408,25600,33792,41984,50176,0,8192,16384,24576,32768,40960,49152,299008,7630848
.long 28672,29696,304896,70656,1052448,1380128,5185536,555264,8445952,12697600,12476416,5506176,565248,737920,7629824,1792
.long 3072,11264,19456,27648,35840,44032,52224,2048,10240,18432,26624,34816,43008,51200,299008,7904256
.long 30720,31744,305024,70656,1707808,2035488,5187584,637184,8445952,12697600,12476416,5506208,565248,758400,7903232,1920
.long 5120,13312,21504,29696,37888,46080,54272,4096,12288,20480,28672,36864,45056,53248,299008,7906304
.long 250880,249856,308992,71168,2363168,2690848,5189632,555392,8445952,12697600,12476416,5506240,565248,778880,7905280,1792
.long 7168,15360,23552,31744,39936,48128,268435456,6144,14336,22528,30720,38912,47104,268436480,299008,8179712
.long 252928,251904,309120,71168,3018528,3346208,5191680,637312,8445952,12697600,12476416,5506272,565248,799360,7907328,1920
.long 1024,9216,17408,25600,33792,41984,50176,0,8192,16384,24576,32768,40960,49152,331776,8181760
.long 0,1024,335872,74752,1053728,1381408,5513216,565504,7340032,14467072,14245888,4196480,606208,1392640,8180736,0
.long 3072,11264,19456,27648,35840,44032,52224,2048,10240,18432,26624,34816,43008,51200,331776,8183808
.long 2048,3072,336000,74752,1709088,2036768,5515264,647424,7340032,14467072,14245888,4196512,606208,1413120,8182784,128
.long 5120,13312,21504,29696,37888,46080,54272,4096,12288,20480,28672,36864,45056,53248,331776,8457216
.long 222208,221184,339968,75264,2364448,2692128,5517312,565632,7340032,14467072,14245888,4196544,606208,1433600,8456192,0
.long 7168,15360,23552,31744,39936,48128,268435456,6144,14336,22528,30720,38912,47104,268436480,331776,8459264
.long 224256,223232,340096,75264,3019808,3347488,5519360,647552,7340032,14467072,14245888,4196576,606208,1454080,8458240,128
.long 1024,9216,17408,25600,33792,41984,50176,0,8192,16384,24576,32768,40960,49152,331776,8732672
.long 28672,29696,337664,74752,1055008,1382688,5840896,575744,8445952,14467072,14245888,5507200,647168,1393280,8460288,1792
.long 3072,11264,19456,27648,35840,44032,52224,2048,10240,18432,26624,34816,43008,51200,331776,8734720
.long 30720,31744,337792,74752,1710368,2038048,5842944,657664,8445952,14467072,14245888,5507232,647168,1413760,8733696,1920
.long 5120,13312,21504,29696,37888,46080,54272,4096,12288,20480,28672,36864,45056,53248,331776,8736768
.long 250880,249856,341760,75264,2365728,2693408,5844992,575872,8445952,14467072,14245888,5507264,647168,1434240,8735744,1792
.long 7168,15360,23552,31744,39936,48128,268435456,6144,14336,22528,30720,38912,47104,268436480,331776,9010176
.long 252928,251904,341888,75264,3021088,3348768,5847040,657792,8445952,14467072,14245888,5507296,647168,1454720,9009152,1920
.long 1024,9216,17408,25600,33792,41984,50176,0,8192,16384,24576,32768,40960,49152,364544,9012224
.long 0,1024,368640,78848,1056288,1383968,6168576,585984,7340032,16236544,16015360,4197504,606208,2048000,9011200,0
.long 3072,11264,19456,27648,35840,44032,52224,2048,10240,18432,26624,34816,43008,51200,364544,9285632
.long 2048,3072,368768,78848,1711648,2039328,6170624,667904,7340032,16236544,16015360,4197536,606208,2068480,9013248,128
.long 5120,13312,21504,29696,37888,46080,54272,4096,12288,20480,28672,36864,45056,53248,364544,9287680
.long 222208,221184,372736,79360,2367008,2694688,6172672,586112,7340032,16236544,16015360,4197568,606208,2088960,9286656,0
.long 7168,15360,23552,31744,39936,48128,268435456,6144,14336,22528,30720,38912,47104,268436480,364544,9289728
.long 224256,223232,372864,79360,3022368,3350048,6174720,668032,7340032,16236544,16015360,4197600,606208,2109440,9288704,128
.long 1024,9216,17408,25600,33792,41984,50176,0,8192,16384,24576,32768,40960,49152,364544,7356416
.long 28672,29696,370432,78848,1057568,1385248,6496256,596224,8445952,16236544,16015360,5508224,647168,2048640,7355392,1792
.long 3072,11264,19456,27648,35840,44032,52224,2048,10240,18432,26624,34816,43008,51200,364544,7358464
.long 30720,31744,370560,78848,1712928,2040608,6498304,678144,8445952,16236544,16015360,5508256,647168,2069120,7357440,1920
.long 5120,13312,21504,29696,37888,46080,54272,4096,12288,20480,28672,36864,45056,53248,364544,7631872
.long 250880,249856,374528,79360,2368288,2695968,6500352,596352,8445952,16236544,16015360,5508288,647168,2089600,7359488,1792
.long 7168,15360,23552,31744,39936,48128,268435456,6144,14336,22528,30720,38912,47104,268436480,364544,7633920
.long 252928,251904,374656,79360,3023648,3351328,6502400,678272,8445952,16236544,16015360,5508320,647168,2110080,7632896,1920
.long 0,8192,16384,24576,32768,40960,49152,1024,9216,17408,25600,33792,41984,50176,270336,7635968
.long 0,1024,278528,67584,1048640,1376320,4210688,524800,7340032,11370496,10928128,4194560,524288,163840,7634944,0
.long 2048,10240,18432,26624,34816,43008,51200,3072,11264,19456,27648,35840,44032,52224,270336,7909376
.long 2048,3072,278656,67584,1704000,2031680,4212736,606720,7340032,11370496,10928128,4194592,524288,184320,7908352,128
.long 4096,12288,20480,28672,36864,45056,53248,5120,13312,21504,29696,37888,46080,54272,270336,7911424
.long 222208,221184,282624,68096,2359360,2687040,4214784,524928,7340032,11370496,10928128,4194624,524288,204800,7910400,0
.long 6144,14336,22528,30720,38912,47104,268435456,7168,15360,23552,31744,39936,48128,268436480,270336,8184832
.long 224256,223232,282752,68096,3014720,3342400,4216832,606848,7340032,11370496,10928128,4194656,524288,225280,7912448,128
.long 0,8192,16384,24576,32768,40960,49152,1024,9216,17408,25600,33792,41984,50176,270336,8186880
.long 28672,29696,280320,67584,1049920,1377600,4538368,535040,8445952,11370496,10928128,5505280,565248,164480,8185856,1792
.long 2048,10240,18432,26624,34816,43008,51200,3072,11264,19456,27648,35840,44032,52224,270336,8188928
.long 30720,31744,280448,67584,1705280,2032960,4540416,616960,8445952,11370496,10928128,5505312,565248,184960,8187904,1920
.long 4096,12288,20480,28672,36864,45056,53248,5120,13312,21504,29696,37888,46080,54272,270336,8462336
.long 250880,249856,284416,68096,2360640,2688320,4542464,535168,8445952,11370496,10928128,5505344,565248,205440,8461312,1792
.long 6144,14336,22528,30720,38912,47104,268435456,7168,15360,23552,31744,39936,48128,268436480,270336,8464384
.long 252928,251904,284544,68096,3016000,3343680,4544512,617088,8445952,11370496,10928128,5505376,565248,225920,8463360,1920
.long 0,8192,16384,24576,32768,40960,49152,1024,9216,17408,25600,33792,41984,50176,303104,8737792
.long 0,1024,311296,71680,1051200,1378880,4866048,545280,7340032,13139968,12697600,4195584,524288,819200,8465408,0
.long 2048,10240,18432,26624,34816,43008,51200,3072,11264,19456,27648,35840,44032,52224,303104,8739840
.long 2048,3072,311424,71680,1706560,2034240,4868096,627200,7340032,13139968,12697600,4195616,524288,839680,8738816,128
.long 4096,12288,20480,28672,36864,45056,53248,5120,13312,21504,29696,37888,46080,54272,303104,8741888
.long 222208,221184,315392,72192,2361920,2689600,4870144,545408,7340032,13139968,12697600,4195648,524288,860160,8740864,0
.long 6144,14336,22528,30720,38912,47104,268435456,7168,15360,23552,31744,39936,48128,268436480,303104,9015296
.long 224256,223232,315520,72192,3017280,3344960,4872192,627328,7340032,13139968,12697600,4195680,524288,880640,9014272,128
.long 0,8192,16384,24576,32768,40960,49152,1024,9216,17408,25600,33792,41984,50176,303104,9017344
.long 28672,29696,313088,71680,1052480,1380160,5193728,555520,8445952,13139968,12697600,5506304,565248,819840,9016320,1792
.long 2048,10240,18432,26624,34816,43008,51200,3072,11264,19456,27648,35840,44032,52224,303104,9290752
.long 30720,31744,313216,71680,1707840,2035520,5195776,637440,8445952,13139968,12697600,5506336,565248,840320,9018368,1920
.long 4096,12288,20480,28672,36864,45056,53248,5120,13312,21504,29696,37888,46080,54272,303104,9292800
.long 250880,249856,317184,72192,2363200,2690880,5197824,555648,8445952,13139968,12697600,5506368,565248,860800,9291776,1792
.long 6144,14336,22528,30720,38912,47104,268435456,7168,15360,23552,31744,39936,48128,268436480,303104,9294848
.long 252928,251904,317312,72192,3018560,3346240,5199872,637568,8445952,13139968,12697600,5506400,565248,881280,9293824,1920
.long 0,8192,16384,24576,32768,40960,49152,1024,9216,17408,25600,33792,41984,50176,335872,7361536
.long 0,1024,344064,75776,1053760,1381440,5521408,565760,7340032,14909440,14467072,4196608,606208,1474560,7360512,0
.long 2048,10240,18432,26624,34816,43008,51200,3072,11264,19456,27648,35840,44032,52224,335872,7363584
.long 2048,3072,344192,75776,1709120,2036800,5523456,647680,7340032,14909440,14467072,4196640,606208,1495040,7362560,128
.long 4096,12288,20480,28672,36864,45056,53248,5120,13312,21504,29696,37888,46080,54272,335872,7636992
.long 222208,221184,348160,76288,2364480,2692160,5525504,565888,7340032,14909440,14467072,4196672,606208,1515520,7364608,0
.long 6144,14336,22528,30720,38912,47104,268435456,7168,15360,23552,31744,39936,48128,268436480,335872,7639040
.long 224256,223232,348288,76288,3019840,3347520,5527552,647808,7340032,14909440,14467072,4196704,606208,1536000,7638016,128
.long 0,8192,16384,24576,32768,40960,49152,1024,9216,17408,25600,33792,41984,50176,335872,7641088
.long 28672,29696,345856,75776,1055040,1382720,5849088,576000,8445952,14909440,14467072,5507328,647168,1475200,7640064,1792
.long 2048,10240,18432,26624,34816,43008,51200,3072,11264,19456,27648,35840,44032,52224,335872,7914496
.long 30720,31744,345984,75776,1710400,2038080,5851136,657920,8445952,14909440,14467072,5507360,647168,1495680,7913472,1920
.long 4096,12288,20480,28672,36864,45056,53248,5120,13312,21504,29696,37888,46080,54272,335872,7916544
.long 250880,249856,349952,76288,2365760,2693440,5853184,576128,8445952,14909440,14467072,5507392,647168,1516160,7915520,1792
.long 6144,14336,22528,30720,38912,47104,268435456,7168,15360,23552,31744,39936,48128,268436480,335872,8189952
.long 252928,251904,350080,76288,3021120,3348800,5855232,658048,8445952,14909440,14467072,5507424,647168,1536640,7917568,1920
.long 0,8192,16384,24576,32768,40960,49152,1024,9216,17408,25600,33792,41984,50176,368640,8192000
.long 0,1024,376832,79872,1056320,1384000,6176768,586240,7340032,16678912,16236544,4197632,606208,2129920,8190976,0
.long 2048,10240,18432,26624,34816,43008,51200,3072,11264,19456,27648,35840,44032,52224,368640,8194048
.long 2048,3072,376960,79872,1711680,2039360,6178816,668160,7340032,16678912,16236544,4197664,606208,2150400,8193024,128
.long 4096,12288,20480,28672,36864,45056,53248,5120,13312,21504,29696,37888,46080,54272,368640,8467456
.long 222208,221184,380928,80384,2367040,2694720,6180864,586368,7340032,16678912,16236544,4197696,606208,2170880,8466432,0
.long 6144,14336,22528,30720,38912,47104,268435456,7168,15360,23552,31744,39936,48128,268436480,368640,8469504
.long 224256,223232,381056,80384,3022400,3350080,6182912,668288,7340032,16678912,16236544,4197728,606208,2191360,8468480,128
.long 0,8192,16384,24576,32768,40960,49152,1024,9216,17408,25600,33792,41984,50176,368640,8742912
.long 28672,29696,378624,79872,1057600,1385280,6504448,596480,8445952,16678912,16236544,5508352,647168,2130560,8470528,1792
.long 2048,10240,18432,26624,34816,43008,51200,3072,11264,19456,27648,35840,44032,52224,368640,8744960
.long 30720,31744,378752,79872,1712960,2040640,6506496,678400,8445952,16678912,16236544,5508384,647168,2151040,8743936,1920
.long 4096,12288,20480,28672,36864,45056,53248,5120,13312,21504,29696,37888,46080,54272,368640,8747008
.long 250880,249856,382720,80384,2368320,2696000,6508544,596608,8445952,16678912,16236544,5508416,647168,2171520,8745984,1792
.long 6144,14336,22528,30720,38912,47104,268435456,7168,15360,23552,31744,39936,48128,268436480,368640,9020416
.long 252928,251904,382848,80384,3023680,3351360,6510592,678528,8445952,16678912,16236544,5508448,647168,2192000,9019392,1920
.long 1024,9216,17408,25600,33792,41984,50176,0,8192,16384,24576,32768,40960,49152,274432,9022464
.long 0,1024,286720,68608,1048672,1376352,4218880,525056,7340032,11812864,11149312,4194688,524288,245760,9021440,0
.long 3072,11264,19456,27648,35840,44032,52224,2048,10240,18432,26624,34816,43008,51200,274432,9295872
.long 2048,3072,286848,68608,1704032,2031712,4220928,606976,7340032,11812864,11149312,4194720,524288,266240,9023488,128
.long 5120,13312,21504,29696,37888,46080,54272,4096,12288,20480,28672,36864,45056,53248,274432,9297920
.long 222208,221184,290816,69120,2359392,2687072,4222976,525184,7340032,11812864,11149312,4194752,524288,286720,9296896,0
.long 7168,15360,23552,31744,39936,48128,268435456,6144,14336,22528,30720,38912,47104,268436480,274432,9299968
.long 224256,223232,290944,69120,3014752,3342432,4225024,607104,7340032,11812864,11149312,4194784,524288,307200,9298944,128
.long 1024,9216,17408,25600,33792,41984,50176,0,8192,16384,24576,32768,40960,49152,274432,7366656
.long 28672,29696,288512,68608,1049952,1377632,4546560,535296,8445952,11812864,11149312,5505408,565248,246400,7365632,1792
.long 3072,11264,19456,27648,35840,44032,52224,2048,10240,18432,26624,34816,43008,51200,274432,7368704
.long 30720,31744,288640,68608,1705312,2032992,4548608,617216,8445952,11812864,11149312,5505440,565248,266880,7367680,1920
.long 5120,13312,21504,29696,37888,46080,54272,4096,12288,20480,28672,36864,45056,53248,274432,7642112
.long 250880,249856,292608,69120,2360672,2688352,4550656,535424,8445952,11812864,11149312,5505472,565248,287360,7369728,1792
.long 7168,15360,23552,31744,39936,48128,268435456,6144,14336,22528,30720,38912,47104,268436480,274432,7644160
.long 252928,251904,292736,69120,3016032,3343712,4552704,617344,8445952,11812864,11149312,5505504,565248,307840,7643136,1920
.long 1024,9216,17408,25600,33792,41984,50176,0,8192,16384,24576,32768,40960,49152,307200,7646208
.long 0,1024,319488,72704,1051232,1378912,4874240,545536,7340032,13582336,12918784,4195712,524288,901120,7645184,0
.long 3072,11264,19456,27648,35840,44032,52224,2048,10240,18432,26624,34816,43008,51200,307200,7919616
.long 2048,3072,319616,72704,1706592,2034272,4876288,627456,7340032,13582336,12918784,4195744,524288,921600,7918592,128
.long 5120,13312,21504,29696,37888,46080,54272,4096,12288,20480,28672,36864,45056,53248,307200,7921664
.long 222208,221184,323584,73216,2361952,2689632,4878336,545664,7340032,13582336,12918784,4195776,524288,942080,7920640,0
.long 7168,15360,23552,31744,39936,48128,268435456,6144,14336,22528,30720,38912,47104,268436480,307200,8195072
.long 224256,223232,323712,73216,3017312,3344992,4880384,627584,7340032,13582336,12918784,4195808,524288,962560,7922688,128
.long 1024,9216,17408,25600,33792,41984,50176,0,8192,16384,24576,32768,40960,49152,307200,8197120
.long 28672,29696,321280,72704,1052512,1380192,5201920,555776,8445952,13582336,12918784,5506432,565248,901760,8196096,1792
.long 3072,11264,19456,27648,35840,44032,52224,2048,10240,18432,26624,34816,43008,51200,307200,8199168
.long 30720,31744,321408,72704,1707872,2035552,5203968,637696,8445952,13582336,12918784,5506464,565248,922240,8198144,1920
.long 5120,13312,21504,29696,37888,46080,54272,4096,12288,20480,28672,36864,45056,53248,307200,8472576
.long 250880,249856,325376,73216,2363232,2690912,5206016,555904,8445952,13582336,12918784,5506496,565248,942720,8471552,1792
.long 7168,15360,23552,31744,39936,48128,268435456,6144,14336,22528,30720,38912,47104,268436480,307200,8474624
.long 252928,251904,325504,73216,3018592,3346272,5208064,637824,8445952,13582336,12918784,5506528,565248,963200,8473600,1920
.long 1024,9216,17408,25600,33792,41984,50176,0,8192,16384,24576,32768,40960,49152,339968,8748032
.long 0,1024,352256,76800,1053792,1381472,5529600,566016,7340032,15351808,14688256,4196736,606208,1556480,8475648,0
.long 3072,11264,19456,27648,35840,44032,52224,2048,10240,18432,26624,34816,43008,51200,339968,8750080
.long 2048,3072,352384,76800,1709152,2036832,5531648,647936,7340032,15351808,14688256,4196768,606208,1576960,8749056,128
.long 5120,13312,21504,29696,37888,46080,54272,4096,12288,20480,28672,36864,45056,53248,339968,8752128
.long 222208,221184,356352,77312,2364512,2692192,5533696,566144,7340032,15351808,14688256,4196800,606208,1597440,8751104,0
.long 7168,15360,23552,31744,39936,48128,268435456,6144,14336,22528,30720,38912,47104,268436480,339968,9025536
.long 224256,223232,356480,77312,3019872,3347552,5535744,648064,7340032,15351808,14688256,4196832,606208,1617920,9024512,128
.long 1024,9216,17408,25600,33792,41984,50176,0,8192,16384,24576,32768,40960,49152,339968,9027584
.long 28672,29696,354048,76800,1055072,1382752,5857280,576256,8445952,15351808,14688256,5507456,647168,1557120,9026560,1792
.long 3072,11264,19456,27648,35840,44032,52224,2048,10240,18432,26624,34816,43008,51200,339968,9300992
.long 30720,31744,354176,76800,1710432,2038112,5859328,658176,8445952,15351808,14688256,5507488,647168,1577600,9028608,1920
.long 5120,13312,21504,29696,37888,46080,54272,4096,12288,20480,28672,36864,45056,53248,339968,9303040
.long 250880,249856,358144,77312,2365792,2693472,5861376,576384,8445952,15351808,14688256,5507520,647168,1598080,9302016,1792
.long 7168,15360,23552,31744,39936,48128,268435456,6144,14336,22528,30720,38912,47104,268436480,339968,9305088
.long 252928,251904,358272,77312,3021152,3348832,5863424,658304,8445952,15351808,14688256,5507552,647168,1618560,9304064,1920
.long 1024,9216,17408,25600,33792,41984,50176,0,8192,16384,24576,32768,40960,49152,372736,7371776
.long 0,1024,385024,80896,1056352,1384032,6184960,586496,7340032,17121280,16457728,4197760,606208,2211840,7370752,0
.long 3072,11264,19456,27648,35840,44032,52224,2048,10240,18432,26624,34816,43008,51200,372736,7373824
.long 2048,3072,385152,80896,1711712,2039392,6187008,668416,7340032,17121280,16457728,4197792,606208,2232320,7372800,128
.long 5120,13312,21504,29696,37888,46080,54272,4096,12288,20480,28672,36864,45056,53248,372736,7647232
.long 222208,221184,389120,81408,2367072,2694752,6189056,586624,7340032,17121280,16457728,4197824,606208,2252800,7374848,0
.long 7168,15360,23552,31744,39936,48128,268435456,6144,14336,22528,30720,38912,47104,268436480,372736,7649280
.long 224256,223232,389248,81408,3022432,3350112,6191104,668544,7340032,17121280,16457728,4197856,606208,2273280,7648256,128
.long 1024,9216,17408,25600,33792,41984,50176,0,8192,16384,24576,32768,40960,49152,372736,7651328
.long 28672,29696,386816,80896,1057632,1385312,6512640,596736,8445952,17121280,16457728,5508480,647168,2212480,7650304,1792
.long 3072,11264,19456,27648,35840,44032,52224,2048,10240,18432,26624,34816,43008,51200,372736,7924736
.long 30720,31744,386944,80896,1712992,2040672,6514688,678656,8445952,17121280,16457728,5508512,647168,2232960,7923712,1920
.long 5120,13312,21504,29696,37888,46080,54272,4096,12288,20480,28672,36864,45056,53248,372736,7926784
.long 250880,249856,390912,81408,2368352,2696032,6516736,596864,8445952,17121280,16457728,5508544,647168,2253440,7925760,1792
.long 7168,15360,23552,31744,39936,48128,268435456,6144,14336,22528,30720,38912,47104,268436480,372736,8200192
.long 252928,251904,391040,81408,3023712,3351392,6518784,678784,8445952,17121280,16457728,5508576,647168,2273920,7927808,1920
.long 0,8192,16384,24576,32768,40960,49152,1024,9216,17408,25600,33792,41984,50176,278528,8202240
.long 4096,5120,262400,65536,1048704,1376384,4227072,525312,7340032,10485760,11370496,4194816,524288,327680,8201216,256
.long 2048,10240,18432,26624,34816,43008,51200,3072,11264,19456,27648,35840,44032,52224,278528,8204288
.long 6144,7168,262528,65536,1704064,2031744,4229120,607232,7340032,10485760,11370496,4194848,524288,348160,8203264,384
.long 4096,12288,20480,28672,36864,45056,53248,5120,13312,21504,29696,37888,46080,54272,278528,8477696
.long 226304,225280,266496,66048,2359424,2687104,4231168,525440,7340032,10485760,11370496,4194880,524288,368640,8476672,256
.long 6144,14336,22528,30720,38912,47104,268435456,7168,15360,23552,31744,39936,48128,268436480,278528,8479744
.long 228352,227328,266624,66048,3014784,3342464,4233216,607360,7340032,10485760,11370496,4194912,524288,389120,8478720,384
.long 0,8192,16384,24576,32768,40960,49152,1024,9216,17408,25600,33792,41984,50176,278528,8753152
.long 32768,33792,264192,65536,1049984,1377664,4554752,535552,8445952,10485760,11370496,5505536,565248,328320,8480768,2048
.long 2048,10240,18432,26624,34816,43008,51200,3072,11264,19456,27648,35840,44032,52224,278528,8755200
.long 34816,35840,264320,65536,1705344,2033024,4556800,617472,8445952,10485760,11370496,5505568,565248,348800,8754176,2176
.long 4096,12288,20480,28672,36864,45056,53248,5120,13312,21504,29696,37888,46080,54272,278528,8757248
.long 254976,253952,268288,66048,2360704,2688384,4558848,535680,8445952,10485760,11370496,5505600,565248,369280,8756224,2048
.long 6144,14336,22528,30720,38912,47104,268435456,7168,15360,23552,31744,39936,48128,268436480,278528,9030656
.long 257024,256000,268416,66048,3016064,3343744,4560896,617600,8445952,10485760,11370496,5505632,565248,389760,9029632,2176
.long 0,8192,16384,24576,32768,40960,49152,1024,9216,17408,25600,33792,41984,50176,311296,9032704
.long 4096,5120,295168,69632,1051264,1378944,4882432,545792,7340032,12255232,13139968,4195840,524288,983040,9031680,256
.long 2048,10240,18432,26624,34816,43008,51200,3072,11264,19456,27648,35840,44032,52224,311296,9306112
.long 6144,7168,295296,69632,1706624,2034304,4884480,627712,7340032,12255232,13139968,4195872,524288,1003520,9033728,384
.long 4096,12288,20480,28672,36864,45056,53248,5120,13312,21504,29696,37888,46080,54272,311296,9308160
.long 226304,225280,299264,70144,2361984,2689664,4886528,545920,7340032,12255232,13139968,4195904,524288,1024000,9307136,256
.long 6144,14336,22528,30720,38912,47104,268435456,7168,15360,23552,31744,39936,48128,268436480,311296,9310208
.long 228352,227328,299392,70144,3017344,3345024,4888576,627840,7340032,12255232,13139968,4195936,524288,1044480,9309184,384
.long 0,8192,16384,24576,32768,40960,49152,1024,9216,17408,25600,33792,41984,50176,311296,7376896
.long 32768,33792,296960,69632,1052544,1380224,5210112,556032,8445952,12255232,13139968,5506560,565248,983680,7375872,2048
.long 2048,10240,18432,26624,34816,43008,51200,3072,11264,19456,27648,35840,44032,52224,311296,7378944
.long 34816,35840,297088,69632,1707904,2035584,5212160,637952,8445952,12255232,13139968,5506592,565248,1004160,7377920,2176
.long 4096,12288,20480,28672,36864,45056,53248,5120,13312,21504,29696,37888,46080,54272,311296,7652352
.long 254976,253952,301056,70144,2363264,2690944,5214208,556160,8445952,12255232,13139968,5506624,565248,1024640,7379968,2048
.long 6144,14336,22528,30720,38912,47104,268435456,7168,15360,23552,31744,39936,48128,268436480,311296,7654400
.long 257024,256000,301184,70144,3018624,3346304,5216256,638080,8445952,12255232,13139968,5506656,565248,1045120,7653376,2176
.long 0,8192,16384,24576,32768,40960,49152,1024,9216,17408,25600,33792,41984,50176,344064,7656448
.long 4096,5120,327936,73728,1053824,1381504,5537792,566272,7340032,14024704,14909440,4196864,606208,1638400,7655424,256
.long 2048,10240,18432,26624,34816,43008,51200,3072,11264,19456,27648,35840,44032,52224,344064,7929856
.long 6144,7168,328064,73728,1709184,2036864,5539840,648192,7340032,14024704,14909440,4196896,606208,1658880,7928832,384
.long 4096,12288,20480,28672,36864,45056,53248,5120,13312,21504,29696,37888,46080,54272,344064,7931904
.long 226304,225280,332032,74240,2364544,2692224,5541888,566400,7340032,14024704,14909440,4196928,606208,1679360,7930880,256
.long 6144,14336,22528,30720,38912,47104,268435456,7168,15360,23552,31744,39936,48128,268436480,344064,8205312
.long 228352,227328,332160,74240,3019904,3347584,5543936,648320,7340032,14024704,14909440,4196960,606208,1699840,7932928,384
.long 0,8192,16384,24576,32768,40960,49152,1024,9216,17408,25600,33792,41984,50176,344064,8207360
.long 32768,33792,329728,73728,1055104,1382784,5865472,576512,8445952,14024704,14909440,5507584,647168,1639040,8206336,2048
.long 2048,10240,18432,26624,34816,43008,51200,3072,11264,19456,27648,35840,44032,52224,344064,8209408
.long 34816,35840,329856,73728,1710464,2038144,5867520,658432,8445952,14024704,14909440,5507616,647168,1659520,8208384,2176
.long 4096,12288,20480,28672,36864,45056,53248,5120,13312,21504,29696,37888,46080,54272,344064,8482816
.long 254976,253952,333824,74240,2365824,2693504,5869568,576640,8445952,14024704,14909440,5507648,647168,1680000,8481792,2048
.long 6144,14336,22528,30720,38912,47104,268435456,7168,15360,23552,31744,39936,48128,268436480,344064,8484864
.long 257024,256000,333952,74240,3021184,3348864,5871616,658560,8445952,14024704,14909440,5507680,647168,1700480,8483840,2176
.long 0,8192,16384,24576,32768,40960,49152,1024,9216,17408,25600,33792,41984,50176,376832,8758272
.long 4096,5120,360704,77824,1056384,1384064,6193152,586752,7340032,15794176,16678912,4197888,606208,2293760,8485888,256
.long 2048,10240,18432,26624,34816,43008,51200,3072,11264,19456,27648,35840,44032,52224,376832,8760320
.long 6144,7168,360832,77824,1711744,2039424,6195200,668672,7340032,15794176,16678912,4197920,606208,2314240,8759296,384
.long 4096,12288,20480,28672,36864,45056,53248,5120,13312,21504,29696,37888,46080,54272,376832,8762368
.long 226304,225280,364800,78336,2367104,2694784,6197248,586880,7340032,15794176,16678912,4197952,606208,2334720,8761344,256
.long 6144,14336,22528,30720,38912,47104,268435456,7168,15360,23552,31744,39936,48128,268436480,376832,9035776
.long 228352,227328,364928,78336,3022464,3350144,6199296,668800,7340032,15794176,16678912,4197984,606208,2355200,9034752,384
.long 0,8192,16384,24576,32768,40960,49152,1024,9216,17408,25600,33792,41984,50176,376832,9037824
.long 32768,33792,362496,77824,1057664,1385344,6520832,596992,8445952,15794176,16678912,5508608,647168,2294400,9036800,2048
.long 2048,10240,18432,26624,34816,43008,51200,3072,11264,19456,27648,35840,44032,52224,376832,9311232
.long 34816,35840,362624,77824,1713024,2040704,6522880,678912,8445952,15794176,16678912,5508640,647168,2314880,9038848,2176
.long 4096,12288,20480,28672,36864,45056,53248,5120,13312,21504,29696,37888,46080,54272,376832,9313280
.long 254976,253952,366592,78336,2368384,2696064,6524928,597120,8445952,15794176,16678912,5508672,647168,2335360,9312256,2048
.long 6144,14336,22528,30720,38912,47104,268435456,7168,15360,23552,31744,39936,48128,268436480,376832,9315328
.long 257024,256000,366720,78336,3023744,3351424,6526976,679040,8445952,15794176,16678912,5508704,647168,2355840,9314304,2176
.long 1024,9216,17408,25600,33792,41984,50176,0,8192,16384,24576,32768,40960,49152,282624,7382016
.long 4096,5120,270592,66560,1048736,1376416,4235264,525568,7340032,10928128,11591680,4194944,524288,409600,7380992,256
.long 3072,11264,19456,27648,35840,44032,52224,2048,10240,18432,26624,34816,43008,51200,282624,7384064
.long 6144,7168,270720,66560,1704096,2031776,4237312,607488,7340032,10928128,11591680,4194976,524288,430080,7383040,384
.long 5120,13312,21504,29696,37888,46080,54272,4096,12288,20480,28672,36864,45056,53248,282624,7657472
.long 226304,225280,274688,67072,2359456,2687136,4239360,525696,7340032,10928128,11591680,4195008,524288,450560,7385088,256
.long 7168,15360,23552,31744,39936,48128,268435456,6144,14336,22528,30720,38912,47104,268436480,282624,7659520
.long 228352,227328,274816,67072,3014816,3342496,4241408,607616,7340032,10928128,11591680,4195040,524288,471040,7658496,384
.long 1024,9216,17408,25600,33792,41984,50176,0,8192,16384,24576,32768,40960,49152,282624,7661568
.long 32768,33792,272384,66560,1050016,1377696,4562944,535808,8445952,10928128,11591680,5505664,565248,410240,7660544,2048
.long 3072,11264,19456,27648,35840,44032,52224,2048,10240,18432,26624,34816,43008,51200,282624,7934976
.long 34816,35840,272512,66560,1705376,2033056,4564992,617728,8445952,10928128,11591680,5505696,565248,430720,7933952,2176
.long 5120,13312,21504,29696,37888,46080,54272,4096,12288,20480,28672,36864,45056,53248,282624,7937024
.long 254976,253952,276480,67072,2360736,2688416,4567040,535936,8445952,10928128,11591680,5505728,565248,451200,7936000,2048
.long 7168,15360,23552,31744,39936,48128,268435456,6144,14336,22528,30720,38912,47104,268436480,282624,8210432
.long 257024,256000,276608,67072,3016096,3343776,4569088,617856,8445952,10928128,11591680,5505760,565248,471680,7938048,2176
.long 1024,9216,17408,25600,33792,41984,50176,0,8192,16384,24576,32768,40960,49152,315392,8212480
.long 4096,5120,303360,70656,1051296,1378976,4890624,546048,7340032,12697600,13361152,4195968,524288,1064960,8211456,256
.long 3072,11264,19456,27648,35840,44032,52224,2048,10240,18432,26624,34816,43008,51200,315392,8214528
.long 6144,7168,303488,70656,1706656,2034336,4892672,627968,7340032,12697600,13361152,4196000,524288,1085440,8213504,384
.long 5120,13312,21504,29696,37888,46080,54272,4096,12288,20480,28672,36864,45056,53248,315392,8487936
.long 226304,225280,307456,71168,2362016,2689696,4894720,546176,7340032,12697600,13361152,4196032,524288,1105920,8486912,256
.long 7168,15360,23552,31744,39936,48128,268435456,6144,14336,22528,30720,38912,47104,268436480,315392,8489984
.long 228352,227328,307584,71168,3017376,3345056,4896768,628096,7340032,12697600,13361152,4196064,524288,1126400,8488960,384
.long 1024,9216,17408,25600,33792,41984,50176,0,8192,16384,24576,32768,40960,49152,315392,8763392
.long 32768,33792,305152,70656,1052576,1380256,5218304,556288,8445952,12697600,13361152,5506688,565248,1065600,8491008,2048
.long 3072,11264,19456,27648,35840,44032,52224,2048,10240,18432,26624,34816,43008,51200,315392,8765440
.long 34816,35840,305280,70656,1707936,2035616,5220352,638208,8445952,12697600,13361152,5506720,565248,1086080,8764416,2176
.long 5120,13312,21504,29696,37888,46080,54272,4096,12288,20480,28672,36864,45056,53248,315392,8767488
.long 254976,253952,309248,71168,2363296,2690976,5222400,556416,8445952,12697600,13361152,5506752,565248,1106560,8766464,2048
.long 7168,15360,23552,31744,39936,48128,268435456,6144,14336,22528,30720,38912,47104,268436480,315392,9040896
.long 257024,256000,309376,71168,3018656,3346336,5224448,638336,8445952,12697600,13361152,5506784,565248,1127040,9039872,2176
.long 1024,9216,17408,25600,33792,41984,50176,0,8192,16384,24576,32768,40960,49152,348160,9042944
.long 4096,5120,336128,74752,1053856,1381536,5545984,566528,7340032,14467072,15130624,4196992,606208,1720320,9041920,256
.long 3072,11264,19456,27648,35840,44032,52224,2048,10240,18432,26624,34816,43008,51200,348160,9316352
.long 6144,7168,336256,74752,1709216,2036896,5548032,648448,7340032,14467072,15130624,4197024,606208,1740800,9043968,384
.long 5120,13312,21504,29696,37888,46080,54272,4096,12288,20480,28672,36864,45056,53248,348160,9318400
.long 226304,225280,340224,75264,2364576,2692256,5550080,566656,7340032,14467072,15130624,4197056,606208,1761280,9317376,256
.long 7168,15360,23552,31744,39936,48128,268435456,6144,14336,22528,30720,38912,47104,268436480,348160,9320448
.long 228352,227328,340352,75264,3019936,3347616,5552128,648576,7340032,14467072,15130624,4197088,606208,1781760,9319424,384
.long 1024,9216,17408,25600,33792,41984,50176,0,8192,16384,24576,32768,40960,49152,348160,7387136
.long 32768,33792,337920,74752,1055136,1382816,5873664,576768,8445952,14467072,15130624,5507712,647168,1720960,7386112,2048
.long 3072,11264,19456,27648,35840,44032,52224,2048,10240,18432,26624,34816,43008,51200,348160,7389184
.long 34816,35840,338048,74752,1710496,2038176,5875712,658688,8445952,14467072,15130624,5507744,647168,1741440,7388160,2176
.long 5120,13312,21504,29696,37888,46080,54272,4096,12288,20480,28672,36864,45056,53248,348160,7662592
.long 254976,253952,342016,75264,2365856,2693536,5877760,576896,8445952,14467072,15130624,5507776,647168,1761920,7390208,2048
.long 7168,15360,23552,31744,39936,48128,268435456,6144,14336,22528,30720,38912,47104,268436480,348160,7664640
.long 257024,256000,342144,75264,3021216,3348896,5879808,658816,8445952,14467072,15130624,5507808,647168,1782400,7663616,2176
.long 1024,9216,17408,25600,33792,41984,50176,0,8192,16384,24576,32768,40960,49152,380928,7666688
.long 4096,5120,368896,78848,1056416,1384096,6201344,587008,7340032,16236544,16900096,4198016,606208,2375680,7665664,256
.long 3072,11264,19456,27648,35840,44032,52224,2048,10240,18432,26624,34816,43008,51200,380928,7940096
.long 6144,7168,369024,78848,1711776,2039456,6203392,668928,7340032,16236544,16900096,4198048,606208,2396160,7939072,384
.long 5120,13312,21504,29696,37888,46080,54272,4096,12288,20480,28672,36864,45056,53248,380928,7942144
.long 226304,225280,372992,79360,2367136,2694816,6205440,587136,7340032,16236544,16900096,4198080,606208,2416640,7941120,256
.long 7168,15360,23552,31744,39936,48128,268435456,6144,14336,22528,30720,38912,47104,268436480,380928,8215552
.long 228352,227328,373120,79360,3022496,3350176,6207488,669056,7340032,16236544,16900096,4198112,606208,2437120,7943168,384
.long 1024,9216,17408,25600,33792,41984,50176,0,8192,16384,24576,32768,40960,49152,380928,8217600
.long 32768,33792,370688,78848,1057696,1385376,6529024,597248,8445952,16236544,16900096,5508736,647168,2376320,8216576,2048
.long 3072,11264,19456,27648,35840,44032,52224,2048,10240,18432,26624,34816,43008,51200,380928,8219648
.long 34816,35840,370816,78848,1713056,2040736,6531072,679168,8445952,16236544,16900096,5508768,647168,2396800,8218624,2176
.long 5120,13312,21504,29696,37888,46080,54272,4096,12288,20480,28672,36864,45056,53248,380928,8493056
.long 254976,253952,374784,79360,2368416,2696096,6533120,597376,8445952,16236544,16900096,5508800,647168,2417280,8492032,2048
.long 7168,15360,23552,31744,39936,48128,268435456,6144,14336,22528,30720,38912,47104,268436480,380928,8495104
.long 257024,256000,374912,79360,3023776,3351456,6535168,679296,8445952,16236544,16900096,5508832,647168,2437760,8494080,2176
.long 0,8192,16384,24576,32768,40960,49152,1024,9216,17408,25600,33792,41984,50176,286720,8768512
.long 4096,5120,278784,67584,1048768,1376448,4243456,525824,7340032,11370496,11812864,4195072,524288,491520,8496128,256
.long 2048,10240,18432,26624,34816,43008,51200,3072,11264,19456,27648,35840,44032,52224,286720,8770560
.long 6144,7168,278912,67584,1704128,2031808,4245504,607744,7340032,11370496,11812864,4195104,524288,512000,8769536,384
.long 4096,12288,20480,28672,36864,45056,53248,5120,13312,21504,29696,37888,46080,54272,286720,8772608
.long 226304,225280,282880,68096,2359488,2687168,4247552,525952,7340032,11370496,11812864,4195136,524288,532480,8771584,256
.long 6144,14336,22528,30720,38912,47104,268435456,7168,15360,23552,31744,39936,48128,268436480,286720,9046016
.long 228352,227328,283008,68096,3014848,3342528,4249600,607872,7340032,11370496,11812864,4195168,524288,552960,9044992,384
.long 0,8192,16384,24576,32768,40960,49152,1024,9216,17408,25600,33792,41984,50176,286720,9048064
.long 32768,33792,280576,67584,1050048,1377728,4571136,536064,8445952,11370496,11812864,5505792,565248,492160,9047040,2048
.long 2048,10240,18432,26624,34816,43008,51200,3072,11264,19456,27648,35840,44032,52224,286720,9321472
.long 34816,35840,280704,67584,1705408,2033088,4573184,617984,8445952,11370496,11812864,5505824,565248,512640,9049088,2176
.long 4096,12288,20480,28672,36864,45056,53248,5120,13312,21504,29696,37888,46080,54272,286720,9323520
.long 254976,253952,284672,68096,2360768,2688448,4575232,536192,8445952,11370496,11812864,5505856,565248,533120,9322496,2048
.long 6144,14336,22528,30720,38912,47104,268435456,7168,15360,23552,31744,39936,48128,268436480,286720,9325568
.long 257024,256000,284800,68096,3016128,3343808,4577280,618112,8445952,11370496,11812864,5505888,565248,553600,9324544,2176
.long 0,8192,16384,24576,32768,40960,49152,1024,9216,17408,25600,33792,41984,50176,319488,7392256
.long 4096,5120,311552,71680,1051328,1379008,4898816,546304,7340032,13139968,13582336,4196096,524288,1146880,7391232,256
.long 2048,10240,18432,26624,34816,43008,51200,3072,11264,19456,27648,35840,44032,52224,319488,7394304
.long 6144,7168,311680,71680,1706688,2034368,4900864,628224,7340032,13139968,13582336,4196128,524288,1167360,7393280,384
.long 4096,12288,20480,28672,36864,45056,53248,5120,13312,21504,29696,37888,46080,54272,319488,7667712
.long 226304,225280,315648,72192,2362048,2689728,4902912,546432,7340032,13139968,13582336,4196160,524288,1187840,7395328,256
.long 6144,14336,22528,30720,38912,47104,268435456,7168,15360,23552,31744,39936,48128,268436480,319488,7669760
.long 228352,227328,315776,72192,3017408,3345088,4904960,628352,7340032,13139968,13582336,4196192,524288,1208320,7668736,384
.long 0,8192,16384,24576,32768,40960,49152,1024,9216,17408,25600,33792,41984,50176,319488,7671808
.long 32768,33792,313344,71680,1052608,1380288,5226496,556544,8445952,13139968,13582336,5506816,565248,1147520,7670784,2048
.long 2048,10240,18432,26624,34816,43008,51200,3072,11264,19456,27648,35840,44032,52224,319488,7945216
.long 34816,35840,313472,71680,1707968,2035648,5228544,638464,8445952,13139968,13582336,5506848,565248,1168000,7944192,2176
.long 4096,12288,20480,28672,36864,45056,53248,5120,13312,21504,29696,37888,46080,54272,319488,7947264
.long 254976,253952,317440,72192,2363328,2691008,5230592,556672,8445952,13139968,13582336,5506880,565248,1188480,7946240,2048
.long 6144,14336,22528,30720,38912,47104,268435456,7168,15360,23552,31744,39936,48128,268436480,319488,8220672
.long 257024,256000,317568,72192,3018688,3346368,5232640,638592,8445952,13139968,13582336,5506912,565248,1208960,7948288,2176
.long 0,8192,16384,24576,32768,40960,49152,1024,9216,17408,25600,33792,41984,50176,352256,8222720
.long 4096,5120,344320,75776,1053888,1381568,5554176,566784,7340032,14909440,15351808,4197120,606208,1802240,8221696,256
.long 2048,10240,18432,26624,34816,43008,51200,3072,11264,19456,27648,35840,44032,52224,352256,8224768
.long 6144,7168,344448,75776,1709248,2036928,5556224,648704,7340032,14909440,15351808,4197152,606208,1822720,8223744,384
.long 4096,12288,20480,28672,36864,45056,53248,5120,13312,21504,29696,37888,46080,54272,352256,8498176
.long 226304,225280,348416,76288,2364608,2692288,5558272,566912,7340032,14909440,15351808,4197184,606208,1843200,8497152,256
.long 6144,14336,22528,30720,38912,47104,268435456,7168,15360,23552,31744,39936,48128,268436480,352256,8500224
.long 228352,227328,348544,76288,3019968,3347648,5560320,648832,7340032,14909440,15351808,4197216,606208,1863680,8499200,384
.long 0,8192,16384,24576,32768,40960,49152,1024,9216,17408,25600,33792,41984,50176,352256,8773632
.long 32768,33792,346112,75776,1055168,1382848,5881856,577024,8445952,14909440,15351808,5507840,647168,1802880,8501248,2048
.long 2048,10240,18432,26624,34816,43008,51200,3072,11264,19456,27648,35840,44032,52224,352256,8775680
.long 34816,35840,346240,75776,1710528,2038208,5883904,658944,8445952,14909440,15351808,5507872,647168,1823360,8774656,2176
.long 4096,12288,20480,28672,36864,45056,53248,5120,13312,21504,29696,37888,46080,54272,352256,8777728
.long 254976,253952,350208,76288,2365888,2693568,5885952,577152,8445952,14909440,15351808,5507904,647168,1843840,8776704,2048
.long 6144,14336,22528,30720,38912,47104,268435456,7168,15360,23552,31744,39936,48128,268436480,352256,9051136
.long 257024,256000,350336,76288,3021248,3348928,5888000,659072,8445952,14909440,15351808,5507936,647168,1864320,9050112,2176
.long 0,8192,16384,24576,32768,40960,49152,1024,9216,17408,25600,33792,41984,50176,385024,9053184
.long 4096,5120,377088,79872,1056448,1384128,6209536,587264,7340032,16678912,17121280,4198144,606208,2457600,9052160,256
.long 2048,10240,18432,26624,34816,43008,51200,3072,11264,19456,27648,35840,44032,52224,385024,9326592
.long 6144,7168,377216,79872,1711808,2039488,6211584,669184,7340032,16678912,17121280,4198176,606208,2478080,9054208,384
.long 4096,12288,20480,28672,36864,45056,53248,5120,13312,21504,29696,37888,46080,54272,385024,9328640
.long 226304,225280,381184,80384,2367168,2694848,6213632,587392,7340032,16678912,17121280,4198208,606208,2498560,9327616,256
.long 6144,14336,22528,30720,38912,47104,268435456,7168,15360,23552,31744,39936,48128,268436480,385024,9330688
.long 228352,227328,381312,80384,3022528,3350208,6215680,669312,7340032,16678912,17121280,4198240,606208,2519040,9329664,384
.long 0,8192,16384,24576,32768,40960,49152,1024,9216,17408,25600,33792,41984,50176,385024,7397376
.long 32768,33792,378880,79872,1057728,1385408,6537216,597504,8445952,16678912,17121280,5508864,647168,2458240,7396352,2048
.long 2048,10240,18432,26624,34816,43008,51200,3072,11264,19456,27648,35840,44032,52224,385024,7399424
.long 34816,35840,379008,79872,1713088,2040768,6539264,679424,8445952,16678912,17121280,5508896,647168,2478720,7398400,2176
.long 4096,12288,20480,28672,36864,45056,53248,5120,13312,21504,29696,37888,46080,54272,385024,7672832
.long 254976,253952,382976,80384,2368448,2696128,6541312,597632,8445952,16678912,17121280,5508928,647168,2499200,7400448,2048
.long 6144,14336,22528,30720,38912,47104,268435456,7168,15360,23552,31744,39936,48128,268436480,385024,7674880
.long 257024,256000,383104,80384,3023808,3351488,6543360,679552,8445952,16678912,17121280,5508960,647168,2519680,7673856,2176
.long 1024,9216,17408,25600,33792,41984,50176,0,8192,16384,24576,32768,40960,49152,290816,7676928
.long 4096,5120,286976,68608,1048800,1376480,4251648,526080,7340032,11812864,12034048,4195200,524288,573440,7675904,256
.long 3072,11264,19456,27648,35840,44032,52224,2048,10240,18432,26624,34816,43008,51200,290816,7950336
.long 6144,7168,287104,68608,1704160,2031840,4253696,608000,7340032,11812864,12034048,4195232,524288,593920,7949312,384
.long 5120,13312,21504,29696,37888,46080,54272,4096,12288,20480,28672,36864,45056,53248,290816,7952384
.long 226304,225280,291072,69120,2359520,2687200,4255744,526208,7340032,11812864,12034048,4195264,524288,614400,7951360,256
.long 7168,15360,23552,31744,39936,48128,268435456,6144,14336,22528,30720,38912,47104,268436480,290816,8225792
.long 228352,227328,291200,69120,3014880,3342560,4257792,608128,7340032,11812864,12034048,4195296,524288,634880,7953408,384
.long 1024,9216,17408,25600,33792,41984,50176,0,8192,16384,24576,32768,40960,49152,290816,8227840
.long 32768,33792,288768,68608,1050080,1377760,4579328,536320,8445952,11812864,12034048,5505920,565248,574080,8226816,2048
.long 3072,11264,19456,27648,35840,44032,52224,2048,10240,18432,26624,34816,43008,51200,290816,8229888
.long 34816,35840,288896,68608,1705440,2033120,4581376,618240,8445952,11812864,12034048,5505952,565248,594560,8228864,2176
.long 5120,13312,21504,29696,37888,46080,54272,4096,12288,20480,28672,36864,45056,53248,290816,8503296
.long 254976,253952,292864,69120,2360800,2688480,4583424,536448,8445952,11812864,12034048,5505984,565248,615040,8502272,2048
.long 7168,15360,23552,31744,39936,48128,268435456,6144,14336,22528,30720,38912,47104,268436480,290816,8505344
.long 257024,256000,292992,69120,3016160,3343840,4585472,618368,8445952,11812864,12034048,5506016,565248,635520,8504320,2176
.long 1024,9216,17408,25600,33792,41984,50176,0,8192,16384,24576,32768,40960,49152,323584,8778752
.long 4096,5120,319744,72704,1051360,1379040,4907008,546560,7340032,13582336,13803520,4196224,524288,1228800,8506368,256
.long 3072,11264,19456,27648,35840,44032,52224,2048,10240,18432,26624,34816,43008,51200,323584,8780800
.long 6144,7168,319872,72704,1706720,2034400,4909056,628480,7340032,13582336,13803520,4196256,524288,1249280,8779776,384
.long 5120,13312,21504,29696,37888,46080,54272,4096,12288,20480,28672,36864,45056,53248,323584,8782848
.long 226304,225280,323840,73216,2362080,2689760,4911104,546688,7340032,13582336,13803520,4196288,524288,1269760,8781824,256
.long 7168,15360,23552,31744,39936,48128,268435456,6144,14336,22528,30720,38912,47104,268436480,323584,9056256
.long 228352,227328,323968,73216,3017440,3345120,4913152,628608,7340032,13582336,13803520,4196320,524288,1290240,9055232,384
.long 1024,9216,17408,25600,33792,41984,50176,0,8192,16384,24576,32768,40960,49152,323584,9058304
.long 32768,33792,321536,72704,1052640,1380320,5234688,556800,8445952,13582336,13803520,5506944,565248,1229440,9057280,2048
.long 3072,11264,19456,27648,35840,44032,52224,2048,10240,18432,26624,34816,43008,51200,323584,9331712
.long 34816,35840,321664,72704,1708000,2035680,5236736,638720,8445952,13582336,13803520,5506976,565248,1249920,9059328,2176
.long 5120,13312,21504,29696,37888,46080,54272,4096,12288,20480,28672,36864,45056,53248,323584,9333760
.long 254976,253952,325632,73216,2363360,2691040,5238784,556928,8445952,13582336,13803520,5507008,565248,1270400,9332736,2048
.long 7168,15360,23552,31744,39936,48128,268435456,6144,14336,22528,30720,38912,47104,268436480,323584,9335808
.long 257024,256000,325760,73216,3018720,3346400,5240832,638848,8445952,13582336,13803520,5507040,565248,1290880,9334784,2176
.long 1024,9216,17408,25600,33792,41984,50176,0,8192,16384,24576,32768,40960,49152,356352,7402496
.long 4096,5120,352512,76800,1053920,1381600,5562368,567040,7340032,15351808,15572992,4197248,606208,1884160,7401472,256
.long 3072,11264,19456,27648,35840,44032,52224,2048,10240,18432,26624,34816,43008,51200,356352,7404544
.long 6144,7168,352640,76800,1709280,2036960,5564416,648960,7340032,15351808,15572992,4197280,606208,1904640,7403520,384
.long 5120,13312,21504,29696,37888,46080,54272,4096,12288,20480,28672,36864,45056,53248,356352,7677952
.long 226304,225280,356608,77312,2364640,2692320,5566464,567168,7340032,15351808,15572992,4197312,606208,1925120,7405568,256
.long 7168,15360,23552,31744,39936,48128,268435456,6144,14336,22528,30720,38912,47104,268436480,356352,7680000
.long 228352,227328,356736,77312,3020000,3347680,5568512,649088,7340032,15351808,15572992,4197344,606208,1945600,7678976,384
.long 1024,9216,17408,25600,33792,41984,50176,0,8192,16384,24576,32768,40960,49152,356352,7682048
.long 32768,33792,354304,76800,1055200,1382880,5890048,577280,8445952,15351808,15572992,5507968,647168,1884800,7681024,2048
.long 3072,11264,19456,27648,35840,44032,52224,2048,10240,18432,26624,34816,43008,51200,356352,7955456
.long 34816,35840,354432,76800,1710560,2038240,5892096,659200,8445952,15351808,15572992,5508000,647168,1905280,7954432,2176
.long 5120,13312,21504,29696,37888,46080,54272,4096,12288,20480,28672,36864,45056,53248,356352,7957504
.long 254976,253952,358400,77312,2365920,2693600,5894144,577408,8445952,15351808,15572992,5508032,647168,1925760,7956480,2048
.long 7168,15360,23552,31744,39936,48128,268435456,6144,14336,22528,30720,38912,47104,268436480,356352,8230912
.long 257024,256000,358528,77312,3021280,3348960,5896192,659328,8445952,15351808,15572992,5508064,647168,1946240,7958528,2176
.long 1024,9216,17408,25600,33792,41984,50176,0,8192,16384,24576,32768,40960,49152,389120,8232960
.long 4096,5120,385280,80896,1056480,1384160,6217728,587520,7340032,17121280,17342464,4198272,606208,2539520,8231936,256
.long 3072,11264,19456,27648,35840,44032,52224,2048,10240,18432,26624,34816,43008,51200,389120,8235008
.long 6144,7168,385408,80896,1711840,2039520,6219776,669440,7340032,17121280,17342464,4198304,606208,2560000,8233984,384
.long 5120,13312,21504,29696,37888,46080,54272,4096,12288,20480,28672,36864,45056,53248,389120,8508416
.long 226304,225280,389376,81408,2367200,2694880,6221824,587648,7340032,17121280,17342464,4198336,606208,2580480,8507392,256
.long 7168,15360,23552,31744,39936,48128,268435456,6144,14336,22528,30720,38912,47104,268436480,389120,8510464
.long 228352,227328,389504,81408,3022560,3350240,6223872,669568,7340032,17121280,17342464,4198368,606208,2600960,8509440,384
.long 1024,9216,17408,25600,33792,41984,50176,0,8192,16384,24576,32768,40960,49152,389120,8783872
.long 32768,33792,387072,80896,1057760,1385440,6545408,597760,8445952,17121280,17342464,5508992,647168,2540160,8511488,2048
.long 3072,11264,19456,27648,35840,44032,52224,2048,10240,18432,26624,34816,43008,51200,389120,8785920
.long 34816,35840,387200,80896,1713120,2040800,6547456,679680,8445952,17121280,17342464,5509024,647168,2560640,8784896,2176
.long 5120,13312,21504,29696,37888,46080,54272,4096,12288,20480,28672,36864,45056,53248,389120,8787968
.long 254976,253952,391168,81408,2368480,2696160,6549504,597888,8445952,17121280,17342464,5509056,647168,2581120,8786944,2048
.long 7168,15360,23552,31744,39936,48128,268435456,6144,14336,22528,30720,38912,47104,268436480,389120,9061376
.long 257024,256000,391296,81408,3023840,3351520,6551552,679808,8445952,17121280,17342464,5509088,647168,2601600,9060352,2176
.long 8192,16384,24576,32768,40960,49152,0,9216,17408,25600,33792,41984,50176,1024,262144,9063424
.long 8192,9216,262656,65536,1048832,1376512,4259840,526336,7616512,10485760,10485760,4521984,534528,160,9062400,512
.long 10240,18432,26624,34816,43008,51200,2048,11264,19456,27648,35840,44032,52224,3072,262144,9336832
.long 10240,11264,262784,65536,1704192,2031872,4261888,608256,7616512,10485760,10485760,4522016,534528,20640,9064448,640
.long 12288,20480,28672,36864,45056,53248,4096,13312,21504,29696,37888,46080,54272,5120,262144,9338880
.long 230400,229376,266752,66048,2359552,2687232,4263936,526464,7616512,10485760,10485760,4522048,534528,41120,9337856,512
.long 14336,22528,30720,38912,47104,268435456,6144,15360,23552,31744,39936,48128,268436480,7168,262144,9340928
.long 232448,231424,266880,66048,3014912,3342592,4265984,608384,7616512,10485760,10485760,4522080,534528,61600,9339904,640
.long 8192,16384,24576,32768,40960,49152,0,9216,17408,25600,33792,41984,50176,1024,262144,7407616
.long 36864,37888,264448,65536,1050112,1377792,4587520,536576,8722432,10485760,10485760,5832704,575488,800,7406592,2304
.long 10240,18432,26624,34816,43008,51200,2048,11264,19456,27648,35840,44032,52224,3072,262144,7409664
.long 38912,39936,264576,65536,1705472,2033152,4589568,618496,8722432,10485760,10485760,5832736,575488,21280,7408640,2432
.long 12288,20480,28672,36864,45056,53248,4096,13312,21504,29696,37888,46080,54272,5120,262144,7683072
.long 259072,258048,268544,66048,2360832,2688512,4591616,536704,8722432,10485760,10485760,5832768,575488,41760,7410688,2304
.long 14336,22528,30720,38912,47104,268435456,6144,15360,23552,31744,39936,48128,268436480,7168,262144,7685120
.long 261120,260096,268672,66048,3016192,3343872,4593664,618624,8722432,10485760,10485760,5832800,575488,62240,7684096,2432
.long 8192,16384,24576,32768,40960,49152,0,9216,17408,25600,33792,41984,50176,1024,294912,7687168
.long 8192,9216,295424,69632,1051392,1379072,4915200,546816,7616512,12255232,12255232,4523008,534528,655520,7686144,512
.long 10240,18432,26624,34816,43008,51200,2048,11264,19456,27648,35840,44032,52224,3072,294912,7960576
.long 10240,11264,295552,69632,1706752,2034432,4917248,628736,7616512,12255232,12255232,4523040,534528,676000,7959552,640
.long 12288,20480,28672,36864,45056,53248,4096,13312,21504,29696,37888,46080,54272,5120,294912,7962624
.long 230400,229376,299520,70144,2362112,2689792,4919296,546944,7616512,12255232,12255232,4523072,534528,696480,7961600,512
.long 14336,22528,30720,38912,47104,268435456,6144,15360,23552,31744,39936,48128,268436480,7168,294912,8236032
.long 232448,231424,299648,70144,3017472,3345152,4921344,628864,7616512,12255232,12255232,4523104,534528,716960,7963648,640
.long 8192,16384,24576,32768,40960,49152,0,9216,17408,25600,33792,41984,50176,1024,294912,8238080
.long 36864,37888,297216,69632,1052672,1380352,5242880,557056,8722432,12255232,12255232,5833728,575488,656160,8237056,2304
.long 10240,18432,26624,34816,43008,51200,2048,11264,19456,27648,35840,44032,52224,3072,294912,8240128
.long 38912,39936,297344,69632,1708032,2035712,5244928,638976,8722432,12255232,12255232,5833760,575488,676640,8239104,2432
.long 12288,20480,28672,36864,45056,53248,4096,13312,21504,29696,37888,46080,54272,5120,294912,8513536
.long 259072,258048,301312,70144,2363392,2691072,5246976,557184,8722432,12255232,12255232,5833792,575488,697120,8512512,2304
.long 14336,22528,30720,38912,47104,268435456,6144,15360,23552,31744,39936,48128,268436480,7168,294912,8515584
.long 261120,260096,301440,70144,3018752,3346432,5249024,639104,8722432,12255232,12255232,5833824,575488,717600,8514560,2432
.long 8192,16384,24576,32768,40960,49152,0,9216,17408,25600,33792,41984,50176,1024,327680,8788992
.long 8192,9216,328192,73728,1053952,1381632,5570560,567296,7616512,14024704,14024704,4524032,616448,1310880,8516608,512
.long 10240,18432,26624,34816,43008,51200,2048,11264,19456,27648,35840,44032,52224,3072,327680,8791040
.long 10240,11264,328320,73728,1709312,2036992,5572608,649216,7616512,14024704,14024704,4524064,616448,1331360,8790016,640
.long 12288,20480,28672,36864,45056,53248,4096,13312,21504,29696,37888,46080,54272,5120,327680,8793088
.long 230400,229376,332288,74240,2364672,2692352,5574656,567424,7616512,14024704,14024704,4524096,616448,1351840,8792064,512
.long 14336,22528,30720,38912,47104,268435456,6144,15360,23552,31744,39936,48128,268436480,7168,327680,9066496
.long 232448,231424,332416,74240,3020032,3347712,5576704,649344,7616512,14024704,14024704,4524128,616448,1372320,9065472,640
.long 8192,16384,24576,32768,40960,49152,0,9216,17408,25600,33792,41984,50176,1024,327680,9068544
.long 36864,37888,329984,73728,1055232,1382912,5898240,577536,8722432,14024704,14024704,5834752,657408,1311520,9067520,2304
.long 10240,18432,26624,34816,43008,51200,2048,11264,19456,27648,35840,44032,52224,3072,327680,9341952
.long 38912,39936,330112,73728,1710592,2038272,5900288,659456,8722432,14024704,14024704,5834784,657408,1332000,9069568,2432
.long 12288,20480,28672,36864,45056,53248,4096,13312,21504,29696,37888,46080,54272,5120,327680,9344000
.long 259072,258048,334080,74240,2365952,2693632,5902336,577664,8722432,14024704,14024704,5834816,657408,1352480,9342976,2304
.long 14336,22528,30720,38912,47104,268435456,6144,15360,23552,31744,39936,48128,268436480,7168,327680,9346048
.long 261120,260096,334208,74240,3021312,3348992,5904384,659584,8722432,14024704,14024704,5834848,657408,1372960,9345024,2432
.long 8192,16384,24576,32768,40960,49152,0,9216,17408,25600,33792,41984,50176,1024,360448,7412736
.long 8192,9216,360960,77824,1056512,1384192,6225920,587776,7616512,15794176,15794176,4525056,616448,1966240,7411712,512
.long 10240,18432,26624,34816,43008,51200,2048,11264,19456,27648,35840,44032,52224,3072,360448,7414784
.long 10240,11264,361088,77824,1711872,2039552,6227968,669696,7616512,15794176,15794176,4525088,616448,1986720,7413760,640
.long 12288,20480,28672,36864,45056,53248,4096,13312,21504,29696,37888,46080,54272,5120,360448,7688192
.long 230400,229376,365056,78336,2367232,2694912,6230016,587904,7616512,15794176,15794176,4525120,616448,2007200,7415808,512
.long 14336,22528,30720,38912,47104,268435456,6144,15360,23552,31744,39936,48128,268436480,7168,360448,7690240
.long 232448,231424,365184,78336,3022592,3350272,6232064,669824,7616512,15794176,15794176,4525152,616448,2027680,7689216,640
.long 8192,16384,24576,32768,40960,49152,0,9216,17408,25600,33792,41984,50176,1024,360448,7692288
.long 36864,37888,362752,77824,1057792,1385472,6553600,598016,8722432,15794176,15794176,5835776,657408,1966880,7691264,2304
.long 10240,18432,26624,34816,43008,51200,2048,11264,19456,27648,35840,44032,52224,3072,360448,7965696
.long 38912,39936,362880,77824,1713152,2040832,6555648,679936,8722432,15794176,15794176,5835808,657408,1987360,7964672,2432
.long 12288,20480,28672,36864,45056,53248,4096,13312,21504,29696,37888,46080,54272,5120,360448,7967744
.long 259072,258048,366848,78336,2368512,2696192,6557696,598144,8722432,15794176,15794176,5835840,657408,2007840,7966720,2304
.long 14336,22528,30720,38912,47104,268435456,6144,15360,23552,31744,39936,48128,268436480,7168,360448,8241152
.long 261120,260096,366976,78336,3023872,3351552,6559744,680064,8722432,15794176,15794176,5835872,657408,2028320,7968768,2432
.long 9216,17408,25600,33792,41984,50176,1024,8192,16384,24576,32768,40960,49152,0,266240,8243200
.long 8192,9216,270848,66560,1048864,1376544,4268032,526592,7616512,10928128,10706944,4522112,534528,82080,8242176,512
.long 11264,19456,27648,35840,44032,52224,3072,10240,18432,26624,34816,43008,51200,2048,266240,8245248
.long 10240,11264,270976,66560,1704224,2031904,4270080,608512,7616512,10928128,10706944,4522144,534528,102560,8244224,640
.long 13312,21504,29696,37888,46080,54272,5120,12288,20480,28672,36864,45056,53248,4096,266240,8518656
.long 230400,229376,274944,67072,2359584,2687264,4272128,526720,7616512,10928128,10706944,4522176,534528,123040,8517632,512
.long 15360,23552,31744,39936,48128,268435456,7168,14336,22528,30720,38912,47104,268436480,6144,266240,8520704
.long 232448,231424,275072,67072,3014944,3342624,4274176,608640,7616512,10928128,10706944,4522208,534528,143520,8519680,640
.long 9216,17408,25600,33792,41984,50176,1024,8192,16384,24576,32768,40960,49152,0,266240,8794112
.long 36864,37888,272640,66560,1050144,1377824,4595712,536832,8722432,10928128,10706944,5832832,575488,82720,8521728,2304
.long 11264,19456,27648,35840,44032,52224,3072,10240,18432,26624,34816,43008,51200,2048,266240,8796160
.long 38912,39936,272768,66560,1705504,2033184,4597760,618752,8722432,10928128,10706944,5832864,575488,103200,8795136,2432
.long 13312,21504,29696,37888,46080,54272,5120,12288,20480,28672,36864,45056,53248,4096,266240,8798208
.long 259072,258048,276736,67072,2360864,2688544,4599808,536960,8722432,10928128,10706944,5832896,575488,123680,8797184,2304
.long 15360,23552,31744,39936,48128,268435456,7168,14336,22528,30720,38912,47104,268436480,6144,266240,9071616
.long 261120,260096,276864,67072,3016224,3343904,4601856,618880,8722432,10928128,10706944,5832928,575488,144160,9070592,2432
.long 9216,17408,25600,33792,41984,50176,1024,8192,16384,24576,32768,40960,49152,0,299008,9073664
.long 8192,9216,303616,70656,1051424,1379104,4923392,547072,7616512,12697600,12476416,4523136,534528,737440,9072640,512
.long 11264,19456,27648,35840,44032,52224,3072,10240,18432,26624,34816,43008,51200,2048,299008,9347072
.long 10240,11264,303744,70656,1706784,2034464,4925440,628992,7616512,12697600,12476416,4523168,534528,757920,9074688,640
.long 13312,21504,29696,37888,46080,54272,5120,12288,20480,28672,36864,45056,53248,4096,299008,9349120
.long 230400,229376,307712,71168,2362144,2689824,4927488,547200,7616512,12697600,12476416,4523200,534528,778400,9348096,512
.long 15360,23552,31744,39936,48128,268435456,7168,14336,22528,30720,38912,47104,268436480,6144,299008,9351168
.long 232448,231424,307840,71168,3017504,3345184,4929536,629120,7616512,12697600,12476416,4523232,534528,798880,9350144,640
.long 9216,17408,25600,33792,41984,50176,1024,8192,16384,24576,32768,40960,49152,0,299008,7417856
.long 36864,37888,305408,70656,1052704,1380384,5251072,557312,8722432,12697600,12476416,5833856,575488,738080,7416832,2304
.long 11264,19456,27648,35840,44032,52224,3072,10240,18432,26624,34816,43008,51200,2048,299008,7419904
.long 38912,39936,305536,70656,1708064,2035744,5253120,639232,8722432,12697600,12476416,5833888,575488,758560,7418880,2432
.long 13312,21504,29696,37888,46080,54272,5120,12288,20480,28672,36864,45056,53248,4096,299008,7693312
.long 259072,258048,309504,71168,2363424,2691104,5255168,557440,8722432,12697600,12476416,5833920,575488,779040,7420928,2304
.long 15360,23552,31744,39936,48128,268435456,7168,14336,22528,30720,38912,47104,268436480,6144,299008,7695360
.long 261120,260096,309632,71168,3018784,3346464,5257216,639360,8722432,12697600,12476416,5833952,575488,799520,7694336,2432
.long 9216,17408,25600,33792,41984,50176,1024,8192,16384,24576,32768,40960,49152,0,331776,7697408
.long 8192,9216,336384,74752,1053984,1381664,5578752,567552,7616512,14467072,14245888,4524160,616448,1392800,7696384,512
.long 11264,19456,27648,35840,44032,52224,3072,10240,18432,26624,34816,43008,51200,2048,331776,7970816
.long 10240,11264,336512,74752,1709344,2037024,5580800,649472,7616512,14467072,14245888,4524192,616448,1413280,7969792,640
.long 13312,21504,29696,37888,46080,54272,5120,12288,20480,28672,36864,45056,53248,4096,331776,7972864
.long 230400,229376,340480,75264,2364704,2692384,5582848,567680,7616512,14467072,14245888,4524224,616448,1433760,7971840,512
.long 15360,23552,31744,39936,48128,268435456,7168,14336,22528,30720,38912,47104,268436480,6144,331776,8246272
.long 232448,231424,340608,75264,3020064,3347744,5584896,649600,7616512,14467072,14245888,4524256,616448,1454240,7973888,640
.long 9216,17408,25600,33792,41984,50176,1024,8192,16384,24576,32768,40960,49152,0,331776,8248320
.long 36864,37888,338176,74752,1055264,1382944,5906432,577792,8722432,14467072,14245888,5834880,657408,1393440,8247296,2304
.long 11264,19456,27648,35840,44032,52224,3072,10240,18432,26624,34816,43008,51200,2048,331776,8250368
.long 38912,39936,338304,74752,1710624,2038304,5908480,659712,8722432,14467072,14245888,5834912,657408,1413920,8249344,2432
.long 13312,21504,29696,37888,46080,54272,5120,12288,20480,28672,36864,45056,53248,4096,331776,8523776
.long 259072,258048,342272,75264,2365984,2693664,5910528,577920,8722432,14467072,14245888,5834944,657408,1434400,8522752,2304
.long 15360,23552,31744,39936,48128,268435456,7168,14336,22528,30720,38912,47104,268436480,6144,331776,8525824
.long 261120,260096,342400,75264,3021344,3349024,5912576,659840,8722432,14467072,14245888,5834976,657408,1454880,8524800,2432
.long 9216,17408,25600,33792,41984,50176,1024,8192,16384,24576,32768,40960,49152,0,364544,8799232
.long 8192,9216,369152,78848,1056544,1384224,6234112,588032,7616512,16236544,16015360,4525184,616448,2048160,8526848,512
.long 11264,19456,27648,35840,44032,52224,3072,10240,18432,26624,34816,43008,51200,2048,364544,8801280
.long 10240,11264,369280,78848,1711904,2039584,6236160,669952,7616512,16236544,16015360,4525216,616448,2068640,8800256,640
.long 13312,21504,29696,37888,46080,54272,5120,12288,20480,28672,36864,45056,53248,4096,364544,8803328
.long 230400,229376,373248,79360,2367264,2694944,6238208,588160,7616512,16236544,16015360,4525248,616448,2089120,8802304,512
.long 15360,23552,31744,39936,48128,268435456,7168,14336,22528,30720,38912,47104,268436480,6144,364544,9076736
.long 232448,231424,373376,79360,3022624,3350304,6240256,670080,7616512,16236544,16015360,4525280,616448,2109600,9075712,640
.long 9216,17408,25600,33792,41984,50176,1024,8192,16384,24576,32768,40960,49152,0,364544,9078784
.long 36864,37888,370944,78848,1057824,1385504,6561792,598272,8722432,16236544,16015360,5835904,657408,2048800,9077760,2304
.long 11264,19456,27648,35840,44032,52224,3072,10240,18432,26624,34816,43008,51200,2048,364544,9352192
.long 38912,39936,371072,78848,1713184,2040864,6563840,680192,8722432,16236544,16015360,5835936,657408,2069280,9079808,2432
.long 13312,21504,29696,37888,46080,54272,5120,12288,20480,28672,36864,45056,53248,4096,364544,9354240
.long 259072,258048,375040,79360,2368544,2696224,6565888,598400,8722432,16236544,16015360,5835968,657408,2089760,9353216,2304
.long 15360,23552,31744,39936,48128,268435456,7168,14336,22528,30720,38912,47104,268436480,6144,364544,9356288
.long 261120,260096,375168,79360,3023904,3351584,6567936,680320,8722432,16236544,16015360,5836000,657408,2110240,9355264,2432
.long 8192,16384,24576,32768,40960,49152,0,9216,17408,25600,33792,41984,50176,1024,270336,7422976
.long 8192,9216,279040,67584,1048896,1376576,4276224,526848,7616512,11370496,10928128,4522240,534528,164000,7421952,512
.long 10240,18432,26624,34816,43008,51200,2048,11264,19456,27648,35840,44032,52224,3072,270336,7425024
.long 10240,11264,279168,67584,1704256,2031936,4278272,608768,7616512,11370496,10928128,4522272,534528,184480,7424000,640
.long 12288,20480,28672,36864,45056,53248,4096,13312,21504,29696,37888,46080,54272,5120,270336,7698432
.long 230400,229376,283136,68096,2359616,2687296,4280320,526976,7616512,11370496,10928128,4522304,534528,204960,7426048,512
.long 14336,22528,30720,38912,47104,268435456,6144,15360,23552,31744,39936,48128,268436480,7168,270336,7700480
.long 232448,231424,283264,68096,3014976,3342656,4282368,608896,7616512,11370496,10928128,4522336,534528,225440,7699456,640
.long 8192,16384,24576,32768,40960,49152,0,9216,17408,25600,33792,41984,50176,1024,270336,7702528
.long 36864,37888,280832,67584,1050176,1377856,4603904,537088,8722432,11370496,10928128,5832960,575488,164640,7701504,2304
.long 10240,18432,26624,34816,43008,51200,2048,11264,19456,27648,35840,44032,52224,3072,270336,7975936
.long 38912,39936,280960,67584,1705536,2033216,4605952,619008,8722432,11370496,10928128,5832992,575488,185120,7974912,2432
.long 12288,20480,28672,36864,45056,53248,4096,13312,21504,29696,37888,46080,54272,5120,270336,7977984
.long 259072,258048,284928,68096,2360896,2688576,4608000,537216,8722432,11370496,10928128,5833024,575488,205600,7976960,2304
.long 14336,22528,30720,38912,47104,268435456,6144,15360,23552,31744,39936,48128,268436480,7168,270336,8251392
.long 261120,260096,285056,68096,3016256,3343936,4610048,619136,8722432,11370496,10928128,5833056,575488,226080,7979008,2432
.long 8192,16384,24576,32768,40960,49152,0,9216,17408,25600,33792,41984,50176,1024,303104,8253440
.long 8192,9216,311808,71680,1051456,1379136,4931584,547328,7616512,13139968,12697600,4523264,534528,819360,8252416,512
.long 10240,18432,26624,34816,43008,51200,2048,11264,19456,27648,35840,44032,52224,3072,303104,8255488
.long 10240,11264,311936,71680,1706816,2034496,4933632,629248,7616512,13139968,12697600,4523296,534528,839840,8254464,640
.long 12288,20480,28672,36864,45056,53248,4096,13312,21504,29696,37888,46080,54272,5120,303104,8528896
.long 230400,229376,315904,72192,2362176,2689856,4935680,547456,7616512,13139968,12697600,4523328,534528,860320,8527872,512
.long 14336,22528,30720,38912,47104,268435456,6144,15360,23552,31744,39936,48128,268436480,7168,303104,8530944
.long 232448,231424,316032,72192,3017536,3345216,4937728,629376,7616512,13139968,12697600,4523360,534528,880800,8529920,640
.long 8192,16384,24576,32768,40960,49152,0,9216,17408,25600,33792,41984,50176,1024,303104,8804352
.long 36864,37888,313600,71680,1052736,1380416,5259264,557568,8722432,13139968,12697600,5833984,575488,820000,8531968,2304
.long 10240,18432,26624,34816,43008,51200,2048,11264,19456,27648,35840,44032,52224,3072,303104,8806400
.long 38912,39936,313728,71680,1708096,2035776,5261312,639488,8722432,13139968,12697600,5834016,575488,840480,8805376,2432
.long 12288,20480,28672,36864,45056,53248,4096,13312,21504,29696,37888,46080,54272,5120,303104,8808448
.long 259072,258048,317696,72192,2363456,2691136,5263360,557696,8722432,13139968,12697600,5834048,575488,860960,8807424,2304
.long 14336,22528,30720,38912,47104,268435456,6144,15360,23552,31744,39936,48128,268436480,7168,303104,9081856
.long 261120,260096,317824,72192,3018816,3346496,5265408,639616,8722432,13139968,12697600,5834080,575488,881440,9080832,2432
.long 8192,16384,24576,32768,40960,49152,0,9216,17408,25600,33792,41984,50176,1024,335872,9083904
.long 8192,9216,344576,75776,1054016,1381696,5586944,567808,7616512,14909440,14467072,4524288,616448,1474720,9082880,512
.long 10240,18432,26624,34816,43008,51200,2048,11264,19456,27648,35840,44032,52224,3072,335872,9357312
.long 10240,11264,344704,75776,1709376,2037056,5588992,649728,7616512,14909440,14467072,4524320,616448,1495200,9084928,640
.long 12288,20480,28672,36864,45056,53248,4096,13312,21504,29696,37888,46080,54272,5120,335872,9359360
.long 230400,229376,348672,76288,2364736,2692416,5591040,567936,7616512,14909440,14467072,4524352,616448,1515680,9358336,512
.long 14336,22528,30720,38912,47104,268435456,6144,15360,23552,31744,39936,48128,268436480,7168,335872,9361408
.long 232448,231424,348800,76288,3020096,3347776,5593088,649856,7616512,14909440,14467072,4524384,616448,1536160,9360384,640
.long 8192,16384,24576,32768,40960,49152,0,9216,17408,25600,33792,41984,50176,1024,335872,7428096
.long 36864,37888,346368,75776,1055296,1382976,5914624,578048,8722432,14909440,14467072,5835008,657408,1475360,7427072,2304
.long 10240,18432,26624,34816,43008,51200,2048,11264,19456,27648,35840,44032,52224,3072,335872,7430144
.long 38912,39936,346496,75776,1710656,2038336,5916672,659968,8722432,14909440,14467072,5835040,657408,1495840,7429120,2432
.long 12288,20480,28672,36864,45056,53248,4096,13312,21504,29696,37888,46080,54272,5120,335872,7703552
.long 259072,258048,350464,76288,2366016,2693696,5918720,578176,8722432,14909440,14467072,5835072,657408,1516320,7431168,2304
.long 14336,22528,30720,38912,47104,268435456,6144,15360,23552,31744,39936,48128,268436480,7168,335872,7705600
.long 261120,260096,350592,76288,3021376,3349056,5920768,660096,8722432,14909440,14467072,5835104,657408,1536800,7704576,2432
.long 8192,16384,24576,32768,40960,49152,0,9216,17408,25600,33792,41984,50176,1024,368640,7707648
.long 8192,9216,377344,79872,1056576,1384256,6242304,588288,7616512,16678912,16236544,4525312,616448,2130080,7706624,512
.long 10240,18432,26624,34816,43008,51200,2048,11264,19456,27648,35840,44032,52224,3072,368640,7981056
.long 10240,11264,377472,79872,1711936,2039616,6244352,670208,7616512,16678912,16236544,4525344,616448,2150560,7980032,640
.long 12288,20480,28672,36864,45056,53248,4096,13312,21504,29696,37888,46080,54272,5120,368640,7983104
.long 230400,229376,381440,80384,2367296,2694976,6246400,588416,7616512,16678912,16236544,4525376,616448,2171040,7982080,512
.long 14336,22528,30720,38912,47104,268435456,6144,15360,23552,31744,39936,48128,268436480,7168,368640,8256512
.long 232448,231424,381568,80384,3022656,3350336,6248448,670336,7616512,16678912,16236544,4525408,616448,2191520,7984128,640
.long 8192,16384,24576,32768,40960,49152,0,9216,17408,25600,33792,41984,50176,1024,368640,8258560
.long 36864,37888,379136,79872,1057856,1385536,6569984,598528,8722432,16678912,16236544,5836032,657408,2130720,8257536,2304
.long 10240,18432,26624,34816,43008,51200,2048,11264,19456,27648,35840,44032,52224,3072,368640,8260608
.long 38912,39936,379264,79872,1713216,2040896,6572032,680448,8722432,16678912,16236544,5836064,657408,2151200,8259584,2432
.long 12288,20480,28672,36864,45056,53248,4096,13312,21504,29696,37888,46080,54272,5120,368640,8534016
.long 259072,258048,383232,80384,2368576,2696256,6574080,598656,8722432,16678912,16236544,5836096,657408,2171680,8532992,2304
.long 14336,22528,30720,38912,47104,268435456,6144,15360,23552,31744,39936,48128,268436480,7168,368640,8536064
.long 261120,260096,383360,80384,3023936,3351616,6576128,680576,8722432,16678912,16236544,5836128,657408,2192160,8535040,2432
.long 9216,17408,25600,33792,41984,50176,1024,8192,16384,24576,32768,40960,49152,0,274432,8809472
.long 8192,9216,287232,68608,1048928,1376608,4284416,527104,7616512,11812864,11149312,4522368,534528,245920,8537088,512
.long 11264,19456,27648,35840,44032,52224,3072,10240,18432,26624,34816,43008,51200,2048,274432,8811520
.long 10240,11264,287360,68608,1704288,2031968,4286464,609024,7616512,11812864,11149312,4522400,534528,266400,8810496,640
.long 13312,21504,29696,37888,46080,54272,5120,12288,20480,28672,36864,45056,53248,4096,274432,8813568
.long 230400,229376,291328,69120,2359648,2687328,4288512,527232,7616512,11812864,11149312,4522432,534528,286880,8812544,512
.long 15360,23552,31744,39936,48128,268435456,7168,14336,22528,30720,38912,47104,268436480,6144,274432,9086976
.long 232448,231424,291456,69120,3015008,3342688,4290560,609152,7616512,11812864,11149312,4522464,534528,307360,9085952,640
.long 9216,17408,25600,33792,41984,50176,1024,8192,16384,24576,32768,40960,49152,0,274432,9089024
.long 36864,37888,289024,68608,1050208,1377888,4612096,537344,8722432,11812864,11149312,5833088,575488,246560,9088000,2304
.long 11264,19456,27648,35840,44032,52224,3072,10240,18432,26624,34816,43008,51200,2048,274432,9362432
.long 38912,39936,289152,68608,1705568,2033248,4614144,619264,8722432,11812864,11149312,5833120,575488,267040,9090048,2432
.long 13312,21504,29696,37888,46080,54272,5120,12288,20480,28672,36864,45056,53248,4096,274432,9364480
.long 259072,258048,293120,69120,2360928,2688608,4616192,537472,8722432,11812864,11149312,5833152,575488,287520,9363456,2304
.long 15360,23552,31744,39936,48128,268435456,7168,14336,22528,30720,38912,47104,268436480,6144,274432,9366528
.long 261120,260096,293248,69120,3016288,3343968,4618240,619392,8722432,11812864,11149312,5833184,575488,308000,9365504,2432
.long 9216,17408,25600,33792,41984,50176,1024,8192,16384,24576,32768,40960,49152,0,307200,7433216
.long 8192,9216,320000,72704,1051488,1379168,4939776,547584,7616512,13582336,12918784,4523392,534528,901280,7432192,512
.long 11264,19456,27648,35840,44032,52224,3072,10240,18432,26624,34816,43008,51200,2048,307200,7435264
.long 10240,11264,320128,72704,1706848,2034528,4941824,629504,7616512,13582336,12918784,4523424,534528,921760,7434240,640
.long 13312,21504,29696,37888,46080,54272,5120,12288,20480,28672,36864,45056,53248,4096,307200,7708672
.long 230400,229376,324096,73216,2362208,2689888,4943872,547712,7616512,13582336,12918784,4523456,534528,942240,7436288,512
.long 15360,23552,31744,39936,48128,268435456,7168,14336,22528,30720,38912,47104,268436480,6144,307200,7710720
.long 232448,231424,324224,73216,3017568,3345248,4945920,629632,7616512,13582336,12918784,4523488,534528,962720,7709696,640
.long 9216,17408,25600,33792,41984,50176,1024,8192,16384,24576,32768,40960,49152,0,307200,7712768
.long 36864,37888,321792,72704,1052768,1380448,5267456,557824,8722432,13582336,12918784,5834112,575488,901920,7711744,2304
.long 11264,19456,27648,35840,44032,52224,3072,10240,18432,26624,34816,43008,51200,2048,307200,7986176
.long 38912,39936,321920,72704,1708128,2035808,5269504,639744,8722432,13582336,12918784,5834144,575488,922400,7985152,2432
.long 13312,21504,29696,37888,46080,54272,5120,12288,20480,28672,36864,45056,53248,4096,307200,7988224
.long 259072,258048,325888,73216,2363488,2691168,5271552,557952,8722432,13582336,12918784,5834176,575488,942880,7987200,2304
.long 15360,23552,31744,39936,48128,268435456,7168,14336,22528,30720,38912,47104,268436480,6144,307200,8261632
.long 261120,260096,326016,73216,3018848,3346528,5273600,639872,8722432,13582336,12918784,5834208,575488,963360,7989248,2432
.long 9216,17408,25600,33792,41984,50176,1024,8192,16384,24576,32768,40960,49152,0,339968,8263680
.long 8192,9216,352768,76800,1054048,1381728,5595136,568064,7616512,15351808,14688256,4524416,616448,1556640,8262656,512
.long 11264,19456,27648,35840,44032,52224,3072,10240,18432,26624,34816,43008,51200,2048,339968,8265728
.long 10240,11264,352896,76800,1709408,2037088,5597184,649984,7616512,15351808,14688256,4524448,616448,1577120,8264704,640
.long 13312,21504,29696,37888,46080,54272,5120,12288,20480,28672,36864,45056,53248,4096,339968,8539136
.long 230400,229376,356864,77312,2364768,2692448,5599232,568192,7616512,15351808,14688256,4524480,616448,1597600,8538112,512
.long 15360,23552,31744,39936,48128,268435456,7168,14336,22528,30720,38912,47104,268436480,6144,339968,8541184
.long 232448,231424,356992,77312,3020128,3347808,5601280,650112,7616512,15351808,14688256,4524512,616448,1618080,8540160,640
.long 9216,17408,25600,33792,41984,50176,1024,8192,16384,24576,32768,40960,49152,0,339968,8814592
.long 36864,37888,354560,76800,1055328,1383008,5922816,578304,8722432,15351808,14688256,5835136,657408,1557280,8542208,2304
.long 11264,19456,27648,35840,44032,52224,3072,10240,18432,26624,34816,43008,51200,2048,339968,8816640
.long 38912,39936,354688,76800,1710688,2038368,5924864,660224,8722432,15351808,14688256,5835168,657408,1577760,8815616,2432
.long 13312,21504,29696,37888,46080,54272,5120,12288,20480,28672,36864,45056,53248,4096,339968,8818688
.long 259072,258048,358656,77312,2366048,2693728,5926912,578432,8722432,15351808,14688256,5835200,657408,1598240,8817664,2304
.long 15360,23552,31744,39936,48128,268435456,7168,14336,22528,30720,38912,47104,268436480,6144,339968,9092096
.long 261120,260096,358784,77312,3021408,3349088,5928960,660352,8722432,15351808,14688256,5835232,657408,1618720,9091072,2432
.long 9216,17408,25600,33792,41984,50176,1024,8192,16384,24576,32768,40960,49152,0,372736,9094144
.long 8192,9216,385536,80896,1056608,1384288,6250496,588544,7616512,17121280,16457728,4525440,616448,2212000,9093120,512
.long 11264,19456,27648,35840,44032,52224,3072,10240,18432,26624,34816,43008,51200,2048,372736,9367552
.long 10240,11264,385664,80896,1711968,2039648,6252544,670464,7616512,17121280,16457728,4525472,616448,2232480,9095168,640
.long 13312,21504,29696,37888,46080,54272,5120,12288,20480,28672,36864,45056,53248,4096,372736,9369600
.long 230400,229376,389632,81408,2367328,2695008,6254592,588672,7616512,17121280,16457728,4525504,616448,2252960,9368576,512
.long 15360,23552,31744,39936,48128,268435456,7168,14336,22528,30720,38912,47104,268436480,6144,372736,9371648
.long 232448,231424,389760,81408,3022688,3350368,6256640,670592,7616512,17121280,16457728,4525536,616448,2273440,9370624,640
.long 9216,17408,25600,33792,41984,50176,1024,8192,16384,24576,32768,40960,49152,0,372736,7438336
.long 36864,37888,387328,80896,1057888,1385568,6578176,598784,8722432,17121280,16457728,5836160,657408,2212640,7437312,2304
.long 11264,19456,27648,35840,44032,52224,3072,10240,18432,26624,34816,43008,51200,2048,372736,7440384
.long 38912,39936,387456,80896,1713248,2040928,6580224,680704,8722432,17121280,16457728,5836192,657408,2233120,7439360,2432
.long 13312,21504,29696,37888,46080,54272,5120,12288,20480,28672,36864,45056,53248,4096,372736,7713792
.long 259072,258048,391424,81408,2368608,2696288,6582272,598912,8722432,17121280,16457728,5836224,657408,2253600,7441408,2304
.long 15360,23552,31744,39936,48128,268435456,7168,14336,22528,30720,38912,47104,268436480,6144,372736,7715840
.long 261120,260096,391552,81408,3023968,3351648,6584320,680832,8722432,17121280,16457728,5836256,657408,2274080,7714816,2432
.long 8192,16384,24576,32768,40960,49152,0,9216,17408,25600,33792,41984,50176,1024,278528,7717888
.long 12288,13312,262912,65536,1048960,1376640,4292608,527360,7616512,10485760,11370496,4522496,534528,327840,7716864,768
.long 10240,18432,26624,34816,43008,51200,2048,11264,19456,27648,35840,44032,52224,3072,278528,7991296
.long 14336,15360,263040,65536,1704320,2032000,4294656,609280,7616512,10485760,11370496,4522528,534528,348320,7990272,896
.long 12288,20480,28672,36864,45056,53248,4096,13312,21504,29696,37888,46080,54272,5120,278528,7993344
.long 234496,233472,267008,66048,2359680,2687360,4296704,527488,7616512,10485760,11370496,4522560,534528,368800,7992320,768
.long 14336,22528,30720,38912,47104,268435456,6144,15360,23552,31744,39936,48128,268436480,7168,278528,8266752
.long 236544,235520,267136,66048,3015040,3342720,4298752,609408,7616512,10485760,11370496,4522592,534528,389280,7994368,896
.long 8192,16384,24576,32768,40960,49152,0,9216,17408,25600,33792,41984,50176,1024,278528,8268800
.long 40960,41984,264704,65536,1050240,1377920,4620288,537600,8722432,10485760,11370496,5833216,575488,328480,8267776,2560
.long 10240,18432,26624,34816,43008,51200,2048,11264,19456,27648,35840,44032,52224,3072,278528,8270848
.long 43008,44032,264832,65536,1705600,2033280,4622336,619520,8722432,10485760,11370496,5833248,575488,348960,8269824,2688
.long 12288,20480,28672,36864,45056,53248,4096,13312,21504,29696,37888,46080,54272,5120,278528,8544256
.long 263168,262144,268800,66048,2360960,2688640,4624384,537728,8722432,10485760,11370496,5833280,575488,369440,8543232,2560
.long 14336,22528,30720,38912,47104,268435456,6144,15360,23552,31744,39936,48128,268436480,7168,278528,8546304
.long 265216,264192,268928,66048,3016320,3344000,4626432,619648,8722432,10485760,11370496,5833312,575488,389920,8545280,2688
.long 8192,16384,24576,32768,40960,49152,0,9216,17408,25600,33792,41984,50176,1024,311296,8819712
.long 12288,13312,295680,69632,1051520,1379200,4947968,547840,7616512,12255232,13139968,4523520,534528,983200,8547328,768
.long 10240,18432,26624,34816,43008,51200,2048,11264,19456,27648,35840,44032,52224,3072,311296,8821760
.long 14336,15360,295808,69632,1706880,2034560,4950016,629760,7616512,12255232,13139968,4523552,534528,1003680,8820736,896
.long 12288,20480,28672,36864,45056,53248,4096,13312,21504,29696,37888,46080,54272,5120,311296,8823808
.long 234496,233472,299776,70144,2362240,2689920,4952064,547968,7616512,12255232,13139968,4523584,534528,1024160,8822784,768
.long 14336,22528,30720,38912,47104,268435456,6144,15360,23552,31744,39936,48128,268436480,7168,311296,9097216
.long 236544,235520,299904,70144,3017600,3345280,4954112,629888,7616512,12255232,13139968,4523616,534528,1044640,9096192,896
.long 8192,16384,24576,32768,40960,49152,0,9216,17408,25600,33792,41984,50176,1024,311296,9099264
.long 40960,41984,297472,69632,1052800,1380480,5275648,558080,8722432,12255232,13139968,5834240,575488,983840,9098240,2560
.long 10240,18432,26624,34816,43008,51200,2048,11264,19456,27648,35840,44032,52224,3072,311296,9372672
.long 43008,44032,297600,69632,1708160,2035840,5277696,640000,8722432,12255232,13139968,5834272,575488,1004320,9100288,2688
.long 12288,20480,28672,36864,45056,53248,4096,13312,21504,29696,37888,46080,54272,5120,311296,9374720
.long 263168,262144,301568,70144,2363520,2691200,5279744,558208,8722432,12255232,13139968,5834304,575488,1024800,9373696,2560
.long 14336,22528,30720,38912,47104,268435456,6144,15360,23552,31744,39936,48128,268436480,7168,311296,9376768
.long 265216,264192,301696,70144,3018880,3346560,5281792,640128,8722432,12255232,13139968,5834336,575488,1045280,9375744,2688
.long 8192,16384,24576,32768,40960,49152,0,9216,17408,25600,33792,41984,50176,1024,344064,7443456
.long 12288,13312,328448,73728,1054080,1381760,5603328,568320,7616512,14024704,14909440,4524544,616448,1638560,7442432,768
.long 10240,18432,26624,34816,43008,51200,2048,11264,19456,27648,35840,44032,52224,3072,344064,7445504
.long 14336,15360,328576,73728,1709440,2037120,5605376,650240,7616512,14024704,14909440,4524576,616448,1659040,7444480,896
.long 12288,20480,28672,36864,45056,53248,4096,13312,21504,29696,37888,46080,54272,5120,344064,7718912
.long 234496,233472,332544,74240,2364800,2692480,5607424,568448,7616512,14024704,14909440,4524608,616448,1679520,7446528,768
.long 14336,22528,30720,38912,47104,268435456,6144,15360,23552,31744,39936,48128,268436480,7168,344064,7720960
.long 236544,235520,332672,74240,3020160,3347840,5609472,650368,7616512,14024704,14909440,4524640,616448,1700000,7719936,896
.long 8192,16384,24576,32768,40960,49152,0,9216,17408,25600,33792,41984,50176,1024,344064,7723008
.long 40960,41984,330240,73728,1055360,1383040,5931008,578560,8722432,14024704,14909440,5835264,657408,1639200,7721984,2560
.long 10240,18432,26624,34816,43008,51200,2048,11264,19456,27648,35840,44032,52224,3072,344064,7996416
.long 43008,44032,330368,73728,1710720,2038400,5933056,660480,8722432,14024704,14909440,5835296,657408,1659680,7995392,2688
.long 12288,20480,28672,36864,45056,53248,4096,13312,21504,29696,37888,46080,54272,5120,344064,7998464
.long 263168,262144,334336,74240,2366080,2693760,5935104,578688,8722432,14024704,14909440,5835328,657408,1680160,7997440,2560
.long 14336,22528,30720,38912,47104,268435456,6144,15360,23552,31744,39936,48128,268436480,7168,344064,8271872
.long 265216,264192,334464,74240,3021440,3349120,5937152,660608,8722432,14024704,14909440,5835360,657408,1700640,7999488,2688
.long 8192,16384,24576,32768,40960,49152,0,9216,17408,25600,33792,41984,50176,1024,376832,8273920
.long 12288,13312,361216,77824,1056640,1384320,6258688,588800,7616512,15794176,16678912,4525568,616448,2293920,8272896,768
.long 10240,18432,26624,34816,43008,51200,2048,11264,19456,27648,35840,44032,52224,3072,376832,8275968
.long 14336,15360,361344,77824,1712000,2039680,6260736,670720,7616512,15794176,16678912,4525600,616448,2314400,8274944,896
.long 12288,20480,28672,36864,45056,53248,4096,13312,21504,29696,37888,46080,54272,5120,376832,8549376
.long 234496,233472,365312,78336,2367360,2695040,6262784,588928,7616512,15794176,16678912,4525632,616448,2334880,8548352,768
.long 14336,22528,30720,38912,47104,268435456,6144,15360,23552,31744,39936,48128,268436480,7168,376832,8551424
.long 236544,235520,365440,78336,3022720,3350400,6264832,670848,7616512,15794176,16678912,4525664,616448,2355360,8550400,896
.long 8192,16384,24576,32768,40960,49152,0,9216,17408,25600,33792,41984,50176,1024,376832,8824832
.long 40960,41984,363008,77824,1057920,1385600,6586368,599040,8722432,15794176,16678912,5836288,657408,2294560,8552448,2560
.long 10240,18432,26624,34816,43008,51200,2048,11264,19456,27648,35840,44032,52224,3072,376832,8826880
.long 43008,44032,363136,77824,1713280,2040960,6588416,680960,8722432,15794176,16678912,5836320,657408,2315040,8825856,2688
.long 12288,20480,28672,36864,45056,53248,4096,13312,21504,29696,37888,46080,54272,5120,376832,8828928
.long 263168,262144,367104,78336,2368640,2696320,6590464,599168,8722432,15794176,16678912,5836352,657408,2335520,8827904,2560
.long 14336,22528,30720,38912,47104,268435456,6144,15360,23552,31744,39936,48128,268436480,7168,376832,9102336
.long 265216,264192,367232,78336,3024000,3351680,6592512,681088,8722432,15794176,16678912,5836384,657408,2356000,9101312,2688
.long 9216,17408,25600,33792,41984,50176,1024,8192,16384,24576,32768,40960,49152,0,282624,9104384
.long 12288,13312,271104,66560,1048992,1376672,4300800,527616,7616512,10928128,11591680,4522624,534528,409760,9103360,768
.long 11264,19456,27648,35840,44032,52224,3072,10240,18432,26624,34816,43008,51200,2048,282624,9377792
.long 14336,15360,271232,66560,1704352,2032032,4302848,609536,7616512,10928128,11591680,4522656,534528,430240,9105408,896
.long 13312,21504,29696,37888,46080,54272,5120,12288,20480,28672,36864,45056,53248,4096,282624,9379840
.long 234496,233472,275200,67072,2359712,2687392,4304896,527744,7616512,10928128,11591680,4522688,534528,450720,9378816,768
.long 15360,23552,31744,39936,48128,268435456,7168,14336,22528,30720,38912,47104,268436480,6144,282624,9381888
.long 236544,235520,275328,67072,3015072,3342752,4306944,609664,7616512,10928128,11591680,4522720,534528,471200,9380864,896
.long 9216,17408,25600,33792,41984,50176,1024,8192,16384,24576,32768,40960,49152,0,282624,7448576
.long 40960,41984,272896,66560,1050272,1377952,4628480,537856,8722432,10928128,11591680,5833344,575488,410400,7447552,2560
.long 11264,19456,27648,35840,44032,52224,3072,10240,18432,26624,34816,43008,51200,2048,282624,7450624
.long 43008,44032,273024,66560,1705632,2033312,4630528,619776,8722432,10928128,11591680,5833376,575488,430880,7449600,2688
.long 13312,21504,29696,37888,46080,54272,5120,12288,20480,28672,36864,45056,53248,4096,282624,7724032
.long 263168,262144,276992,67072,2360992,2688672,4632576,537984,8722432,10928128,11591680,5833408,575488,451360,7451648,2560
.long 15360,23552,31744,39936,48128,268435456,7168,14336,22528,30720,38912,47104,268436480,6144,282624,7726080
.long 265216,264192,277120,67072,3016352,3344032,4634624,619904,8722432,10928128,11591680,5833440,575488,471840,7725056,2688
.long 9216,17408,25600,33792,41984,50176,1024,8192,16384,24576,32768,40960,49152,0,315392,7728128
.long 12288,13312,303872,70656,1051552,1379232,4956160,548096,7616512,12697600,13361152,4523648,534528,1065120,7727104,768
.long 11264,19456,27648,35840,44032,52224,3072,10240,18432,26624,34816,43008,51200,2048,315392,8001536
.long 14336,15360,304000,70656,1706912,2034592,4958208,630016,7616512,12697600,13361152,4523680,534528,1085600,8000512,896
.long 13312,21504,29696,37888,46080,54272,5120,12288,20480,28672,36864,45056,53248,4096,315392,8003584
.long 234496,233472,307968,71168,2362272,2689952,4960256,548224,7616512,12697600,13361152,4523712,534528,1106080,8002560,768
.long 15360,23552,31744,39936,48128,268435456,7168,14336,22528,30720,38912,47104,268436480,6144,315392,8276992
.long 236544,235520,308096,71168,3017632,3345312,4962304,630144,7616512,12697600,13361152,4523744,534528,1126560,8004608,896
.long 9216,17408,25600,33792,41984,50176,1024,8192,16384,24576,32768,40960,49152,0,315392,8279040
.long 40960,41984,305664,70656,1052832,1380512,5283840,558336,8722432,12697600,13361152,5834368,575488,1065760,8278016,2560
.long 11264,19456,27648,35840,44032,52224,3072,10240,18432,26624,34816,43008,51200,2048,315392,8281088
.long 43008,44032,305792,70656,1708192,2035872,5285888,640256,8722432,12697600,13361152,5834400,575488,1086240,8280064,2688
.long 13312,21504,29696,37888,46080,54272,5120,12288,20480,28672,36864,45056,53248,4096,315392,8554496
.long 263168,262144,309760,71168,2363552,2691232,5287936,558464,8722432,12697600,13361152,5834432,575488,1106720,8553472,2560
.long 15360,23552,31744,39936,48128,268435456,7168,14336,22528,30720,38912,47104,268436480,6144,315392,8556544
.long 265216,264192,309888,71168,3018912,3346592,5289984,640384,8722432,12697600,13361152,5834464,575488,1127200,8555520,2688
.long 9216,17408,25600,33792,41984,50176,1024,8192,16384,24576,32768,40960,49152,0,348160,8829952
.long 12288,13312,336640,74752,1054112,1381792,5611520,568576,7616512,14467072,15130624,4524672,616448,1720480,8557568,768
.long 11264,19456,27648,35840,44032,52224,3072,10240,18432,26624,34816,43008,51200,2048,348160,8832000
.long 14336,15360,336768,74752,1709472,2037152,5613568,650496,7616512,14467072,15130624,4524704,616448,1740960,8830976,896
.long 13312,21504,29696,37888,46080,54272,5120,12288,20480,28672,36864,45056,53248,4096,348160,8834048
.long 234496,233472,340736,75264,2364832,2692512,5615616,568704,7616512,14467072,15130624,4524736,616448,1761440,8833024,768
.long 15360,23552,31744,39936,48128,268435456,7168,14336,22528,30720,38912,47104,268436480,6144,348160,9107456
.long 236544,235520,340864,75264,3020192,3347872,5617664,650624,7616512,14467072,15130624,4524768,616448,1781920,9106432,896
.long 9216,17408,25600,33792,41984,50176,1024,8192,16384,24576,32768,40960,49152,0,348160,9109504
.long 40960,41984,338432,74752,1055392,1383072,5939200,578816,8722432,14467072,15130624,5835392,657408,1721120,9108480,2560
.long 11264,19456,27648,35840,44032,52224,3072,10240,18432,26624,34816,43008,51200,2048,348160,9382912
.long 43008,44032,338560,74752,1710752,2038432,5941248,660736,8722432,14467072,15130624,5835424,657408,1741600,9110528,2688
.long 13312,21504,29696,37888,46080,54272,5120,12288,20480,28672,36864,45056,53248,4096,348160,9384960
.long 263168,262144,342528,75264,2366112,2693792,5943296,578944,8722432,14467072,15130624,5835456,657408,1762080,9383936,2560
.long 15360,23552,31744,39936,48128,268435456,7168,14336,22528,30720,38912,47104,268436480,6144,348160,9387008
.long 265216,264192,342656,75264,3021472,3349152,5945344,660864,8722432,14467072,15130624,5835488,657408,1782560,9385984,2688
.long 9216,17408,25600,33792,41984,50176,1024,8192,16384,24576,32768,40960,49152,0,380928,7453696
.long 12288,13312,369408,78848,1056672,1384352,6266880,589056,7616512,16236544,16900096,4525696,616448,2375840,7452672,768
.long 11264,19456,27648,35840,44032,52224,3072,10240,18432,26624,34816,43008,51200,2048,380928,7455744
.long 14336,15360,369536,78848,1712032,2039712,6268928,670976,7616512,16236544,16900096,4525728,616448,2396320,7454720,896
.long 13312,21504,29696,37888,46080,54272,5120,12288,20480,28672,36864,45056,53248,4096,380928,7729152
.long 234496,233472,373504,79360,2367392,2695072,6270976,589184,7616512,16236544,16900096,4525760,616448,2416800,7456768,768
.long 15360,23552,31744,39936,48128,268435456,7168,14336,22528,30720,38912,47104,268436480,6144,380928,7731200
.long 236544,235520,373632,79360,3022752,3350432,6273024,671104,7616512,16236544,16900096,4525792,616448,2437280,7730176,896
.long 9216,17408,25600,33792,41984,50176,1024,8192,16384,24576,32768,40960,49152,0,380928,7733248
.long 40960,41984,371200,78848,1057952,1385632,6594560,599296,8722432,16236544,16900096,5836416,657408,2376480,7732224,2560
.long 11264,19456,27648,35840,44032,52224,3072,10240,18432,26624,34816,43008,51200,2048,380928,8006656
.long 43008,44032,371328,78848,1713312,2040992,6596608,681216,8722432,16236544,16900096,5836448,657408,2396960,8005632,2688
.long 13312,21504,29696,37888,46080,54272,5120,12288,20480,28672,36864,45056,53248,4096,380928,8008704
.long 263168,262144,375296,79360,2368672,2696352,6598656,599424,8722432,16236544,16900096,5836480,657408,2417440,8007680,2560
.long 15360,23552,31744,39936,48128,268435456,7168,14336,22528,30720,38912,47104,268436480,6144,380928,8282112
.long 265216,264192,375424,79360,3024032,3351712,6600704,681344,8722432,16236544,16900096,5836512,657408,2437920,8009728,2688
.long 8192,16384,24576,32768,40960,49152,0,9216,17408,25600,33792,41984,50176,1024,286720,8284160
.long 12288,13312,279296,67584,1049024,1376704,4308992,527872,7616512,11370496,11812864,4522752,534528,491680,8283136,768
.long 10240,18432,26624,34816,43008,51200,2048,11264,19456,27648,35840,44032,52224,3072,286720,8286208
.long 14336,15360,279424,67584,1704384,2032064,4311040,609792,7616512,11370496,11812864,4522784,534528,512160,8285184,896
.long 12288,20480,28672,36864,45056,53248,4096,13312,21504,29696,37888,46080,54272,5120,286720,8559616
.long 234496,233472,283392,68096,2359744,2687424,4313088,528000,7616512,11370496,11812864,4522816,534528,532640,8558592,768
.long 14336,22528,30720,38912,47104,268435456,6144,15360,23552,31744,39936,48128,268436480,7168,286720,8561664
.long 236544,235520,283520,68096,3015104,3342784,4315136,609920,7616512,11370496,11812864,4522848,534528,553120,8560640,896
.long 8192,16384,24576,32768,40960,49152,0,9216,17408,25600,33792,41984,50176,1024,286720,8835072
.long 40960,41984,281088,67584,1050304,1377984,4636672,538112,8722432,11370496,11812864,5833472,575488,492320,8562688,2560
.long 10240,18432,26624,34816,43008,51200,2048,11264,19456,27648,35840,44032,52224,3072,286720,8837120
.long 43008,44032,281216,67584,1705664,2033344,4638720,620032,8722432,11370496,11812864,5833504,575488,512800,8836096,2688
.long 12288,20480,28672,36864,45056,53248,4096,13312,21504,29696,37888,46080,54272,5120,286720,8839168
.long 263168,262144,285184,68096,2361024,2688704,4640768,538240,8722432,11370496,11812864,5833536,575488,533280,8838144,2560
.long 14336,22528,30720,38912,47104,268435456,6144,15360,23552,31744,39936,48128,268436480,7168,286720,9112576
.long 265216,264192,285312,68096,3016384,3344064,4642816,620160,8722432,11370496,11812864,5833568,575488,553760,9111552,2688
.long 8192,16384,24576,32768,40960,49152,0,9216,17408,25600,33792,41984,50176,1024,319488,9114624
.long 12288,13312,312064,71680,1051584,1379264,4964352,548352,7616512,13139968,13582336,4523776,534528,1147040,9113600,768
.long 10240,18432,26624,34816,43008,51200,2048,11264,19456,27648,35840,44032,52224,3072,319488,9388032
.long 14336,15360,312192,71680,1706944,2034624,4966400,630272,7616512,13139968,13582336,4523808,534528,1167520,9115648,896
.long 12288,20480,28672,36864,45056,53248,4096,13312,21504,29696,37888,46080,54272,5120,319488,9390080
.long 234496,233472,316160,72192,2362304,2689984,4968448,548480,7616512,13139968,13582336,4523840,534528,1188000,9389056,768
.long 14336,22528,30720,38912,47104,268435456,6144,15360,23552,31744,39936,48128,268436480,7168,319488,9392128
.long 236544,235520,316288,72192,3017664,3345344,4970496,630400,7616512,13139968,13582336,4523872,534528,1208480,9391104,896
.long 8192,16384,24576,32768,40960,49152,0,9216,17408,25600,33792,41984,50176,1024,319488,7458816
.long 40960,41984,313856,71680,1052864,1380544,5292032,558592,8722432,13139968,13582336,5834496,575488,1147680,7457792,2560
.long 10240,18432,26624,34816,43008,51200,2048,11264,19456,27648,35840,44032,52224,3072,319488,7460864
.long 43008,44032,313984,71680,1708224,2035904,5294080,640512,8722432,13139968,13582336,5834528,575488,1168160,7459840,2688
.long 12288,20480,28672,36864,45056,53248,4096,13312,21504,29696,37888,46080,54272,5120,319488,7734272
.long 263168,262144,317952,72192,2363584,2691264,5296128,558720,8722432,13139968,13582336,5834560,575488,1188640,7461888,2560
.long 14336,22528,30720,38912,47104,268435456,6144,15360,23552,31744,39936,48128,268436480,7168,319488,7736320
.long 265216,264192,318080,72192,3018944,3346624,5298176,640640,8722432,13139968,13582336,5834592,575488,1209120,7735296,2688
.long 8192,16384,24576,32768,40960,49152,0,9216,17408,25600,33792,41984,50176,1024,352256,7738368
.long 12288,13312,344832,75776,1054144,1381824,5619712,568832,7616512,14909440,15351808,4524800,616448,1802400,7737344,768
.long 10240,18432,26624,34816,43008,51200,2048,11264,19456,27648,35840,44032,52224,3072,352256,8011776
.long 14336,15360,344960,75776,1709504,2037184,5621760,650752,7616512,14909440,15351808,4524832,616448,1822880,8010752,896
.long 12288,20480,28672,36864,45056,53248,4096,13312,21504,29696,37888,46080,54272,5120,352256,8013824
.long 234496,233472,348928,76288,2364864,2692544,5623808,568960,7616512,14909440,15351808,4524864,616448,1843360,8012800,768
.long 14336,22528,30720,38912,47104,268435456,6144,15360,23552,31744,39936,48128,268436480,7168,352256,8287232
.long 236544,235520,349056,76288,3020224,3347904,5625856,650880,7616512,14909440,15351808,4524896,616448,1863840,8014848,896
.long 8192,16384,24576,32768,40960,49152,0,9216,17408,25600,33792,41984,50176,1024,352256,8289280
.long 40960,41984,346624,75776,1055424,1383104,5947392,579072,8722432,14909440,15351808,5835520,657408,1803040,8288256,2560
.long 10240,18432,26624,34816,43008,51200,2048,11264,19456,27648,35840,44032,52224,3072,352256,8291328
.long 43008,44032,346752,75776,1710784,2038464,5949440,660992,8722432,14909440,15351808,5835552,657408,1823520,8290304,2688
.long 12288,20480,28672,36864,45056,53248,4096,13312,21504,29696,37888,46080,54272,5120,352256,8564736
.long 263168,262144,350720,76288,2366144,2693824,5951488,579200,8722432,14909440,15351808,5835584,657408,1844000,8563712,2560
.long 14336,22528,30720,38912,47104,268435456,6144,15360,23552,31744,39936,48128,268436480,7168,352256,8566784
.long 265216,264192,350848,76288,3021504,3349184,5953536,661120,8722432,14909440,15351808,5835616,657408,1864480,8565760,2688
.long 8192,16384,24576,32768,40960,49152,0,9216,17408,25600,33792,41984,50176,1024,385024,8840192
.long 12288,13312,377600,79872,1056704,1384384,6275072,589312,7616512,16678912,17121280,4525824,616448,2457760,8567808,768
.long 10240,18432,26624,34816,43008,51200,2048,11264,19456,27648,35840,44032,52224,3072,385024,8842240
.long 14336,15360,377728,79872,1712064,2039744,6277120,671232,7616512,16678912,17121280,4525856,616448,2478240,8841216,896
.long 12288,20480,28672,36864,45056,53248,4096,13312,21504,29696,37888,46080,54272,5120,385024,8844288
.long 234496,233472,381696,80384,2367424,2695104,6279168,589440,7616512,16678912,17121280,4525888,616448,2498720,8843264,768
.long 14336,22528,30720,38912,47104,268435456,6144,15360,23552,31744,39936,48128,268436480,7168,385024,9117696
.long 236544,235520,381824,80384,3022784,3350464,6281216,671360,7616512,16678912,17121280,4525920,616448,2519200,9116672,896
.long 8192,16384,24576,32768,40960,49152,0,9216,17408,25600,33792,41984,50176,1024,385024,9119744
.long 40960,41984,379392,79872,1057984,1385664,6602752,599552,8722432,16678912,17121280,5836544,657408,2458400,9118720,2560
.long 10240,18432,26624,34816,43008,51200,2048,11264,19456,27648,35840,44032,52224,3072,385024,9393152
.long 43008,44032,379520,79872,1713344,2041024,6604800,681472,8722432,16678912,17121280,5836576,657408,2478880,9120768,2688
.long 12288,20480,28672,36864,45056,53248,4096,13312,21504,29696,37888,46080,54272,5120,385024,9395200
.long 263168,262144,383488,80384,2368704,2696384,6606848,599680,8722432,16678912,17121280,5836608,657408,2499360,9394176,2560
.long 14336,22528,30720,38912,47104,268435456,6144,15360,23552,31744,39936,48128,268436480,7168,385024,9397248
.long 265216,264192,383616,80384,3024064,3351744,6608896,681600,8722432,16678912,17121280,5836640,657408,2519840,9396224,2688
.long 9216,17408,25600,33792,41984,50176,1024,8192,16384,24576,32768,40960,49152,0,290816,7463936
.long 12288,13312,287488,68608,1049056,1376736,4317184,528128,7616512,11812864,12034048,4522880,534528,573600,7462912,768
.long 11264,19456,27648,35840,44032,52224,3072,10240,18432,26624,34816,43008,51200,2048,290816,7465984
.long 14336,15360,287616,68608,1704416,2032096,4319232,610048,7616512,11812864,12034048,4522912,534528,594080,7464960,896
.long 13312,21504,29696,37888,46080,54272,5120,12288,20480,28672,36864,45056,53248,4096,290816,7739392
.long 234496,233472,291584,69120,2359776,2687456,4321280,528256,7616512,11812864,12034048,4522944,534528,614560,7467008,768
.long 15360,23552,31744,39936,48128,268435456,7168,14336,22528,30720,38912,47104,268436480,6144,290816,7741440
.long 236544,235520,291712,69120,3015136,3342816,4323328,610176,7616512,11812864,12034048,4522976,534528,635040,7740416,896
.long 9216,17408,25600,33792,41984,50176,1024,8192,16384,24576,32768,40960,49152,0,290816,7743488
.long 40960,41984,289280,68608,1050336,1378016,4644864,538368,8722432,11812864,12034048,5833600,575488,574240,7742464,2560
.long 11264,19456,27648,35840,44032,52224,3072,10240,18432,26624,34816,43008,51200,2048,290816,8016896
.long 43008,44032,289408,68608,1705696,2033376,4646912,620288,8722432,11812864,12034048,5833632,575488,594720,8015872,2688
.long 13312,21504,29696,37888,46080,54272,5120,12288,20480,28672,36864,45056,53248,4096,290816,8018944
.long 263168,262144,293376,69120,2361056,2688736,4648960,538496,8722432,11812864,12034048,5833664,575488,615200,8017920,2560
.long 15360,23552,31744,39936,48128,268435456,7168,14336,22528,30720,38912,47104,268436480,6144,290816,8292352
.long 265216,264192,293504,69120,3016416,3344096,4651008,620416,8722432,11812864,12034048,5833696,575488,635680,8019968,2688
.long 9216,17408,25600,33792,41984,50176,1024,8192,16384,24576,32768,40960,49152,0,323584,8294400
.long 12288,13312,320256,72704,1051616,1379296,4972544,548608,7616512,13582336,13803520,4523904,534528,1228960,8293376,768
.long 11264,19456,27648,35840,44032,52224,3072,10240,18432,26624,34816,43008,51200,2048,323584,8296448
.long 14336,15360,320384,72704,1706976,2034656,4974592,630528,7616512,13582336,13803520,4523936,534528,1249440,8295424,896
.long 13312,21504,29696,37888,46080,54272,5120,12288,20480,28672,36864,45056,53248,4096,323584,8569856
.long 234496,233472,324352,73216,2362336,2690016,4976640,548736,7616512,13582336,13803520,4523968,534528,1269920,8568832,768
.long 15360,23552,31744,39936,48128,268435456,7168,14336,22528,30720,38912,47104,268436480,6144,323584,8571904
.long 236544,235520,324480,73216,3017696,3345376,4978688,630656,7616512,13582336,13803520,4524000,534528,1290400,8570880,896
.long 9216,17408,25600,33792,41984,50176,1024,8192,16384,24576,32768,40960,49152,0,323584,8845312
.long 40960,41984,322048,72704,1052896,1380576,5300224,558848,8722432,13582336,13803520,5834624,575488,1229600,8572928,2560
.long 11264,19456,27648,35840,44032,52224,3072,10240,18432,26624,34816,43008,51200,2048,323584,8847360
.long 43008,44032,322176,72704,1708256,2035936,5302272,640768,8722432,13582336,13803520,5834656,575488,1250080,8846336,2688
.long 13312,21504,29696,37888,46080,54272,5120,12288,20480,28672,36864,45056,53248,4096,323584,8849408
.long 263168,262144,326144,73216,2363616,2691296,5304320,558976,8722432,13582336,13803520,5834688,575488,1270560,8848384,2560
.long 15360,23552,31744,39936,48128,268435456,7168,14336,22528,30720,38912,47104,268436480,6144,323584,9122816
.long 265216,264192,326272,73216,3018976,3346656,5306368,640896,8722432,13582336,13803520,5834720,575488,1291040,9121792,2688
.long 9216,17408,25600,33792,41984,50176,1024,8192,16384,24576,32768,40960,49152,0,356352,9124864
.long 12288,13312,353024,76800,1054176,1381856,5627904,569088,7616512,15351808,15572992,4524928,616448,1884320,9123840,768
.long 11264,19456,27648,35840,44032,52224,3072,10240,18432,26624,34816,43008,51200,2048,356352,9398272
.long 14336,15360,353152,76800,1709536,2037216,5629952,651008,7616512,15351808,15572992,4524960,616448,1904800,9125888,896
.long 13312,21504,29696,37888,46080,54272,5120,12288,20480,28672,36864,45056,53248,4096,356352,9400320
.long 234496,233472,357120,77312,2364896,2692576,5632000,569216,7616512,15351808,15572992,4524992,616448,1925280,9399296,768
.long 15360,23552,31744,39936,48128,268435456,7168,14336,22528,30720,38912,47104,268436480,6144,356352,9402368
.long 236544,235520,357248,77312,3020256,3347936,5634048,651136,7616512,15351808,15572992,4525024,616448,1945760,9401344,896
.long 9216,17408,25600,33792,41984,50176,1024,8192,16384,24576,32768,40960,49152,0,356352,7469056
.long 40960,41984,354816,76800,1055456,1383136,5955584,579328,8722432,15351808,15572992,5835648,657408,1884960,7468032,2560
.long 11264,19456,27648,35840,44032,52224,3072,10240,18432,26624,34816,43008,51200,2048,356352,7471104
.long 43008,44032,354944,76800,1710816,2038496,5957632,661248,8722432,15351808,15572992,5835680,657408,1905440,7470080,2688
.long 13312,21504,29696,37888,46080,54272,5120,12288,20480,28672,36864,45056,53248,4096,356352,7744512
.long 263168,262144,358912,77312,2366176,2693856,5959680,579456,8722432,15351808,15572992,5835712,657408,1925920,7472128,2560
.long 15360,23552,31744,39936,48128,268435456,7168,14336,22528,30720,38912,47104,268436480,6144,356352,7746560
.long 265216,264192,359040,77312,3021536,3349216,5961728,661376,8722432,15351808,15572992,5835744,657408,1946400,7745536,2688
.long 9216,17408,25600,33792,41984,50176,1024,8192,16384,24576,32768,40960,49152,0,389120,7748608
.long 12288,13312,385792,80896,1056736,1384416,6283264,589568,7616512,17121280,17342464,4525952,616448,2539680,7747584,768
.long 11264,19456,27648,35840,44032,52224,3072,10240,18432,26624,34816,43008,51200,2048,389120,8022016
.long 14336,15360,385920,80896,1712096,2039776,6285312,671488,7616512,17121280,17342464,4525984,616448,2560160,8020992,896
.long 13312,21504,29696,37888,46080,54272,5120,12288,20480,28672,36864,45056,53248,4096,389120,8024064
.long 234496,233472,389888,81408,2367456,2695136,6287360,589696,7616512,17121280,17342464,4526016,616448,2580640,8023040,768
.long 15360,23552,31744,39936,48128,268435456,7168,14336,22528,30720,38912,47104,268436480,6144,389120,8297472
.long 236544,235520,390016,81408,3022816,3350496,6289408,671616,7616512,17121280,17342464,4526048,616448,2601120,8025088,896
.long 9216,17408,25600,33792,41984,50176,1024,8192,16384,24576,32768,40960,49152,0,389120,8299520
.long 40960,41984,387584,80896,1058016,1385696,6610944,599808,8722432,17121280,17342464,5836672,657408,2540320,8298496,2560
.long 11264,19456,27648,35840,44032,52224,3072,10240,18432,26624,34816,43008,51200,2048,389120,8301568
.long 43008,44032,387712,80896,1713376,2041056,6612992,681728,8722432,17121280,17342464,5836704,657408,2560800,8300544,2688
.long 13312,21504,29696,37888,46080,54272,5120,12288,20480,28672,36864,45056,53248,4096,389120,8574976
.long 263168,262144,391680,81408,2368736,2696416,6615040,599936,8722432,17121280,17342464,5836736,657408,2581280,8573952,2560
.long 15360,23552,31744,39936,48128,268435456,7168,14336,22528,30720,38912,47104,268436480,6144,389120,8577024
.long 265216,264192,391808,81408,3024096,3351776,6617088,681856,8722432,17121280,17342464,5836768,657408,2601760,8576000,2688
.long 16384,24576,32768,40960,49152,0,8192,17408,25600,33792,41984,50176,1024,9216,262144,8850432
.long 16384,17408,263168,65536,1049088,1376768,4325376,528384,7892992,10485760,10485760,4849664,544768,320,8578048,1024
.long 18432,26624,34816,43008,51200,2048,10240,19456,27648,35840,44032,52224,3072,11264,262144,8852480
.long 18432,19456,263296,65536,1704448,2032128,4327424,610304,7892992,10485760,10485760,4849696,544768,20800,8851456,1152
.long 20480,28672,36864,45056,53248,4096,12288,21504,29696,37888,46080,54272,5120,13312,262144,8854528
.long 238592,237568,267264,66048,2359808,2687488,4329472,528512,7892992,10485760,10485760,4849728,544768,41280,8853504,1024
.long 22528,30720,38912,47104,268435456,6144,14336,23552,31744,39936,48128,268436480,7168,15360,262144,9127936
.long 240640,239616,267392,66048,3015168,3342848,4331520,610432,7892992,10485760,10485760,4849760,544768,61760,9126912,1152
.long 16384,24576,32768,40960,49152,0,8192,17408,25600,33792,41984,50176,1024,9216,262144,9129984
.long 45056,46080,264960,65536,1050368,1378048,4653056,538624,8998912,10485760,10485760,6160384,585728,960,9128960,2816
.long 18432,26624,34816,43008,51200,2048,10240,19456,27648,35840,44032,52224,3072,11264,262144,9403392
.long 47104,48128,265088,65536,1705728,2033408,4655104,620544,8998912,10485760,10485760,6160416,585728,21440,9131008,2944
.long 20480,28672,36864,45056,53248,4096,12288,21504,29696,37888,46080,54272,5120,13312,262144,9405440
.long 267264,266240,269056,66048,2361088,2688768,4657152,538752,8998912,10485760,10485760,6160448,585728,41920,9404416,2816
.long 22528,30720,38912,47104,268435456,6144,14336,23552,31744,39936,48128,268436480,7168,15360,262144,9407488
.long 269312,268288,269184,66048,3016448,3344128,4659200,620672,8998912,10485760,10485760,6160480,585728,62400,9406464,2944
.long 16384,24576,32768,40960,49152,0,8192,17408,25600,33792,41984,50176,1024,9216,294912,7474176
.long 16384,17408,295936,69632,1051648,1379328,4980736,548864,7892992,12255232,12255232,4850688,544768,655680,7473152,1024
.long 18432,26624,34816,43008,51200,2048,10240,19456,27648,35840,44032,52224,3072,11264,294912,7476224
.long 18432,19456,296064,69632,1707008,2034688,4982784,630784,7892992,12255232,12255232,4850720,544768,676160,7475200,1152
.long 20480,28672,36864,45056,53248,4096,12288,21504,29696,37888,46080,54272,5120,13312,294912,7749632
.long 238592,237568,300032,70144,2362368,2690048,4984832,548992,7892992,12255232,12255232,4850752,544768,696640,7477248,1024
.long 22528,30720,38912,47104,268435456,6144,14336,23552,31744,39936,48128,268436480,7168,15360,294912,7751680
.long 240640,239616,300160,70144,3017728,3345408,4986880,630912,7892992,12255232,12255232,4850784,544768,717120,7750656,1152
.long 16384,24576,32768,40960,49152,0,8192,17408,25600,33792,41984,50176,1024,9216,294912,7753728
.long 45056,46080,297728,69632,1052928,1380608,5308416,559104,8998912,12255232,12255232,6161408,585728,656320,7752704,2816
.long 18432,26624,34816,43008,51200,2048,10240,19456,27648,35840,44032,52224,3072,11264,294912,8027136
.long 47104,48128,297856,69632,1708288,2035968,5310464,641024,8998912,12255232,12255232,6161440,585728,676800,8026112,2944
.long 20480,28672,36864,45056,53248,4096,12288,21504,29696,37888,46080,54272,5120,13312,294912,8029184
.long 267264,266240,301824,70144,2363648,2691328,5312512,559232,8998912,12255232,12255232,6161472,585728,697280,8028160,2816
.long 22528,30720,38912,47104,268435456,6144,14336,23552,31744,39936,48128,268436480,7168,15360,294912,8302592
.long 269312,268288,301952,70144,3019008,3346688,5314560,641152,8998912,12255232,12255232,6161504,585728,717760,8030208,2944
.long 16384,24576,32768,40960,49152,0,8192,17408,25600,33792,41984,50176,1024,9216,327680,8304640
.long 16384,17408,328704,73728,1054208,1381888,5636096,569344,7892992,14024704,14024704,4851712,626688,1311040,8303616,1024
.long 18432,26624,34816,43008,51200,2048,10240,19456,27648,35840,44032,52224,3072,11264,327680,8306688
.long 18432,19456,328832,73728,1709568,2037248,5638144,651264,7892992,14024704,14024704,4851744,626688,1331520,8305664,1152
.long 20480,28672,36864,45056,53248,4096,12288,21504,29696,37888,46080,54272,5120,13312,327680,8580096
.long 238592,237568,332800,74240,2364928,2692608,5640192,569472,7892992,14024704,14024704,4851776,626688,1352000,8579072,1024
.long 22528,30720,38912,47104,268435456,6144,14336,23552,31744,39936,48128,268436480,7168,15360,327680,8582144
.long 240640,239616,332928,74240,3020288,3347968,5642240,651392,7892992,14024704,14024704,4851808,626688,1372480,8581120,1152
.long 16384,24576,32768,40960,49152,0,8192,17408,25600,33792,41984,50176,1024,9216,327680,8855552
.long 45056,46080,330496,73728,1055488,1383168,5963776,579584,8998912,14024704,14024704,6162432,667648,1311680,8583168,2816
.long 18432,26624,34816,43008,51200,2048,10240,19456,27648,35840,44032,52224,3072,11264,327680,8857600
.long 47104,48128,330624,73728,1710848,2038528,5965824,661504,8998912,14024704,14024704,6162464,667648,1332160,8856576,2944
.long 20480,28672,36864,45056,53248,4096,12288,21504,29696,37888,46080,54272,5120,13312,327680,8859648
.long 267264,266240,334592,74240,2366208,2693888,5967872,579712,8998912,14024704,14024704,6162496,667648,1352640,8858624,2816
.long 22528,30720,38912,47104,268435456,6144,14336,23552,31744,39936,48128,268436480,7168,15360,327680,9133056
.long 269312,268288,334720,74240,3021568,3349248,5969920,661632,8998912,14024704,14024704,6162528,667648,1373120,9132032,2944
.long 16384,24576,32768,40960,49152,0,8192,17408,25600,33792,41984,50176,1024,9216,360448,9135104
.long 16384,17408,361472,77824,1056768,1384448,6291456,589824,7892992,15794176,15794176,4852736,626688,1966400,9134080,1024
.long 18432,26624,34816,43008,51200,2048,10240,19456,27648,35840,44032,52224,3072,11264,360448,9408512
.long 18432,19456,361600,77824,1712128,2039808,6293504,671744,7892992,15794176,15794176,4852768,626688,1986880,9136128,1152
.long 20480,28672,36864,45056,53248,4096,12288,21504,29696,37888,46080,54272,5120,13312,360448,9410560
.long 238592,237568,365568,78336,2367488,2695168,6295552,589952,7892992,15794176,15794176,4852800,626688,2007360,9409536,1024
.long 22528,30720,38912,47104,268435456,6144,14336,23552,31744,39936,48128,268436480,7168,15360,360448,9412608
.long 240640,239616,365696,78336,3022848,3350528,6297600,671872,7892992,15794176,15794176,4852832,626688,2027840,9411584,1152
.long 16384,24576,32768,40960,49152,0,8192,17408,25600,33792,41984,50176,1024,9216,360448,7479296
.long 45056,46080,363264,77824,1058048,1385728,6619136,600064,8998912,15794176,15794176,6163456,667648,1967040,7478272,2816
.long 18432,26624,34816,43008,51200,2048,10240,19456,27648,35840,44032,52224,3072,11264,360448,7481344
.long 47104,48128,363392,77824,1713408,2041088,6621184,681984,8998912,15794176,15794176,6163488,667648,1987520,7480320,2944
.long 20480,28672,36864,45056,53248,4096,12288,21504,29696,37888,46080,54272,5120,13312,360448,7754752
.long 267264,266240,367360,78336,2368768,2696448,6623232,600192,8998912,15794176,15794176,6163520,667648,2008000,7482368,2816
.long 22528,30720,38912,47104,268435456,6144,14336,23552,31744,39936,48128,268436480,7168,15360,360448,7756800
.long 269312,268288,367488,78336,3024128,3351808,6625280,682112,8998912,15794176,15794176,6163552,667648,2028480,7755776,2944
.long 17408,25600,33792,41984,50176,1024,9216,16384,24576,32768,40960,49152,0,8192,266240,7758848
.long 16384,17408,271360,66560,1049120,1376800,4333568,528640,7892992,10928128,10706944,4849792,544768,82240,7757824,1024
.long 19456,27648,35840,44032,52224,3072,11264,18432,26624,34816,43008,51200,2048,10240,266240,8032256
.long 18432,19456,271488,66560,1704480,2032160,4335616,610560,7892992,10928128,10706944,4849824,544768,102720,8031232,1152
.long 21504,29696,37888,46080,54272,5120,13312,20480,28672,36864,45056,53248,4096,12288,266240,8034304
.long 238592,237568,275456,67072,2359840,2687520,4337664,528768,7892992,10928128,10706944,4849856,544768,123200,8033280,1024
.long 23552,31744,39936,48128,268435456,7168,15360,22528,30720,38912,47104,268436480,6144,14336,266240,8307712
.long 240640,239616,275584,67072,3015200,3342880,4339712,610688,7892992,10928128,10706944,4849888,544768,143680,8035328,1152
.long 17408,25600,33792,41984,50176,1024,9216,16384,24576,32768,40960,49152,0,8192,266240,8309760
.long 45056,46080,273152,66560,1050400,1378080,4661248,538880,8998912,10928128,10706944,6160512,585728,82880,8308736,2816
.long 19456,27648,35840,44032,52224,3072,11264,18432,26624,34816,43008,51200,2048,10240,266240,8311808
.long 47104,48128,273280,66560,1705760,2033440,4663296,620800,8998912,10928128,10706944,6160544,585728,103360,8310784,2944
.long 21504,29696,37888,46080,54272,5120,13312,20480,28672,36864,45056,53248,4096,12288,266240,8585216
.long 267264,266240,277248,67072,2361120,2688800,4665344,539008,8998912,10928128,10706944,6160576,585728,123840,8584192,2816
.long 23552,31744,39936,48128,268435456,7168,15360,22528,30720,38912,47104,268436480,6144,14336,266240,8587264
.long 269312,268288,277376,67072,3016480,3344160,4667392,620928,8998912,10928128,10706944,6160608,585728,144320,8586240,2944
.long 17408,25600,33792,41984,50176,1024,9216,16384,24576,32768,40960,49152,0,8192,299008,8860672
.long 16384,17408,304128,70656,1051680,1379360,4988928,549120,7892992,12697600,12476416,4850816,544768,737600,8588288,1024
.long 19456,27648,35840,44032,52224,3072,11264,18432,26624,34816,43008,51200,2048,10240,299008,8862720
.long 18432,19456,304256,70656,1707040,2034720,4990976,631040,7892992,12697600,12476416,4850848,544768,758080,8861696,1152
.long 21504,29696,37888,46080,54272,5120,13312,20480,28672,36864,45056,53248,4096,12288,299008,8864768
.long 238592,237568,308224,71168,2362400,2690080,4993024,549248,7892992,12697600,12476416,4850880,544768,778560,8863744,1024
.long 23552,31744,39936,48128,268435456,7168,15360,22528,30720,38912,47104,268436480,6144,14336,299008,9138176
.long 240640,239616,308352,71168,3017760,3345440,4995072,631168,7892992,12697600,12476416,4850912,544768,799040,9137152,1152
.long 17408,25600,33792,41984,50176,1024,9216,16384,24576,32768,40960,49152,0,8192,299008,9140224
.long 45056,46080,305920,70656,1052960,1380640,5316608,559360,8998912,12697600,12476416,6161536,585728,738240,9139200,2816
.long 19456,27648,35840,44032,52224,3072,11264,18432,26624,34816,43008,51200,2048,10240,299008,9413632
.long 47104,48128,306048,70656,1708320,2036000,5318656,641280,8998912,12697600,12476416,6161568,585728,758720,9141248,2944
.long 21504,29696,37888,46080,54272,5120,13312,20480,28672,36864,45056,53248,4096,12288,299008,9415680
.long 267264,266240,310016,71168,2363680,2691360,5320704,559488,8998912,12697600,12476416,6161600,585728,779200,9414656,2816
.long 23552,31744,39936,48128,268435456,7168,15360,22528,30720,38912,47104,268436480,6144,14336,299008,9417728
.long 269312,268288,310144,71168,3019040,3346720,5322752,641408,8998912,12697600,12476416,6161632,585728,799680,9416704,2944
.long 17408,25600,33792,41984,50176,1024,9216,16384,24576,32768,40960,49152,0,8192,331776,7484416
.long 16384,17408,336896,74752,1054240,1381920,5644288,569600,7892992,14467072,14245888,4851840,626688,1392960,7483392,1024
.long 19456,27648,35840,44032,52224,3072,11264,18432,26624,34816,43008,51200,2048,10240,331776,7486464
.long 18432,19456,337024,74752,1709600,2037280,5646336,651520,7892992,14467072,14245888,4851872,626688,1413440,7485440,1152
.long 21504,29696,37888,46080,54272,5120,13312,20480,28672,36864,45056,53248,4096,12288,331776,7759872
.long 238592,237568,340992,75264,2364960,2692640,5648384,569728,7892992,14467072,14245888,4851904,626688,1433920,7487488,1024
.long 23552,31744,39936,48128,268435456,7168,15360,22528,30720,38912,47104,268436480,6144,14336,331776,7761920
.long 240640,239616,341120,75264,3020320,3348000,5650432,651648,7892992,14467072,14245888,4851936,626688,1454400,7760896,1152
.long 17408,25600,33792,41984,50176,1024,9216,16384,24576,32768,40960,49152,0,8192,331776,7763968
.long 45056,46080,338688,74752,1055520,1383200,5971968,579840,8998912,14467072,14245888,6162560,667648,1393600,7762944,2816
.long 19456,27648,35840,44032,52224,3072,11264,18432,26624,34816,43008,51200,2048,10240,331776,8037376
.long 47104,48128,338816,74752,1710880,2038560,5974016,661760,8998912,14467072,14245888,6162592,667648,1414080,8036352,2944
.long 21504,29696,37888,46080,54272,5120,13312,20480,28672,36864,45056,53248,4096,12288,331776,8039424
.long 267264,266240,342784,75264,2366240,2693920,5976064,579968,8998912,14467072,14245888,6162624,667648,1434560,8038400,2816
.long 23552,31744,39936,48128,268435456,7168,15360,22528,30720,38912,47104,268436480,6144,14336,331776,8312832
.long 269312,268288,342912,75264,3021600,3349280,5978112,661888,8998912,14467072,14245888,6162656,667648,1455040,8040448,2944
.long 17408,25600,33792,41984,50176,1024,9216,16384,24576,32768,40960,49152,0,8192,364544,8314880
.long 16384,17408,369664,78848,1056800,1384480,6299648,590080,7892992,16236544,16015360,4852864,626688,2048320,8313856,1024
.long 19456,27648,35840,44032,52224,3072,11264,18432,26624,34816,43008,51200,2048,10240,364544,8316928
.long 18432,19456,369792,78848,1712160,2039840,6301696,672000,7892992,16236544,16015360,4852896,626688,2068800,8315904,1152
.long 21504,29696,37888,46080,54272,5120,13312,20480,28672,36864,45056,53248,4096,12288,364544,8590336
.long 238592,237568,373760,79360,2367520,2695200,6303744,590208,7892992,16236544,16015360,4852928,626688,2089280,8589312,1024
.long 23552,31744,39936,48128,268435456,7168,15360,22528,30720,38912,47104,268436480,6144,14336,364544,8592384
.long 240640,239616,373888,79360,3022880,3350560,6305792,672128,7892992,16236544,16015360,4852960,626688,2109760,8591360,1152
.long 17408,25600,33792,41984,50176,1024,9216,16384,24576,32768,40960,49152,0,8192,364544,8865792
.long 45056,46080,371456,78848,1058080,1385760,6627328,600320,8998912,16236544,16015360,6163584,667648,2048960,8593408,2816
.long 19456,27648,35840,44032,52224,3072,11264,18432,26624,34816,43008,51200,2048,10240,364544,8867840
.long 47104,48128,371584,78848,1713440,2041120,6629376,682240,8998912,16236544,16015360,6163616,667648,2069440,8866816,2944
.long 21504,29696,37888,46080,54272,5120,13312,20480,28672,36864,45056,53248,4096,12288,364544,8869888
.long 267264,266240,375552,79360,2368800,2696480,6631424,600448,8998912,16236544,16015360,6163648,667648,2089920,8868864,2816
.long 23552,31744,39936,48128,268435456,7168,15360,22528,30720,38912,47104,268436480,6144,14336,364544,9143296
.long 269312,268288,375680,79360,3024160,3351840,6633472,682368,8998912,16236544,16015360,6163680,667648,2110400,9142272,2944
.long 16384,24576,32768,40960,49152,0,8192,17408,25600,33792,41984,50176,1024,9216,270336,9145344
.long 16384,17408,279552,67584,1049152,1376832,4341760,528896,7892992,11370496,10928128,4849920,544768,164160,9144320,1024
.long 18432,26624,34816,43008,51200,2048,10240,19456,27648,35840,44032,52224,3072,11264,270336,9418752
.long 18432,19456,279680,67584,1704512,2032192,4343808,610816,7892992,11370496,10928128,4849952,544768,184640,9146368,1152
.long 20480,28672,36864,45056,53248,4096,12288,21504,29696,37888,46080,54272,5120,13312,270336,9420800
.long 238592,237568,283648,68096,2359872,2687552,4345856,529024,7892992,11370496,10928128,4849984,544768,205120,9419776,1024
.long 22528,30720,38912,47104,268435456,6144,14336,23552,31744,39936,48128,268436480,7168,15360,270336,9422848
.long 240640,239616,283776,68096,3015232,3342912,4347904,610944,7892992,11370496,10928128,4850016,544768,225600,9421824,1152
.long 16384,24576,32768,40960,49152,0,8192,17408,25600,33792,41984,50176,1024,9216,270336,7489536
.long 45056,46080,281344,67584,1050432,1378112,4669440,539136,8998912,11370496,10928128,6160640,585728,164800,7488512,2816
.long 18432,26624,34816,43008,51200,2048,10240,19456,27648,35840,44032,52224,3072,11264,270336,7491584
.long 47104,48128,281472,67584,1705792,2033472,4671488,621056,8998912,11370496,10928128,6160672,585728,185280,7490560,2944
.long 20480,28672,36864,45056,53248,4096,12288,21504,29696,37888,46080,54272,5120,13312,270336,7764992
.long 267264,266240,285440,68096,2361152,2688832,4673536,539264,8998912,11370496,10928128,6160704,585728,205760,7492608,2816
.long 22528,30720,38912,47104,268435456,6144,14336,23552,31744,39936,48128,268436480,7168,15360,270336,7767040
.long 269312,268288,285568,68096,3016512,3344192,4675584,621184,8998912,11370496,10928128,6160736,585728,226240,7766016,2944
.long 16384,24576,32768,40960,49152,0,8192,17408,25600,33792,41984,50176,1024,9216,303104,7769088
.long 16384,17408,312320,71680,1051712,1379392,4997120,549376,7892992,13139968,12697600,4850944,544768,819520,7768064,1024
.long 18432,26624,34816,43008,51200,2048,10240,19456,27648,35840,44032,52224,3072,11264,303104,8042496
.long 18432,19456,312448,71680,1707072,2034752,4999168,631296,7892992,13139968,12697600,4850976,544768,840000,8041472,1152
.long 20480,28672,36864,45056,53248,4096,12288,21504,29696,37888,46080,54272,5120,13312,303104,8044544
.long 238592,237568,316416,72192,2362432,2690112,5001216,549504,7892992,13139968,12697600,4851008,544768,860480,8043520,1024
.long 22528,30720,38912,47104,268435456,6144,14336,23552,31744,39936,48128,268436480,7168,15360,303104,8317952
.long 240640,239616,316544,72192,3017792,3345472,5003264,631424,7892992,13139968,12697600,4851040,544768,880960,8045568,1152
.long 16384,24576,32768,40960,49152,0,8192,17408,25600,33792,41984,50176,1024,9216,303104,8320000
.long 45056,46080,314112,71680,1052992,1380672,5324800,559616,8998912,13139968,12697600,6161664,585728,820160,8318976,2816
.long 18432,26624,34816,43008,51200,2048,10240,19456,27648,35840,44032,52224,3072,11264,303104,8322048
.long 47104,48128,314240,71680,1708352,2036032,5326848,641536,8998912,13139968,12697600,6161696,585728,840640,8321024,2944
.long 20480,28672,36864,45056,53248,4096,12288,21504,29696,37888,46080,54272,5120,13312,303104,8595456
.long 267264,266240,318208,72192,2363712,2691392,5328896,559744,8998912,13139968,12697600,6161728,585728,861120,8594432,2816
.long 22528,30720,38912,47104,268435456,6144,14336,23552,31744,39936,48128,268436480,7168,15360,303104,8597504
.long 269312,268288,318336,72192,3019072,3346752,5330944,641664,8998912,13139968,12697600,6161760,585728,881600,8596480,2944
.long 16384,24576,32768,40960,49152,0,8192,17408,25600,33792,41984,50176,1024,9216,335872,8870912
.long 16384,17408,345088,75776,1054272,1381952,5652480,569856,7892992,14909440,14467072,4851968,626688,1474880,8598528,1024
.long 18432,26624,34816,43008,51200,2048,10240,19456,27648,35840,44032,52224,3072,11264,335872,8872960
.long 18432,19456,345216,75776,1709632,2037312,5654528,651776,7892992,14909440,14467072,4852000,626688,1495360,8871936,1152
.long 20480,28672,36864,45056,53248,4096,12288,21504,29696,37888,46080,54272,5120,13312,335872,8875008
.long 238592,237568,349184,76288,2364992,2692672,5656576,569984,7892992,14909440,14467072,4852032,626688,1515840,8873984,1024
.long 22528,30720,38912,47104,268435456,6144,14336,23552,31744,39936,48128,268436480,7168,15360,335872,9148416
.long 240640,239616,349312,76288,3020352,3348032,5658624,651904,7892992,14909440,14467072,4852064,626688,1536320,9147392,1152
.long 16384,24576,32768,40960,49152,0,8192,17408,25600,33792,41984,50176,1024,9216,335872,9150464
.long 45056,46080,346880,75776,1055552,1383232,5980160,580096,8998912,14909440,14467072,6162688,667648,1475520,9149440,2816
.long 18432,26624,34816,43008,51200,2048,10240,19456,27648,35840,44032,52224,3072,11264,335872,9423872
.long 47104,48128,347008,75776,1710912,2038592,5982208,662016,8998912,14909440,14467072,6162720,667648,1496000,9151488,2944
.long 20480,28672,36864,45056,53248,4096,12288,21504,29696,37888,46080,54272,5120,13312,335872,9425920
.long 267264,266240,350976,76288,2366272,2693952,5984256,580224,8998912,14909440,14467072,6162752,667648,1516480,9424896,2816
.long 22528,30720,38912,47104,268435456,6144,14336,23552,31744,39936,48128,268436480,7168,15360,335872,9427968
.long 269312,268288,351104,76288,3021632,3349312,5986304,662144,8998912,14909440,14467072,6162784,667648,1536960,9426944,2944
.long 16384,24576,32768,40960,49152,0,8192,17408,25600,33792,41984,50176,1024,9216,368640,7494656
.long 16384,17408,377856,79872,1056832,1384512,6307840,590336,7892992,16678912,16236544,4852992,626688,2130240,7493632,1024
.long 18432,26624,34816,43008,51200,2048,10240,19456,27648,35840,44032,52224,3072,11264,368640,7496704
.long 18432,19456,377984,79872,1712192,2039872,6309888,672256,7892992,16678912,16236544,4853024,626688,2150720,7495680,1152
.long 20480,28672,36864,45056,53248,4096,12288,21504,29696,37888,46080,54272,5120,13312,368640,7770112
.long 238592,237568,381952,80384,2367552,2695232,6311936,590464,7892992,16678912,16236544,4853056,626688,2171200,7497728,1024
.long 22528,30720,38912,47104,268435456,6144,14336,23552,31744,39936,48128,268436480,7168,15360,368640,7772160
.long 240640,239616,382080,80384,3022912,3350592,6313984,672384,7892992,16678912,16236544,4853088,626688,2191680,7771136,1152
.long 16384,24576,32768,40960,49152,0,8192,17408,25600,33792,41984,50176,1024,9216,368640,7774208
.long 45056,46080,379648,79872,1058112,1385792,6635520,600576,8998912,16678912,16236544,6163712,667648,2130880,7773184,2816
.long 18432,26624,34816,43008,51200,2048,10240,19456,27648,35840,44032,52224,3072,11264,368640,8047616
.long 47104,48128,379776,79872,1713472,2041152,6637568,682496,8998912,16678912,16236544,6163744,667648,2151360,8046592,2944
.long 20480,28672,36864,45056,53248,4096,12288,21504,29696,37888,46080,54272,5120,13312,368640,8049664
.long 267264,266240,383744,80384,2368832,2696512,6639616,600704,8998912,16678912,16236544,6163776,667648,2171840,8048640,2816
.long 22528,30720,38912,47104,268435456,6144,14336,23552,31744,39936,48128,268436480,7168,15360,368640,8323072
.long 269312,268288,383872,80384,3024192,3351872,6641664,682624,8998912,16678912,16236544,6163808,667648,2192320,8050688,2944
.long 17408,25600,33792,41984,50176,1024,9216,16384,24576,32768,40960,49152,0,8192,274432,8325120
.long 16384,17408,287744,68608,1049184,1376864,4349952,529152,7892992,11812864,11149312,4850048,544768,246080,8324096,1024
.long 19456,27648,35840,44032,52224,3072,11264,18432,26624,34816,43008,51200,2048,10240,274432,8327168
.long 18432,19456,287872,68608,1704544,2032224,4352000,611072,7892992,11812864,11149312,4850080,544768,266560,8326144,1152
.long 21504,29696,37888,46080,54272,5120,13312,20480,28672,36864,45056,53248,4096,12288,274432,8600576
.long 238592,237568,291840,69120,2359904,2687584,4354048,529280,7892992,11812864,11149312,4850112,544768,287040,8599552,1024
.long 23552,31744,39936,48128,268435456,7168,15360,22528,30720,38912,47104,268436480,6144,14336,274432,8602624
.long 240640,239616,291968,69120,3015264,3342944,4356096,611200,7892992,11812864,11149312,4850144,544768,307520,8601600,1152
.long 17408,25600,33792,41984,50176,1024,9216,16384,24576,32768,40960,49152,0,8192,274432,8876032
.long 45056,46080,289536,68608,1050464,1378144,4677632,539392,8998912,11812864,11149312,6160768,585728,246720,8603648,2816
.long 19456,27648,35840,44032,52224,3072,11264,18432,26624,34816,43008,51200,2048,10240,274432,8878080
.long 47104,48128,289664,68608,1705824,2033504,4679680,621312,8998912,11812864,11149312,6160800,585728,267200,8877056,2944
.long 21504,29696,37888,46080,54272,5120,13312,20480,28672,36864,45056,53248,4096,12288,274432,8880128
.long 267264,266240,293632,69120,2361184,2688864,4681728,539520,8998912,11812864,11149312,6160832,585728,287680,8879104,2816
.long 23552,31744,39936,48128,268435456,7168,15360,22528,30720,38912,47104,268436480,6144,14336,274432,9153536
.long 269312,268288,293760,69120,3016544,3344224,4683776,621440,8998912,11812864,11149312,6160864,585728,308160,9152512,2944
.long 17408,25600,33792,41984,50176,1024,9216,16384,24576,32768,40960,49152,0,8192,307200,9155584
.long 16384,17408,320512,72704,1051744,1379424,5005312,549632,7892992,13582336,12918784,4851072,544768,901440,9154560,1024
.long 19456,27648,35840,44032,52224,3072,11264,18432,26624,34816,43008,51200,2048,10240,307200,9428992
.long 18432,19456,320640,72704,1707104,2034784,5007360,631552,7892992,13582336,12918784,4851104,544768,921920,9156608,1152
.long 21504,29696,37888,46080,54272,5120,13312,20480,28672,36864,45056,53248,4096,12288,307200,9431040
.long 238592,237568,324608,73216,2362464,2690144,5009408,549760,7892992,13582336,12918784,4851136,544768,942400,9430016,1024
.long 23552,31744,39936,48128,268435456,7168,15360,22528,30720,38912,47104,268436480,6144,14336,307200,9433088
.long 240640,239616,324736,73216,3017824,3345504,5011456,631680,7892992,13582336,12918784,4851168,544768,962880,9432064,1152
.long 17408,25600,33792,41984,50176,1024,9216,16384,24576,32768,40960,49152,0,8192,307200,7499776
.long 45056,46080,322304,72704,1053024,1380704,5332992,559872,8998912,13582336,12918784,6161792,585728,902080,7498752,2816
.long 19456,27648,35840,44032,52224,3072,11264,18432,26624,34816,43008,51200,2048,10240,307200,7501824
.long 47104,48128,322432,72704,1708384,2036064,5335040,641792,8998912,13582336,12918784,6161824,585728,922560,7500800,2944
.long 21504,29696,37888,46080,54272,5120,13312,20480,28672,36864,45056,53248,4096,12288,307200,7775232
.long 267264,266240,326400,73216,2363744,2691424,5337088,560000,8998912,13582336,12918784,6161856,585728,943040,7502848,2816
.long 23552,31744,39936,48128,268435456,7168,15360,22528,30720,38912,47104,268436480,6144,14336,307200,7777280
.long 269312,268288,326528,73216,3019104,3346784,5339136,641920,8998912,13582336,12918784,6161888,585728,963520,7776256,2944
.long 17408,25600,33792,41984,50176,1024,9216,16384,24576,32768,40960,49152,0,8192,339968,7779328
.long 16384,17408,353280,76800,1054304,1381984,5660672,570112,7892992,15351808,14688256,4852096,626688,1556800,7778304,1024
.long 19456,27648,35840,44032,52224,3072,11264,18432,26624,34816,43008,51200,2048,10240,339968,8052736
.long 18432,19456,353408,76800,1709664,2037344,5662720,652032,7892992,15351808,14688256,4852128,626688,1577280,8051712,1152
.long 21504,29696,37888,46080,54272,5120,13312,20480,28672,36864,45056,53248,4096,12288,339968,8054784
.long 238592,237568,357376,77312,2365024,2692704,5664768,570240,7892992,15351808,14688256,4852160,626688,1597760,8053760,1024
.long 23552,31744,39936,48128,268435456,7168,15360,22528,30720,38912,47104,268436480,6144,14336,339968,8328192
.long 240640,239616,357504,77312,3020384,3348064,5666816,652160,7892992,15351808,14688256,4852192,626688,1618240,8055808,1152
.long 17408,25600,33792,41984,50176,1024,9216,16384,24576,32768,40960,49152,0,8192,339968,8330240
.long 45056,46080,355072,76800,1055584,1383264,5988352,580352,8998912,15351808,14688256,6162816,667648,1557440,8329216,2816
.long 19456,27648,35840,44032,52224,3072,11264,18432,26624,34816,43008,51200,2048,10240,339968,8332288
.long 47104,48128,355200,76800,1710944,2038624,5990400,662272,8998912,15351808,14688256,6162848,667648,1577920,8331264,2944
.long 21504,29696,37888,46080,54272,5120,13312,20480,28672,36864,45056,53248,4096,12288,339968,8605696
.long 267264,266240,359168,77312,2366304,2693984,5992448,580480,8998912,15351808,14688256,6162880,667648,1598400,8604672,2816
.long 23552,31744,39936,48128,268435456,7168,15360,22528,30720,38912,47104,268436480,6144,14336,339968,8607744
.long 269312,268288,359296,77312,3021664,3349344,5994496,662400,8998912,15351808,14688256,6162912,667648,1618880,8606720,2944
.long 17408,25600,33792,41984,50176,1024,9216,16384,24576,32768,40960,49152,0,8192,372736,8881152
.long 16384,17408,386048,80896,1056864,1384544,6316032,590592,7892992,17121280,16457728,4853120,626688,2212160,8608768,1024
.long 19456,27648,35840,44032,52224,3072,11264,18432,26624,34816,43008,51200,2048,10240,372736,8883200
.long 18432,19456,386176,80896,1712224,2039904,6318080,672512,7892992,17121280,16457728,4853152,626688,2232640,8882176,1152
.long 21504,29696,37888,46080,54272,5120,13312,20480,28672,36864,45056,53248,4096,12288,372736,8885248
.long 238592,237568,390144,81408,2367584,2695264,6320128,590720,7892992,17121280,16457728,4853184,626688,2253120,8884224,1024
.long 23552,31744,39936,48128,268435456,7168,15360,22528,30720,38912,47104,268436480,6144,14336,372736,9158656
.long 240640,239616,390272,81408,3022944,3350624,6322176,672640,7892992,17121280,16457728,4853216,626688,2273600,9157632,1152
.long 17408,25600,33792,41984,50176,1024,9216,16384,24576,32768,40960,49152,0,8192,372736,9160704
.long 45056,46080,387840,80896,1058144,1385824,6643712,600832,8998912,17121280,16457728,6163840,667648,2212800,9159680,2816
.long 19456,27648,35840,44032,52224,3072,11264,18432,26624,34816,43008,51200,2048,10240,372736,9434112
.long 47104,48128,387968,80896,1713504,2041184,6645760,682752,8998912,17121280,16457728,6163872,667648,2233280,9161728,2944
.long 21504,29696,37888,46080,54272,5120,13312,20480,28672,36864,45056,53248,4096,12288,372736,9436160
.long 267264,266240,391936,81408,2368864,2696544,6647808,600960,8998912,17121280,16457728,6163904,667648,2253760,9435136,2816
.long 23552,31744,39936,48128,268435456,7168,15360,22528,30720,38912,47104,268436480,6144,14336,372736,9438208
.long 269312,268288,392064,81408,3024224,3351904,6649856,682880,8998912,17121280,16457728,6163936,667648,2274240,9437184,2944
.long 16384,24576,32768,40960,49152,0,8192,17408,25600,33792,41984,50176,1024,9216,278528,7504896
.long 20480,21504,263424,65536,1049216,1376896,4358144,529408,7892992,10485760,11370496,4850176,544768,328000,7503872,1280
.long 18432,26624,34816,43008,51200,2048,10240,19456,27648,35840,44032,52224,3072,11264,278528,7506944
.long 22528,23552,263552,65536,1704576,2032256,4360192,611328,7892992,10485760,11370496,4850208,544768,348480,7505920,1408
.long 20480,28672,36864,45056,53248,4096,12288,21504,29696,37888,46080,54272,5120,13312,278528,7780352
.long 242688,241664,267520,66048,2359936,2687616,4362240,529536,7892992,10485760,11370496,4850240,544768,368960,7507968,1280
.long 22528,30720,38912,47104,268435456,6144,14336,23552,31744,39936,48128,268436480,7168,15360,278528,7782400
.long 244736,243712,267648,66048,3015296,3342976,4364288,611456,7892992,10485760,11370496,4850272,544768,389440,7781376,1408
.long 16384,24576,32768,40960,49152,0,8192,17408,25600,33792,41984,50176,1024,9216,278528,7784448
.long 49152,50176,265216,65536,1050496,1378176,4685824,539648,8998912,10485760,11370496,6160896,585728,328640,7783424,3072
.long 18432,26624,34816,43008,51200,2048,10240,19456,27648,35840,44032,52224,3072,11264,278528,8057856
.long 51200,52224,265344,65536,1705856,2033536,4687872,621568,8998912,10485760,11370496,6160928,585728,349120,8056832,3200
.long 20480,28672,36864,45056,53248,4096,12288,21504,29696,37888,46080,54272,5120,13312,278528,8059904
.long 271360,270336,269312,66048,2361216,2688896,4689920,539776,8998912,10485760,11370496,6160960,585728,369600,8058880,3072
.long 22528,30720,38912,47104,268435456,6144,14336,23552,31744,39936,48128,268436480,7168,15360,278528,8333312
.long 273408,272384,269440,66048,3016576,3344256,4691968,621696,8998912,10485760,11370496,6160992,585728,390080,8060928,3200
.long 16384,24576,32768,40960,49152,0,8192,17408,25600,33792,41984,50176,1024,9216,311296,8335360
.long 20480,21504,296192,69632,1051776,1379456,5013504,549888,7892992,12255232,13139968,4851200,544768,983360,8334336,1280
.long 18432,26624,34816,43008,51200,2048,10240,19456,27648,35840,44032,52224,3072,11264,311296,8337408
.long 22528,23552,296320,69632,1707136,2034816,5015552,631808,7892992,12255232,13139968,4851232,544768,1003840,8336384,1408
.long 20480,28672,36864,45056,53248,4096,12288,21504,29696,37888,46080,54272,5120,13312,311296,8610816
.long 242688,241664,300288,70144,2362496,2690176,5017600,550016,7892992,12255232,13139968,4851264,544768,1024320,8609792,1280
.long 22528,30720,38912,47104,268435456,6144,14336,23552,31744,39936,48128,268436480,7168,15360,311296,8612864
.long 244736,243712,300416,70144,3017856,3345536,5019648,631936,7892992,12255232,13139968,4851296,544768,1044800,8611840,1408
.long 16384,24576,32768,40960,49152,0,8192,17408,25600,33792,41984,50176,1024,9216,311296,8886272
.long 49152,50176,297984,69632,1053056,1380736,5341184,560128,8998912,12255232,13139968,6161920,585728,984000,8613888,3072
.long 18432,26624,34816,43008,51200,2048,10240,19456,27648,35840,44032,52224,3072,11264,311296,8888320
.long 51200,52224,298112,69632,1708416,2036096,5343232,642048,8998912,12255232,13139968,6161952,585728,1004480,8887296,3200
.long 20480,28672,36864,45056,53248,4096,12288,21504,29696,37888,46080,54272,5120,13312,311296,8890368
.long 271360,270336,302080,70144,2363776,2691456,5345280,560256,8998912,12255232,13139968,6161984,585728,1024960,8889344,3072
.long 22528,30720,38912,47104,268435456,6144,14336,23552,31744,39936,48128,268436480,7168,15360,311296,9163776
.long 273408,272384,302208,70144,3019136,3346816,5347328,642176,8998912,12255232,13139968,6162016,585728,1045440,9162752,3200
.long 16384,24576,32768,40960,49152,0,8192,17408,25600,33792,41984,50176,1024,9216,344064,9165824
.long 20480,21504,328960,73728,1054336,1382016,5668864,570368,7892992,14024704,14909440,4852224,626688,1638720,9164800,1280
.long 18432,26624,34816,43008,51200,2048,10240,19456,27648,35840,44032,52224,3072,11264,344064,9439232
.long 22528,23552,329088,73728,1709696,2037376,5670912,652288,7892992,14024704,14909440,4852256,626688,1659200,9166848,1408
.long 20480,28672,36864,45056,53248,4096,12288,21504,29696,37888,46080,54272,5120,13312,344064,9441280
.long 242688,241664,333056,74240,2365056,2692736,5672960,570496,7892992,14024704,14909440,4852288,626688,1679680,9440256,1280
.long 22528,30720,38912,47104,268435456,6144,14336,23552,31744,39936,48128,268436480,7168,15360,344064,9443328
.long 244736,243712,333184,74240,3020416,3348096,5675008,652416,7892992,14024704,14909440,4852320,626688,1700160,9442304,1408
.long 16384,24576,32768,40960,49152,0,8192,17408,25600,33792,41984,50176,1024,9216,344064,7510016
.long 49152,50176,330752,73728,1055616,1383296,5996544,580608,8998912,14024704,14909440,6162944,667648,1639360,7508992,3072
.long 18432,26624,34816,43008,51200,2048,10240,19456,27648,35840,44032,52224,3072,11264,344064,7512064
.long 51200,52224,330880,73728,1710976,2038656,5998592,662528,8998912,14024704,14909440,6162976,667648,1659840,7511040,3200
.long 20480,28672,36864,45056,53248,4096,12288,21504,29696,37888,46080,54272,5120,13312,344064,7785472
.long 271360,270336,334848,74240,2366336,2694016,6000640,580736,8998912,14024704,14909440,6163008,667648,1680320,7513088,3072
.long 22528,30720,38912,47104,268435456,6144,14336,23552,31744,39936,48128,268436480,7168,15360,344064,7787520
.long 273408,272384,334976,74240,3021696,3349376,6002688,662656,8998912,14024704,14909440,6163040,667648,1700800,7786496,3200
.long 16384,24576,32768,40960,49152,0,8192,17408,25600,33792,41984,50176,1024,9216,376832,7789568
.long 20480,21504,361728,77824,1056896,1384576,6324224,590848,7892992,15794176,16678912,4853248,626688,2294080,7788544,1280
.long 18432,26624,34816,43008,51200,2048,10240,19456,27648,35840,44032,52224,3072,11264,376832,8062976
.long 22528,23552,361856,77824,1712256,2039936,6326272,672768,7892992,15794176,16678912,4853280,626688,2314560,8061952,1408
.long 20480,28672,36864,45056,53248,4096,12288,21504,29696,37888,46080,54272,5120,13312,376832,8065024
.long 242688,241664,365824,78336,2367616,2695296,6328320,590976,7892992,15794176,16678912,4853312,626688,2335040,8064000,1280
.long 22528,30720,38912,47104,268435456,6144,14336,23552,31744,39936,48128,268436480,7168,15360,376832,8338432
.long 244736,243712,365952,78336,3022976,3350656,6330368,672896,7892992,15794176,16678912,4853344,626688,2355520,8066048,1408
.long 16384,24576,32768,40960,49152,0,8192,17408,25600,33792,41984,50176,1024,9216,376832,8340480
.long 49152,50176,363520,77824,1058176,1385856,6651904,601088,8998912,15794176,16678912,6163968,667648,2294720,8339456,3072
.long 18432,26624,34816,43008,51200,2048,10240,19456,27648,35840,44032,52224,3072,11264,376832,8342528
.long 51200,52224,363648,77824,1713536,2041216,6653952,683008,8998912,15794176,16678912,6164000,667648,2315200,8341504,3200
.long 20480,28672,36864,45056,53248,4096,12288,21504,29696,37888,46080,54272,5120,13312,376832,8615936
.long 271360,270336,367616,78336,2368896,2696576,6656000,601216,8998912,15794176,16678912,6164032,667648,2335680,8614912,3072
.long 22528,30720,38912,47104,268435456,6144,14336,23552,31744,39936,48128,268436480,7168,15360,376832,8617984
.long 273408,272384,367744,78336,3024256,3351936,6658048,683136,8998912,15794176,16678912,6164064,667648,2356160,8616960,3200
.long 17408,25600,33792,41984,50176,1024,9216,16384,24576,32768,40960,49152,0,8192,282624,8891392
.long 20480,21504,271616,66560,1049248,1376928,4366336,529664,7892992,10928128,11591680,4850304,544768,409920,8619008,1280
.long 19456,27648,35840,44032,52224,3072,11264,18432,26624,34816,43008,51200,2048,10240,282624,8893440
.long 22528,23552,271744,66560,1704608,2032288,4368384,611584,7892992,10928128,11591680,4850336,544768,430400,8892416,1408
.long 21504,29696,37888,46080,54272,5120,13312,20480,28672,36864,45056,53248,4096,12288,282624,8895488
.long 242688,241664,275712,67072,2359968,2687648,4370432,529792,7892992,10928128,11591680,4850368,544768,450880,8894464,1280
.long 23552,31744,39936,48128,268435456,7168,15360,22528,30720,38912,47104,268436480,6144,14336,282624,9168896
.long 244736,243712,275840,67072,3015328,3343008,4372480,611712,7892992,10928128,11591680,4850400,544768,471360,9167872,1408
.long 17408,25600,33792,41984,50176,1024,9216,16384,24576,32768,40960,49152,0,8192,282624,9170944
.long 49152,50176,273408,66560,1050528,1378208,4694016,539904,8998912,10928128,11591680,6161024,585728,410560,9169920,3072
.long 19456,27648,35840,44032,52224,3072,11264,18432,26624,34816,43008,51200,2048,10240,282624,9444352
.long 51200,52224,273536,66560,1705888,2033568,4696064,621824,8998912,10928128,11591680,6161056,585728,431040,9171968,3200
.long 21504,29696,37888,46080,54272,5120,13312,20480,28672,36864,45056,53248,4096,12288,282624,9446400
.long 271360,270336,277504,67072,2361248,2688928,4698112,540032,8998912,10928128,11591680,6161088,585728,451520,9445376,3072
.long 23552,31744,39936,48128,268435456,7168,15360,22528,30720,38912,47104,268436480,6144,14336,282624,9448448
.long 273408,272384,277632,67072,3016608,3344288,4700160,621952,8998912,10928128,11591680,6161120,585728,472000,9447424,3200
.long 17408,25600,33792,41984,50176,1024,9216,16384,24576,32768,40960,49152,0,8192,315392,7515136
.long 20480,21504,304384,70656,1051808,1379488,5021696,550144,7892992,12697600,13361152,4851328,544768,1065280,7514112,1280
.long 19456,27648,35840,44032,52224,3072,11264,18432,26624,34816,43008,51200,2048,10240,315392,7517184
.long 22528,23552,304512,70656,1707168,2034848,5023744,632064,7892992,12697600,13361152,4851360,544768,1085760,7516160,1408
.long 21504,29696,37888,46080,54272,5120,13312,20480,28672,36864,45056,53248,4096,12288,315392,7790592
.long 242688,241664,308480,71168,2362528,2690208,5025792,550272,7892992,12697600,13361152,4851392,544768,1106240,7518208,1280
.long 23552,31744,39936,48128,268435456,7168,15360,22528,30720,38912,47104,268436480,6144,14336,315392,7792640
.long 244736,243712,308608,71168,3017888,3345568,5027840,632192,7892992,12697600,13361152,4851424,544768,1126720,7791616,1408
.long 17408,25600,33792,41984,50176,1024,9216,16384,24576,32768,40960,49152,0,8192,315392,7794688
.long 49152,50176,306176,70656,1053088,1380768,5349376,560384,8998912,12697600,13361152,6162048,585728,1065920,7793664,3072
.long 19456,27648,35840,44032,52224,3072,11264,18432,26624,34816,43008,51200,2048,10240,315392,8068096
.long 51200,52224,306304,70656,1708448,2036128,5351424,642304,8998912,12697600,13361152,6162080,585728,1086400,8067072,3200
.long 21504,29696,37888,46080,54272,5120,13312,20480,28672,36864,45056,53248,4096,12288,315392,8070144
.long 271360,270336,310272,71168,2363808,2691488,5353472,560512,8998912,12697600,13361152,6162112,585728,1106880,8069120,3072
.long 23552,31744,39936,48128,268435456,7168,15360,22528,30720,38912,47104,268436480,6144,14336,315392,8343552
.long 273408,272384,310400,71168,3019168,3346848,5355520,642432,8998912,12697600,13361152,6162144,585728,1127360,8071168,3200
.long 17408,25600,33792,41984,50176,1024,9216,16384,24576,32768,40960,49152,0,8192,348160,8345600
.long 20480,21504,337152,74752,1054368,1382048,5677056,570624,7892992,14467072,15130624,4852352,626688,1720640,8344576,1280
.long 19456,27648,35840,44032,52224,3072,11264,18432,26624,34816,43008,51200,2048,10240,348160,8347648
.long 22528,23552,337280,74752,1709728,2037408,5679104,652544,7892992,14467072,15130624,4852384,626688,1741120,8346624,1408
.long 21504,29696,37888,46080,54272,5120,13312,20480,28672,36864,45056,53248,4096,12288,348160,8621056
.long 242688,241664,341248,75264,2365088,2692768,5681152,570752,7892992,14467072,15130624,4852416,626688,1761600,8620032,1280
.long 23552,31744,39936,48128,268435456,7168,15360,22528,30720,38912,47104,268436480,6144,14336,348160,8623104
.long 244736,243712,341376,75264,3020448,3348128,5683200,652672,7892992,14467072,15130624,4852448,626688,1782080,8622080,1408
.long 17408,25600,33792,41984,50176,1024,9216,16384,24576,32768,40960,49152,0,8192,348160,8896512
.long 49152,50176,338944,74752,1055648,1383328,6004736,580864,8998912,14467072,15130624,6163072,667648,1721280,8624128,3072
.long 19456,27648,35840,44032,52224,3072,11264,18432,26624,34816,43008,51200,2048,10240,348160,8898560
.long 51200,52224,339072,74752,1711008,2038688,6006784,662784,8998912,14467072,15130624,6163104,667648,1741760,8897536,3200
.long 21504,29696,37888,46080,54272,5120,13312,20480,28672,36864,45056,53248,4096,12288,348160,8900608
.long 271360,270336,343040,75264,2366368,2694048,6008832,580992,8998912,14467072,15130624,6163136,667648,1762240,8899584,3072
.long 23552,31744,39936,48128,268435456,7168,15360,22528,30720,38912,47104,268436480,6144,14336,348160,9174016
.long 273408,272384,343168,75264,3021728,3349408,6010880,662912,8998912,14467072,15130624,6163168,667648,1782720,9172992,3200
.long 17408,25600,33792,41984,50176,1024,9216,16384,24576,32768,40960,49152,0,8192,380928,9176064
.long 20480,21504,369920,78848,1056928,1384608,6332416,591104,7892992,16236544,16900096,4853376,626688,2376000,9175040,1280
.long 19456,27648,35840,44032,52224,3072,11264,18432,26624,34816,43008,51200,2048,10240,380928,9449472
.long 22528,23552,370048,78848,1712288,2039968,6334464,673024,7892992,16236544,16900096,4853408,626688,2396480,9177088,1408
.long 21504,29696,37888,46080,54272,5120,13312,20480,28672,36864,45056,53248,4096,12288,380928,9451520
.long 242688,241664,374016,79360,2367648,2695328,6336512,591232,7892992,16236544,16900096,4853440,626688,2416960,9450496,1280
.long 23552,31744,39936,48128,268435456,7168,15360,22528,30720,38912,47104,268436480,6144,14336,380928,9453568
.long 244736,243712,374144,79360,3023008,3350688,6338560,673152,7892992,16236544,16900096,4853472,626688,2437440,9452544,1408
.long 17408,25600,33792,41984,50176,1024,9216,16384,24576,32768,40960,49152,0,8192,380928,7520256
.long 49152,50176,371712,78848,1058208,1385888,6660096,601344,8998912,16236544,16900096,6164096,667648,2376640,7519232,3072
.long 19456,27648,35840,44032,52224,3072,11264,18432,26624,34816,43008,51200,2048,10240,380928,7522304
.long 51200,52224,371840,78848,1713568,2041248,6662144,683264,8998912,16236544,16900096,6164128,667648,2397120,7521280,3200
.long 21504,29696,37888,46080,54272,5120,13312,20480,28672,36864,45056,53248,4096,12288,380928,7795712
.long 271360,270336,375808,79360,2368928,2696608,6664192,601472,8998912,16236544,16900096,6164160,667648,2417600,7523328,3072
.long 23552,31744,39936,48128,268435456,7168,15360,22528,30720,38912,47104,268436480,6144,14336,380928,7797760
.long 273408,272384,375936,79360,3024288,3351968,6666240,683392,8998912,16236544,16900096,6164192,667648,2438080,7796736,3200
.long 16384,24576,32768,40960,49152,0,8192,17408,25600,33792,41984,50176,1024,9216,286720,7799808
.long 20480,21504,279808,67584,1049280,1376960,4374528,529920,7892992,11370496,11812864,4850432,544768,491840,7798784,1280
.long 18432,26624,34816,43008,51200,2048,10240,19456,27648,35840,44032,52224,3072,11264,286720,8073216
.long 22528,23552,279936,67584,1704640,2032320,4376576,611840,7892992,11370496,11812864,4850464,544768,512320,8072192,1408
.long 20480,28672,36864,45056,53248,4096,12288,21504,29696,37888,46080,54272,5120,13312,286720,8075264
.long 242688,241664,283904,68096,2360000,2687680,4378624,530048,7892992,11370496,11812864,4850496,544768,532800,8074240,1280
.long 22528,30720,38912,47104,268435456,6144,14336,23552,31744,39936,48128,268436480,7168,15360,286720,8348672
.long 244736,243712,284032,68096,3015360,3343040,4380672,611968,7892992,11370496,11812864,4850528,544768,553280,8076288,1408
.long 16384,24576,32768,40960,49152,0,8192,17408,25600,33792,41984,50176,1024,9216,286720,8350720
.long 49152,50176,281600,67584,1050560,1378240,4702208,540160,8998912,11370496,11812864,6161152,585728,492480,8349696,3072
.long 18432,26624,34816,43008,51200,2048,10240,19456,27648,35840,44032,52224,3072,11264,286720,8352768
.long 51200,52224,281728,67584,1705920,2033600,4704256,622080,8998912,11370496,11812864,6161184,585728,512960,8351744,3200
.long 20480,28672,36864,45056,53248,4096,12288,21504,29696,37888,46080,54272,5120,13312,286720,8626176
.long 271360,270336,285696,68096,2361280,2688960,4706304,540288,8998912,11370496,11812864,6161216,585728,533440,8625152,3072
.long 22528,30720,38912,47104,268435456,6144,14336,23552,31744,39936,48128,268436480,7168,15360,286720,8628224
.long 273408,272384,285824,68096,3016640,3344320,4708352,622208,8998912,11370496,11812864,6161248,585728,553920,8627200,3200
.long 16384,24576,32768,40960,49152,0,8192,17408,25600,33792,41984,50176,1024,9216,319488,8901632
.long 20480,21504,312576,71680,1051840,1379520,5029888,550400,7892992,13139968,13582336,4851456,544768,1147200,8629248,1280
.long 18432,26624,34816,43008,51200,2048,10240,19456,27648,35840,44032,52224,3072,11264,319488,8903680
.long 22528,23552,312704,71680,1707200,2034880,5031936,632320,7892992,13139968,13582336,4851488,544768,1167680,8902656,1408
.long 20480,28672,36864,45056,53248,4096,12288,21504,29696,37888,46080,54272,5120,13312,319488,8905728
.long 242688,241664,316672,72192,2362560,2690240,5033984,550528,7892992,13139968,13582336,4851520,544768,1188160,8904704,1280
.long 22528,30720,38912,47104,268435456,6144,14336,23552,31744,39936,48128,268436480,7168,15360,319488,9179136
.long 244736,243712,316800,72192,3017920,3345600,5036032,632448,7892992,13139968,13582336,4851552,544768,1208640,9178112,1408
.long 16384,24576,32768,40960,49152,0,8192,17408,25600,33792,41984,50176,1024,9216,319488,9181184
.long 49152,50176,314368,71680,1053120,1380800,5357568,560640,8998912,13139968,13582336,6162176,585728,1147840,9180160,3072
.long 18432,26624,34816,43008,51200,2048,10240,19456,27648,35840,44032,52224,3072,11264,319488,9454592
.long 51200,52224,314496,71680,1708480,2036160,5359616,642560,8998912,13139968,13582336,6162208,585728,1168320,9182208,3200
.long 20480,28672,36864,45056,53248,4096,12288,21504,29696,37888,46080,54272,5120,13312,319488,9456640
.long 271360,270336,318464,72192,2363840,2691520,5361664,560768,8998912,13139968,13582336,6162240,585728,1188800,9455616,3072
.long 22528,30720,38912,47104,268435456,6144,14336,23552,31744,39936,48128,268436480,7168,15360,319488,9458688
.long 273408,272384,318592,72192,3019200,3346880,5363712,642688,8998912,13139968,13582336,6162272,585728,1209280,9457664,3200
.long 16384,24576,32768,40960,49152,0,8192,17408,25600,33792,41984,50176,1024,9216,352256,7525376
.long 20480,21504,345344,75776,1054400,1382080,5685248,570880,7892992,14909440,15351808,4852480,626688,1802560,7524352,1280
.long 18432,26624,34816,43008,51200,2048,10240,19456,27648,35840,44032,52224,3072,11264,352256,7527424
.long 22528,23552,345472,75776,1709760,2037440,5687296,652800,7892992,14909440,15351808,4852512,626688,1823040,7526400,1408
.long 20480,28672,36864,45056,53248,4096,12288,21504,29696,37888,46080,54272,5120,13312,352256,7800832
.long 242688,241664,349440,76288,2365120,2692800,5689344,571008,7892992,14909440,15351808,4852544,626688,1843520,7528448,1280
.long 22528,30720,38912,47104,268435456,6144,14336,23552,31744,39936,48128,268436480,7168,15360,352256,7802880
.long 244736,243712,349568,76288,3020480,3348160,5691392,652928,7892992,14909440,15351808,4852576,626688,1864000,7801856,1408
.long 16384,24576,32768,40960,49152,0,8192,17408,25600,33792,41984,50176,1024,9216,352256,7804928
.long 49152,50176,347136,75776,1055680,1383360,6012928,581120,8998912,14909440,15351808,6163200,667648,1803200,7803904,3072
.long 18432,26624,34816,43008,51200,2048,10240,19456,27648,35840,44032,52224,3072,11264,352256,8078336
.long 51200,52224,347264,75776,1711040,2038720,6014976,663040,8998912,14909440,15351808,6163232,667648,1823680,8077312,3200
.long 20480,28672,36864,45056,53248,4096,12288,21504,29696,37888,46080,54272,5120,13312,352256,8080384
.long 271360,270336,351232,76288,2366400,2694080,6017024,581248,8998912,14909440,15351808,6163264,667648,1844160,8079360,3072
.long 22528,30720,38912,47104,268435456,6144,14336,23552,31744,39936,48128,268436480,7168,15360,352256,8353792
.long 273408,272384,351360,76288,3021760,3349440,6019072,663168,8998912,14909440,15351808,6163296,667648,1864640,8081408,3200
.long 16384,24576,32768,40960,49152,0,8192,17408,25600,33792,41984,50176,1024,9216,385024,8355840
.long 20480,21504,378112,79872,1056960,1384640,6340608,591360,7892992,16678912,17121280,4853504,626688,2457920,8354816,1280
.long 18432,26624,34816,43008,51200,2048,10240,19456,27648,35840,44032,52224,3072,11264,385024,8357888
.long 22528,23552,378240,79872,1712320,2040000,6342656,673280,7892992,16678912,17121280,4853536,626688,2478400,8356864,1408
.long 20480,28672,36864,45056,53248,4096,12288,21504,29696,37888,46080,54272,5120,13312,385024,8631296
.long 242688,241664,382208,80384,2367680,2695360,6344704,591488,7892992,16678912,17121280,4853568,626688,2498880,8630272,1280
.long 22528,30720,38912,47104,268435456,6144,14336,23552,31744,39936,48128,268436480,7168,15360,385024,8633344
.long 244736,243712,382336,80384,3023040,3350720,6346752,673408,7892992,16678912,17121280,4853600,626688,2519360,8632320,1408
.long 16384,24576,32768,40960,49152,0,8192,17408,25600,33792,41984,50176,1024,9216,385024,8906752
.long 49152,50176,379904,79872,1058240,1385920,6668288,601600,8998912,16678912,17121280,6164224,667648,2458560,8634368,3072
.long 18432,26624,34816,43008,51200,2048,10240,19456,27648,35840,44032,52224,3072,11264,385024,8908800
.long 51200,52224,380032,79872,1713600,2041280,6670336,683520,8998912,16678912,17121280,6164256,667648,2479040,8907776,3200
.long 20480,28672,36864,45056,53248,4096,12288,21504,29696,37888,46080,54272,5120,13312,385024,8910848
.long 271360,270336,384000,80384,2368960,2696640,6672384,601728,8998912,16678912,17121280,6164288,667648,2499520,8909824,3072
.long 22528,30720,38912,47104,268435456,6144,14336,23552,31744,39936,48128,268436480,7168,15360,385024,9184256
.long 273408,272384,384128,80384,3024320,3352000,6674432,683648,8998912,16678912,17121280,6164320,667648,2520000,9183232,3200
.long 17408,25600,33792,41984,50176,1024,9216,16384,24576,32768,40960,49152,0,8192,290816,9186304
.long 20480,21504,288000,68608,1049312,1376992,4382720,530176,7892992,11812864,12034048,4850560,544768,573760,9185280,1280
.long 19456,27648,35840,44032,52224,3072,11264,18432,26624,34816,43008,51200,2048,10240,290816,9459712
.long 22528,23552,288128,68608,1704672,2032352,4384768,612096,7892992,11812864,12034048,4850592,544768,594240,9187328,1408
.long 21504,29696,37888,46080,54272,5120,13312,20480,28672,36864,45056,53248,4096,12288,290816,9461760
.long 242688,241664,292096,69120,2360032,2687712,4386816,530304,7892992,11812864,12034048,4850624,544768,614720,9460736,1280
.long 23552,31744,39936,48128,268435456,7168,15360,22528,30720,38912,47104,268436480,6144,14336,290816,9463808
.long 244736,243712,292224,69120,3015392,3343072,4388864,612224,7892992,11812864,12034048,4850656,544768,635200,9462784,1408
.long 17408,25600,33792,41984,50176,1024,9216,16384,24576,32768,40960,49152,0,8192,290816,7530496
.long 49152,50176,289792,68608,1050592,1378272,4710400,540416,8998912,11812864,12034048,6161280,585728,574400,7529472,3072
.long 19456,27648,35840,44032,52224,3072,11264,18432,26624,34816,43008,51200,2048,10240,290816,7532544
.long 51200,52224,289920,68608,1705952,2033632,4712448,622336,8998912,11812864,12034048,6161312,585728,594880,7531520,3200
.long 21504,29696,37888,46080,54272,5120,13312,20480,28672,36864,45056,53248,4096,12288,290816,7805952
.long 271360,270336,293888,69120,2361312,2688992,4714496,540544,8998912,11812864,12034048,6161344,585728,615360,7533568,3072
.long 23552,31744,39936,48128,268435456,7168,15360,22528,30720,38912,47104,268436480,6144,14336,290816,7808000
.long 273408,272384,294016,69120,3016672,3344352,4716544,622464,8998912,11812864,12034048,6161376,585728,635840,7806976,3200
.long 17408,25600,33792,41984,50176,1024,9216,16384,24576,32768,40960,49152,0,8192,323584,7810048
.long 20480,21504,320768,72704,1051872,1379552,5038080,550656,7892992,13582336,13803520,4851584,544768,1229120,7809024,1280
.long 19456,27648,35840,44032,52224,3072,11264,18432,26624,34816,43008,51200,2048,10240,323584,8083456
.long 22528,23552,320896,72704,1707232,2034912,5040128,632576,7892992,13582336,13803520,4851616,544768,1249600,8082432,1408
.long 21504,29696,37888,46080,54272,5120,13312,20480,28672,36864,45056,53248,4096,12288,323584,8085504
.long 242688,241664,324864,73216,2362592,2690272,5042176,550784,7892992,13582336,13803520,4851648,544768,1270080,8084480,1280
.long 23552,31744,39936,48128,268435456,7168,15360,22528,30720,38912,47104,268436480,6144,14336,323584,8358912
.long 244736,243712,324992,73216,3017952,3345632,5044224,632704,7892992,13582336,13803520,4851680,544768,1290560,8086528,1408
.long 17408,25600,33792,41984,50176,1024,9216,16384,24576,32768,40960,49152,0,8192,323584,8360960
.long 49152,50176,322560,72704,1053152,1380832,5365760,560896,8998912,13582336,13803520,6162304,585728,1229760,8359936,3072
.long 19456,27648,35840,44032,52224,3072,11264,18432,26624,34816,43008,51200,2048,10240,323584,8363008
.long 51200,52224,322688,72704,1708512,2036192,5367808,642816,8998912,13582336,13803520,6162336,585728,1250240,8361984,3200
.long 21504,29696,37888,46080,54272,5120,13312,20480,28672,36864,45056,53248,4096,12288,323584,8636416
.long 271360,270336,326656,73216,2363872,2691552,5369856,561024,8998912,13582336,13803520,6162368,585728,1270720,8635392,3072
.long 23552,31744,39936,48128,268435456,7168,15360,22528,30720,38912,47104,268436480,6144,14336,323584,8638464
.long 273408,272384,326784,73216,3019232,3346912,5371904,642944,8998912,13582336,13803520,6162400,585728,1291200,8637440,3200
.long 17408,25600,33792,41984,50176,1024,9216,16384,24576,32768,40960,49152,0,8192,356352,8911872
.long 20480,21504,353536,76800,1054432,1382112,5693440,571136,7892992,15351808,15572992,4852608,626688,1884480,8639488,1280
.long 19456,27648,35840,44032,52224,3072,11264,18432,26624,34816,43008,51200,2048,10240,356352,8913920
.long 22528,23552,353664,76800,1709792,2037472,5695488,653056,7892992,15351808,15572992,4852640,626688,1904960,8912896,1408
.long 21504,29696,37888,46080,54272,5120,13312,20480,28672,36864,45056,53248,4096,12288,356352,8915968
.long 242688,241664,357632,77312,2365152,2692832,5697536,571264,7892992,15351808,15572992,4852672,626688,1925440,8914944,1280
.long 23552,31744,39936,48128,268435456,7168,15360,22528,30720,38912,47104,268436480,6144,14336,356352,9189376
.long 244736,243712,357760,77312,3020512,3348192,5699584,653184,7892992,15351808,15572992,4852704,626688,1945920,9188352,1408
.long 17408,25600,33792,41984,50176,1024,9216,16384,24576,32768,40960,49152,0,8192,356352,9191424
.long 49152,50176,355328,76800,1055712,1383392,6021120,581376,8998912,15351808,15572992,6163328,667648,1885120,9190400,3072
.long 19456,27648,35840,44032,52224,3072,11264,18432,26624,34816,43008,51200,2048,10240,356352,9464832
.long 51200,52224,355456,76800,1711072,2038752,6023168,663296,8998912,15351808,15572992,6163360,667648,1905600,9192448,3200
.long 21504,29696,37888,46080,54272,5120,13312,20480,28672,36864,45056,53248,4096,12288,356352,9466880
.long 271360,270336,359424,77312,2366432,2694112,6025216,581504,8998912,15351808,15572992,6163392,667648,1926080,9465856,3072
.long 23552,31744,39936,48128,268435456,7168,15360,22528,30720,38912,47104,268436480,6144,14336,356352,9468928
.long 273408,272384,359552,77312,3021792,3349472,6027264,663424,8998912,15351808,15572992,6163424,667648,1946560,9467904,3200
.long 17408,25600,33792,41984,50176,1024,9216,16384,24576,32768,40960,49152,0,8192,389120,7535616
.long 20480,21504,386304,80896,1056992,1384672,6348800,591616,7892992,17121280,17342464,4853632,626688,2539840,7534592,1280
.long 19456,27648,35840,44032,52224,3072,11264,18432,26624,34816,43008,51200,2048,10240,389120,7537664
.long 22528,23552,386432,80896,1712352,2040032,6350848,673536,7892992,17121280,17342464,4853664,626688,2560320,7536640,1408
.long 21504,29696,37888,46080,54272,5120,13312,20480,28672,36864,45056,53248,4096,12288,389120,7811072
.long 242688,241664,390400,81408,2367712,2695392,6352896,591744,7892992,17121280,17342464,4853696,626688,2580800,7538688,1280
.long 23552,31744,39936,48128,268435456,7168,15360,22528,30720,38912,47104,268436480,6144,14336,389120,7813120
.long 244736,243712,390528,81408,3023072,3350752,6354944,673664,7892992,17121280,17342464,4853728,626688,2601280,7812096,1408
.long 17408,25600,33792,41984,50176,1024,9216,16384,24576,32768,40960,49152,0,8192,389120,7815168
.long 49152,50176,388096,80896,1058272,1385952,6676480,601856,8998912,17121280,17342464,6164352,667648,2540480,7814144,3072
.long 19456,27648,35840,44032,52224,3072,11264,18432,26624,34816,43008,51200,2048,10240,389120,8088576
.long 51200,52224,388224,80896,1713632,2041312,6678528,683776,8998912,17121280,17342464,6164384,667648,2560960,8087552,3200
.long 21504,29696,37888,46080,54272,5120,13312,20480,28672,36864,45056,53248,4096,12288,389120,8090624
.long 271360,270336,392192,81408,2368992,2696672,6680576,601984,8998912,17121280,17342464,6164416,667648,2581440,8089600,3072
.long 23552,31744,39936,48128,268435456,7168,15360,22528,30720,38912,47104,268436480,6144,14336,389120,8364032
.long 273408,272384,392320,81408,3024352,3352032,6682624,683904,8998912,17121280,17342464,6164448,667648,2601920,8091648,3200
.long 24576,32768,40960,49152,0,8192,16384,25600,33792,41984,50176,1024,9216,17408,262144,8366080
.long 24576,25600,263680,65536,1049344,1377024,4390912,530432,8169472,10485760,10485760,5177344,555008,480,8365056,1536
.long 26624,34816,43008,51200,2048,10240,18432,27648,35840,44032,52224,3072,11264,19456,262144,8368128
.long 26624,27648,263808,65536,1704704,2032384,4392960,612352,8169472,10485760,10485760,5177376,555008,20960,8367104,1664
.long 28672,36864,45056,53248,4096,12288,20480,29696,37888,46080,54272,5120,13312,21504,262144,8641536
.long 246784,245760,267776,66048,2360064,2687744,4395008,530560,8169472,10485760,10485760,5177408,555008,41440,8640512,1536
.long 30720,38912,47104,268435456,6144,14336,22528,31744,39936,48128,268436480,7168,15360,23552,262144,8643584
.long 248832,247808,267904,66048,3015424,3343104,4397056,612480,8169472,10485760,10485760,5177440,555008,61920,8642560,1664
.long 24576,32768,40960,49152,0,8192,16384,25600,33792,41984,50176,1024,9216,17408,262144,8916992
.long 53248,54272,265472,65536,1050624,1378304,4718592,540672,9275392,10485760,10485760,6488064,595968,1120,8644608,3328
.long 26624,34816,43008,51200,2048,10240,18432,27648,35840,44032,52224,3072,11264,19456,262144,8919040
.long 268435456,268436480,265600,65536,1705984,2033664,4720640,622592,9275392,10485760,10485760,6488096,595968,21600,8918016,3328
.long 28672,36864,45056,53248,4096,12288,20480,29696,37888,46080,54272,5120,13312,21504,262144,8921088
.long 275456,274432,269568,66048,2361344,2689024,4722688,540800,9275392,10485760,10485760,6488128,595968,42080,8920064,3328
.long 30720,38912,47104,268435456,6144,14336,22528,31744,39936,48128,268436480,7168,15360,23552,262144,9194496
.long 268435456,268436480,269696,66048,3016704,3344384,4724736,622720,9275392,10485760,10485760,6488160,595968,62560,9193472,3328
.long 24576,32768,40960,49152,0,8192,16384,25600,33792,41984,50176,1024,9216,17408,294912,9196544
.long 24576,25600,296448,69632,1051904,1379584,5046272,550912,8169472,12255232,12255232,5178368,555008,655840,9195520,1536
.long 26624,34816,43008,51200,2048,10240,18432,27648,35840,44032,52224,3072,11264,19456,294912,9469952
.long 26624,27648,296576,69632,1707264,2034944,5048320,632832,8169472,12255232,12255232,5178400,555008,676320,9197568,1664
.long 28672,36864,45056,53248,4096,12288,20480,29696,37888,46080,54272,5120,13312,21504,294912,9472000
.long 246784,245760,300544,70144,2362624,2690304,5050368,551040,8169472,12255232,12255232,5178432,555008,696800,9470976,1536
.long 30720,38912,47104,268435456,6144,14336,22528,31744,39936,48128,268436480,7168,15360,23552,294912,9474048
.long 248832,247808,300672,70144,3017984,3345664,5052416,632960,8169472,12255232,12255232,5178464,555008,717280,9473024,1664
.long 24576,32768,40960,49152,0,8192,16384,25600,33792,41984,50176,1024,9216,17408,294912,7540736
.long 53248,54272,298240,69632,1053184,1380864,5373952,561152,9275392,12255232,12255232,6489088,595968,656480,7539712,3328
.long 26624,34816,43008,51200,2048,10240,18432,27648,35840,44032,52224,3072,11264,19456,294912,7542784
.long 268435456,268436480,298368,69632,1708544,2036224,5376000,643072,9275392,12255232,12255232,6489120,595968,676960,7541760,3328
.long 28672,36864,45056,53248,4096,12288,20480,29696,37888,46080,54272,5120,13312,21504,294912,7816192
.long 275456,274432,302336,70144,2363904,2691584,5378048,561280,9275392,12255232,12255232,6489152,595968,697440,7543808,3328
.long 30720,38912,47104,268435456,6144,14336,22528,31744,39936,48128,268436480,7168,15360,23552,294912,7818240
.long 268435456,268436480,302464,70144,3019264,3346944,5380096,643200,9275392,12255232,12255232,6489184,595968,717920,7817216,3328
.long 24576,32768,40960,49152,0,8192,16384,25600,33792,41984,50176,1024,9216,17408,327680,7820288
.long 24576,25600,329216,73728,1054464,1382144,5701632,571392,8169472,14024704,14024704,5179392,636928,1311200,7819264,1536
.long 26624,34816,43008,51200,2048,10240,18432,27648,35840,44032,52224,3072,11264,19456,327680,8093696
.long 26624,27648,329344,73728,1709824,2037504,5703680,653312,8169472,14024704,14024704,5179424,636928,1331680,8092672,1664
.long 28672,36864,45056,53248,4096,12288,20480,29696,37888,46080,54272,5120,13312,21504,327680,8095744
.long 246784,245760,333312,74240,2365184,2692864,5705728,571520,8169472,14024704,14024704,5179456,636928,1352160,8094720,1536
.long 30720,38912,47104,268435456,6144,14336,22528,31744,39936,48128,268436480,7168,15360,23552,327680,8369152
.long 248832,247808,333440,74240,3020544,3348224,5707776,653440,8169472,14024704,14024704,5179488,636928,1372640,8096768,1664
.long 24576,32768,40960,49152,0,8192,16384,25600,33792,41984,50176,1024,9216,17408,327680,8371200
.long 53248,54272,331008,73728,1055744,1383424,6029312,581632,9275392,14024704,14024704,6490112,677888,1311840,8370176,3328
.long 26624,34816,43008,51200,2048,10240,18432,27648,35840,44032,52224,3072,11264,19456,327680,8373248
.long 268435456,268436480,331136,73728,1711104,2038784,6031360,663552,9275392,14024704,14024704,6490144,677888,1332320,8372224,3328
.long 28672,36864,45056,53248,4096,12288,20480,29696,37888,46080,54272,5120,13312,21504,327680,8646656
.long 275456,274432,335104,74240,2366464,2694144,6033408,581760,9275392,14024704,14024704,6490176,677888,1352800,8645632,3328
.long 30720,38912,47104,268435456,6144,14336,22528,31744,39936,48128,268436480,7168,15360,23552,327680,8648704
.long 268435456,268436480,335232,74240,3021824,3349504,6035456,663680,9275392,14024704,14024704,6490208,677888,1373280,8647680,3328
.long 24576,32768,40960,49152,0,8192,16384,25600,33792,41984,50176,1024,9216,17408,360448,8922112
.long 24576,25600,361984,77824,1057024,1384704,6356992,591872,8169472,15794176,15794176,5180416,636928,1966560,8649728,1536
.long 26624,34816,43008,51200,2048,10240,18432,27648,35840,44032,52224,3072,11264,19456,360448,8924160
.long 26624,27648,362112,77824,1712384,2040064,6359040,673792,8169472,15794176,15794176,5180448,636928,1987040,8923136,1664
.long 28672,36864,45056,53248,4096,12288,20480,29696,37888,46080,54272,5120,13312,21504,360448,8926208
.long 246784,245760,366080,78336,2367744,2695424,6361088,592000,8169472,15794176,15794176,5180480,636928,2007520,8925184,1536
.long 30720,38912,47104,268435456,6144,14336,22528,31744,39936,48128,268436480,7168,15360,23552,360448,9199616
.long 248832,247808,366208,78336,3023104,3350784,6363136,673920,8169472,15794176,15794176,5180512,636928,2028000,9198592,1664
.long 24576,32768,40960,49152,0,8192,16384,25600,33792,41984,50176,1024,9216,17408,360448,9201664
.long 53248,54272,363776,77824,1058304,1385984,6684672,602112,9275392,15794176,15794176,6491136,677888,1967200,9200640,3328
.long 26624,34816,43008,51200,2048,10240,18432,27648,35840,44032,52224,3072,11264,19456,360448,9475072
.long 268435456,268436480,363904,77824,1713664,2041344,6686720,684032,9275392,15794176,15794176,6491168,677888,1987680,9202688,3328
.long 28672,36864,45056,53248,4096,12288,20480,29696,37888,46080,54272,5120,13312,21504,360448,9477120
.long 275456,274432,367872,78336,2369024,2696704,6688768,602240,9275392,15794176,15794176,6491200,677888,2008160,9476096,3328
.long 30720,38912,47104,268435456,6144,14336,22528,31744,39936,48128,268436480,7168,15360,23552,360448,9479168
.long 268435456,268436480,368000,78336,3024384,3352064,6690816,684160,9275392,15794176,15794176,6491232,677888,2028640,9478144,3328
.long 25600,33792,41984,50176,1024,9216,17408,24576,32768,40960,49152,0,8192,16384,266240,7545856
.long 24576,25600,271872,66560,1049376,1377056,4399104,530688,8169472,10928128,10706944,5177472,555008,82400,7544832,1536
.long 27648,35840,44032,52224,3072,11264,19456,26624,34816,43008,51200,2048,10240,18432,266240,7547904
.long 26624,27648,272000,66560,1704736,2032416,4401152,612608,8169472,10928128,10706944,5177504,555008,102880,7546880,1664
.long 29696,37888,46080,54272,5120,13312,21504,28672,36864,45056,53248,4096,12288,20480,266240,7821312
.long 246784,245760,275968,67072,2360096,2687776,4403200,530816,8169472,10928128,10706944,5177536,555008,123360,7548928,1536
.long 31744,39936,48128,268435456,7168,15360,23552,30720,38912,47104,268436480,6144,14336,22528,266240,7823360
.long 248832,247808,276096,67072,3015456,3343136,4405248,612736,8169472,10928128,10706944,5177568,555008,143840,7822336,1664
.long 25600,33792,41984,50176,1024,9216,17408,24576,32768,40960,49152,0,8192,16384,266240,7825408
.long 53248,54272,273664,66560,1050656,1378336,4726784,540928,9275392,10928128,10706944,6488192,595968,83040,7824384,3328
.long 27648,35840,44032,52224,3072,11264,19456,26624,34816,43008,51200,2048,10240,18432,266240,8098816
.long 268435456,268436480,273792,66560,1706016,2033696,4728832,622848,9275392,10928128,10706944,6488224,595968,103520,8097792,3328
.long 29696,37888,46080,54272,5120,13312,21504,28672,36864,45056,53248,4096,12288,20480,266240,8100864
.long 275456,274432,277760,67072,2361376,2689056,4730880,541056,9275392,10928128,10706944,6488256,595968,124000,8099840,3328
.long 31744,39936,48128,268435456,7168,15360,23552,30720,38912,47104,268436480,6144,14336,22528,266240,8374272
.long 268435456,268436480,277888,67072,3016736,3344416,4732928,622976,9275392,10928128,10706944,6488288,595968,144480,8101888,3328
.long 25600,33792,41984,50176,1024,9216,17408,24576,32768,40960,49152,0,8192,16384,299008,8376320
.long 24576,25600,304640,70656,1051936,1379616,5054464,551168,8169472,12697600,12476416,5178496,555008,737760,8375296,1536
.long 27648,35840,44032,52224,3072,11264,19456,26624,34816,43008,51200,2048,10240,18432,299008,8378368
.long 26624,27648,304768,70656,1707296,2034976,5056512,633088,8169472,12697600,12476416,5178528,555008,758240,8377344,1664
.long 29696,37888,46080,54272,5120,13312,21504,28672,36864,45056,53248,4096,12288,20480,299008,8651776
.long 246784,245760,308736,71168,2362656,2690336,5058560,551296,8169472,12697600,12476416,5178560,555008,778720,8650752,1536
.long 31744,39936,48128,268435456,7168,15360,23552,30720,38912,47104,268436480,6144,14336,22528,299008,8653824
.long 248832,247808,308864,71168,3018016,3345696,5060608,633216,8169472,12697600,12476416,5178592,555008,799200,8652800,1664
.long 25600,33792,41984,50176,1024,9216,17408,24576,32768,40960,49152,0,8192,16384,299008,8927232
.long 53248,54272,306432,70656,1053216,1380896,5382144,561408,9275392,12697600,12476416,6489216,595968,738400,8654848,3328
.long 27648,35840,44032,52224,3072,11264,19456,26624,34816,43008,51200,2048,10240,18432,299008,8929280
.long 268435456,268436480,306560,70656,1708576,2036256,5384192,643328,9275392,12697600,12476416,6489248,595968,758880,8928256,3328
.long 29696,37888,46080,54272,5120,13312,21504,28672,36864,45056,53248,4096,12288,20480,299008,8931328
.long 275456,274432,310528,71168,2363936,2691616,5386240,561536,9275392,12697600,12476416,6489280,595968,779360,8930304,3328
.long 31744,39936,48128,268435456,7168,15360,23552,30720,38912,47104,268436480,6144,14336,22528,299008,9204736
.long 268435456,268436480,310656,71168,3019296,3346976,5388288,643456,9275392,12697600,12476416,6489312,595968,799840,9203712,3328
.long 25600,33792,41984,50176,1024,9216,17408,24576,32768,40960,49152,0,8192,16384,331776,9206784
.long 24576,25600,337408,74752,1054496,1382176,5709824,571648,8169472,14467072,14245888,5179520,636928,1393120,9205760,1536
.long 27648,35840,44032,52224,3072,11264,19456,26624,34816,43008,51200,2048,10240,18432,331776,9480192
.long 26624,27648,337536,74752,1709856,2037536,5711872,653568,8169472,14467072,14245888,5179552,636928,1413600,9207808,1664
.long 29696,37888,46080,54272,5120,13312,21504,28672,36864,45056,53248,4096,12288,20480,331776,9482240
.long 246784,245760,341504,75264,2365216,2692896,5713920,571776,8169472,14467072,14245888,5179584,636928,1434080,9481216,1536
.long 31744,39936,48128,268435456,7168,15360,23552,30720,38912,47104,268436480,6144,14336,22528,331776,9484288
.long 248832,247808,341632,75264,3020576,3348256,5715968,653696,8169472,14467072,14245888,5179616,636928,1454560,9483264,1664
.long 25600,33792,41984,50176,1024,9216,17408,24576,32768,40960,49152,0,8192,16384,331776,7550976
.long 53248,54272,339200,74752,1055776,1383456,6037504,581888,9275392,14467072,14245888,6490240,677888,1393760,7549952,3328
.long 27648,35840,44032,52224,3072,11264,19456,26624,34816,43008,51200,2048,10240,18432,331776,7553024
.long 268435456,268436480,339328,74752,1711136,2038816,6039552,663808,9275392,14467072,14245888,6490272,677888,1414240,7552000,3328
.long 29696,37888,46080,54272,5120,13312,21504,28672,36864,45056,53248,4096,12288,20480,331776,7826432
.long 275456,274432,343296,75264,2366496,2694176,6041600,582016,9275392,14467072,14245888,6490304,677888,1434720,7554048,3328
.long 31744,39936,48128,268435456,7168,15360,23552,30720,38912,47104,268436480,6144,14336,22528,331776,7828480
.long 268435456,268436480,343424,75264,3021856,3349536,6043648,663936,9275392,14467072,14245888,6490336,677888,1455200,7827456,3328
.long 25600,33792,41984,50176,1024,9216,17408,24576,32768,40960,49152,0,8192,16384,364544,7830528
.long 24576,25600,370176,78848,1057056,1384736,6365184,592128,8169472,16236544,16015360,5180544,636928,2048480,7829504,1536
.long 27648,35840,44032,52224,3072,11264,19456,26624,34816,43008,51200,2048,10240,18432,364544,8103936
.long 26624,27648,370304,78848,1712416,2040096,6367232,674048,8169472,16236544,16015360,5180576,636928,2068960,8102912,1664
.long 29696,37888,46080,54272,5120,13312,21504,28672,36864,45056,53248,4096,12288,20480,364544,8105984
.long 246784,245760,374272,79360,2367776,2695456,6369280,592256,8169472,16236544,16015360,5180608,636928,2089440,8104960,1536
.long 31744,39936,48128,268435456,7168,15360,23552,30720,38912,47104,268436480,6144,14336,22528,364544,8379392
.long 248832,247808,374400,79360,3023136,3350816,6371328,674176,8169472,16236544,16015360,5180640,636928,2109920,8107008,1664
.long 25600,33792,41984,50176,1024,9216,17408,24576,32768,40960,49152,0,8192,16384,364544,8381440
.long 53248,54272,371968,78848,1058336,1386016,6692864,602368,9275392,16236544,16015360,6491264,677888,2049120,8380416,3328
.long 27648,35840,44032,52224,3072,11264,19456,26624,34816,43008,51200,2048,10240,18432,364544,8383488
.long 268435456,268436480,372096,78848,1713696,2041376,6694912,684288,9275392,16236544,16015360,6491296,677888,2069600,8382464,3328
.long 29696,37888,46080,54272,5120,13312,21504,28672,36864,45056,53248,4096,12288,20480,364544,8656896
.long 275456,274432,376064,79360,2369056,2696736,6696960,602496,9275392,16236544,16015360,6491328,677888,2090080,8655872,3328
.long 31744,39936,48128,268435456,7168,15360,23552,30720,38912,47104,268436480,6144,14336,22528,364544,8658944
.long 268435456,268436480,376192,79360,3024416,3352096,6699008,684416,9275392,16236544,16015360,6491360,677888,2110560,8657920,3328
.long 24576,32768,40960,49152,0,8192,16384,25600,33792,41984,50176,1024,9216,17408,270336,8932352
.long 24576,25600,280064,67584,1049408,1377088,4407296,530944,8169472,11370496,10928128,5177600,555008,164320,8659968,1536
.long 26624,34816,43008,51200,2048,10240,18432,27648,35840,44032,52224,3072,11264,19456,270336,8934400
.long 26624,27648,280192,67584,1704768,2032448,4409344,612864,8169472,11370496,10928128,5177632,555008,184800,8933376,1664
.long 28672,36864,45056,53248,4096,12288,20480,29696,37888,46080,54272,5120,13312,21504,270336,8936448
.long 246784,245760,284160,68096,2360128,2687808,4411392,531072,8169472,11370496,10928128,5177664,555008,205280,8935424,1536
.long 30720,38912,47104,268435456,6144,14336,22528,31744,39936,48128,268436480,7168,15360,23552,270336,9209856
.long 248832,247808,284288,68096,3015488,3343168,4413440,612992,8169472,11370496,10928128,5177696,555008,225760,9208832,1664
.long 24576,32768,40960,49152,0,8192,16384,25600,33792,41984,50176,1024,9216,17408,270336,9211904
.long 53248,54272,281856,67584,1050688,1378368,4734976,541184,9275392,11370496,10928128,6488320,595968,164960,9210880,3328
.long 26624,34816,43008,51200,2048,10240,18432,27648,35840,44032,52224,3072,11264,19456,270336,9485312
.long 268435456,268436480,281984,67584,1706048,2033728,4737024,623104,9275392,11370496,10928128,6488352,595968,185440,9212928,3328
.long 28672,36864,45056,53248,4096,12288,20480,29696,37888,46080,54272,5120,13312,21504,270336,9487360
.long 275456,274432,285952,68096,2361408,2689088,4739072,541312,9275392,11370496,10928128,6488384,595968,205920,9486336,3328
.long 30720,38912,47104,268435456,6144,14336,22528,31744,39936,48128,268436480,7168,15360,23552,270336,9489408
.long 268435456,268436480,286080,68096,3016768,3344448,4741120,623232,9275392,11370496,10928128,6488416,595968,226400,9488384,3328
.long 24576,32768,40960,49152,0,8192,16384,25600,33792,41984,50176,1024,9216,17408,303104,7556096
.long 24576,25600,312832,71680,1051968,1379648,5062656,551424,8169472,13139968,12697600,5178624,555008,819680,7555072,1536
.long 26624,34816,43008,51200,2048,10240,18432,27648,35840,44032,52224,3072,11264,19456,303104,7558144
.long 26624,27648,312960,71680,1707328,2035008,5064704,633344,8169472,13139968,12697600,5178656,555008,840160,7557120,1664
.long 28672,36864,45056,53248,4096,12288,20480,29696,37888,46080,54272,5120,13312,21504,303104,7831552
.long 246784,245760,316928,72192,2362688,2690368,5066752,551552,8169472,13139968,12697600,5178688,555008,860640,7559168,1536
.long 30720,38912,47104,268435456,6144,14336,22528,31744,39936,48128,268436480,7168,15360,23552,303104,7833600
.long 248832,247808,317056,72192,3018048,3345728,5068800,633472,8169472,13139968,12697600,5178720,555008,881120,7832576,1664
.long 24576,32768,40960,49152,0,8192,16384,25600,33792,41984,50176,1024,9216,17408,303104,7835648
.long 53248,54272,314624,71680,1053248,1380928,5390336,561664,9275392,13139968,12697600,6489344,595968,820320,7834624,3328
.long 26624,34816,43008,51200,2048,10240,18432,27648,35840,44032,52224,3072,11264,19456,303104,8109056
.long 268435456,268436480,314752,71680,1708608,2036288,5392384,643584,9275392,13139968,12697600,6489376,595968,840800,8108032,3328
.long 28672,36864,45056,53248,4096,12288,20480,29696,37888,46080,54272,5120,13312,21504,303104,8111104
.long 275456,274432,318720,72192,2363968,2691648,5394432,561792,9275392,13139968,12697600,6489408,595968,861280,8110080,3328
.long 30720,38912,47104,268435456,6144,14336,22528,31744,39936,48128,268436480,7168,15360,23552,303104,8384512
.long 268435456,268436480,318848,72192,3019328,3347008,5396480,643712,9275392,13139968,12697600,6489440,595968,881760,8112128,3328
.long 24576,32768,40960,49152,0,8192,16384,25600,33792,41984,50176,1024,9216,17408,335872,8386560
.long 24576,25600,345600,75776,1054528,1382208,5718016,571904,8169472,14909440,14467072,5179648,636928,1475040,8385536,1536
.long 26624,34816,43008,51200,2048,10240,18432,27648,35840,44032,52224,3072,11264,19456,335872,8388608
.long 26624,27648,345728,75776,1709888,2037568,5720064,653824,8169472,14909440,14467072,5179680,636928,1495520,8387584,1664
.long 28672,36864,45056,53248,4096,12288,20480,29696,37888,46080,54272,5120,13312,21504,335872,8662016
.long 246784,245760,349696,76288,2365248,2692928,5722112,572032,8169472,14909440,14467072,5179712,636928,1516000,8660992,1536
.long 30720,38912,47104,268435456,6144,14336,22528,31744,39936,48128,268436480,7168,15360,23552,335872,8664064
.long 248832,247808,349824,76288,3020608,3348288,5724160,653952,8169472,14909440,14467072,5179744,636928,1536480,8663040,1664
.long 24576,32768,40960,49152,0,8192,16384,25600,33792,41984,50176,1024,9216,17408,335872,8937472
.long 53248,54272,347392,75776,1055808,1383488,6045696,582144,9275392,14909440,14467072,6490368,677888,1475680,8665088,3328
.long 26624,34816,43008,51200,2048,10240,18432,27648,35840,44032,52224,3072,11264,19456,335872,8939520
.long 268435456,268436480,347520,75776,1711168,2038848,6047744,664064,9275392,14909440,14467072,6490400,677888,1496160,8938496,3328
.long 28672,36864,45056,53248,4096,12288,20480,29696,37888,46080,54272,5120,13312,21504,335872,8941568
.long 275456,274432,351488,76288,2366528,2694208,6049792,582272,9275392,14909440,14467072,6490432,677888,1516640,8940544,3328
.long 30720,38912,47104,268435456,6144,14336,22528,31744,39936,48128,268436480,7168,15360,23552,335872,9214976
.long 268435456,268436480,351616,76288,3021888,3349568,6051840,664192,9275392,14909440,14467072,6490464,677888,1537120,9213952,3328
.long 24576,32768,40960,49152,0,8192,16384,25600,33792,41984,50176,1024,9216,17408,368640,9217024
.long 24576,25600,378368,79872,1057088,1384768,6373376,592384,8169472,16678912,16236544,5180672,636928,2130400,9216000,1536
.long 26624,34816,43008,51200,2048,10240,18432,27648,35840,44032,52224,3072,11264,19456,368640,9490432
.long 26624,27648,378496,79872,1712448,2040128,6375424,674304,8169472,16678912,16236544,5180704,636928,2150880,9218048,1664
.long 28672,36864,45056,53248,4096,12288,20480,29696,37888,46080,54272,5120,13312,21504,368640,9492480
.long 246784,245760,382464,80384,2367808,2695488,6377472,592512,8169472,16678912,16236544,5180736,636928,2171360,9491456,1536
.long 30720,38912,47104,268435456,6144,14336,22528,31744,39936,48128,268436480,7168,15360,23552,368640,9494528
.long 248832,247808,382592,80384,3023168,3350848,6379520,674432,8169472,16678912,16236544,5180768,636928,2191840,9493504,1664
.long 24576,32768,40960,49152,0,8192,16384,25600,33792,41984,50176,1024,9216,17408,368640,7561216
.long 53248,54272,380160,79872,1058368,1386048,6701056,602624,9275392,16678912,16236544,6491392,677888,2131040,7560192,3328
.long 26624,34816,43008,51200,2048,10240,18432,27648,35840,44032,52224,3072,11264,19456,368640,7563264
.long 268435456,268436480,380288,79872,1713728,2041408,6703104,684544,9275392,16678912,16236544,6491424,677888,2151520,7562240,3328
.long 28672,36864,45056,53248,4096,12288,20480,29696,37888,46080,54272,5120,13312,21504,368640,7836672
.long 275456,274432,384256,80384,2369088,2696768,6705152,602752,9275392,16678912,16236544,6491456,677888,2172000,7564288,3328
.long 30720,38912,47104,268435456,6144,14336,22528,31744,39936,48128,268436480,7168,15360,23552,368640,7838720
.long 268435456,268436480,384384,80384,3024448,3352128,6707200,684672,9275392,16678912,16236544,6491488,677888,2192480,7837696,3328
.long 25600,33792,41984,50176,1024,9216,17408,24576,32768,40960,49152,0,8192,16384,274432,7840768
.long 24576,25600,288256,68608,1049440,1377120,4415488,531200,8169472,11812864,11149312,5177728,555008,246240,7839744,1536
.long 27648,35840,44032,52224,3072,11264,19456,26624,34816,43008,51200,2048,10240,18432,274432,8114176
.long 26624,27648,288384,68608,1704800,2032480,4417536,613120,8169472,11812864,11149312,5177760,555008,266720,8113152,1664
.long 29696,37888,46080,54272,5120,13312,21504,28672,36864,45056,53248,4096,12288,20480,274432,8116224
.long 246784,245760,292352,69120,2360160,2687840,4419584,531328,8169472,11812864,11149312,5177792,555008,287200,8115200,1536
.long 31744,39936,48128,268435456,7168,15360,23552,30720,38912,47104,268436480,6144,14336,22528,274432,8389632
.long 248832,247808,292480,69120,3015520,3343200,4421632,613248,8169472,11812864,11149312,5177824,555008,307680,8117248,1664
.long 25600,33792,41984,50176,1024,9216,17408,24576,32768,40960,49152,0,8192,16384,274432,8391680
.long 53248,54272,290048,68608,1050720,1378400,4743168,541440,9275392,11812864,11149312,6488448,595968,246880,8390656,3328
.long 27648,35840,44032,52224,3072,11264,19456,26624,34816,43008,51200,2048,10240,18432,274432,8393728
.long 268435456,268436480,290176,68608,1706080,2033760,4745216,623360,9275392,11812864,11149312,6488480,595968,267360,8392704,3328
.long 29696,37888,46080,54272,5120,13312,21504,28672,36864,45056,53248,4096,12288,20480,274432,8667136
.long 275456,274432,294144,69120,2361440,2689120,4747264,541568,9275392,11812864,11149312,6488512,595968,287840,8666112,3328
.long 31744,39936,48128,268435456,7168,15360,23552,30720,38912,47104,268436480,6144,14336,22528,274432,8669184
.long 268435456,268436480,294272,69120,3016800,3344480,4749312,623488,9275392,11812864,11149312,6488544,595968,308320,8668160,3328
.long 25600,33792,41984,50176,1024,9216,17408,24576,32768,40960,49152,0,8192,16384,307200,8942592
.long 24576,25600,321024,72704,1052000,1379680,5070848,551680,8169472,13582336,12918784,5178752,555008,901600,8670208,1536
.long 27648,35840,44032,52224,3072,11264,19456,26624,34816,43008,51200,2048,10240,18432,307200,8944640
.long 26624,27648,321152,72704,1707360,2035040,5072896,633600,8169472,13582336,12918784,5178784,555008,922080,8943616,1664
.long 29696,37888,46080,54272,5120,13312,21504,28672,36864,45056,53248,4096,12288,20480,307200,8946688
.long 246784,245760,325120,73216,2362720,2690400,5074944,551808,8169472,13582336,12918784,5178816,555008,942560,8945664,1536
.long 31744,39936,48128,268435456,7168,15360,23552,30720,38912,47104,268436480,6144,14336,22528,307200,9220096
.long 248832,247808,325248,73216,3018080,3345760,5076992,633728,8169472,13582336,12918784,5178848,555008,963040,9219072,1664
.long 25600,33792,41984,50176,1024,9216,17408,24576,32768,40960,49152,0,8192,16384,307200,9222144
.long 53248,54272,322816,72704,1053280,1380960,5398528,561920,9275392,13582336,12918784,6489472,595968,902240,9221120,3328
.long 27648,35840,44032,52224,3072,11264,19456,26624,34816,43008,51200,2048,10240,18432,307200,9495552
.long 268435456,268436480,322944,72704,1708640,2036320,5400576,643840,9275392,13582336,12918784,6489504,595968,922720,9223168,3328
.long 29696,37888,46080,54272,5120,13312,21504,28672,36864,45056,53248,4096,12288,20480,307200,9497600
.long 275456,274432,326912,73216,2364000,2691680,5402624,562048,9275392,13582336,12918784,6489536,595968,943200,9496576,3328
.long 31744,39936,48128,268435456,7168,15360,23552,30720,38912,47104,268436480,6144,14336,22528,307200,9499648
.long 268435456,268436480,327040,73216,3019360,3347040,5404672,643968,9275392,13582336,12918784,6489568,595968,963680,9498624,3328
.long 25600,33792,41984,50176,1024,9216,17408,24576,32768,40960,49152,0,8192,16384,339968,7566336
.long 24576,25600,353792,76800,1054560,1382240,5726208,572160,8169472,15351808,14688256,5179776,636928,1556960,7565312,1536
.long 27648,35840,44032,52224,3072,11264,19456,26624,34816,43008,51200,2048,10240,18432,339968,7568384
.long 26624,27648,353920,76800,1709920,2037600,5728256,654080,8169472,15351808,14688256,5179808,636928,1577440,7567360,1664
.long 29696,37888,46080,54272,5120,13312,21504,28672,36864,45056,53248,4096,12288,20480,339968,7841792
.long 246784,245760,357888,77312,2365280,2692960,5730304,572288,8169472,15351808,14688256,5179840,636928,1597920,7569408,1536
.long 31744,39936,48128,268435456,7168,15360,23552,30720,38912,47104,268436480,6144,14336,22528,339968,7843840
.long 248832,247808,358016,77312,3020640,3348320,5732352,654208,8169472,15351808,14688256,5179872,636928,1618400,7842816,1664
.long 25600,33792,41984,50176,1024,9216,17408,24576,32768,40960,49152,0,8192,16384,339968,7845888
.long 53248,54272,355584,76800,1055840,1383520,6053888,582400,9275392,15351808,14688256,6490496,677888,1557600,7844864,3328
.long 27648,35840,44032,52224,3072,11264,19456,26624,34816,43008,51200,2048,10240,18432,339968,8119296
.long 268435456,268436480,355712,76800,1711200,2038880,6055936,664320,9275392,15351808,14688256,6490528,677888,1578080,8118272,3328
.long 29696,37888,46080,54272,5120,13312,21504,28672,36864,45056,53248,4096,12288,20480,339968,8121344
.long 275456,274432,359680,77312,2366560,2694240,6057984,582528,9275392,15351808,14688256,6490560,677888,1598560,8120320,3328
.long 31744,39936,48128,268435456,7168,15360,23552,30720,38912,47104,268436480,6144,14336,22528,339968,8394752
.long 268435456,268436480,359808,77312,3021920,3349600,6060032,664448,9275392,15351808,14688256,6490592,677888,1619040,8122368,3328
.long 25600,33792,41984,50176,1024,9216,17408,24576,32768,40960,49152,0,8192,16384,372736,8396800
.long 24576,25600,386560,80896,1057120,1384800,6381568,592640,8169472,17121280,16457728,5180800,636928,2212320,8395776,1536
.long 27648,35840,44032,52224,3072,11264,19456,26624,34816,43008,51200,2048,10240,18432,372736,8398848
.long 26624,27648,386688,80896,1712480,2040160,6383616,674560,8169472,17121280,16457728,5180832,636928,2232800,8397824,1664
.long 29696,37888,46080,54272,5120,13312,21504,28672,36864,45056,53248,4096,12288,20480,372736,8672256
.long 246784,245760,390656,81408,2367840,2695520,6385664,592768,8169472,17121280,16457728,5180864,636928,2253280,8671232,1536
.long 31744,39936,48128,268435456,7168,15360,23552,30720,38912,47104,268436480,6144,14336,22528,372736,8674304
.long 248832,247808,390784,81408,3023200,3350880,6387712,674688,8169472,17121280,16457728,5180896,636928,2273760,8673280,1664
.long 25600,33792,41984,50176,1024,9216,17408,24576,32768,40960,49152,0,8192,16384,372736,8947712
.long 53248,54272,388352,80896,1058400,1386080,6709248,602880,9275392,17121280,16457728,6491520,677888,2212960,8675328,3328
.long 27648,35840,44032,52224,3072,11264,19456,26624,34816,43008,51200,2048,10240,18432,372736,8949760
.long 268435456,268436480,388480,80896,1713760,2041440,6711296,684800,9275392,17121280,16457728,6491552,677888,2233440,8948736,3328
.long 29696,37888,46080,54272,5120,13312,21504,28672,36864,45056,53248,4096,12288,20480,372736,8951808
.long 275456,274432,392448,81408,2369120,2696800,6713344,603008,9275392,17121280,16457728,6491584,677888,2253920,8950784,3328
.long 31744,39936,48128,268435456,7168,15360,23552,30720,38912,47104,268436480,6144,14336,22528,372736,9225216
.long 268435456,268436480,392576,81408,3024480,3352160,6715392,684928,9275392,17121280,16457728,6491616,677888,2274400,9224192,3328
.long 24576,32768,40960,49152,0,8192,16384,25600,33792,41984,50176,1024,9216,17408,278528,9227264
.long 7880704,7881728,268435456,0,1049472,1377152,4423680,531456,8169472,81920,11370496,5177856,555008,328160,9226240,163840
.long 26624,34816,43008,51200,2048,10240,18432,27648,35840,44032,52224,3072,11264,19456,278528,9500672
.long 8154112,8155136,268435456,552960,1704832,2032512,4425728,613376,8169472,81920,11370496,5177888,555008,348640,9228288,163840
.long 28672,36864,45056,53248,4096,12288,20480,29696,37888,46080,54272,5120,13312,21504,278528,9502720
.long 8156160,8157184,268435456,1105920,2360192,2687872,4427776,531584,8169472,81920,11370496,5177920,555008,369120,9501696,163840
.long 30720,38912,47104,268435456,6144,14336,22528,31744,39936,48128,268436480,7168,15360,23552,278528,9504768
.long 8158208,8430592,268435456,1658880,3015552,3343232,4429824,613504,8169472,81920,11370496,5177952,555008,389600,9503744,163840
.long 24576,32768,40960,49152,0,8192,16384,25600,33792,41984,50176,1024,9216,17408,278528,7571456
.long 8431616,8432640,268435456,1792,1050752,1378432,4751360,541696,9275392,85504,11370496,6488576,595968,328800,7570432,165632
.long 26624,34816,43008,51200,2048,10240,18432,27648,35840,44032,52224,3072,11264,19456,278528,7573504
.long 8433664,8434688,268435456,554752,1706112,2033792,4753408,623616,9275392,85504,11370496,6488608,595968,349280,7572480,165632
.long 28672,36864,45056,53248,4096,12288,20480,29696,37888,46080,54272,5120,13312,21504,278528,7846912
.long 8707072,8708096,268435456,1107712,2361472,2689152,4755456,541824,9275392,85504,11370496,6488640,595968,369760,7574528,165632
.long 30720,38912,47104,268435456,6144,14336,22528,31744,39936,48128,268436480,7168,15360,23552,278528,7848960
.long 8709120,8710144,268435456,1660672,3016832,3344512,4757504,623744,9275392,85504,11370496,6488672,595968,390240,7847936,165632
.long 24576,32768,40960,49152,0,8192,16384,25600,33792,41984,50176,1024,9216,17408,311296,7851008
.long 8711168,8983552,268435456,512,1052032,1379712,5079040,551936,8169472,82944,13139968,5178880,555008,983520,7849984,164352
.long 26624,34816,43008,51200,2048,10240,18432,27648,35840,44032,52224,3072,11264,19456,311296,8124416
.long 8984576,8985600,268435456,553472,1707392,2035072,5081088,633856,8169472,82944,13139968,5178912,555008,1004000,8123392,164352
.long 28672,36864,45056,53248,4096,12288,20480,29696,37888,46080,54272,5120,13312,21504,311296,8126464
.long 8986624,8987648,268435456,1106432,2362752,2690432,5083136,552064,8169472,82944,13139968,5178944,555008,1024480,8125440,164352
.long 30720,38912,47104,268435456,6144,14336,22528,31744,39936,48128,268436480,7168,15360,23552,311296,8399872
.long 9260032,9261056,268435456,1659392,3018112,3345792,5085184,633984,8169472,82944,13139968,5178976,555008,1044960,8127488,164352
.long 24576,32768,40960,49152,0,8192,16384,25600,33792,41984,50176,1024,9216,17408,311296,8401920
.long 9262080,9263104,268435456,2304,1053312,1380992,5406720,562176,9275392,86528,13139968,6489600,595968,984160,8400896,166144
.long 26624,34816,43008,51200,2048,10240,18432,27648,35840,44032,52224,3072,11264,19456,311296,8403968
.long 9264128,9536512,268435456,555264,1708672,2036352,5408768,644096,9275392,86528,13139968,6489632,595968,1004640,8402944,166144
.long 28672,36864,45056,53248,4096,12288,20480,29696,37888,46080,54272,5120,13312,21504,311296,8677376
.long 9537536,9538560,268435456,1108224,2364032,2691712,5410816,562304,9275392,86528,13139968,6489664,595968,1025120,8676352,166144
.long 30720,38912,47104,268435456,6144,14336,22528,31744,39936,48128,268436480,7168,15360,23552,311296,8679424
.long 9539584,9540608,268435456,1661184,3019392,3347072,5412864,644224,9275392,86528,13139968,6489696,595968,1045600,8678400,166144
.long 24576,32768,40960,49152,0,8192,16384,25600,33792,41984,50176,1024,9216,17408,344064,8952832
.long 7606272,7607296,268435456,1024,1054592,1382272,5734400,572416,8169472,83968,14909440,5179904,636928,1638880,8680448,164864
.long 26624,34816,43008,51200,2048,10240,18432,27648,35840,44032,52224,3072,11264,19456,344064,8954880
.long 7608320,7609344,268435456,553984,1709952,2037632,5736448,654336,8169472,83968,14909440,5179936,636928,1659360,8953856,164864
.long 28672,36864,45056,53248,4096,12288,20480,29696,37888,46080,54272,5120,13312,21504,344064,8956928
.long 7610368,7882752,268435456,1106944,2365312,2692992,5738496,572544,8169472,83968,14909440,5179968,636928,1679840,8955904,164864
.long 30720,38912,47104,268435456,6144,14336,22528,31744,39936,48128,268436480,7168,15360,23552,344064,9230336
.long 7883776,7884800,268435456,1659904,3020672,3348352,5740544,654464,8169472,83968,14909440,5180000,636928,1700320,9229312,164864
.long 24576,32768,40960,49152,0,8192,16384,25600,33792,41984,50176,1024,9216,17408,344064,9232384
.long 7885824,7886848,268435456,2816,1055872,1383552,6062080,582656,9275392,87552,14909440,6490624,677888,1639520,9231360,166656
.long 26624,34816,43008,51200,2048,10240,18432,27648,35840,44032,52224,3072,11264,19456,344064,9505792
.long 8159232,8160256,268435456,555776,1711232,2038912,6064128,664576,9275392,87552,14909440,6490656,677888,1660000,9233408,166656
.long 28672,36864,45056,53248,4096,12288,20480,29696,37888,46080,54272,5120,13312,21504,344064,9507840
.long 8161280,8162304,268435456,1108736,2366592,2694272,6066176,582784,9275392,87552,14909440,6490688,677888,1680480,9506816,166656
.long 30720,38912,47104,268435456,6144,14336,22528,31744,39936,48128,268436480,7168,15360,23552,344064,9509888
.long 8163328,8435712,268435456,1661696,3021952,3349632,6068224,664704,9275392,87552,14909440,6490720,677888,1700960,9508864,166656
.long 24576,32768,40960,49152,0,8192,16384,25600,33792,41984,50176,1024,9216,17408,376832,7576576
.long 8436736,8437760,268435456,1536,1057152,1384832,6389760,592896,8169472,84992,16678912,5180928,636928,2294240,7575552,165376
.long 26624,34816,43008,51200,2048,10240,18432,27648,35840,44032,52224,3072,11264,19456,376832,7578624
.long 8438784,8439808,268435456,554496,1712512,2040192,6391808,674816,8169472,84992,16678912,5180960,636928,2314720,7577600,165376
.long 28672,36864,45056,53248,4096,12288,20480,29696,37888,46080,54272,5120,13312,21504,376832,7852032
.long 8712192,8713216,268435456,1107456,2367872,2695552,6393856,593024,8169472,84992,16678912,5180992,636928,2335200,7579648,165376
.long 30720,38912,47104,268435456,6144,14336,22528,31744,39936,48128,268436480,7168,15360,23552,376832,7854080
.long 8714240,8715264,268435456,1660416,3023232,3350912,6395904,674944,8169472,84992,16678912,5181024,636928,2355680,7853056,165376
.long 24576,32768,40960,49152,0,8192,16384,25600,33792,41984,50176,1024,9216,17408,376832,7856128
.long 8716288,8988672,268435456,3328,1058432,1386112,6717440,603136,9275392,88576,16678912,6491648,677888,2294880,7855104,167168
.long 26624,34816,43008,51200,2048,10240,18432,27648,35840,44032,52224,3072,11264,19456,376832,8129536
.long 8989696,8990720,268435456,556288,1713792,2041472,6719488,685056,9275392,88576,16678912,6491680,677888,2315360,8128512,167168
.long 28672,36864,45056,53248,4096,12288,20480,29696,37888,46080,54272,5120,13312,21504,376832,8131584
.long 8991744,8992768,268435456,1109248,2369152,2696832,6721536,603264,9275392,88576,16678912,6491712,677888,2335840,8130560,167168
.long 30720,38912,47104,268435456,6144,14336,22528,31744,39936,48128,268436480,7168,15360,23552,376832,8404992
.long 9265152,9266176,268435456,1662208,3024512,3352192,6723584,685184,9275392,88576,16678912,6491744,677888,2356320,8132608,167168
.long 25600,33792,41984,50176,1024,9216,17408,24576,32768,40960,49152,0,8192,16384,282624,8407040
.long 9267200,9268224,268435456,128,1049568,1377248,4448256,532224,8169472,82176,11591680,5177984,555008,410080,8406016,163968
.long 27648,35840,44032,52224,3072,11264,19456,26624,34816,43008,51200,2048,10240,18432,282624,8409088
.long 9269248,9541632,268435456,553088,1704928,2032608,4450304,614144,8169472,82176,11591680,5178016,555008,430560,8408064,163968
.long 29696,37888,46080,54272,5120,13312,21504,28672,36864,45056,53248,4096,12288,20480,282624,8682496
.long 9542656,9543680,268435456,1106048,2360288,2687968,4452352,532352,8169472,82176,11591680,5178048,555008,451040,8681472,163968
.long 31744,39936,48128,268435456,7168,15360,23552,30720,38912,47104,268436480,6144,14336,22528,282624,8684544
.long 9544704,9545728,268435456,1659008,3015648,3343328,4454400,614272,8169472,82176,11591680,5178080,555008,471520,8683520,163968
.long 25600,33792,41984,50176,1024,9216,17408,24576,32768,40960,49152,0,8192,16384,282624,8957952
.long 7611392,7612416,268435456,1920,1050848,1378528,4775936,542464,9275392,85760,11591680,6488704,595968,410720,8685568,165760
.long 27648,35840,44032,52224,3072,11264,19456,26624,34816,43008,51200,2048,10240,18432,282624,8960000
.long 7613440,7614464,268435456,554880,1706208,2033888,4777984,624384,9275392,85760,11591680,6488736,595968,431200,8958976,165760
.long 29696,37888,46080,54272,5120,13312,21504,28672,36864,45056,53248,4096,12288,20480,282624,8962048
.long 7615488,7887872,268435456,1107840,2361568,2689248,4780032,542592,9275392,85760,11591680,6488768,595968,451680,8961024,165760
.long 31744,39936,48128,268435456,7168,15360,23552,30720,38912,47104,268436480,6144,14336,22528,282624,9235456
.long 7888896,7889920,268435456,1660800,3016928,3344608,4782080,624512,9275392,85760,11591680,6488800,595968,472160,9234432,165760
.long 25600,33792,41984,50176,1024,9216,17408,24576,32768,40960,49152,0,8192,16384,315392,9237504
.long 7890944,7891968,268435456,640,1052128,1379808,5103616,552704,8169472,83200,13361152,5179008,555008,1065440,9236480,164480
.long 27648,35840,44032,52224,3072,11264,19456,26624,34816,43008,51200,2048,10240,18432,315392,9510912
.long 8164352,8165376,268435456,553600,1707488,2035168,5105664,634624,8169472,83200,13361152,5179040,555008,1085920,9238528,164480
.long 29696,37888,46080,54272,5120,13312,21504,28672,36864,45056,53248,4096,12288,20480,315392,9512960
.long 8166400,8167424,268435456,1106560,2362848,2690528,5107712,552832,8169472,83200,13361152,5179072,555008,1106400,9511936,164480
.long 31744,39936,48128,268435456,7168,15360,23552,30720,38912,47104,268436480,6144,14336,22528,315392,9515008
.long 8168448,8440832,268435456,1659520,3018208,3345888,5109760,634752,8169472,83200,13361152,5179104,555008,1126880,9513984,164480
.long 25600,33792,41984,50176,1024,9216,17408,24576,32768,40960,49152,0,8192,16384,315392,7581696
.long 8441856,8442880,268435456,2432,1053408,1381088,5431296,562944,9275392,86784,13361152,6489728,595968,1066080,7580672,166272
.long 27648,35840,44032,52224,3072,11264,19456,26624,34816,43008,51200,2048,10240,18432,315392,7583744
.long 8443904,8444928,268435456,555392,1708768,2036448,5433344,644864,9275392,86784,13361152,6489760,595968,1086560,7582720,166272
.long 29696,37888,46080,54272,5120,13312,21504,28672,36864,45056,53248,4096,12288,20480,315392,7857152
.long 8717312,8718336,268435456,1108352,2364128,2691808,5435392,563072,9275392,86784,13361152,6489792,595968,1107040,7584768,166272
.long 31744,39936,48128,268435456,7168,15360,23552,30720,38912,47104,268436480,6144,14336,22528,315392,7859200
.long 8719360,8720384,268435456,1661312,3019488,3347168,5437440,644992,9275392,86784,13361152,6489824,595968,1127520,7858176,166272
.long 25600,33792,41984,50176,1024,9216,17408,24576,32768,40960,49152,0,8192,16384,348160,7861248
.long 8721408,8993792,268435456,1152,1054688,1382368,5758976,573184,8169472,84224,15130624,5180032,636928,1720800,7860224,164992
.long 27648,35840,44032,52224,3072,11264,19456,26624,34816,43008,51200,2048,10240,18432,348160,8134656
.long 8994816,8995840,268435456,554112,1710048,2037728,5761024,655104,8169472,84224,15130624,5180064,636928,1741280,8133632,164992
.long 29696,37888,46080,54272,5120,13312,21504,28672,36864,45056,53248,4096,12288,20480,348160,8136704
.long 8996864,8997888,268435456,1107072,2365408,2693088,5763072,573312,8169472,84224,15130624,5180096,636928,1761760,8135680,164992
.long 31744,39936,48128,268435456,7168,15360,23552,30720,38912,47104,268436480,6144,14336,22528,348160,8410112
.long 9270272,9271296,268435456,1660032,3020768,3348448,5765120,655232,8169472,84224,15130624,5180128,636928,1782240,8137728,164992
.long 25600,33792,41984,50176,1024,9216,17408,24576,32768,40960,49152,0,8192,16384,348160,8412160
.long 9272320,9273344,268435456,2944,1055968,1383648,6086656,583424,9275392,87808,15130624,6490752,677888,1721440,8411136,166784
.long 27648,35840,44032,52224,3072,11264,19456,26624,34816,43008,51200,2048,10240,18432,348160,8414208
.long 9274368,9546752,268435456,555904,1711328,2039008,6088704,665344,9275392,87808,15130624,6490784,677888,1741920,8413184,166784
.long 29696,37888,46080,54272,5120,13312,21504,28672,36864,45056,53248,4096,12288,20480,348160,8687616
.long 9547776,9548800,268435456,1108864,2366688,2694368,6090752,583552,9275392,87808,15130624,6490816,677888,1762400,8686592,166784
.long 31744,39936,48128,268435456,7168,15360,23552,30720,38912,47104,268436480,6144,14336,22528,348160,8689664
.long 9549824,9550848,268435456,1661824,3022048,3349728,6092800,665472,9275392,87808,15130624,6490848,677888,1782880,8688640,166784
.long 25600,33792,41984,50176,1024,9216,17408,24576,32768,40960,49152,0,8192,16384,380928,8963072
.long 1073741824,1073741824,268435456,1664,1057248,1384928,6414336,593664,8169472,85248,16900096,5181056,636928,2376160,8690688,165504
.long 27648,35840,44032,52224,3072,11264,19456,26624,34816,43008,51200,2048,10240,18432,380928,8965120
.long 1073741824,1073741824,268435456,554624,1712608,2040288,6416384,675584,8169472,85248,16900096,5181088,636928,2396640,8964096,165504
.long 29696,37888,46080,54272,5120,13312,21504,28672,36864,45056,53248,4096,12288,20480,380928,8967168
.long 1073741824,1073741824,268435456,1107584,2367968,2695648,6418432,593792,8169472,85248,16900096,5181120,636928,2417120,8966144,165504
.long 31744,39936,48128,268435456,7168,15360,23552,30720,38912,47104,268436480,6144,14336,22528,380928,9240576
.long 1073741824,1073741824,268435456,1660544,3023328,3351008,6420480,675712,8169472,85248,16900096,5181152,636928,2437600,9239552,165504
.long 25600,33792,41984,50176,1024,9216,17408,24576,32768,40960,49152,0,8192,16384,380928,9242624
.long 1073741824,1073741824,268435456,268435456,1058528,1386208,6742016,603904,9275392,1073741824,16900096,6491776,677888,2376800,9241600,1073741824
.long 27648,35840,44032,52224,3072,11264,19456,26624,34816,43008,51200,2048,10240,18432,380928,9516032
.long 1073741824,1073741824,268435456,268435456,1713888,2041568,6744064,685824,9275392,1073741824,16900096,6491808,677888,2397280,9243648,1073741824
.long 29696,37888,46080,54272,5120,13312,21504,28672,36864,45056,53248,4096,12288,20480,380928,9518080
.long 1073741824,1073741824,268435456,268435456,2369248,2696928,6746112,604032,9275392,1073741824,16900096,6491840,677888,2417760,9517056,1073741824
.long 31744,39936,48128,268435456,7168,15360,23552,30720,38912,47104,268436480,6144,14336,22528,380928,9520128
.long 1073741824,1073741824,268435456,268435456,3024608,3352288,6748160,685952,9275392,1073741824,16900096,6491872,677888,2438240,9519104,1073741824
.long 24576,32768,40960,49152,0,8192,16384,25600,33792,41984,50176,1024,9216,17408,286720,7586816
.long 1073741824,1073741824,268435456,256,1049664,1377344,4472832,532992,8169472,82432,11812864,5178112,555008,492000,7585792,164096
.long 26624,34816,43008,51200,2048,10240,18432,27648,35840,44032,52224,3072,11264,19456,286720,7588864
.long 1073741824,1073741824,268435456,553216,1705024,2032704,4474880,614912,8169472,82432,11812864,5178144,555008,512480,7587840,164096
.long 28672,36864,45056,53248,4096,12288,20480,29696,37888,46080,54272,5120,13312,21504,286720,7862272
.long 1073741824,1073741824,268435456,1106176,2360384,2688064,4476928,533120,8169472,82432,11812864,5178176,555008,532960,7589888,164096
.long 30720,38912,47104,268435456,6144,14336,22528,31744,39936,48128,268436480,7168,15360,23552,286720,7864320
.long 1073741824,1073741824,268435456,1659136,3015744,3343424,4478976,615040,8169472,82432,11812864,5178208,555008,553440,7863296,164096
.long 24576,32768,40960,49152,0,8192,16384,25600,33792,41984,50176,1024,9216,17408,286720,7866368
.long 1073741824,1073741824,268435456,2048,1050944,1378624,4800512,543232,9275392,86016,11812864,6488832,595968,492640,7865344,165888
.long 26624,34816,43008,51200,2048,10240,18432,27648,35840,44032,52224,3072,11264,19456,286720,8139776
.long 1073741824,1073741824,268435456,555008,1706304,2033984,4802560,625152,9275392,86016,11812864,6488864,595968,513120,8138752,165888
.long 28672,36864,45056,53248,4096,12288,20480,29696,37888,46080,54272,5120,13312,21504,286720,8141824
.long 1073741824,1073741824,268435456,1107968,2361664,2689344,4804608,543360,9275392,86016,11812864,6488896,595968,533600,8140800,165888
.long 30720,38912,47104,268435456,6144,14336,22528,31744,39936,48128,268436480,7168,15360,23552,286720,8415232
.long 1073741824,1073741824,268435456,1660928,3017024,3344704,4806656,625280,9275392,86016,11812864,6488928,595968,554080,8142848,165888
.long 24576,32768,40960,49152,0,8192,16384,25600,33792,41984,50176,1024,9216,17408,319488,8417280
.long 1073741824,1073741824,268435456,768,1052224,1379904,5128192,553472,8169472,83456,13582336,5179136,555008,1147360,8416256,164608
.long 26624,34816,43008,51200,2048,10240,18432,27648,35840,44032,52224,3072,11264,19456,319488,8419328
.long 1073741824,1073741824,268435456,553728,1707584,2035264,5130240,635392,8169472,83456,13582336,5179168,555008,1167840,8418304,164608
.long 28672,36864,45056,53248,4096,12288,20480,29696,37888,46080,54272,5120,13312,21504,319488,8692736
.long 1073741824,1073741824,268435456,1106688,2362944,2690624,5132288,553600,8169472,83456,13582336,5179200,555008,1188320,8691712,164608
.long 30720,38912,47104,268435456,6144,14336,22528,31744,39936,48128,268436480,7168,15360,23552,319488,8694784
.long 1073741824,1073741824,268435456,1659648,3018304,3345984,5134336,635520,8169472,83456,13582336,5179232,555008,1208800,8693760,164608
.long 24576,32768,40960,49152,0,8192,16384,25600,33792,41984,50176,1024,9216,17408,319488,8968192
.long 1073741824,1073741824,268435456,2560,1053504,1381184,5455872,563712,9275392,87040,13582336,6489856,595968,1148000,8695808,166400
.long 26624,34816,43008,51200,2048,10240,18432,27648,35840,44032,52224,3072,11264,19456,319488,8970240
.long 1073741824,1073741824,268435456,555520,1708864,2036544,5457920,645632,9275392,87040,13582336,6489888,595968,1168480,8969216,166400
.long 28672,36864,45056,53248,4096,12288,20480,29696,37888,46080,54272,5120,13312,21504,319488,8972288
.long 1073741824,1073741824,268435456,1108480,2364224,2691904,5459968,563840,9275392,87040,13582336,6489920,595968,1188960,8971264,166400
.long 30720,38912,47104,268435456,6144,14336,22528,31744,39936,48128,268436480,7168,15360,23552,319488,9245696
.long 1073741824,1073741824,268435456,1661440,3019584,3347264,5462016,645760,9275392,87040,13582336,6489952,595968,1209440,9244672,166400
.long 24576,32768,40960,49152,0,8192,16384,25600,33792,41984,50176,1024,9216,17408,352256,9247744
.long 1073741824,1073741824,268435456,1280,1054784,1382464,5783552,573952,8169472,84480,15351808,5180160,636928,1802720,9246720,165120
.long 26624,34816,43008,51200,2048,10240,18432,27648,35840,44032,52224,3072,11264,19456,352256,9521152
.long 1073741824,1073741824,268435456,554240,1710144,2037824,5785600,655872,8169472,84480,15351808,5180192,636928,1823200,9248768,165120
.long 28672,36864,45056,53248,4096,12288,20480,29696,37888,46080,54272,5120,13312,21504,352256,9523200
.long 1073741824,1073741824,268435456,1107200,2365504,2693184,5787648,574080,8169472,84480,15351808,5180224,636928,1843680,9522176,165120
.long 30720,38912,47104,268435456,6144,14336,22528,31744,39936,48128,268436480,7168,15360,23552,352256,9525248
.long 1073741824,1073741824,268435456,1660160,3020864,3348544,5789696,656000,8169472,84480,15351808,5180256,636928,1864160,9524224,165120
.long 24576,32768,40960,49152,0,8192,16384,25600,33792,41984,50176,1024,9216,17408,352256,7591936
.long 1073741824,1073741824,268435456,3072,1056064,1383744,6111232,584192,9275392,88064,15351808,6490880,677888,1803360,7590912,166912
.long 26624,34816,43008,51200,2048,10240,18432,27648,35840,44032,52224,3072,11264,19456,352256,7593984
.long 1073741824,1073741824,268435456,556032,1711424,2039104,6113280,666112,9275392,88064,15351808,6490912,677888,1823840,7592960,166912
.long 28672,36864,45056,53248,4096,12288,20480,29696,37888,46080,54272,5120,13312,21504,352256,7867392
.long 1073741824,1073741824,268435456,1108992,2366784,2694464,6115328,584320,9275392,88064,15351808,6490944,677888,1844320,7595008,166912
.long 30720,38912,47104,268435456,6144,14336,22528,31744,39936,48128,268436480,7168,15360,23552,352256,7869440
.long 1073741824,1073741824,268435456,1661952,3022144,3349824,6117376,666240,9275392,88064,15351808,6490976,677888,1864800,7868416,166912
.long 24576,32768,40960,49152,0,8192,16384,25600,33792,41984,50176,1024,9216,17408,385024,7871488
.long 1073741824,1073741824,268435456,268435456,1057344,1385024,6438912,594432,8169472,1073741824,17121280,5181184,636928,2458080,7870464,1073741824
.long 26624,34816,43008,51200,2048,10240,18432,27648,35840,44032,52224,3072,11264,19456,385024,8144896
.long 1073741824,1073741824,268435456,268435456,1712704,2040384,6440960,676352,8169472,1073741824,17121280,5181216,636928,2478560,8143872,1073741824
.long 28672,36864,45056,53248,4096,12288,20480,29696,37888,46080,54272,5120,13312,21504,385024,8146944
.long 1073741824,1073741824,268435456,268435456,2368064,2695744,6443008,594560,8169472,1073741824,17121280,5181248,636928,2499040,8145920,1073741824
.long 30720,38912,47104,268435456,6144,14336,22528,31744,39936,48128,268436480,7168,15360,23552,385024,8420352
.long 1073741824,1073741824,268435456,268435456,3023424,3351104,6445056,676480,8169472,1073741824,17121280,5181280,636928,2519520,8147968,1073741824
.long 24576,32768,40960,49152,0,8192,16384,25600,33792,41984,50176,1024,9216,17408,385024,8422400
.long 1073741824,1073741824,268435456,268435456,1058624,1386304,6766592,604672,9275392,1073741824,17121280,6491904,677888,2458720,8421376,1073741824
.long 26624,34816,43008,51200,2048,10240,18432,27648,35840,44032,52224,3072,11264,19456,385024,8424448
.long 1073741824,1073741824,268435456,268435456,1713984,2041664,6768640,686592,9275392,1073741824,17121280,6491936,677888,2479200,8423424,1073741824
.long 28672,36864,45056,53248,4096,12288,20480,29696,37888,46080,54272,5120,13312,21504,385024,8697856
.long 1073741824,1073741824,268435456,268435456,2369344,2697024,6770688,604800,9275392,1073741824,17121280,6491968,677888,2499680,8696832,1073741824
.long 30720,38912,47104,268435456,6144,14336,22528,31744,39936,48128,268436480,7168,15360,23552,385024,8699904
.long 1073741824,1073741824,268435456,268435456,3024704,3352384,6772736,686720,9275392,1073741824,17121280,6492000,677888,2520160,8698880,1073741824
.long 25600,33792,41984,50176,1024,9216,17408,24576,32768,40960,49152,0,8192,16384,290816,8973312
.long 1073741824,1073741824,268435456,384,1049760,1377440,4497408,533760,8169472,82688,12034048,5178240,555008,573920,8700928,164224
.long 27648,35840,44032,52224,3072,11264,19456,26624,34816,43008,51200,2048,10240,18432,290816,8975360
.long 1073741824,1073741824,268435456,553344,1705120,2032800,4499456,615680,8169472,82688,12034048,5178272,555008,594400,8974336,164224
.long 29696,37888,46080,54272,5120,13312,21504,28672,36864,45056,53248,4096,12288,20480,290816,8977408
.long 1073741824,1073741824,268435456,1106304,2360480,2688160,4501504,533888,8169472,82688,12034048,5178304,555008,614880,8976384,164224
.long 31744,39936,48128,268435456,7168,15360,23552,30720,38912,47104,268436480,6144,14336,22528,290816,9250816
.long 1073741824,1073741824,268435456,1659264,3015840,3343520,4503552,615808,8169472,82688,12034048,5178336,555008,635360,9249792,164224
.long 25600,33792,41984,50176,1024,9216,17408,24576,32768,40960,49152,0,8192,16384,290816,9252864
.long 1073741824,1073741824,268435456,2176,1051040,1378720,4825088,544000,9275392,86272,12034048,6488960,595968,574560,9251840,166016
.long 27648,35840,44032,52224,3072,11264,19456,26624,34816,43008,51200,2048,10240,18432,290816,9526272
.long 1073741824,1073741824,268435456,555136,1706400,2034080,4827136,625920,9275392,86272,12034048,6488992,595968,595040,9253888,166016
.long 29696,37888,46080,54272,5120,13312,21504,28672,36864,45056,53248,4096,12288,20480,290816,9528320
.long 1073741824,1073741824,268435456,1108096,2361760,2689440,4829184,544128,9275392,86272,12034048,6489024,595968,615520,9527296,166016
.long 31744,39936,48128,268435456,7168,15360,23552,30720,38912,47104,268436480,6144,14336,22528,290816,9530368
.long 1073741824,1073741824,268435456,1661056,3017120,3344800,4831232,626048,9275392,86272,12034048,6489056,595968,636000,9529344,166016
.long 25600,33792,41984,50176,1024,9216,17408,24576,32768,40960,49152,0,8192,16384,323584,7597056
.long 1073741824,1073741824,268435456,896,1052320,1380000,5152768,554240,8169472,83712,13803520,5179264,555008,1229280,7596032,164736
.long 27648,35840,44032,52224,3072,11264,19456,26624,34816,43008,51200,2048,10240,18432,323584,7599104
.long 1073741824,1073741824,268435456,553856,1707680,2035360,5154816,636160,8169472,83712,13803520,5179296,555008,1249760,7598080,164736
.long 29696,37888,46080,54272,5120,13312,21504,28672,36864,45056,53248,4096,12288,20480,323584,7872512
.long 1073741824,1073741824,268435456,1106816,2363040,2690720,5156864,554368,8169472,83712,13803520,5179328,555008,1270240,7600128,164736
.long 31744,39936,48128,268435456,7168,15360,23552,30720,38912,47104,268436480,6144,14336,22528,323584,7874560
.long 1073741824,1073741824,268435456,1659776,3018400,3346080,5158912,636288,8169472,83712,13803520,5179360,555008,1290720,7873536,164736
.long 25600,33792,41984,50176,1024,9216,17408,24576,32768,40960,49152,0,8192,16384,323584,7876608
.long 1073741824,1073741824,268435456,2688,1053600,1381280,5480448,564480,9275392,87296,13803520,6489984,595968,1229920,7875584,166528
.long 27648,35840,44032,52224,3072,11264,19456,26624,34816,43008,51200,2048,10240,18432,323584,8150016
.long 1073741824,1073741824,268435456,555648,1708960,2036640,5482496,646400,9275392,87296,13803520,6490016,595968,1250400,8148992,166528
.long 29696,37888,46080,54272,5120,13312,21504,28672,36864,45056,53248,4096,12288,20480,323584,8152064
.long 1073741824,1073741824,268435456,1108608,2364320,2692000,5484544,564608,9275392,87296,13803520,6490048,595968,1270880,8151040,166528
.long 31744,39936,48128,268435456,7168,15360,23552,30720,38912,47104,268436480,6144,14336,22528,323584,8425472
.long 1073741824,1073741824,268435456,1661568,3019680,3347360,5486592,646528,9275392,87296,13803520,6490080,595968,1291360,8153088,166528
.long 25600,33792,41984,50176,1024,9216,17408,24576,32768,40960,49152,0,8192,16384,356352,8427520
.long 1073741824,1073741824,268435456,1408,1054880,1382560,5808128,574720,8169472,84736,15572992,5180288,636928,1884640,8426496,165248
.long 27648,35840,44032,52224,3072,11264,19456,26624,34816,43008,51200,2048,10240,18432,356352,8429568
.long 1073741824,1073741824,268435456,554368,1710240,2037920,5810176,656640,8169472,84736,15572992,5180320,636928,1905120,8428544,165248
.long 29696,37888,46080,54272,5120,13312,21504,28672,36864,45056,53248,4096,12288,20480,356352,8702976
.long 1073741824,1073741824,268435456,1107328,2365600,2693280,5812224,574848,8169472,84736,15572992,5180352,636928,1925600,8701952,165248
.long 31744,39936,48128,268435456,7168,15360,23552,30720,38912,47104,268436480,6144,14336,22528,356352,8705024
.long 1073741824,1073741824,268435456,1660288,3020960,3348640,5814272,656768,8169472,84736,15572992,5180384,636928,1946080,8704000,165248
.long 25600,33792,41984,50176,1024,9216,17408,24576,32768,40960,49152,0,8192,16384,356352,8978432
.long 1073741824,1073741824,268435456,3200,1056160,1383840,6135808,584960,9275392,88320,15572992,6491008,677888,1885280,8706048,167040
.long 27648,35840,44032,52224,3072,11264,19456,26624,34816,43008,51200,2048,10240,18432,356352,8980480
.long 1073741824,1073741824,268435456,556160,1711520,2039200,6137856,666880,9275392,88320,15572992,6491040,677888,1905760,8979456,167040
.long 29696,37888,46080,54272,5120,13312,21504,28672,36864,45056,53248,4096,12288,20480,356352,8982528
.long 1073741824,1073741824,268435456,1109120,2366880,2694560,6139904,585088,9275392,88320,15572992,6491072,677888,1926240,8981504,167040
.long 31744,39936,48128,268435456,7168,15360,23552,30720,38912,47104,268436480,6144,14336,22528,356352,9255936
.long 1073741824,1073741824,268435456,1662080,3022240,3349920,6141952,667008,9275392,88320,15572992,6491104,677888,1946720,9254912,167040
.long 25600,33792,41984,50176,1024,9216,17408,24576,32768,40960,49152,0,8192,16384,389120,9257984
.long 1073741824,1073741824,268435456,268435456,1057440,1385120,6463488,595200,8169472,1073741824,17342464,5181312,636928,2540000,9256960,1073741824
.long 27648,35840,44032,52224,3072,11264,19456,26624,34816,43008,51200,2048,10240,18432,389120,9531392
.long 1073741824,1073741824,268435456,268435456,1712800,2040480,6465536,677120,8169472,1073741824,17342464,5181344,636928,2560480,9259008,1073741824
.long 29696,37888,46080,54272,5120,13312,21504,28672,36864,45056,53248,4096,12288,20480,389120,9533440
.long 1073741824,1073741824,268435456,268435456,2368160,2695840,6467584,595328,8169472,1073741824,17342464,5181376,636928,2580960,9532416,1073741824
.long 31744,39936,48128,268435456,7168,15360,23552,30720,38912,47104,268436480,6144,14336,22528,389120,9535488
.long 1073741824,1073741824,268435456,268435456,3023520,3351200,6469632,677248,8169472,1073741824,17342464,5181408,636928,2601440,9534464,1073741824
.long 25600,33792,41984,50176,1024,9216,17408,24576,32768,40960,49152,0,8192,16384,389120,7602176
.long 1073741824,1073741824,268435456,268435456,1058720,1386400,6791168,605440,9275392,1073741824,17342464,6492032,677888,2540640,7601152,1073741824
.long 27648,35840,44032,52224,3072,11264,19456,26624,34816,43008,51200,2048,10240,18432,389120,7604224
.long 1073741824,1073741824,268435456,268435456,1714080,2041760,6793216,687360,9275392,1073741824,17342464,6492064,677888,2561120,7603200,1073741824
.long 29696,37888,46080,54272,5120,13312,21504,28672,36864,45056,53248,4096,12288,20480,389120,7877632
.long 1073741824,1073741824,268435456,268435456,2369440,2697120,6795264,605568,9275392,1073741824,17342464,6492096,677888,2581600,7605248,1073741824
.long 31744,39936,48128,268435456,7168,15360,23552,30720,38912,47104,268436480,6144,14336,22528,389120,7879680
.long 1073741824,1073741824,268435456,268435456,3024800,3352480,6797312,687488,9275392,1073741824,17342464,6492128,677888,2602080,7878656,1073741824
L_sc_end:
.size L_sc, L_sc_end-L_sc
.section .rodata,"a"
.p2align 6
.amdhsa_kernel parallel_sum__ssm_conv_s4d__mixer_channel_mlp__prompt_kernel
  .amdhsa_next_free_vgpr 512
  .amdhsa_next_free_sgpr 102
  .amdhsa_accum_offset 256
  .amdhsa_group_segment_fixed_size 0
  .amdhsa_kernarg_size 120
  .amdhsa_user_sgpr_count 2
  .amdhsa_user_sgpr_kernarg_segment_ptr 1
  .amdhsa_system_sgpr_workgroup_id_x 1
  .amdhsa_float_denorm_mode_32 3
.end_amdhsa_kernel
```
